```python
import torch

def _softmax(x, axis=-1):
    return torch.softmax(x, dim=axis)

def _gelu(x):
    return torch.nn.functional.gelu(x, approximate='tanh')

def _silu(x):
    return torch.nn.functional.silu(x)

def _sigmoid(x):
    return torch.sigmoid(x)

def _layernorm(x, axis=-1, eps=1e-05):
    m = x.mean(dim=axis, keepdim=True)
    v = x.var(dim=axis, keepdim=True, unbiased=False)
    return (x - m) / torch.sqrt(v + eps)

def _scatter_add(tgt, idx, src, axis=0):
    return tgt.clone().index_add_(axis, idx, src)

def _segment_sum(src, seg, n):
    out = torch.zeros((n,) + src.shape[1:], dtype=src.dtype)
    return out.index_add_(0, seg, src)

def _pad(x, pw):
    flat = tuple((v for pair in reversed(pw) for v in pair))
    return torch.nn.functional.pad(x, flat)
kernel_name = 'adaLN_cond__softmax_full_mha__glu_gated_geglu__prompt'

def setup_inputs():

    _w = lambda a: (lambda t: t.to(torch.bfloat16) if t.is_floating_point() else t)(torch.as_tensor(a))

    def _A_setup():
        B, S, D = (1, 2048, 576)
        return {'x': _w((lambda *s: torch.randn(*s, dtype=torch.bfloat16) * 0.05)(B, S, D)), 'wqkv': _w((lambda *s: torch.randn(*s, dtype=torch.bfloat16) * 0.05)(D, 3 * D)), 'wo': _w((lambda *s: torch.randn(*s, dtype=torch.bfloat16) * 0.05)(D, D))}
    _A_in = _A_setup()

    def _B_setup():
        B, S, Dm, Df = (1, 2048, 576, 4608)
        return {'x': _w((lambda *s: torch.randn(*s, dtype=torch.bfloat16) * 0.05)(B, S, Dm)), 'w_gate': _w((lambda *s: torch.randn(*s, dtype=torch.bfloat16) * 0.8)(Dm, Df) * Dm ** (-0.5)), 'w_up': _w((lambda *s: torch.randn(*s, dtype=torch.bfloat16) * 0.8)(Dm, Df) * Dm ** (-0.5)), 'w_down': _w((lambda *s: torch.randn(*s, dtype=torch.bfloat16) * 0.8)(Df, Dm) * Df ** (-0.5))}
    _B_in = _B_setup()
    return {'A_x': _A_in['x'], 'A_wqkv': _A_in['wqkv'], 'A_wo': _A_in['wo'], 'B_x': _B_in['x'], 'B_w_gate': _B_in['w_gate'], 'B_w_up': _B_in['w_up'], 'B_w_down': _B_in['w_down'], 'c': _w((lambda *s: torch.randn(*s, dtype=torch.bfloat16) * 0.1)(1, 576) * 8.0), 'w_mod': _w((lambda *s: torch.randn(*s, dtype=torch.bfloat16) * 0.1)(576, 6 * 576) * 576 ** (-0.5) * 8.0)}

def reference(A_x, A_wqkv, A_wo, B_x, B_w_gate, B_w_up, B_w_down, c, w_mod):

    def _A_ref(x, wqkv, wo):
        B, S, D = x.shape
        H = 32
        Dh = D // H
        qkv = (lambda x, *d: x.permute(*d))((x @ wqkv).reshape(B, S, 3, H, Dh), 2, 0, 3, 1, 4)
        q, k, v = (qkv[0], qkv[1], qkv[2])
        scale = Dh ** (-0.5)
        scores = torch.einsum('bhqd,bhkd->bhqk', q, k) * scale
        p = _softmax(scores, axis=-1)
        o = torch.einsum('bhqk,bhkd->bhqd', p, v)
        return (lambda x, *d: x.permute(*d))(o, 0, 2, 1, 3).reshape(B, S, D) @ wo

    def _B_ref(x, w_gate, w_up, w_down):
        g = torch.einsum('bsd,df->bsf', x, w_gate)
        u = torch.einsum('bsd,df->bsf', x, w_up)
        h = _gelu(g) * u
        return torch.einsum('bsf,fd->bsd', h, w_down)
    x = A_x
    mod = (_silu(c) @ w_mod).reshape(c.shape[0], 6, 1, -1)
    sa, ca, ga, sb, cb, gb = (mod[:, 0].clone(), mod[:, 1].clone(), mod[:, 2].clone(), mod[:, 3].clone(), mod[:, 4].clone(), mod[:, 5].clone())
    h = _layernorm(x, axis=-1) * (1 + ca) + sa
    x = x + ga * _A_ref(h, A_wqkv, A_wo)
    h = _layernorm(x, axis=-1) * (1 + cb) + sb
    x = x + gb * _B_ref(h, B_w_gate, B_w_up, B_w_down)
    return x
```

```asm
; @launch kernel=k1_kernel grid=(792,1,1) block=(256,1,1) lds=1024
; @launch kernel=k2_kernel grid=(242,1,1) block=(512,1,1) lds=156672
; @launch kernel=k3_kernel grid=(256,1,1) block=(768,1,1) lds=163840
; @launch kernel=k4_kernel grid=(256,1,1) block=(256,1,1) lds=156672
.amdgcn_target "amdgcn-amd-amdhsa--gfx950"
.text
.globl k1_kernel
.p2align 8
.type k1_kernel,@function
k1_kernel:
    s_cmp_ge_u32 s2, 792
    s_cbranch_scc1 K1_EXIT
    s_load_dwordx2 s[4:5], s[0:1], 88
    s_load_dwordx4 s[8:11], s[0:1], 0
    s_load_dwordx4 s[12:15], s[0:1], 56
    v_lshrrev_b32 v1, 6, v0
    s_nop 0
    v_readfirstlane_b32 s3, v1
    s_lshr_b32 s7, s2, 8
    s_min_u32 s7, s7, 2
    s_lshl_b32 s6, s7, 8
    s_sub_u32 s6, s2, s6
    v_and_b32 v63, 63, v0
    s_waitcnt lgkmcnt(0)
    s_mov_b32 s16, s4
    s_mov_b32 s17, s5
    s_mov_b32 s18, 0x5000000
    s_mov_b32 s19, 0x00020000
    s_cmp_eq_u32 s7, 2
    s_cbranch_scc1 K1_RELAY
    s_cmp_eq_u32 s7, 1
    s_cbranch_scc1 K1_LN
    s_and_b32 s20, s6, 7
    s_lshr_b32 s21, s6, 3
    s_and_b32 s22, s21, 3
    s_lshr_b32 s21, s21, 2
    s_lshl_b32 s21, s21, 3
    s_add_u32 s21, s21, s20
    s_cmp_ge_u32 s21, 54
    s_cbranch_scc1 K1_PF
    s_lshl_b32 s23, s21, 6
    s_lshl_b32 s22, s22, 4
    s_add_u32 s23, s23, s22
    s_mov_b32 s24, s14
    s_mov_b32 s25, s15
    s_mov_b32 s26, 0x3cc000
    s_mov_b32 s27, 0x00020000
    s_mov_b32 s28, s12
    s_mov_b32 s29, s13
    s_mov_b32 s30, 0x480
    s_mov_b32 s31, 0x00020000
    v_lshrrev_b32 v1, 1, v0
    v_and_b32 v2, 1, v0
    v_lshlrev_b32 v4, 1, v1
    buffer_load_ushort v10, v4, s[28:31], 0 offen offset:0
    buffer_load_ushort v11, v4, s[28:31], 0 offen offset:256
    buffer_load_ushort v12, v4, s[28:31], 0 offen offset:512
    buffer_load_ushort v13, v4, s[28:31], 0 offen offset:768
    buffer_load_ushort v14, v4, s[28:31], 0 offen offset:1024
    v_mul_u32_u24 v3, 6912, v1
    v_lshl_add_u32 v3, v2, 4, v3
    s_lshl_b32 s32, s23, 1
    v_add_u32 v3, s32, v3
    buffer_load_dwordx4 v[16:19], v3, s[24:27], 0 offen nt
    v_add_u32 v3, 884736, v3
    buffer_load_dwordx4 v[20:23], v3, s[24:27], 0 offen nt
    v_add_u32 v3, 884736, v3
    buffer_load_dwordx4 v[24:27], v3, s[24:27], 0 offen nt
    v_add_u32 v3, 884736, v3
    buffer_load_dwordx4 v[28:31], v3, s[24:27], 0 offen nt
    v_add_u32 v3, 884736, v3
    buffer_load_dwordx4 v[32:35], v3, s[24:27], 0 offen nt
    s_waitcnt vmcnt(5)
    v_lshlrev_b32 v10, 16, v10
    v_lshlrev_b32 v11, 16, v11
    v_lshlrev_b32 v12, 16, v12
    v_lshlrev_b32 v13, 16, v13
    v_lshlrev_b32 v14, 16, v14
    v_mul_f32 v48, 0xbfb8aa3b, v10
    v_mul_f32 v49, 0xbfb8aa3b, v11
    v_mul_f32 v50, 0xbfb8aa3b, v12
    v_mul_f32 v51, 0xbfb8aa3b, v13
    v_mul_f32 v52, 0xbfb8aa3b, v14
    v_exp_f32 v48, v48
    v_exp_f32 v49, v49
    v_exp_f32 v50, v50
    v_exp_f32 v51, v51
    v_exp_f32 v52, v52
    v_add_f32 v48, 1.0, v48
    v_add_f32 v49, 1.0, v49
    v_add_f32 v50, 1.0, v50
    v_add_f32 v51, 1.0, v51
    v_add_f32 v52, 1.0, v52
    v_rcp_f32 v48, v48
    v_rcp_f32 v49, v49
    v_rcp_f32 v50, v50
    v_rcp_f32 v51, v51
    v_rcp_f32 v52, v52
    v_mul_f32 v10, v10, v48
    v_mul_f32 v11, v11, v49
    v_mul_f32 v12, v12, v50
    v_mul_f32 v13, v13, v51
    v_mul_f32 v14, v14, v52
    v_cvt_pk_bf16_f32 v48, v10, 0
    v_cvt_pk_bf16_f32 v54, 0, v10
    v_cvt_pk_bf16_f32 v49, v11, 0
    v_cvt_pk_bf16_f32 v55, 0, v11
    v_cvt_pk_bf16_f32 v50, v12, 0
    v_cvt_pk_bf16_f32 v56, 0, v12
    v_cvt_pk_bf16_f32 v51, v13, 0
    v_cvt_pk_bf16_f32 v57, 0, v13
    v_cvt_pk_bf16_f32 v52, v14, 0
    v_cvt_pk_bf16_f32 v58, 0, v14
    s_waitcnt vmcnt(4)
    v_dot2_f32_bf16 v40, v16, v48, 0
    v_dot2_f32_bf16 v41, v16, v54, 0
    v_dot2_f32_bf16 v42, v17, v48, 0
    v_dot2_f32_bf16 v43, v17, v54, 0
    v_dot2_f32_bf16 v44, v18, v48, 0
    v_dot2_f32_bf16 v45, v18, v54, 0
    v_dot2_f32_bf16 v46, v19, v48, 0
    v_dot2_f32_bf16 v47, v19, v54, 0
    s_waitcnt vmcnt(3)
    v_dot2_f32_bf16 v40, v20, v49, v40
    v_dot2_f32_bf16 v41, v20, v55, v41
    v_dot2_f32_bf16 v42, v21, v49, v42
    v_dot2_f32_bf16 v43, v21, v55, v43
    v_dot2_f32_bf16 v44, v22, v49, v44
    v_dot2_f32_bf16 v45, v22, v55, v45
    v_dot2_f32_bf16 v46, v23, v49, v46
    v_dot2_f32_bf16 v47, v23, v55, v47
    s_waitcnt vmcnt(2)
    v_dot2_f32_bf16 v40, v24, v50, v40
    v_dot2_f32_bf16 v41, v24, v56, v41
    v_dot2_f32_bf16 v42, v25, v50, v42
    v_dot2_f32_bf16 v43, v25, v56, v43
    v_dot2_f32_bf16 v44, v26, v50, v44
    v_dot2_f32_bf16 v45, v26, v56, v45
    v_dot2_f32_bf16 v46, v27, v50, v46
    v_dot2_f32_bf16 v47, v27, v56, v47
    s_waitcnt vmcnt(1)
    v_dot2_f32_bf16 v40, v28, v51, v40
    v_dot2_f32_bf16 v41, v28, v57, v41
    v_dot2_f32_bf16 v42, v29, v51, v42
    v_dot2_f32_bf16 v43, v29, v57, v43
    v_dot2_f32_bf16 v44, v30, v51, v44
    v_dot2_f32_bf16 v45, v30, v57, v45
    v_dot2_f32_bf16 v46, v31, v51, v46
    v_dot2_f32_bf16 v47, v31, v57, v47
    s_waitcnt vmcnt(0)
    v_dot2_f32_bf16 v40, v32, v52, v40
    v_dot2_f32_bf16 v41, v32, v58, v41
    v_dot2_f32_bf16 v42, v33, v52, v42
    v_dot2_f32_bf16 v43, v33, v58, v43
    v_dot2_f32_bf16 v44, v34, v52, v44
    v_dot2_f32_bf16 v45, v34, v58, v45
    v_dot2_f32_bf16 v46, v35, v52, v46
    v_dot2_f32_bf16 v47, v35, v58, v47
    v_add_f32_dpp v40, v40, v40 quad_perm:[2,3,0,1] row_mask:0xf bank_mask:0xf
    v_add_f32_dpp v41, v41, v41 quad_perm:[2,3,0,1] row_mask:0xf bank_mask:0xf
    v_add_f32_dpp v42, v42, v42 quad_perm:[2,3,0,1] row_mask:0xf bank_mask:0xf
    v_add_f32_dpp v43, v43, v43 quad_perm:[2,3,0,1] row_mask:0xf bank_mask:0xf
    v_add_f32_dpp v44, v44, v44 quad_perm:[2,3,0,1] row_mask:0xf bank_mask:0xf
    v_add_f32_dpp v45, v45, v45 quad_perm:[2,3,0,1] row_mask:0xf bank_mask:0xf
    v_add_f32_dpp v46, v46, v46 quad_perm:[2,3,0,1] row_mask:0xf bank_mask:0xf
    v_add_f32_dpp v47, v47, v47 quad_perm:[2,3,0,1] row_mask:0xf bank_mask:0xf
    v_add_f32_dpp v40, v40, v40 row_ror:4 row_mask:0xf bank_mask:0xf
    v_add_f32_dpp v41, v41, v41 row_ror:4 row_mask:0xf bank_mask:0xf
    v_add_f32_dpp v42, v42, v42 row_ror:4 row_mask:0xf bank_mask:0xf
    v_add_f32_dpp v43, v43, v43 row_ror:4 row_mask:0xf bank_mask:0xf
    v_add_f32_dpp v44, v44, v44 row_ror:4 row_mask:0xf bank_mask:0xf
    v_add_f32_dpp v45, v45, v45 row_ror:4 row_mask:0xf bank_mask:0xf
    v_add_f32_dpp v46, v46, v46 row_ror:4 row_mask:0xf bank_mask:0xf
    v_add_f32_dpp v47, v47, v47 row_ror:4 row_mask:0xf bank_mask:0xf
    v_add_f32_dpp v40, v40, v40 row_ror:8 row_mask:0xf bank_mask:0xf
    v_add_f32_dpp v41, v41, v41 row_ror:8 row_mask:0xf bank_mask:0xf
    v_add_f32_dpp v42, v42, v42 row_ror:8 row_mask:0xf bank_mask:0xf
    v_add_f32_dpp v43, v43, v43 row_ror:8 row_mask:0xf bank_mask:0xf
    v_add_f32_dpp v44, v44, v44 row_ror:8 row_mask:0xf bank_mask:0xf
    v_add_f32_dpp v45, v45, v45 row_ror:8 row_mask:0xf bank_mask:0xf
    v_add_f32_dpp v46, v46, v46 row_ror:8 row_mask:0xf bank_mask:0xf
    v_add_f32_dpp v47, v47, v47 row_ror:8 row_mask:0xf bank_mask:0xf
    v_lshrrev_b32 v5, 4, v0
    v_lshlrev_b32 v5, 6, v5
    v_lshl_add_u32 v5, v2, 5, v5
    v_and_b32 v6, 14, v0
    v_cmp_eq_u32 vcc, 0, v6
    s_nop 0
    s_and_saveexec_b64 s[34:35], vcc
    ds_write_b128 v5, v[40:43]
    ds_write_b128 v5, v[44:47] offset:16
    s_mov_b64 exec, -1
    s_waitcnt lgkmcnt(0)
    s_barrier
    s_cmp_lg_u32 s3, 0
    s_cbranch_scc1 K1_END
    s_mov_b64 exec, 0xffff
    v_lshlrev_b32 v5, 2, v0
    ds_read2_b32 v[16:17], v5 offset0:0 offset1:16
    ds_read2_b32 v[18:19], v5 offset0:32 offset1:48
    ds_read2_b32 v[20:21], v5 offset0:64 offset1:80
    ds_read2_b32 v[22:23], v5 offset0:96 offset1:112
    ds_read2_b32 v[24:25], v5 offset0:128 offset1:144
    ds_read2_b32 v[26:27], v5 offset0:160 offset1:176
    ds_read2_b32 v[28:29], v5 offset0:192 offset1:208
    ds_read2_b32 v[30:31], v5 offset0:224 offset1:240
    s_mul_i32 s36, s23, 7282
    s_lshr_b32 s36, s36, 22
    s_mul_i32 s37, s36, 576
    s_sub_u32 s37, s23, s37
    s_waitcnt lgkmcnt(0)
    v_add_f32 v16, v16, v24
    v_add_f32 v17, v17, v25
    v_add_f32 v18, v18, v26
    v_add_f32 v19, v19, v27
    v_add_f32 v20, v20, v28
    v_add_f32 v21, v21, v29
    v_add_f32 v22, v22, v30
    v_add_f32 v23, v23, v31
    v_add_f32 v16, v16, v20
    v_add_f32 v17, v17, v21
    v_add_f32 v18, v18, v22
    v_add_f32 v19, v19, v23
    v_add_f32 v16, v16, v18
    v_add_f32 v17, v17, v19
    v_add_f32 v16, v16, v17
    v_cvt_pk_bf16_f32 v16, v16, v16
    v_and_b32 v16, 0xffff0000, v16
    v_add_f32 v17, 1.0, v16
    v_cvt_pk_bf16_f32 v17, v17, v17
    v_and_b32 v17, 0xffff0000, v17
    s_cmp_eq_u32 s36, 1
    s_cbranch_scc1 K1_PLUS1
    s_cmp_eq_u32 s36, 4
    s_cbranch_scc0 K1_NOPLUS
K1_PLUS1:
    v_mov_b32 v16, v17
K1_NOPLUS:
    s_lshl_b32 s38, s23, 2
    buffer_store_dword v16, v5, s[16:19], s38 offen offset:0
    s_cmp_ge_u32 s36, 2
    s_cbranch_scc1 K1_END
    s_lshr_b32 s37, s37, 4
    s_lshr_b32 s40, s37, 1
    s_lshl_b32 s40, s40, 9
    s_xor_b32 s39, s36, 1
    s_lshl_b32 s39, s39, 2
    s_add_u32 s40, s40, s39
    s_and_b32 s37, s37, 1
    s_lshl_b32 s37, s37, 6
    s_add_u32 s40, s40, s37
    s_add_u32 s40, s40, 16384
    v_lshrrev_b32 v6, 3, v0
    v_lshlrev_b32 v6, 8, v6
    v_and_b32 v7, 7, v0
    v_lshl_add_u32 v6, v7, 3, v6
    buffer_store_dword v16, v6, s[16:19], s40 offen
    buffer_store_dword v16, v6, s[16:19], s40 offen offset:128
    s_branch K1_END
K1_PF:
    s_getpc_b64 s[36:37]
PF_k2_kernel_249:
    s_add_u32 s36, s36, k2_kernel-PF_k2_kernel_249
    s_addc_u32 s37, s37, 0
    s_mov_b32 s38, k2_kernel_end-k2_kernel
    s_mov_b32 s39, 0x00020000
    v_lshlrev_b32 v60, 7, v0
    buffer_load_dword v61, v60, s[36:39], 0 offen
    s_getpc_b64 s[40:41]
PF_k3_kernel_257:
    s_add_u32 s40, s40, k3_kernel-PF_k3_kernel_257
    s_addc_u32 s41, s41, 0
    s_mov_b32 s42, k3_kernel_end-k3_kernel
    s_mov_b32 s43, 0x00020000
    v_lshlrev_b32 v60, 7, v0
    buffer_load_dword v62, v60, s[40:43], 0 offen
    s_cmp_lt_u32 s6, 224
    s_cbranch_scc1 K1_END
    s_sub_u32 s20, s6, 224
    s_lshl_b32 s20, s20, 12
    s_add_u32 s20, s20, 0x60000
    v_mov_b32 v8, 0
    v_mov_b32 v9, 0
    v_mov_b32 v10, 0
    v_mov_b32 v11, 0
    v_lshlrev_b32 v4, 4, v0
    buffer_store_dwordx4 v[8:11], v4, s[16:19], s20 offen
    s_add_u32 s20, s20, 0x20000
    buffer_store_dwordx4 v[8:11], v4, s[16:19], s20 offen
    s_add_u32 s20, s20, 0x20000
    buffer_store_dwordx4 v[8:11], v4, s[16:19], s20 offen
    s_branch K1_END
K1_LN:
    s_mov_b32 s24, s8
    s_mov_b32 s25, s9
    s_mov_b32 s26, 0x240000
    s_mov_b32 s27, 0x00020000
    s_lshl_b32 s20, s6, 3
    s_lshl_b32 s21, s3, 1
    s_add_u32 s20, s20, s21
    v_lshrrev_b32 v1, 5, v63
    v_add_u32 v1, s20, v1
    v_and_b32 v2, 31, v0
    v_mul_u32_u24 v3, 1152, v1
    v_lshl_add_u32 v3, v2, 2, v3
    buffer_load_dword v10, v3, s[24:27], 0 offen offset:0 nt
    buffer_load_dword v11, v3, s[24:27], 0 offen offset:128 nt
    buffer_load_dword v12, v3, s[24:27], 0 offen offset:256 nt
    buffer_load_dword v13, v3, s[24:27], 0 offen offset:384 nt
    buffer_load_dword v14, v3, s[24:27], 0 offen offset:512 nt
    buffer_load_dword v15, v3, s[24:27], 0 offen offset:640 nt
    buffer_load_dword v16, v3, s[24:27], 0 offen offset:768 nt
    buffer_load_dword v17, v3, s[24:27], 0 offen offset:896 nt
    buffer_load_dword v18, v3, s[24:27], 0 offen offset:1024 nt
    v_lshrrev_b32 v4, 5, v1
    v_mul_u32_u24 v4, 36864, v4
    v_lshrrev_b32 v5, 2, v2
    v_lshl_add_u32 v4, v5, 9, v4
    v_and_b32 v5, 31, v1
    v_lshl_add_u32 v4, v5, 4, v4
    v_and_b32 v5, 3, v2
    v_lshl_add_u32 v4, v5, 2, v4
    s_mov_b32 s40, 0x100000
    s_mov_b32 s41, 0x101000
    s_mov_b32 s42, 0x102000
    s_mov_b32 s43, 0x103000
    s_mov_b32 s44, 0x104000
    s_mov_b32 s45, 0x105000
    s_mov_b32 s46, 0x106000
    s_mov_b32 s47, 0x107000
    s_mov_b32 s48, 0x108000
    s_waitcnt vmcnt(8)
    v_lshlrev_b32 v20, 16, v10
    v_and_b32 v21, 0xffff0000, v10
    s_waitcnt vmcnt(7)
    v_lshlrev_b32 v22, 16, v11
    v_and_b32 v23, 0xffff0000, v11
    s_waitcnt vmcnt(6)
    v_lshlrev_b32 v24, 16, v12
    v_and_b32 v25, 0xffff0000, v12
    s_waitcnt vmcnt(5)
    v_lshlrev_b32 v26, 16, v13
    v_and_b32 v27, 0xffff0000, v13
    s_waitcnt vmcnt(4)
    v_lshlrev_b32 v28, 16, v14
    v_and_b32 v29, 0xffff0000, v14
    s_waitcnt vmcnt(3)
    v_lshlrev_b32 v30, 16, v15
    v_and_b32 v31, 0xffff0000, v15
    s_waitcnt vmcnt(2)
    v_lshlrev_b32 v32, 16, v16
    v_and_b32 v33, 0xffff0000, v16
    s_waitcnt vmcnt(1)
    v_lshlrev_b32 v34, 16, v17
    v_and_b32 v35, 0xffff0000, v17
    s_waitcnt vmcnt(0)
    v_lshlrev_b32 v36, 16, v18
    v_and_b32 v37, 0xffff0000, v18
    v_add_f32 v6, v20, v21
    v_add_f32 v7, v22, v23
    v_add_f32 v6, v6, v24
    v_add_f32 v7, v7, v25
    v_add_f32 v6, v6, v26
    v_add_f32 v7, v7, v27
    v_add_f32 v6, v6, v28
    v_add_f32 v7, v7, v29
    v_add_f32 v6, v6, v30
    v_add_f32 v7, v7, v31
    v_add_f32 v6, v6, v32
    v_add_f32 v7, v7, v33
    v_add_f32 v6, v6, v34
    v_add_f32 v7, v7, v35
    v_add_f32 v6, v6, v36
    v_add_f32 v7, v7, v37
    v_add_f32 v6, v6, v7
    s_nop 1
    v_add_f32_dpp v6, v6, v6 quad_perm:[1,0,3,2] row_mask:0xf bank_mask:0xf
    s_nop 1
    v_add_f32_dpp v6, v6, v6 quad_perm:[2,3,0,1] row_mask:0xf bank_mask:0xf
    s_nop 1
    v_add_f32_dpp v6, v6, v6 row_half_mirror row_mask:0xf bank_mask:0xf
    s_nop 1
    v_add_f32_dpp v6, v6, v6 row_mirror row_mask:0xf bank_mask:0xf
    v_mov_b32 v8, v6
    v_mov_b32 v9, v6
    s_nop 1
    v_permlane16_swap_b32 v8, v9
    v_add_f32 v6, v8, v9
    v_mul_f32 v6, 0x3ae38e39, v6
    v_sub_f32 v20, v20, v6
    v_sub_f32 v21, v21, v6
    v_sub_f32 v22, v22, v6
    v_sub_f32 v23, v23, v6
    v_sub_f32 v24, v24, v6
    v_sub_f32 v25, v25, v6
    v_sub_f32 v26, v26, v6
    v_sub_f32 v27, v27, v6
    v_sub_f32 v28, v28, v6
    v_sub_f32 v29, v29, v6
    v_sub_f32 v30, v30, v6
    v_sub_f32 v31, v31, v6
    v_sub_f32 v32, v32, v6
    v_sub_f32 v33, v33, v6
    v_sub_f32 v34, v34, v6
    v_sub_f32 v35, v35, v6
    v_sub_f32 v36, v36, v6
    v_sub_f32 v37, v37, v6
    v_mul_f32 v6, v20, v20
    v_mul_f32 v7, v21, v21
    v_fmac_f32 v6, v22, v22
    v_fmac_f32 v7, v23, v23
    v_fmac_f32 v6, v24, v24
    v_fmac_f32 v7, v25, v25
    v_fmac_f32 v6, v26, v26
    v_fmac_f32 v7, v27, v27
    v_fmac_f32 v6, v28, v28
    v_fmac_f32 v7, v29, v29
    v_fmac_f32 v6, v30, v30
    v_fmac_f32 v7, v31, v31
    v_fmac_f32 v6, v32, v32
    v_fmac_f32 v7, v33, v33
    v_fmac_f32 v6, v34, v34
    v_fmac_f32 v7, v35, v35
    v_fmac_f32 v6, v36, v36
    v_fmac_f32 v7, v37, v37
    v_add_f32 v6, v6, v7
    s_nop 1
    v_add_f32_dpp v6, v6, v6 quad_perm:[1,0,3,2] row_mask:0xf bank_mask:0xf
    s_nop 1
    v_add_f32_dpp v6, v6, v6 quad_perm:[2,3,0,1] row_mask:0xf bank_mask:0xf
    s_nop 1
    v_add_f32_dpp v6, v6, v6 row_half_mirror row_mask:0xf bank_mask:0xf
    s_nop 1
    v_add_f32_dpp v6, v6, v6 row_mirror row_mask:0xf bank_mask:0xf
    v_mov_b32 v8, v6
    v_mov_b32 v9, v6
    s_nop 1
    v_permlane16_swap_b32 v8, v9
    v_add_f32 v6, v8, v9
    v_mov_b32 v7, 0x3727c5ac
    v_fmac_f32 v7, 0x3ae38e39, v6
    v_rsq_f32 v7, v7
    v_mov_b32 v8, 0x0d800000
    s_mov_b32 s50, 0xffff0000
    v_mul_f32 v20, v20, v7
    v_fma_f32 v21, v21, v7, v8
    v_mul_f32 v22, v22, v7
    v_fma_f32 v23, v23, v7, v8
    v_mul_f32 v24, v24, v7
    v_fma_f32 v25, v25, v7, v8
    v_mul_f32 v26, v26, v7
    v_fma_f32 v27, v27, v7, v8
    v_mul_f32 v28, v28, v7
    v_fma_f32 v29, v29, v7, v8
    v_mul_f32 v30, v30, v7
    v_fma_f32 v31, v31, v7, v8
    v_mul_f32 v32, v32, v7
    v_fma_f32 v33, v33, v7, v8
    v_mul_f32 v34, v34, v7
    v_fma_f32 v35, v35, v7, v8
    v_mul_f32 v36, v36, v7
    v_fma_f32 v37, v37, v7, v8
    v_cvt_pk_bf16_f32 v10, v20, 0
    v_add_u32 v21, 0x8000, v21
    v_cvt_pk_bf16_f32 v11, v22, 0
    v_add_u32 v23, 0x8000, v23
    v_cvt_pk_bf16_f32 v12, v24, 0
    v_add_u32 v25, 0x8000, v25
    v_cvt_pk_bf16_f32 v13, v26, 0
    v_add_u32 v27, 0x8000, v27
    v_cvt_pk_bf16_f32 v14, v28, 0
    v_add_u32 v29, 0x8000, v29
    v_cvt_pk_bf16_f32 v15, v30, 0
    v_add_u32 v31, 0x8000, v31
    v_cvt_pk_bf16_f32 v16, v32, 0
    v_add_u32 v33, 0x8000, v33
    v_cvt_pk_bf16_f32 v17, v34, 0
    v_add_u32 v35, 0x8000, v35
    v_cvt_pk_bf16_f32 v18, v36, 0
    v_add_u32 v37, 0x8000, v37
    v_sub_u32 v21, v21, v10
    v_sub_u32 v23, v23, v11
    v_sub_u32 v25, v25, v12
    v_sub_u32 v27, v27, v13
    v_sub_u32 v29, v29, v14
    v_sub_u32 v31, v31, v15
    v_sub_u32 v33, v33, v16
    v_sub_u32 v35, v35, v17
    v_sub_u32 v37, v37, v18
    v_bfi_b32 v10, s50, v21, v10
    buffer_store_dword v10, v4, s[16:19], s40 offen
    v_bfi_b32 v11, s50, v23, v11
    buffer_store_dword v11, v4, s[16:19], s41 offen
    v_bfi_b32 v12, s50, v25, v12
    buffer_store_dword v12, v4, s[16:19], s42 offen
    v_bfi_b32 v13, s50, v27, v13
    buffer_store_dword v13, v4, s[16:19], s43 offen
    v_bfi_b32 v14, s50, v29, v14
    buffer_store_dword v14, v4, s[16:19], s44 offen
    v_bfi_b32 v15, s50, v31, v15
    buffer_store_dword v15, v4, s[16:19], s45 offen
    v_bfi_b32 v16, s50, v33, v16
    buffer_store_dword v16, v4, s[16:19], s46 offen
    v_bfi_b32 v17, s50, v35, v17
    buffer_store_dword v17, v4, s[16:19], s47 offen
    v_bfi_b32 v18, s50, v37, v18
    buffer_store_dword v18, v4, s[16:19], s48 offen
    s_branch K1_END
K1_RELAY:
    s_lshr_b32 s22, s6, 3
    s_mul_i32 s20, s22, 9363
    s_lshr_b32 s20, s20, 16
    s_mul_i32 s21, s20, 7
    s_sub_u32 s21, s22, s21
    s_lshl_b32 s20, s20, 3
    s_and_b32 s22, s6, 7
    s_add_u32 s20, s20, s22
    s_cmp_ge_u32 s20, 36
    s_cbranch_scc1 K1_END
    s_lshl_b32 s21, s21, 3
    s_lshl_b32 s22, s3, 1
    s_add_u32 s21, s21, s22
    s_cmp_ge_u32 s21, 54
    s_cbranch_scc1 K1_END
    s_mov_b32 s24, s10
    s_mov_b32 s25, s11
    s_mov_b32 s26, 0x1e6000
    s_mov_b32 s27, 0x00020000
    s_mov_b32 s40, 0
    s_mov_b32 s41, 3456
    s_mov_b32 s42, 6912
    s_mov_b32 s43, 10368
    s_mov_b32 s44, 13824
    s_mov_b32 s45, 17280
    s_mov_b32 s46, 20736
    s_mov_b32 s47, 24192
    v_and_b32 v1, 31, v0
    v_lshrrev_b32 v2, 5, v63
    v_mul_u32_u24 v2, 27648, v2
    s_mul_i32 s23, s20, 55296
    v_add_u32 v2, s23, v2
    s_cmp_ge_u32 s21, 36
    s_cbranch_scc1 K1_RV
    s_cmp_ge_u32 s21, 32
    s_cbranch_scc1 K1_RR
    v_lshrrev_b32 v3, 4, v1
    v_mul_u32_u24 v3, 18, v3
    v_and_b32 v4, 15, v1
    v_add_u32 v3, v3, v4
    s_and_b32 s28, s21, 15
    s_mul_i32 s28, s28, 36
    s_cmp_ge_u32 s21, 16
    s_cselect_b32 s29, 576, 0
    s_add_u32 s28, s28, s29
    s_mov_b32 s29, 72
    s_branch K1_RGO
K1_RR:
    v_lshrrev_b32 v3, 1, v1
    v_mul_u32_u24 v3, 18, v3
    v_and_b32 v4, 1, v1
    v_add_u32 v3, v3, v4
    s_cmp_ge_u32 s21, 34
    s_cselect_b32 s28, 592, 16
    s_mov_b32 s29, 576
    s_branch K1_RGO
K1_RV:
    v_mov_b32 v3, v1
    s_sub_u32 s28, s21, 36
    s_lshl_b32 s28, s28, 5
    s_add_u32 s28, s28, 1152
    s_mov_b32 s29, 64
K1_RGO:
    v_add_u32 v3, s28, v3
    v_lshl_add_u32 v2, v3, 1, v2
    v_add_u32 v3, s29, v2
    buffer_load_ushort v10, v2, s[24:27], s40 offen nt
    buffer_load_ushort v11, v2, s[24:27], s41 offen nt
    buffer_load_ushort v12, v2, s[24:27], s42 offen nt
    buffer_load_ushort v13, v2, s[24:27], s43 offen nt
    buffer_load_ushort v14, v2, s[24:27], s44 offen nt
    buffer_load_ushort v15, v2, s[24:27], s45 offen nt
    buffer_load_ushort v16, v2, s[24:27], s46 offen nt
    buffer_load_ushort v17, v2, s[24:27], s47 offen nt
    buffer_load_ushort v18, v3, s[24:27], s40 offen nt
    buffer_load_ushort v19, v3, s[24:27], s41 offen nt
    buffer_load_ushort v20, v3, s[24:27], s42 offen nt
    buffer_load_ushort v21, v3, s[24:27], s43 offen nt
    buffer_load_ushort v22, v3, s[24:27], s44 offen nt
    buffer_load_ushort v23, v3, s[24:27], s45 offen nt
    buffer_load_ushort v24, v3, s[24:27], s46 offen nt
    buffer_load_ushort v25, v3, s[24:27], s47 offen nt
    s_mul_i32 s28, s21, 36
    s_add_u32 s28, s28, s20
    s_lshl_b32 s28, s28, 10
    s_add_u32 s28, s28, 0x400000
    s_add_u32 s29, s28, 36864
    v_lshlrev_b32 v4, 4, v63
    s_waitcnt vmcnt(8)
    v_lshl_or_b32 v28, v11, 16, v10
    v_lshl_or_b32 v29, v13, 16, v12
    v_lshl_or_b32 v30, v15, 16, v14
    v_lshl_or_b32 v31, v17, 16, v16
    buffer_store_dwordx4 v[28:31], v4, s[16:19], s28 offen
    s_waitcnt vmcnt(1)
    v_lshl_or_b32 v32, v19, 16, v18
    v_lshl_or_b32 v33, v21, 16, v20
    v_lshl_or_b32 v34, v23, 16, v22
    v_lshl_or_b32 v35, v25, 16, v24
    buffer_store_dwordx4 v[32:35], v4, s[16:19], s29 offen
K1_END:
K1_EXIT:
    s_endpgm
k1_kernel_end:
.globl k2_kernel
.p2align 8
.type k2_kernel,@function
k2_kernel:
    s_cmp_ge_u32 s2, 242
    s_cbranch_scc1 K2_EXIT
    s_load_dwordx2 s[4:5], s[0:1], 88
    v_lshrrev_b32 v1, 6, v0
    s_nop 0
    v_readfirstlane_b32 s3, v1
    s_and_b32 s6, s2, 7
    s_lshr_b32 s7, s2, 3
    s_and_b32 s8, s6, 3
    s_lshl_b32 s8, s8, 2
    s_and_b32 s9, s7, 3
    s_add_u32 s8, s8, s9
    s_lshr_b32 s6, s6, 2
    s_mul_i32 s6, s6, 7
    s_lshr_b32 s7, s7, 2
    s_add_u32 s6, s6, s7
    s_and_b32 s12, s3, 3
    s_lshr_b32 s13, s3, 2
    s_lshl_b32 s8, s8, 2
    s_add_u32 s8, s8, s12
    s_mul_i32 s14, s13, 18432
    s_mul_i32 s30, s12, 36864
    s_add_u32 s30, s30, s14
    s_lshl_b32 s9, s6, 2
    s_add_u32 s31, s9, s12
    s_min_u32 s31, s31, 53
    s_mul_i32 s31, s31, 36864
    s_add_u32 s31, s31, s14
    s_add_u32 s31, s31, 0x400000
    s_mul_i32 s32, s8, 36864
    s_add_u32 s32, s32, s14
    s_add_u32 s32, s32, 0x100000
    s_lshl_b32 s36, s3, 10
    s_add_u32 s35, s36, 0x4000
    s_add_u32 m0, s36, 147456
    s_mul_i32 s37, s13, 4608
    s_add_u32 s37, s37, 147456
    v_and_b32 v1, 63, v0
    v_lshlrev_b32 v2, 4, v1
    v_mov_b32 v3, v2
    v_lshl_add_u32 v8, v1, 3, s37
    s_mov_b32 s38, 0xffff0000
    s_waitcnt lgkmcnt(0)
    s_mov_b32 s16, s4
    s_mov_b32 s17, s5
    s_mov_b32 s18, 0x5000000
    s_mov_b32 s19, 0x00020000
    s_cmp_ge_u32 s2, 224
    s_cbranch_scc1 K2_BIAS
    buffer_load_dwordx4 v2, s[16:19], s35 offen lds
    s_mov_b32 m0, 155648
    s_mov_b32 s35, 0x6000
    buffer_load_dwordx4 v2, s[16:19], s35 offen lds
    s_add_u32 m0, s30, 0
    buffer_load_dwordx4 v[140:143], v3, s[16:19], s32 offen offset:0
    buffer_load_dwordx4 v3, s[16:19], s31 offen offset:0 lds
    buffer_load_dwordx4 v[144:147], v3, s[16:19], s32 offen offset:1024
    buffer_load_dwordx4 v3, s[16:19], s31 offen offset:1024 lds
    buffer_load_dwordx4 v[148:151], v3, s[16:19], s32 offen offset:2048
    buffer_load_dwordx4 v3, s[16:19], s31 offen offset:2048 lds
    v_add_u32 v3, 3072, v3
    s_barrier
    s_add_u32 m0, s30, 3072
    buffer_load_dwordx4 v[152:155], v3, s[16:19], s32 offen offset:0
    buffer_load_dwordx4 v3, s[16:19], s31 offen offset:0 lds
    buffer_load_dwordx4 v[156:159], v3, s[16:19], s32 offen offset:1024
    buffer_load_dwordx4 v3, s[16:19], s31 offen offset:1024 lds
    buffer_load_dwordx4 v[160:163], v3, s[16:19], s32 offen offset:2048
    buffer_load_dwordx4 v3, s[16:19], s31 offen offset:2048 lds
    v_add_u32 v3, 3072, v3
    s_mul_i32 s15, s13, 73728
    s_add_u32 s33, s15, s14
    s_sub_u32 s34, s14, s15
    s_add_u32 s34, s34, 73728
    v_add_u32 v4, s33, v2
    v_add_u32 v5, 36864, v4
    v_add_u32 v6, s34, v2
    v_add_u32 v7, 36864, v6
    v_add_u32 v10, s30, v2
    s_lshl_b32 s15, s14, 1
    s_sub_u32 s15, s30, s15
    s_add_u32 s15, s15, 18432
    v_add_u32 v9, s15, v2
    s_lshl_b32 s15, s13, 1
    s_add_u32 s9, s9, s15
    s_cmp_ge_u32 s6, 9
    s_cbranch_scc1 K2_V
    s_waitcnt vmcnt(6)
    s_barrier
    ds_read_b64 v[104:105], v8 offset:0
    ds_read_b64 v[106:107], v8 offset:512
    ds_read_b64 v[108:109], v8 offset:1024
    ds_read_b64 v[110:111], v8 offset:1536
    ds_read_b64 v[112:113], v8 offset:2048
    ds_read_b64 v[114:115], v8 offset:2560
    ds_read_b64 v[116:117], v8 offset:3072
    ds_read_b64 v[118:119], v8 offset:3584
    ds_read_b64 v[120:121], v8 offset:4096
    ds_read_b128 a[0:3], v4 offset:0
    ds_read_b128 a[4:7], v5 offset:0
    ds_read_b128 a[8:11], v6 offset:0
    ds_read_b128 a[12:15], v7 offset:0
    s_waitcnt lgkmcnt(4)
    v_lshlrev_b32 v88, 16, v140
    v_mul_f32_dpp v97, v104, v140 row_newbcast:1 row_mask:0xf bank_mask:0xf
    v_lshlrev_b32 v89, 16, v141
    v_mul_f32_dpp v99, v104, v141 row_newbcast:3 row_mask:0xf bank_mask:0xf
    v_lshlrev_b32 v90, 16, v142
    v_mul_f32_dpp v101, v104, v142 row_newbcast:5 row_mask:0xf bank_mask:0xf
    v_lshlrev_b32 v91, 16, v143
    v_mul_f32_dpp v103, v104, v143 row_newbcast:7 row_mask:0xf bank_mask:0xf
    v_mul_f32_dpp v96, v104, v88 row_newbcast:0 row_mask:0xf bank_mask:0xf
    v_mul_f32_dpp v98, v104, v89 row_newbcast:2 row_mask:0xf bank_mask:0xf
    v_mul_f32_dpp v100, v104, v90 row_newbcast:4 row_mask:0xf bank_mask:0xf
    v_mul_f32_dpp v102, v104, v91 row_newbcast:6 row_mask:0xf bank_mask:0xf
    v_cvt_pk_bf16_f32 v80, v96, v97
    v_cvt_pk_bf16_f32 v81, v98, v99
    v_cvt_pk_bf16_f32 v82, v100, v101
    v_cvt_pk_bf16_f32 v83, v102, v103
    s_waitcnt lgkmcnt(2)
    s_nop 0
    v_mfma_f32_32x32x16_bf16 v[16:31], a[0:3], v[80:83], 0
    ds_read_b128 a[16:19], v4 offset:1024
    v_lshlrev_b32 v88, 16, v144
    v_mul_f32_dpp v97, v104, v144 row_newbcast:9 row_mask:0xf bank_mask:0xf
    v_lshlrev_b32 v89, 16, v145
    v_mul_f32_dpp v99, v104, v145 row_newbcast:11 row_mask:0xf bank_mask:0xf
    s_add_u32 m0, s30, 6144
    v_mfma_f32_32x32x16_bf16 v[32:47], a[4:7], v[80:83], 0
    ds_read_b128 a[20:23], v5 offset:1024
    v_lshlrev_b32 v90, 16, v146
    v_mul_f32_dpp v101, v104, v146 row_newbcast:13 row_mask:0xf bank_mask:0xf
    v_lshlrev_b32 v91, 16, v147
    v_mul_f32_dpp v103, v104, v147 row_newbcast:15 row_mask:0xf bank_mask:0xf
    s_waitcnt lgkmcnt(2)
    v_mfma_f32_32x32x16_bf16 v[48:63], a[8:11], v[80:83], 0
    ds_read_b128 a[24:27], v6 offset:1024
    v_mul_f32_dpp v96, v104, v88 row_newbcast:8 row_mask:0xf bank_mask:0xf
    v_mul_f32_dpp v98, v104, v89 row_newbcast:10 row_mask:0xf bank_mask:0xf
    v_mul_f32_dpp v100, v104, v90 row_newbcast:12 row_mask:0xf bank_mask:0xf
    v_mul_f32_dpp v102, v104, v91 row_newbcast:14 row_mask:0xf bank_mask:0xf
    buffer_load_dwordx4 v[164:167], v3, s[16:19], s32 offen offset:0
    v_mfma_f32_32x32x16_bf16 v[64:79], a[12:15], v[80:83], 0
    buffer_load_dwordx4 v3, s[16:19], s31 offen offset:0 lds
    v_cvt_pk_bf16_f32 v84, v96, v97
    v_cvt_pk_bf16_f32 v85, v98, v99
    v_cvt_pk_bf16_f32 v86, v100, v101
    v_cvt_pk_bf16_f32 v87, v102, v103
    ds_read_b128 a[28:31], v7 offset:1024
    s_waitcnt lgkmcnt(2)
    v_mfma_f32_32x32x16_bf16 v[16:31], a[16:19], v[84:87], v[16:31]
    ds_read_b128 a[0:3], v4 offset:2048
    v_lshlrev_b32 v88, 16, v148
    v_mul_f32_dpp v97, v106, v148 row_newbcast:1 row_mask:0xf bank_mask:0xf
    v_lshlrev_b32 v89, 16, v149
    v_mul_f32_dpp v99, v106, v149 row_newbcast:3 row_mask:0xf bank_mask:0xf
    buffer_load_dwordx4 v[168:171], v3, s[16:19], s32 offen offset:1024
    v_mfma_f32_32x32x16_bf16 v[32:47], a[20:23], v[84:87], v[32:47]
    ds_read_b128 a[4:7], v5 offset:2048
    v_lshlrev_b32 v90, 16, v150
    v_mul_f32_dpp v101, v106, v150 row_newbcast:5 row_mask:0xf bank_mask:0xf
    v_lshlrev_b32 v91, 16, v151
    v_mul_f32_dpp v103, v106, v151 row_newbcast:7 row_mask:0xf bank_mask:0xf
    s_waitcnt lgkmcnt(2)
    v_mfma_f32_32x32x16_bf16 v[48:63], a[24:27], v[84:87], v[48:63]
    ds_read_b128 a[8:11], v6 offset:2048
    v_mul_f32_dpp v96, v106, v88 row_newbcast:0 row_mask:0xf bank_mask:0xf
    v_mul_f32_dpp v98, v106, v89 row_newbcast:2 row_mask:0xf bank_mask:0xf
    v_mul_f32_dpp v100, v106, v90 row_newbcast:4 row_mask:0xf bank_mask:0xf
    v_mul_f32_dpp v102, v106, v91 row_newbcast:6 row_mask:0xf bank_mask:0xf
    buffer_load_dwordx4 v3, s[16:19], s31 offen offset:1024 lds
    v_mfma_f32_32x32x16_bf16 v[64:79], a[28:31], v[84:87], v[64:79]
    buffer_load_dwordx4 v[172:175], v3, s[16:19], s32 offen offset:2048
    v_cvt_pk_bf16_f32 v80, v96, v97
    v_cvt_pk_bf16_f32 v81, v98, v99
    v_cvt_pk_bf16_f32 v82, v100, v101
    v_cvt_pk_bf16_f32 v83, v102, v103
    ds_read_b128 a[12:15], v7 offset:2048
    s_waitcnt vmcnt(5)
    s_barrier
    s_waitcnt lgkmcnt(2)
    v_mfma_f32_32x32x16_bf16 v[16:31], a[0:3], v[80:83], v[16:31]
    ds_read_b128 a[16:19], v4 offset:3072
    v_lshlrev_b32 v88, 16, v152
    v_mul_f32_dpp v97, v106, v152 row_newbcast:9 row_mask:0xf bank_mask:0xf
    v_lshlrev_b32 v89, 16, v153
    v_mul_f32_dpp v99, v106, v153 row_newbcast:11 row_mask:0xf bank_mask:0xf
    buffer_load_dwordx4 v3, s[16:19], s31 offen offset:2048 lds
    v_add_u32 v3, 3072, v3
    v_mfma_f32_32x32x16_bf16 v[32:47], a[4:7], v[80:83], v[32:47]
    ds_read_b128 a[20:23], v5 offset:3072
    v_lshlrev_b32 v90, 16, v154
    v_mul_f32_dpp v101, v106, v154 row_newbcast:13 row_mask:0xf bank_mask:0xf
    v_lshlrev_b32 v91, 16, v155
    v_mul_f32_dpp v103, v106, v155 row_newbcast:15 row_mask:0xf bank_mask:0xf
    s_waitcnt lgkmcnt(2)
    v_mfma_f32_32x32x16_bf16 v[48:63], a[8:11], v[80:83], v[48:63]
    ds_read_b128 a[24:27], v6 offset:3072
    v_mul_f32_dpp v96, v106, v88 row_newbcast:8 row_mask:0xf bank_mask:0xf
    v_mul_f32_dpp v98, v106, v89 row_newbcast:10 row_mask:0xf bank_mask:0xf
    v_mul_f32_dpp v100, v106, v90 row_newbcast:12 row_mask:0xf bank_mask:0xf
    v_mul_f32_dpp v102, v106, v91 row_newbcast:14 row_mask:0xf bank_mask:0xf
    v_mfma_f32_32x32x16_bf16 v[64:79], a[12:15], v[80:83], v[64:79]
    v_cvt_pk_bf16_f32 v84, v96, v97
    v_cvt_pk_bf16_f32 v85, v98, v99
    v_cvt_pk_bf16_f32 v86, v100, v101
    v_cvt_pk_bf16_f32 v87, v102, v103
    ds_read_b128 a[28:31], v7 offset:3072
    s_waitcnt lgkmcnt(2)
    v_mfma_f32_32x32x16_bf16 v[16:31], a[16:19], v[84:87], v[16:31]
    ds_read_b128 a[0:3], v4 offset:4096
    v_lshlrev_b32 v88, 16, v156
    v_mul_f32_dpp v97, v108, v156 row_newbcast:1 row_mask:0xf bank_mask:0xf
    v_lshlrev_b32 v89, 16, v157
    v_mul_f32_dpp v99, v108, v157 row_newbcast:3 row_mask:0xf bank_mask:0xf
    s_add_u32 m0, s30, 9216
    v_mfma_f32_32x32x16_bf16 v[32:47], a[20:23], v[84:87], v[32:47]
    ds_read_b128 a[4:7], v5 offset:4096
    v_lshlrev_b32 v90, 16, v158
    v_mul_f32_dpp v101, v108, v158 row_newbcast:5 row_mask:0xf bank_mask:0xf
    v_lshlrev_b32 v91, 16, v159
    v_mul_f32_dpp v103, v108, v159 row_newbcast:7 row_mask:0xf bank_mask:0xf
    s_waitcnt lgkmcnt(2)
    v_mfma_f32_32x32x16_bf16 v[48:63], a[24:27], v[84:87], v[48:63]
    ds_read_b128 a[8:11], v6 offset:4096
    v_mul_f32_dpp v96, v108, v88 row_newbcast:0 row_mask:0xf bank_mask:0xf
    v_mul_f32_dpp v98, v108, v89 row_newbcast:2 row_mask:0xf bank_mask:0xf
    v_mul_f32_dpp v100, v108, v90 row_newbcast:4 row_mask:0xf bank_mask:0xf
    v_mul_f32_dpp v102, v108, v91 row_newbcast:6 row_mask:0xf bank_mask:0xf
    buffer_load_dwordx4 v[176:179], v3, s[16:19], s32 offen offset:0
    v_mfma_f32_32x32x16_bf16 v[64:79], a[28:31], v[84:87], v[64:79]
    buffer_load_dwordx4 v3, s[16:19], s31 offen offset:0 lds
    v_cvt_pk_bf16_f32 v80, v96, v97
    v_cvt_pk_bf16_f32 v81, v98, v99
    v_cvt_pk_bf16_f32 v82, v100, v101
    v_cvt_pk_bf16_f32 v83, v102, v103
    ds_read_b128 a[12:15], v7 offset:4096
    s_waitcnt lgkmcnt(2)
    v_mfma_f32_32x32x16_bf16 v[16:31], a[0:3], v[80:83], v[16:31]
    ds_read_b128 a[16:19], v4 offset:5120
    v_lshlrev_b32 v88, 16, v160
    v_mul_f32_dpp v97, v108, v160 row_newbcast:9 row_mask:0xf bank_mask:0xf
    v_lshlrev_b32 v89, 16, v161
    v_mul_f32_dpp v99, v108, v161 row_newbcast:11 row_mask:0xf bank_mask:0xf
    buffer_load_dwordx4 v[180:183], v3, s[16:19], s32 offen offset:1024
    v_mfma_f32_32x32x16_bf16 v[32:47], a[4:7], v[80:83], v[32:47]
    ds_read_b128 a[20:23], v5 offset:5120
    v_lshlrev_b32 v90, 16, v162
    v_mul_f32_dpp v101, v108, v162 row_newbcast:13 row_mask:0xf bank_mask:0xf
    v_lshlrev_b32 v91, 16, v163
    v_mul_f32_dpp v103, v108, v163 row_newbcast:15 row_mask:0xf bank_mask:0xf
    s_waitcnt lgkmcnt(2)
    v_mfma_f32_32x32x16_bf16 v[48:63], a[8:11], v[80:83], v[48:63]
    ds_read_b128 a[24:27], v6 offset:5120
    v_mul_f32_dpp v96, v108, v88 row_newbcast:8 row_mask:0xf bank_mask:0xf
    v_mul_f32_dpp v98, v108, v89 row_newbcast:10 row_mask:0xf bank_mask:0xf
    v_mul_f32_dpp v100, v108, v90 row_newbcast:12 row_mask:0xf bank_mask:0xf
    v_mul_f32_dpp v102, v108, v91 row_newbcast:14 row_mask:0xf bank_mask:0xf
    buffer_load_dwordx4 v3, s[16:19], s31 offen offset:1024 lds
    v_mfma_f32_32x32x16_bf16 v[64:79], a[12:15], v[80:83], v[64:79]
    buffer_load_dwordx4 v[184:187], v3, s[16:19], s32 offen offset:2048
    v_cvt_pk_bf16_f32 v84, v96, v97
    v_cvt_pk_bf16_f32 v85, v98, v99
    v_cvt_pk_bf16_f32 v86, v100, v101
    v_cvt_pk_bf16_f32 v87, v102, v103
    ds_read_b128 a[28:31], v7 offset:5120
    s_waitcnt vmcnt(5)
    s_barrier
    s_waitcnt lgkmcnt(2)
    v_mfma_f32_32x32x16_bf16 v[16:31], a[16:19], v[84:87], v[16:31]
    ds_read_b128 a[0:3], v4 offset:6144
    v_lshlrev_b32 v88, 16, v164
    v_mul_f32_dpp v97, v110, v164 row_newbcast:1 row_mask:0xf bank_mask:0xf
    v_lshlrev_b32 v89, 16, v165
    v_mul_f32_dpp v99, v110, v165 row_newbcast:3 row_mask:0xf bank_mask:0xf
    buffer_load_dwordx4 v3, s[16:19], s31 offen offset:2048 lds
    v_add_u32 v3, 3072, v3
    v_mfma_f32_32x32x16_bf16 v[32:47], a[20:23], v[84:87], v[32:47]
    ds_read_b128 a[4:7], v5 offset:6144
    v_lshlrev_b32 v90, 16, v166
    v_mul_f32_dpp v101, v110, v166 row_newbcast:5 row_mask:0xf bank_mask:0xf
    v_lshlrev_b32 v91, 16, v167
    v_mul_f32_dpp v103, v110, v167 row_newbcast:7 row_mask:0xf bank_mask:0xf
    s_waitcnt lgkmcnt(2)
    v_mfma_f32_32x32x16_bf16 v[48:63], a[24:27], v[84:87], v[48:63]
    ds_read_b128 a[8:11], v6 offset:6144
    v_mul_f32_dpp v96, v110, v88 row_newbcast:0 row_mask:0xf bank_mask:0xf
    v_mul_f32_dpp v98, v110, v89 row_newbcast:2 row_mask:0xf bank_mask:0xf
    v_mul_f32_dpp v100, v110, v90 row_newbcast:4 row_mask:0xf bank_mask:0xf
    v_mul_f32_dpp v102, v110, v91 row_newbcast:6 row_mask:0xf bank_mask:0xf
    v_mfma_f32_32x32x16_bf16 v[64:79], a[28:31], v[84:87], v[64:79]
    v_cvt_pk_bf16_f32 v80, v96, v97
    v_cvt_pk_bf16_f32 v81, v98, v99
    v_cvt_pk_bf16_f32 v82, v100, v101
    v_cvt_pk_bf16_f32 v83, v102, v103
    ds_read_b128 a[12:15], v7 offset:6144
    s_waitcnt lgkmcnt(2)
    v_mfma_f32_32x32x16_bf16 v[16:31], a[0:3], v[80:83], v[16:31]
    ds_read_b128 a[16:19], v4 offset:7168
    v_lshlrev_b32 v88, 16, v168
    v_mul_f32_dpp v97, v110, v168 row_newbcast:9 row_mask:0xf bank_mask:0xf
    v_lshlrev_b32 v89, 16, v169
    v_mul_f32_dpp v99, v110, v169 row_newbcast:11 row_mask:0xf bank_mask:0xf
    s_add_u32 m0, s30, 12288
    v_mfma_f32_32x32x16_bf16 v[32:47], a[4:7], v[80:83], v[32:47]
    ds_read_b128 a[20:23], v5 offset:7168
    v_lshlrev_b32 v90, 16, v170
    v_mul_f32_dpp v101, v110, v170 row_newbcast:13 row_mask:0xf bank_mask:0xf
    v_lshlrev_b32 v91, 16, v171
    v_mul_f32_dpp v103, v110, v171 row_newbcast:15 row_mask:0xf bank_mask:0xf
    s_waitcnt lgkmcnt(2)
    v_mfma_f32_32x32x16_bf16 v[48:63], a[8:11], v[80:83], v[48:63]
    ds_read_b128 a[24:27], v6 offset:7168
    v_mul_f32_dpp v96, v110, v88 row_newbcast:8 row_mask:0xf bank_mask:0xf
    v_mul_f32_dpp v98, v110, v89 row_newbcast:10 row_mask:0xf bank_mask:0xf
    v_mul_f32_dpp v100, v110, v90 row_newbcast:12 row_mask:0xf bank_mask:0xf
    v_mul_f32_dpp v102, v110, v91 row_newbcast:14 row_mask:0xf bank_mask:0xf
    buffer_load_dwordx4 v[188:191], v3, s[16:19], s32 offen offset:0
    v_mfma_f32_32x32x16_bf16 v[64:79], a[12:15], v[80:83], v[64:79]
    buffer_load_dwordx4 v3, s[16:19], s31 offen offset:0 lds
    v_cvt_pk_bf16_f32 v84, v96, v97
    v_cvt_pk_bf16_f32 v85, v98, v99
    v_cvt_pk_bf16_f32 v86, v100, v101
    v_cvt_pk_bf16_f32 v87, v102, v103
    ds_read_b128 a[28:31], v7 offset:7168
    s_waitcnt lgkmcnt(2)
    v_mfma_f32_32x32x16_bf16 v[16:31], a[16:19], v[84:87], v[16:31]
    ds_read_b128 a[0:3], v4 offset:8192
    v_lshlrev_b32 v88, 16, v172
    v_mul_f32_dpp v97, v112, v172 row_newbcast:1 row_mask:0xf bank_mask:0xf
    v_lshlrev_b32 v89, 16, v173
    v_mul_f32_dpp v99, v112, v173 row_newbcast:3 row_mask:0xf bank_mask:0xf
    buffer_load_dwordx4 v[192:195], v3, s[16:19], s32 offen offset:1024
    v_mfma_f32_32x32x16_bf16 v[32:47], a[20:23], v[84:87], v[32:47]
    ds_read_b128 a[4:7], v5 offset:8192
    v_lshlrev_b32 v90, 16, v174
    v_mul_f32_dpp v101, v112, v174 row_newbcast:5 row_mask:0xf bank_mask:0xf
    v_lshlrev_b32 v91, 16, v175
    v_mul_f32_dpp v103, v112, v175 row_newbcast:7 row_mask:0xf bank_mask:0xf
    s_waitcnt lgkmcnt(2)
    v_mfma_f32_32x32x16_bf16 v[48:63], a[24:27], v[84:87], v[48:63]
    ds_read_b128 a[8:11], v6 offset:8192
    v_mul_f32_dpp v96, v112, v88 row_newbcast:0 row_mask:0xf bank_mask:0xf
    v_mul_f32_dpp v98, v112, v89 row_newbcast:2 row_mask:0xf bank_mask:0xf
    v_mul_f32_dpp v100, v112, v90 row_newbcast:4 row_mask:0xf bank_mask:0xf
    v_mul_f32_dpp v102, v112, v91 row_newbcast:6 row_mask:0xf bank_mask:0xf
    buffer_load_dwordx4 v3, s[16:19], s31 offen offset:1024 lds
    v_mfma_f32_32x32x16_bf16 v[64:79], a[28:31], v[84:87], v[64:79]
    buffer_load_dwordx4 v[196:199], v3, s[16:19], s32 offen offset:2048
    v_cvt_pk_bf16_f32 v80, v96, v97
    v_cvt_pk_bf16_f32 v81, v98, v99
    v_cvt_pk_bf16_f32 v82, v100, v101
    v_cvt_pk_bf16_f32 v83, v102, v103
    ds_read_b128 a[12:15], v7 offset:8192
    s_waitcnt vmcnt(5)
    s_barrier
    s_waitcnt lgkmcnt(2)
    v_mfma_f32_32x32x16_bf16 v[16:31], a[0:3], v[80:83], v[16:31]
    ds_read_b128 a[16:19], v4 offset:9216
    v_lshlrev_b32 v88, 16, v176
    v_mul_f32_dpp v97, v112, v176 row_newbcast:9 row_mask:0xf bank_mask:0xf
    v_lshlrev_b32 v89, 16, v177
    v_mul_f32_dpp v99, v112, v177 row_newbcast:11 row_mask:0xf bank_mask:0xf
    buffer_load_dwordx4 v3, s[16:19], s31 offen offset:2048 lds
    v_add_u32 v3, 3072, v3
    v_mfma_f32_32x32x16_bf16 v[32:47], a[4:7], v[80:83], v[32:47]
    ds_read_b128 a[20:23], v5 offset:9216
    v_lshlrev_b32 v90, 16, v178
    v_mul_f32_dpp v101, v112, v178 row_newbcast:13 row_mask:0xf bank_mask:0xf
    v_lshlrev_b32 v91, 16, v179
    v_mul_f32_dpp v103, v112, v179 row_newbcast:15 row_mask:0xf bank_mask:0xf
    s_waitcnt lgkmcnt(2)
    v_mfma_f32_32x32x16_bf16 v[48:63], a[8:11], v[80:83], v[48:63]
    ds_read_b128 a[24:27], v6 offset:9216
    v_mul_f32_dpp v96, v112, v88 row_newbcast:8 row_mask:0xf bank_mask:0xf
    v_mul_f32_dpp v98, v112, v89 row_newbcast:10 row_mask:0xf bank_mask:0xf
    v_mul_f32_dpp v100, v112, v90 row_newbcast:12 row_mask:0xf bank_mask:0xf
    v_mul_f32_dpp v102, v112, v91 row_newbcast:14 row_mask:0xf bank_mask:0xf
    v_mfma_f32_32x32x16_bf16 v[64:79], a[12:15], v[80:83], v[64:79]
    v_cvt_pk_bf16_f32 v84, v96, v97
    v_cvt_pk_bf16_f32 v85, v98, v99
    v_cvt_pk_bf16_f32 v86, v100, v101
    v_cvt_pk_bf16_f32 v87, v102, v103
    ds_read_b128 a[28:31], v7 offset:9216
    s_waitcnt lgkmcnt(2)
    v_mfma_f32_32x32x16_bf16 v[16:31], a[16:19], v[84:87], v[16:31]
    ds_read_b128 a[0:3], v4 offset:10240
    v_lshlrev_b32 v88, 16, v180
    v_mul_f32_dpp v97, v114, v180 row_newbcast:1 row_mask:0xf bank_mask:0xf
    v_lshlrev_b32 v89, 16, v181
    v_mul_f32_dpp v99, v114, v181 row_newbcast:3 row_mask:0xf bank_mask:0xf
    s_add_u32 m0, s30, 15360
    v_mfma_f32_32x32x16_bf16 v[32:47], a[20:23], v[84:87], v[32:47]
    ds_read_b128 a[4:7], v5 offset:10240
    v_lshlrev_b32 v90, 16, v182
    v_mul_f32_dpp v101, v114, v182 row_newbcast:5 row_mask:0xf bank_mask:0xf
    v_lshlrev_b32 v91, 16, v183
    v_mul_f32_dpp v103, v114, v183 row_newbcast:7 row_mask:0xf bank_mask:0xf
    s_waitcnt lgkmcnt(2)
    v_mfma_f32_32x32x16_bf16 v[48:63], a[24:27], v[84:87], v[48:63]
    ds_read_b128 a[8:11], v6 offset:10240
    v_mul_f32_dpp v96, v114, v88 row_newbcast:0 row_mask:0xf bank_mask:0xf
    v_mul_f32_dpp v98, v114, v89 row_newbcast:2 row_mask:0xf bank_mask:0xf
    v_mul_f32_dpp v100, v114, v90 row_newbcast:4 row_mask:0xf bank_mask:0xf
    v_mul_f32_dpp v102, v114, v91 row_newbcast:6 row_mask:0xf bank_mask:0xf
    buffer_load_dwordx4 v[200:203], v3, s[16:19], s32 offen offset:0
    v_mfma_f32_32x32x16_bf16 v[64:79], a[28:31], v[84:87], v[64:79]
    buffer_load_dwordx4 v3, s[16:19], s31 offen offset:0 lds
    v_cvt_pk_bf16_f32 v80, v96, v97
    v_cvt_pk_bf16_f32 v81, v98, v99
    v_cvt_pk_bf16_f32 v82, v100, v101
    v_cvt_pk_bf16_f32 v83, v102, v103
    ds_read_b128 a[12:15], v7 offset:10240
    s_waitcnt lgkmcnt(2)
    v_mfma_f32_32x32x16_bf16 v[16:31], a[0:3], v[80:83], v[16:31]
    ds_read_b128 a[16:19], v4 offset:11264
    v_lshlrev_b32 v88, 16, v184
    v_mul_f32_dpp v97, v114, v184 row_newbcast:9 row_mask:0xf bank_mask:0xf
    v_lshlrev_b32 v89, 16, v185
    v_mul_f32_dpp v99, v114, v185 row_newbcast:11 row_mask:0xf bank_mask:0xf
    buffer_load_dwordx4 v[204:207], v3, s[16:19], s32 offen offset:1024
    v_mfma_f32_32x32x16_bf16 v[32:47], a[4:7], v[80:83], v[32:47]
    ds_read_b128 a[20:23], v5 offset:11264
    v_lshlrev_b32 v90, 16, v186
    v_mul_f32_dpp v101, v114, v186 row_newbcast:13 row_mask:0xf bank_mask:0xf
    v_lshlrev_b32 v91, 16, v187
    v_mul_f32_dpp v103, v114, v187 row_newbcast:15 row_mask:0xf bank_mask:0xf
    s_waitcnt lgkmcnt(2)
    v_mfma_f32_32x32x16_bf16 v[48:63], a[8:11], v[80:83], v[48:63]
    ds_read_b128 a[24:27], v6 offset:11264
    v_mul_f32_dpp v96, v114, v88 row_newbcast:8 row_mask:0xf bank_mask:0xf
    v_mul_f32_dpp v98, v114, v89 row_newbcast:10 row_mask:0xf bank_mask:0xf
    v_mul_f32_dpp v100, v114, v90 row_newbcast:12 row_mask:0xf bank_mask:0xf
    v_mul_f32_dpp v102, v114, v91 row_newbcast:14 row_mask:0xf bank_mask:0xf
    buffer_load_dwordx4 v3, s[16:19], s31 offen offset:1024 lds
    v_mfma_f32_32x32x16_bf16 v[64:79], a[12:15], v[80:83], v[64:79]
    buffer_load_dwordx4 v[208:211], v3, s[16:19], s32 offen offset:2048
    v_cvt_pk_bf16_f32 v84, v96, v97
    v_cvt_pk_bf16_f32 v85, v98, v99
    v_cvt_pk_bf16_f32 v86, v100, v101
    v_cvt_pk_bf16_f32 v87, v102, v103
    ds_read_b128 a[28:31], v7 offset:11264
    s_waitcnt vmcnt(5)
    s_barrier
    s_waitcnt lgkmcnt(2)
    v_mfma_f32_32x32x16_bf16 v[16:31], a[16:19], v[84:87], v[16:31]
    ds_read_b128 a[0:3], v4 offset:12288
    v_lshlrev_b32 v88, 16, v188
    v_mul_f32_dpp v97, v116, v188 row_newbcast:1 row_mask:0xf bank_mask:0xf
    v_lshlrev_b32 v89, 16, v189
    v_mul_f32_dpp v99, v116, v189 row_newbcast:3 row_mask:0xf bank_mask:0xf
    buffer_load_dwordx4 v3, s[16:19], s31 offen offset:2048 lds
    v_add_u32 v3, 3072, v3
    v_mfma_f32_32x32x16_bf16 v[32:47], a[20:23], v[84:87], v[32:47]
    ds_read_b128 a[4:7], v5 offset:12288
    v_lshlrev_b32 v90, 16, v190
    v_mul_f32_dpp v101, v116, v190 row_newbcast:5 row_mask:0xf bank_mask:0xf
    v_lshlrev_b32 v91, 16, v191
    v_mul_f32_dpp v103, v116, v191 row_newbcast:7 row_mask:0xf bank_mask:0xf
    s_waitcnt lgkmcnt(2)
    v_mfma_f32_32x32x16_bf16 v[48:63], a[24:27], v[84:87], v[48:63]
    ds_read_b128 a[8:11], v6 offset:12288
    v_mul_f32_dpp v96, v116, v88 row_newbcast:0 row_mask:0xf bank_mask:0xf
    v_mul_f32_dpp v98, v116, v89 row_newbcast:2 row_mask:0xf bank_mask:0xf
    v_mul_f32_dpp v100, v116, v90 row_newbcast:4 row_mask:0xf bank_mask:0xf
    v_mul_f32_dpp v102, v116, v91 row_newbcast:6 row_mask:0xf bank_mask:0xf
    v_mfma_f32_32x32x16_bf16 v[64:79], a[28:31], v[84:87], v[64:79]
    v_cvt_pk_bf16_f32 v80, v96, v97
    v_cvt_pk_bf16_f32 v81, v98, v99
    v_cvt_pk_bf16_f32 v82, v100, v101
    v_cvt_pk_bf16_f32 v83, v102, v103
    ds_read_b128 a[12:15], v7 offset:12288
    s_waitcnt lgkmcnt(2)
    v_mfma_f32_32x32x16_bf16 v[16:31], a[0:3], v[80:83], v[16:31]
    ds_read_b128 a[16:19], v4 offset:13312
    v_lshlrev_b32 v88, 16, v192
    v_mul_f32_dpp v97, v116, v192 row_newbcast:9 row_mask:0xf bank_mask:0xf
    v_lshlrev_b32 v89, 16, v193
    v_mul_f32_dpp v99, v116, v193 row_newbcast:11 row_mask:0xf bank_mask:0xf
    v_mfma_f32_32x32x16_bf16 v[32:47], a[4:7], v[80:83], v[32:47]
    ds_read_b128 a[20:23], v5 offset:13312
    v_lshlrev_b32 v90, 16, v194
    v_mul_f32_dpp v101, v116, v194 row_newbcast:13 row_mask:0xf bank_mask:0xf
    v_lshlrev_b32 v91, 16, v195
    v_mul_f32_dpp v103, v116, v195 row_newbcast:15 row_mask:0xf bank_mask:0xf
    s_waitcnt lgkmcnt(2)
    v_mfma_f32_32x32x16_bf16 v[48:63], a[8:11], v[80:83], v[48:63]
    ds_read_b128 a[24:27], v6 offset:13312
    v_mul_f32_dpp v96, v116, v88 row_newbcast:8 row_mask:0xf bank_mask:0xf
    v_mul_f32_dpp v98, v116, v89 row_newbcast:10 row_mask:0xf bank_mask:0xf
    v_mul_f32_dpp v100, v116, v90 row_newbcast:12 row_mask:0xf bank_mask:0xf
    v_mul_f32_dpp v102, v116, v91 row_newbcast:14 row_mask:0xf bank_mask:0xf
    v_mfma_f32_32x32x16_bf16 v[64:79], a[12:15], v[80:83], v[64:79]
    v_cvt_pk_bf16_f32 v84, v96, v97
    v_cvt_pk_bf16_f32 v85, v98, v99
    v_cvt_pk_bf16_f32 v86, v100, v101
    v_cvt_pk_bf16_f32 v87, v102, v103
    ds_read_b128 a[28:31], v7 offset:13312
    s_waitcnt lgkmcnt(2)
    v_mfma_f32_32x32x16_bf16 v[16:31], a[16:19], v[84:87], v[16:31]
    ds_read_b128 a[0:3], v4 offset:14336
    v_lshlrev_b32 v88, 16, v196
    v_mul_f32_dpp v97, v118, v196 row_newbcast:1 row_mask:0xf bank_mask:0xf
    v_lshlrev_b32 v89, 16, v197
    v_mul_f32_dpp v99, v118, v197 row_newbcast:3 row_mask:0xf bank_mask:0xf
    v_mfma_f32_32x32x16_bf16 v[32:47], a[20:23], v[84:87], v[32:47]
    ds_read_b128 a[4:7], v5 offset:14336
    v_lshlrev_b32 v90, 16, v198
    v_mul_f32_dpp v101, v118, v198 row_newbcast:5 row_mask:0xf bank_mask:0xf
    v_lshlrev_b32 v91, 16, v199
    v_mul_f32_dpp v103, v118, v199 row_newbcast:7 row_mask:0xf bank_mask:0xf
    s_waitcnt lgkmcnt(2)
    v_mfma_f32_32x32x16_bf16 v[48:63], a[24:27], v[84:87], v[48:63]
    ds_read_b128 a[8:11], v6 offset:14336
    v_mul_f32_dpp v96, v118, v88 row_newbcast:0 row_mask:0xf bank_mask:0xf
    v_mul_f32_dpp v98, v118, v89 row_newbcast:2 row_mask:0xf bank_mask:0xf
    v_mul_f32_dpp v100, v118, v90 row_newbcast:4 row_mask:0xf bank_mask:0xf
    v_mul_f32_dpp v102, v118, v91 row_newbcast:6 row_mask:0xf bank_mask:0xf
    v_mfma_f32_32x32x16_bf16 v[64:79], a[28:31], v[84:87], v[64:79]
    v_cvt_pk_bf16_f32 v80, v96, v97
    v_cvt_pk_bf16_f32 v81, v98, v99
    v_cvt_pk_bf16_f32 v82, v100, v101
    v_cvt_pk_bf16_f32 v83, v102, v103
    ds_read_b128 a[12:15], v7 offset:14336
    s_waitcnt vmcnt(0)
    s_barrier
    s_waitcnt lgkmcnt(2)
    v_mfma_f32_32x32x16_bf16 v[16:31], a[0:3], v[80:83], v[16:31]
    ds_read_b128 a[16:19], v4 offset:15360
    v_lshlrev_b32 v88, 16, v200
    v_mul_f32_dpp v97, v118, v200 row_newbcast:9 row_mask:0xf bank_mask:0xf
    v_lshlrev_b32 v89, 16, v201
    v_mul_f32_dpp v99, v118, v201 row_newbcast:11 row_mask:0xf bank_mask:0xf
    v_mfma_f32_32x32x16_bf16 v[32:47], a[4:7], v[80:83], v[32:47]
    ds_read_b128 a[20:23], v5 offset:15360
    v_lshlrev_b32 v90, 16, v202
    v_mul_f32_dpp v101, v118, v202 row_newbcast:13 row_mask:0xf bank_mask:0xf
    v_lshlrev_b32 v91, 16, v203
    v_mul_f32_dpp v103, v118, v203 row_newbcast:15 row_mask:0xf bank_mask:0xf
    s_waitcnt lgkmcnt(2)
    v_mfma_f32_32x32x16_bf16 v[48:63], a[8:11], v[80:83], v[48:63]
    ds_read_b128 a[24:27], v6 offset:15360
    v_mul_f32_dpp v96, v118, v88 row_newbcast:8 row_mask:0xf bank_mask:0xf
    v_mul_f32_dpp v98, v118, v89 row_newbcast:10 row_mask:0xf bank_mask:0xf
    v_mul_f32_dpp v100, v118, v90 row_newbcast:12 row_mask:0xf bank_mask:0xf
    v_mul_f32_dpp v102, v118, v91 row_newbcast:14 row_mask:0xf bank_mask:0xf
    v_mfma_f32_32x32x16_bf16 v[64:79], a[12:15], v[80:83], v[64:79]
    v_cvt_pk_bf16_f32 v84, v96, v97
    v_cvt_pk_bf16_f32 v85, v98, v99
    v_cvt_pk_bf16_f32 v86, v100, v101
    v_cvt_pk_bf16_f32 v87, v102, v103
    ds_read_b128 a[28:31], v7 offset:15360
    s_waitcnt lgkmcnt(2)
    v_mfma_f32_32x32x16_bf16 v[16:31], a[16:19], v[84:87], v[16:31]
    ds_read_b128 a[0:3], v4 offset:16384
    v_lshlrev_b32 v88, 16, v204
    v_mul_f32_dpp v97, v120, v204 row_newbcast:1 row_mask:0xf bank_mask:0xf
    v_lshlrev_b32 v89, 16, v205
    v_mul_f32_dpp v99, v120, v205 row_newbcast:3 row_mask:0xf bank_mask:0xf
    v_mfma_f32_32x32x16_bf16 v[32:47], a[20:23], v[84:87], v[32:47]
    ds_read_b128 a[4:7], v5 offset:16384
    v_lshlrev_b32 v90, 16, v206
    v_mul_f32_dpp v101, v120, v206 row_newbcast:5 row_mask:0xf bank_mask:0xf
    v_lshlrev_b32 v91, 16, v207
    v_mul_f32_dpp v103, v120, v207 row_newbcast:7 row_mask:0xf bank_mask:0xf
    s_waitcnt lgkmcnt(2)
    v_mfma_f32_32x32x16_bf16 v[48:63], a[24:27], v[84:87], v[48:63]
    ds_read_b128 a[8:11], v6 offset:16384
    v_mul_f32_dpp v96, v120, v88 row_newbcast:0 row_mask:0xf bank_mask:0xf
    v_mul_f32_dpp v98, v120, v89 row_newbcast:2 row_mask:0xf bank_mask:0xf
    v_mul_f32_dpp v100, v120, v90 row_newbcast:4 row_mask:0xf bank_mask:0xf
    v_mul_f32_dpp v102, v120, v91 row_newbcast:6 row_mask:0xf bank_mask:0xf
    v_mfma_f32_32x32x16_bf16 v[64:79], a[28:31], v[84:87], v[64:79]
    v_cvt_pk_bf16_f32 v80, v96, v97
    v_cvt_pk_bf16_f32 v81, v98, v99
    v_cvt_pk_bf16_f32 v82, v100, v101
    v_cvt_pk_bf16_f32 v83, v102, v103
    ds_read_b128 a[12:15], v7 offset:16384
    s_waitcnt lgkmcnt(2)
    v_mfma_f32_32x32x16_bf16 v[16:31], a[0:3], v[80:83], v[16:31]
    ds_read_b128 a[16:19], v4 offset:17408
    v_lshlrev_b32 v88, 16, v208
    v_mul_f32_dpp v97, v120, v208 row_newbcast:9 row_mask:0xf bank_mask:0xf
    v_lshlrev_b32 v89, 16, v209
    v_mul_f32_dpp v99, v120, v209 row_newbcast:11 row_mask:0xf bank_mask:0xf
    v_mfma_f32_32x32x16_bf16 v[32:47], a[4:7], v[80:83], v[32:47]
    ds_read_b128 a[20:23], v5 offset:17408
    v_lshlrev_b32 v90, 16, v210
    v_mul_f32_dpp v101, v120, v210 row_newbcast:13 row_mask:0xf bank_mask:0xf
    v_lshlrev_b32 v91, 16, v211
    v_mul_f32_dpp v103, v120, v211 row_newbcast:15 row_mask:0xf bank_mask:0xf
    s_waitcnt lgkmcnt(2)
    v_mfma_f32_32x32x16_bf16 v[48:63], a[8:11], v[80:83], v[48:63]
    ds_read_b128 a[24:27], v6 offset:17408
    v_mul_f32_dpp v96, v120, v88 row_newbcast:8 row_mask:0xf bank_mask:0xf
    v_mul_f32_dpp v98, v120, v89 row_newbcast:10 row_mask:0xf bank_mask:0xf
    v_mul_f32_dpp v100, v120, v90 row_newbcast:12 row_mask:0xf bank_mask:0xf
    v_mul_f32_dpp v102, v120, v91 row_newbcast:14 row_mask:0xf bank_mask:0xf
    v_mfma_f32_32x32x16_bf16 v[64:79], a[12:15], v[80:83], v[64:79]
    v_cvt_pk_bf16_f32 v84, v96, v97
    v_cvt_pk_bf16_f32 v85, v98, v99
    v_cvt_pk_bf16_f32 v86, v100, v101
    v_cvt_pk_bf16_f32 v87, v102, v103
    ds_read_b128 a[28:31], v7 offset:17408
    s_waitcnt lgkmcnt(2)
    v_mfma_f32_32x32x16_bf16 v[16:31], a[16:19], v[84:87], v[16:31]
    v_mfma_f32_32x32x16_bf16 v[32:47], a[20:23], v[84:87], v[32:47]
    s_waitcnt lgkmcnt(0)
    v_mfma_f32_32x32x16_bf16 v[48:63], a[24:27], v[84:87], v[48:63]
    v_mfma_f32_32x32x16_bf16 v[64:79], a[28:31], v[84:87], v[64:79]
    s_nop 10
    ds_write_b128 v9, v[48:51] offset:0
    ds_write_b128 v9, v[52:55] offset:1024
    ds_write_b128 v9, v[56:59] offset:2048
    ds_write_b128 v9, v[60:63] offset:3072
    ds_write_b128 v9, v[64:67] offset:4096
    ds_write_b128 v9, v[68:71] offset:5120
    ds_write_b128 v9, v[72:75] offset:6144
    ds_write_b128 v9, v[76:79] offset:7168
    s_waitcnt lgkmcnt(0)
    s_barrier
    ds_read_b128 v[48:51], v10 offset:0
    ds_read_b128 v[52:55], v10 offset:1024
    ds_read_b128 v[56:59], v10 offset:2048
    ds_read_b128 v[60:63], v10 offset:3072
    ds_read_b128 v[64:67], v10 offset:4096
    ds_read_b128 v[68:71], v10 offset:5120
    ds_read_b128 v[72:75], v10 offset:6144
    ds_read_b128 v[76:79], v10 offset:7168
    s_waitcnt lgkmcnt(7)
    v_add_f32 v16, v16, v48
    v_add_f32 v17, v17, v49
    v_add_f32 v18, v18, v50
    v_add_f32 v19, v19, v51
    s_waitcnt lgkmcnt(6)
    v_add_f32 v20, v20, v52
    v_add_f32 v21, v21, v53
    v_add_f32 v22, v22, v54
    v_add_f32 v23, v23, v55
    s_waitcnt lgkmcnt(5)
    v_add_f32 v24, v24, v56
    v_add_f32 v25, v25, v57
    v_add_f32 v26, v26, v58
    v_add_f32 v27, v27, v59
    s_waitcnt lgkmcnt(4)
    v_add_f32 v28, v28, v60
    v_add_f32 v29, v29, v61
    v_add_f32 v30, v30, v62
    v_add_f32 v31, v31, v63
    s_waitcnt lgkmcnt(3)
    v_add_f32 v32, v32, v64
    v_add_f32 v33, v33, v65
    v_add_f32 v34, v34, v66
    v_add_f32 v35, v35, v67
    s_waitcnt lgkmcnt(2)
    v_add_f32 v36, v36, v68
    v_add_f32 v37, v37, v69
    v_add_f32 v38, v38, v70
    v_add_f32 v39, v39, v71
    s_waitcnt lgkmcnt(1)
    v_add_f32 v40, v40, v72
    v_add_f32 v41, v41, v73
    v_add_f32 v42, v42, v74
    v_add_f32 v43, v43, v75
    s_waitcnt lgkmcnt(0)
    v_add_f32 v44, v44, v76
    v_add_f32 v45, v45, v77
    v_add_f32 v46, v46, v78
    v_add_f32 v47, v47, v79
    s_cmp_eq_u32 s6, 8
    s_cbranch_scc1 K2_REM
    s_and_b32 s10, s9, 15
    s_lshl_b32 s10, s10, 17
    s_lshl_b32 s11, s8, 10
    s_add_u32 s10, s10, s11
    s_cmp_ge_u32 s6, 4
    s_cbranch_scc1 K2_KM
    s_add_u32 s10, s10, 0x600000
    v_mov_b32 v8, 0x3eae1a93
    v_mul_f32 v16, v8, v16
    v_mul_f32 v17, v8, v17
    v_mul_f32 v18, v8, v18
    v_mul_f32 v19, v8, v19
    v_mul_f32 v20, v8, v20
    v_mul_f32 v21, v8, v21
    v_mul_f32 v22, v8, v22
    v_mul_f32 v23, v8, v23
    v_cvt_pk_bf16_f32 v88, v16, v17
    v_cvt_pk_bf16_f32 v89, v18, v19
    v_cvt_pk_bf16_f32 v90, v20, v21
    v_cvt_pk_bf16_f32 v91, v22, v23
    buffer_store_dwordx4 v[88:91], v2, s[16:19], s10 offen
    s_add_u32 s10, s10, 65536
    v_mul_f32 v24, v8, v24
    v_mul_f32 v25, v8, v25
    v_mul_f32 v26, v8, v26
    v_mul_f32 v27, v8, v27
    v_mul_f32 v28, v8, v28
    v_mul_f32 v29, v8, v29
    v_mul_f32 v30, v8, v30
    v_mul_f32 v31, v8, v31
    v_cvt_pk_bf16_f32 v92, v24, v25
    v_cvt_pk_bf16_f32 v93, v26, v27
    v_cvt_pk_bf16_f32 v94, v28, v29
    v_cvt_pk_bf16_f32 v95, v30, v31
    buffer_store_dwordx4 v[92:95], v2, s[16:19], s10 offen
    s_add_u32 s10, s10, 65536
    v_mul_f32 v32, v8, v32
    v_mul_f32 v33, v8, v33
    v_mul_f32 v34, v8, v34
    v_mul_f32 v35, v8, v35
    v_mul_f32 v36, v8, v36
    v_mul_f32 v37, v8, v37
    v_mul_f32 v38, v8, v38
    v_mul_f32 v39, v8, v39
    v_cvt_pk_bf16_f32 v96, v32, v33
    v_cvt_pk_bf16_f32 v97, v34, v35
    v_cvt_pk_bf16_f32 v98, v36, v37
    v_cvt_pk_bf16_f32 v99, v38, v39
    buffer_store_dwordx4 v[96:99], v2, s[16:19], s10 offen
    s_add_u32 s10, s10, 65536
    v_mul_f32 v40, v8, v40
    v_mul_f32 v41, v8, v41
    v_mul_f32 v42, v8, v42
    v_mul_f32 v43, v8, v43
    v_mul_f32 v44, v8, v44
    v_mul_f32 v45, v8, v45
    v_mul_f32 v46, v8, v46
    v_mul_f32 v47, v8, v47
    v_cvt_pk_bf16_f32 v100, v40, v41
    v_cvt_pk_bf16_f32 v101, v42, v43
    v_cvt_pk_bf16_f32 v102, v44, v45
    v_cvt_pk_bf16_f32 v103, v46, v47
    buffer_store_dwordx4 v[100:103], v2, s[16:19], s10 offen
    s_add_u32 s10, s10, 65536
    s_branch K2_END
K2_KM:
    s_add_u32 s10, s10, 0x800000
    v_cvt_pk_bf16_f32 v88, v16, v17
    v_cvt_pk_bf16_f32 v89, v18, v19
    v_cvt_pk_bf16_f32 v90, v20, v21
    v_cvt_pk_bf16_f32 v91, v22, v23
    buffer_store_dwordx4 v[88:91], v2, s[16:19], s10 offen
    s_add_u32 s10, s10, 65536
    v_cvt_pk_bf16_f32 v92, v24, v25
    v_cvt_pk_bf16_f32 v93, v26, v27
    v_cvt_pk_bf16_f32 v94, v28, v29
    v_cvt_pk_bf16_f32 v95, v30, v31
    buffer_store_dwordx4 v[92:95], v2, s[16:19], s10 offen
    s_add_u32 s10, s10, 65536
    v_cvt_pk_bf16_f32 v96, v32, v33
    v_cvt_pk_bf16_f32 v97, v34, v35
    v_cvt_pk_bf16_f32 v98, v36, v37
    v_cvt_pk_bf16_f32 v99, v38, v39
    buffer_store_dwordx4 v[96:99], v2, s[16:19], s10 offen
    s_add_u32 s10, s10, 65536
    v_cvt_pk_bf16_f32 v100, v40, v41
    v_cvt_pk_bf16_f32 v101, v42, v43
    v_cvt_pk_bf16_f32 v102, v44, v45
    v_cvt_pk_bf16_f32 v103, v46, v47
    buffer_store_dwordx4 v[100:103], v2, s[16:19], s10 offen
    s_add_u32 s10, s10, 65536
    v_mul_f32 v104, v16, v16
    v_mul_f32 v105, v24, v24
    v_mul_f32 v106, v32, v32
    v_mul_f32 v107, v40, v40
    v_fmac_f32 v104, v17, v17
    v_fmac_f32 v105, v25, v25
    v_fmac_f32 v106, v33, v33
    v_fmac_f32 v107, v41, v41
    v_fmac_f32 v104, v18, v18
    v_fmac_f32 v105, v26, v26
    v_fmac_f32 v106, v34, v34
    v_fmac_f32 v107, v42, v42
    v_fmac_f32 v104, v19, v19
    v_fmac_f32 v105, v27, v27
    v_fmac_f32 v106, v35, v35
    v_fmac_f32 v107, v43, v43
    v_fmac_f32 v104, v20, v20
    v_fmac_f32 v105, v28, v28
    v_fmac_f32 v106, v36, v36
    v_fmac_f32 v107, v44, v44
    v_fmac_f32 v104, v21, v21
    v_fmac_f32 v105, v29, v29
    v_fmac_f32 v106, v37, v37
    v_fmac_f32 v107, v45, v45
    v_fmac_f32 v104, v22, v22
    v_fmac_f32 v105, v30, v30
    v_fmac_f32 v106, v38, v38
    v_fmac_f32 v107, v46, v46
    v_fmac_f32 v104, v23, v23
    v_fmac_f32 v105, v31, v31
    v_fmac_f32 v106, v39, v39
    v_fmac_f32 v107, v47, v47
    v_mov_b32 v112, v104
    v_mov_b32 v113, v105
    v_mov_b32 v114, v106
    v_mov_b32 v115, v107
    v_permlane32_swap_b32 v104, v112
    v_permlane32_swap_b32 v105, v113
    v_permlane32_swap_b32 v106, v114
    v_permlane32_swap_b32 v107, v115
    v_add_f32 v104, v104, v112
    v_add_f32 v105, v105, v113
    v_add_f32 v106, v106, v114
    v_add_f32 v107, v107, v115
    v_max_f32_dpp v104, v104, v104 quad_perm:[1,0,3,2] row_mask:0xf bank_mask:0xf
    v_max_f32_dpp v105, v105, v105 quad_perm:[1,0,3,2] row_mask:0xf bank_mask:0xf
    v_max_f32_dpp v106, v106, v106 quad_perm:[1,0,3,2] row_mask:0xf bank_mask:0xf
    v_max_f32_dpp v107, v107, v107 quad_perm:[1,0,3,2] row_mask:0xf bank_mask:0xf
    v_max_f32_dpp v104, v104, v104 quad_perm:[2,3,0,1] row_mask:0xf bank_mask:0xf
    v_max_f32_dpp v105, v105, v105 quad_perm:[2,3,0,1] row_mask:0xf bank_mask:0xf
    v_max_f32_dpp v106, v106, v106 quad_perm:[2,3,0,1] row_mask:0xf bank_mask:0xf
    v_max_f32_dpp v107, v107, v107 quad_perm:[2,3,0,1] row_mask:0xf bank_mask:0xf
    v_max_f32_dpp v104, v104, v104 row_half_mirror row_mask:0xf bank_mask:0xf
    v_max_f32_dpp v105, v105, v105 row_half_mirror row_mask:0xf bank_mask:0xf
    v_max_f32_dpp v106, v106, v106 row_half_mirror row_mask:0xf bank_mask:0xf
    v_max_f32_dpp v107, v107, v107 row_half_mirror row_mask:0xf bank_mask:0xf
    v_max_f32_dpp v104, v104, v104 row_mirror row_mask:0xf bank_mask:0xf
    v_max_f32_dpp v105, v105, v105 row_mirror row_mask:0xf bank_mask:0xf
    v_max_f32_dpp v106, v106, v106 row_mirror row_mask:0xf bank_mask:0xf
    v_max_f32_dpp v107, v107, v107 row_mirror row_mask:0xf bank_mask:0xf
    v_mov_b32 v112, v104
    v_mov_b32 v113, v105
    v_mov_b32 v114, v106
    v_mov_b32 v115, v107
    v_permlane16_swap_b32 v104, v112
    v_permlane16_swap_b32 v105, v113
    v_permlane16_swap_b32 v106, v114
    v_permlane16_swap_b32 v107, v115
    v_max_f32 v104, v104, v112
    v_max_f32 v105, v105, v113
    v_max_f32 v106, v106, v114
    v_max_f32 v107, v107, v115
    s_and_b32 s10, s9, 15
    s_lshl_b32 s10, s10, 9
    s_lshl_b32 s11, s8, 2
    s_add_u32 s10, s10, s11
    s_add_u32 s10, s10, 0x9000
    v_mov_b32 v8, 0
    s_mov_b64 exec, 1
    buffer_store_dword v104, v8, s[16:19], s10 offen offset:0
    buffer_store_dword v105, v8, s[16:19], s10 offen offset:256
    buffer_store_dword v106, v8, s[16:19], s10 offen offset:512
    buffer_store_dword v107, v8, s[16:19], s10 offen offset:768
    s_branch K2_END
K2_REM:
    v_and_b32 v9, 31, v1
    v_lshlrev_b32 v9, 2, v9
    v_lshrrev_b32 v10, 5, v1
    v_lshl_add_u32 v9, v10, 14, v9
    s_lshl_b32 s11, s8, 7
    s_mul_i32 s10, s13, 0x40000
    s_add_u32 s11, s11, s10
    s_cmp_eq_u32 s13, 0
    s_cselect_b32 s10, 0x3eae1a93, 1.0
    v_mov_b32 v8, s10
    v_mul_f32 v16, v8, v16
    v_mul_f32 v17, v8, v17
    v_mul_f32 v18, v8, v18
    v_mul_f32 v19, v8, v19
    v_mul_f32 v20, v8, v20
    v_mul_f32 v21, v8, v21
    v_mul_f32 v22, v8, v22
    v_mul_f32 v23, v8, v23
    v_mul_f32 v24, v8, v24
    v_mul_f32 v25, v8, v25
    v_mul_f32 v26, v8, v26
    v_mul_f32 v27, v8, v27
    v_mul_f32 v28, v8, v28
    v_mul_f32 v29, v8, v29
    v_mul_f32 v30, v8, v30
    v_mul_f32 v31, v8, v31
    v_mul_f32 v32, v8, v32
    v_mul_f32 v33, v8, v33
    v_mul_f32 v34, v8, v34
    v_mul_f32 v35, v8, v35
    v_mul_f32 v36, v8, v36
    v_mul_f32 v37, v8, v37
    v_mul_f32 v38, v8, v38
    v_mul_f32 v39, v8, v39
    v_mul_f32 v40, v8, v40
    v_mul_f32 v41, v8, v41
    v_mul_f32 v42, v8, v42
    v_mul_f32 v43, v8, v43
    v_mul_f32 v44, v8, v44
    v_mul_f32 v45, v8, v45
    v_mul_f32 v46, v8, v46
    v_mul_f32 v47, v8, v47
    v_cvt_pk_bf16_f32 v140, v16, v17
    v_cvt_pk_bf16_f32 v141, v18, v19
    v_cvt_pk_bf16_f32 v142, v20, v21
    v_cvt_pk_bf16_f32 v143, v22, v23
    v_cvt_pk_bf16_f32 v144, v24, v25
    v_cvt_pk_bf16_f32 v145, v26, v27
    v_cvt_pk_bf16_f32 v146, v28, v29
    v_cvt_pk_bf16_f32 v147, v30, v31
    s_add_u32 s10, s11, 0xa00000
    buffer_store_dword v140, v9, s[16:19], s10 offen
    s_add_u32 s10, s11, 0xa02000
    buffer_store_dword v141, v9, s[16:19], s10 offen
    s_add_u32 s10, s11, 0xa08000
    buffer_store_dword v142, v9, s[16:19], s10 offen
    s_add_u32 s10, s11, 0xa0a000
    buffer_store_dword v143, v9, s[16:19], s10 offen
    s_add_u32 s10, s11, 0xa10000
    buffer_store_dword v144, v9, s[16:19], s10 offen
    s_add_u32 s10, s11, 0xa12000
    buffer_store_dword v145, v9, s[16:19], s10 offen
    s_add_u32 s10, s11, 0xa18000
    buffer_store_dword v146, v9, s[16:19], s10 offen
    s_add_u32 s10, s11, 0xa1a000
    buffer_store_dword v147, v9, s[16:19], s10 offen
    v_cvt_pk_bf16_f32 v148, v32, v33
    v_cvt_pk_bf16_f32 v149, v34, v35
    v_cvt_pk_bf16_f32 v150, v36, v37
    v_cvt_pk_bf16_f32 v151, v38, v39
    v_cvt_pk_bf16_f32 v152, v40, v41
    v_cvt_pk_bf16_f32 v153, v42, v43
    v_cvt_pk_bf16_f32 v154, v44, v45
    v_cvt_pk_bf16_f32 v155, v46, v47
    s_add_u32 s10, s11, 0xa20000
    buffer_store_dword v148, v9, s[16:19], s10 offen
    s_add_u32 s10, s11, 0xa22000
    buffer_store_dword v149, v9, s[16:19], s10 offen
    s_add_u32 s10, s11, 0xa28000
    buffer_store_dword v150, v9, s[16:19], s10 offen
    s_add_u32 s10, s11, 0xa2a000
    buffer_store_dword v151, v9, s[16:19], s10 offen
    s_add_u32 s10, s11, 0xa30000
    buffer_store_dword v152, v9, s[16:19], s10 offen
    s_add_u32 s10, s11, 0xa32000
    buffer_store_dword v153, v9, s[16:19], s10 offen
    s_add_u32 s10, s11, 0xa38000
    buffer_store_dword v154, v9, s[16:19], s10 offen
    s_add_u32 s10, s11, 0xa3a000
    buffer_store_dword v155, v9, s[16:19], s10 offen
    s_cmp_eq_u32 s13, 0
    s_cbranch_scc1 K2_END
    v_mul_f32 v104, v16, v16
    v_mul_f32 v105, v18, v18
    v_mul_f32 v106, v20, v20
    v_mul_f32 v107, v22, v22
    v_mul_f32 v108, v24, v24
    v_mul_f32 v109, v26, v26
    v_mul_f32 v110, v28, v28
    v_mul_f32 v111, v30, v30
    v_mul_f32 v112, v32, v32
    v_mul_f32 v113, v34, v34
    v_mul_f32 v114, v36, v36
    v_mul_f32 v115, v38, v38
    v_mul_f32 v116, v40, v40
    v_mul_f32 v117, v42, v42
    v_mul_f32 v118, v44, v44
    v_mul_f32 v119, v46, v46
    v_fmac_f32 v104, v17, v17
    v_fmac_f32 v105, v19, v19
    v_fmac_f32 v106, v21, v21
    v_fmac_f32 v107, v23, v23
    v_fmac_f32 v108, v25, v25
    v_fmac_f32 v109, v27, v27
    v_fmac_f32 v110, v29, v29
    v_fmac_f32 v111, v31, v31
    v_fmac_f32 v112, v33, v33
    v_fmac_f32 v113, v35, v35
    v_fmac_f32 v114, v37, v37
    v_fmac_f32 v115, v39, v39
    v_fmac_f32 v116, v41, v41
    v_fmac_f32 v117, v43, v43
    v_fmac_f32 v118, v45, v45
    v_fmac_f32 v119, v47, v47
    v_max3_f32 v104, v104, v105, v106
    v_max3_f32 v104, v104, v107, v108
    v_max3_f32 v104, v104, v109, v110
    v_max3_f32 v104, v104, v111, v112
    v_max3_f32 v104, v104, v113, v114
    v_max3_f32 v104, v104, v115, v116
    v_max3_f32 v104, v104, v117, v118
    v_max_f32 v104, v104, v119
    s_nop 1
    v_max_f32_dpp v104, v104, v104 quad_perm:[1,0,3,2] row_mask:0xf bank_mask:0xf
    s_nop 1
    v_max_f32_dpp v104, v104, v104 quad_perm:[2,3,0,1] row_mask:0xf bank_mask:0xf
    s_nop 1
    v_max_f32_dpp v104, v104, v104 row_half_mirror row_mask:0xf bank_mask:0xf
    s_nop 1
    v_max_f32_dpp v104, v104, v104 row_mirror row_mask:0xf bank_mask:0xf
    v_mov_b32 v120, v104
    s_nop 1
    v_permlane16_swap_b32 v104, v120
    v_max_f32 v104, v104, v120
    v_mov_b32 v105, v104
    s_nop 1
    v_permlane32_swap_b32 v104, v105
    v_max_f32 v104, v104, v105
    s_lshl_b32 s11, s8, 2
    s_add_u32 s10, s11, 0xb000
    s_mov_b64 exec, 1
    buffer_store_dword v104, off, s[16:19], s10
    s_branch K2_END
K2_V:
    s_waitcnt vmcnt(6)
    s_barrier
    ds_read_b64 v[104:105], v8 offset:0
    ds_read_b64 v[106:107], v8 offset:512
    ds_read_b64 v[108:109], v8 offset:1024
    ds_read_b64 v[110:111], v8 offset:1536
    ds_read_b64 v[112:113], v8 offset:2048
    ds_read_b64 v[114:115], v8 offset:2560
    ds_read_b64 v[116:117], v8 offset:3072
    ds_read_b64 v[118:119], v8 offset:3584
    ds_read_b64 v[120:121], v8 offset:4096
    ds_read_b128 a[0:3], v4 offset:0
    ds_read_b128 a[4:7], v5 offset:0
    ds_read_b128 a[8:11], v6 offset:0
    ds_read_b128 a[12:15], v7 offset:0
    s_waitcnt lgkmcnt(4)
    v_lshlrev_b32 v88, 16, v140
    v_mul_f32_dpp v97, v104, v140 row_newbcast:1 row_mask:0xf bank_mask:0xf
    v_lshlrev_b32 v89, 16, v141
    v_mul_f32_dpp v99, v104, v141 row_newbcast:3 row_mask:0xf bank_mask:0xf
    v_lshlrev_b32 v90, 16, v142
    v_mul_f32_dpp v101, v104, v142 row_newbcast:5 row_mask:0xf bank_mask:0xf
    v_lshlrev_b32 v91, 16, v143
    v_mul_f32_dpp v103, v104, v143 row_newbcast:7 row_mask:0xf bank_mask:0xf
    v_mul_f32_dpp v96, v104, v88 row_newbcast:0 row_mask:0xf bank_mask:0xf
    v_mul_f32_dpp v98, v104, v89 row_newbcast:2 row_mask:0xf bank_mask:0xf
    v_mul_f32_dpp v100, v104, v90 row_newbcast:4 row_mask:0xf bank_mask:0xf
    v_mul_f32_dpp v102, v104, v91 row_newbcast:6 row_mask:0xf bank_mask:0xf
    v_cvt_pk_bf16_f32 v80, v96, v97
    v_cvt_pk_bf16_f32 v81, v98, v99
    v_cvt_pk_bf16_f32 v82, v100, v101
    v_cvt_pk_bf16_f32 v83, v102, v103
    s_waitcnt lgkmcnt(2)
    s_nop 0
    v_mfma_f32_32x32x16_bf16 v[16:31], v[80:83], a[0:3], 0
    ds_read_b128 a[16:19], v4 offset:1024
    v_lshlrev_b32 v88, 16, v144
    v_mul_f32_dpp v97, v104, v144 row_newbcast:9 row_mask:0xf bank_mask:0xf
    v_lshlrev_b32 v89, 16, v145
    v_mul_f32_dpp v99, v104, v145 row_newbcast:11 row_mask:0xf bank_mask:0xf
    s_add_u32 m0, s30, 6144
    v_mfma_f32_32x32x16_bf16 v[32:47], v[80:83], a[4:7], 0
    ds_read_b128 a[20:23], v5 offset:1024
    v_lshlrev_b32 v90, 16, v146
    v_mul_f32_dpp v101, v104, v146 row_newbcast:13 row_mask:0xf bank_mask:0xf
    v_lshlrev_b32 v91, 16, v147
    v_mul_f32_dpp v103, v104, v147 row_newbcast:15 row_mask:0xf bank_mask:0xf
    s_waitcnt lgkmcnt(2)
    v_mfma_f32_32x32x16_bf16 v[48:63], v[80:83], a[8:11], 0
    ds_read_b128 a[24:27], v6 offset:1024
    v_mul_f32_dpp v96, v104, v88 row_newbcast:8 row_mask:0xf bank_mask:0xf
    v_mul_f32_dpp v98, v104, v89 row_newbcast:10 row_mask:0xf bank_mask:0xf
    v_mul_f32_dpp v100, v104, v90 row_newbcast:12 row_mask:0xf bank_mask:0xf
    v_mul_f32_dpp v102, v104, v91 row_newbcast:14 row_mask:0xf bank_mask:0xf
    buffer_load_dwordx4 v[164:167], v3, s[16:19], s32 offen offset:0
    v_mfma_f32_32x32x16_bf16 v[64:79], v[80:83], a[12:15], 0
    buffer_load_dwordx4 v3, s[16:19], s31 offen offset:0 lds
    v_cvt_pk_bf16_f32 v84, v96, v97
    v_cvt_pk_bf16_f32 v85, v98, v99
    v_cvt_pk_bf16_f32 v86, v100, v101
    v_cvt_pk_bf16_f32 v87, v102, v103
    ds_read_b128 a[28:31], v7 offset:1024
    s_waitcnt lgkmcnt(2)
    v_mfma_f32_32x32x16_bf16 v[16:31], v[84:87], a[16:19], v[16:31]
    ds_read_b128 a[0:3], v4 offset:2048
    v_lshlrev_b32 v88, 16, v148
    v_mul_f32_dpp v97, v106, v148 row_newbcast:1 row_mask:0xf bank_mask:0xf
    v_lshlrev_b32 v89, 16, v149
    v_mul_f32_dpp v99, v106, v149 row_newbcast:3 row_mask:0xf bank_mask:0xf
    buffer_load_dwordx4 v[168:171], v3, s[16:19], s32 offen offset:1024
    v_mfma_f32_32x32x16_bf16 v[32:47], v[84:87], a[20:23], v[32:47]
    ds_read_b128 a[4:7], v5 offset:2048
    v_lshlrev_b32 v90, 16, v150
    v_mul_f32_dpp v101, v106, v150 row_newbcast:5 row_mask:0xf bank_mask:0xf
    v_lshlrev_b32 v91, 16, v151
    v_mul_f32_dpp v103, v106, v151 row_newbcast:7 row_mask:0xf bank_mask:0xf
    s_waitcnt lgkmcnt(2)
    v_mfma_f32_32x32x16_bf16 v[48:63], v[84:87], a[24:27], v[48:63]
    ds_read_b128 a[8:11], v6 offset:2048
    v_mul_f32_dpp v96, v106, v88 row_newbcast:0 row_mask:0xf bank_mask:0xf
    v_mul_f32_dpp v98, v106, v89 row_newbcast:2 row_mask:0xf bank_mask:0xf
    v_mul_f32_dpp v100, v106, v90 row_newbcast:4 row_mask:0xf bank_mask:0xf
    v_mul_f32_dpp v102, v106, v91 row_newbcast:6 row_mask:0xf bank_mask:0xf
    buffer_load_dwordx4 v3, s[16:19], s31 offen offset:1024 lds
    v_mfma_f32_32x32x16_bf16 v[64:79], v[84:87], a[28:31], v[64:79]
    buffer_load_dwordx4 v[172:175], v3, s[16:19], s32 offen offset:2048
    v_cvt_pk_bf16_f32 v80, v96, v97
    v_cvt_pk_bf16_f32 v81, v98, v99
    v_cvt_pk_bf16_f32 v82, v100, v101
    v_cvt_pk_bf16_f32 v83, v102, v103
    ds_read_b128 a[12:15], v7 offset:2048
    s_waitcnt vmcnt(5)
    s_barrier
    s_waitcnt lgkmcnt(2)
    v_mfma_f32_32x32x16_bf16 v[16:31], v[80:83], a[0:3], v[16:31]
    ds_read_b128 a[16:19], v4 offset:3072
    v_lshlrev_b32 v88, 16, v152
    v_mul_f32_dpp v97, v106, v152 row_newbcast:9 row_mask:0xf bank_mask:0xf
    v_lshlrev_b32 v89, 16, v153
    v_mul_f32_dpp v99, v106, v153 row_newbcast:11 row_mask:0xf bank_mask:0xf
    buffer_load_dwordx4 v3, s[16:19], s31 offen offset:2048 lds
    v_add_u32 v3, 3072, v3
    v_mfma_f32_32x32x16_bf16 v[32:47], v[80:83], a[4:7], v[32:47]
    ds_read_b128 a[20:23], v5 offset:3072
    v_lshlrev_b32 v90, 16, v154
    v_mul_f32_dpp v101, v106, v154 row_newbcast:13 row_mask:0xf bank_mask:0xf
    v_lshlrev_b32 v91, 16, v155
    v_mul_f32_dpp v103, v106, v155 row_newbcast:15 row_mask:0xf bank_mask:0xf
    s_waitcnt lgkmcnt(2)
    v_mfma_f32_32x32x16_bf16 v[48:63], v[80:83], a[8:11], v[48:63]
    ds_read_b128 a[24:27], v6 offset:3072
    v_mul_f32_dpp v96, v106, v88 row_newbcast:8 row_mask:0xf bank_mask:0xf
    v_mul_f32_dpp v98, v106, v89 row_newbcast:10 row_mask:0xf bank_mask:0xf
    v_mul_f32_dpp v100, v106, v90 row_newbcast:12 row_mask:0xf bank_mask:0xf
    v_mul_f32_dpp v102, v106, v91 row_newbcast:14 row_mask:0xf bank_mask:0xf
    v_mfma_f32_32x32x16_bf16 v[64:79], v[80:83], a[12:15], v[64:79]
    v_cvt_pk_bf16_f32 v84, v96, v97
    v_cvt_pk_bf16_f32 v85, v98, v99
    v_cvt_pk_bf16_f32 v86, v100, v101
    v_cvt_pk_bf16_f32 v87, v102, v103
    ds_read_b128 a[28:31], v7 offset:3072
    s_waitcnt lgkmcnt(2)
    v_mfma_f32_32x32x16_bf16 v[16:31], v[84:87], a[16:19], v[16:31]
    ds_read_b128 a[0:3], v4 offset:4096
    v_lshlrev_b32 v88, 16, v156
    v_mul_f32_dpp v97, v108, v156 row_newbcast:1 row_mask:0xf bank_mask:0xf
    v_lshlrev_b32 v89, 16, v157
    v_mul_f32_dpp v99, v108, v157 row_newbcast:3 row_mask:0xf bank_mask:0xf
    s_add_u32 m0, s30, 9216
    v_mfma_f32_32x32x16_bf16 v[32:47], v[84:87], a[20:23], v[32:47]
    ds_read_b128 a[4:7], v5 offset:4096
    v_lshlrev_b32 v90, 16, v158
    v_mul_f32_dpp v101, v108, v158 row_newbcast:5 row_mask:0xf bank_mask:0xf
    v_lshlrev_b32 v91, 16, v159
    v_mul_f32_dpp v103, v108, v159 row_newbcast:7 row_mask:0xf bank_mask:0xf
    s_waitcnt lgkmcnt(2)
    v_mfma_f32_32x32x16_bf16 v[48:63], v[84:87], a[24:27], v[48:63]
    ds_read_b128 a[8:11], v6 offset:4096
    v_mul_f32_dpp v96, v108, v88 row_newbcast:0 row_mask:0xf bank_mask:0xf
    v_mul_f32_dpp v98, v108, v89 row_newbcast:2 row_mask:0xf bank_mask:0xf
    v_mul_f32_dpp v100, v108, v90 row_newbcast:4 row_mask:0xf bank_mask:0xf
    v_mul_f32_dpp v102, v108, v91 row_newbcast:6 row_mask:0xf bank_mask:0xf
    buffer_load_dwordx4 v[176:179], v3, s[16:19], s32 offen offset:0
    v_mfma_f32_32x32x16_bf16 v[64:79], v[84:87], a[28:31], v[64:79]
    buffer_load_dwordx4 v3, s[16:19], s31 offen offset:0 lds
    v_cvt_pk_bf16_f32 v80, v96, v97
    v_cvt_pk_bf16_f32 v81, v98, v99
    v_cvt_pk_bf16_f32 v82, v100, v101
    v_cvt_pk_bf16_f32 v83, v102, v103
    ds_read_b128 a[12:15], v7 offset:4096
    s_waitcnt lgkmcnt(2)
    v_mfma_f32_32x32x16_bf16 v[16:31], v[80:83], a[0:3], v[16:31]
    ds_read_b128 a[16:19], v4 offset:5120
    v_lshlrev_b32 v88, 16, v160
    v_mul_f32_dpp v97, v108, v160 row_newbcast:9 row_mask:0xf bank_mask:0xf
    v_lshlrev_b32 v89, 16, v161
    v_mul_f32_dpp v99, v108, v161 row_newbcast:11 row_mask:0xf bank_mask:0xf
    buffer_load_dwordx4 v[180:183], v3, s[16:19], s32 offen offset:1024
    v_mfma_f32_32x32x16_bf16 v[32:47], v[80:83], a[4:7], v[32:47]
    ds_read_b128 a[20:23], v5 offset:5120
    v_lshlrev_b32 v90, 16, v162
    v_mul_f32_dpp v101, v108, v162 row_newbcast:13 row_mask:0xf bank_mask:0xf
    v_lshlrev_b32 v91, 16, v163
    v_mul_f32_dpp v103, v108, v163 row_newbcast:15 row_mask:0xf bank_mask:0xf
    s_waitcnt lgkmcnt(2)
    v_mfma_f32_32x32x16_bf16 v[48:63], v[80:83], a[8:11], v[48:63]
    ds_read_b128 a[24:27], v6 offset:5120
    v_mul_f32_dpp v96, v108, v88 row_newbcast:8 row_mask:0xf bank_mask:0xf
    v_mul_f32_dpp v98, v108, v89 row_newbcast:10 row_mask:0xf bank_mask:0xf
    v_mul_f32_dpp v100, v108, v90 row_newbcast:12 row_mask:0xf bank_mask:0xf
    v_mul_f32_dpp v102, v108, v91 row_newbcast:14 row_mask:0xf bank_mask:0xf
    buffer_load_dwordx4 v3, s[16:19], s31 offen offset:1024 lds
    v_mfma_f32_32x32x16_bf16 v[64:79], v[80:83], a[12:15], v[64:79]
    buffer_load_dwordx4 v[184:187], v3, s[16:19], s32 offen offset:2048
    v_cvt_pk_bf16_f32 v84, v96, v97
    v_cvt_pk_bf16_f32 v85, v98, v99
    v_cvt_pk_bf16_f32 v86, v100, v101
    v_cvt_pk_bf16_f32 v87, v102, v103
    ds_read_b128 a[28:31], v7 offset:5120
    s_waitcnt vmcnt(5)
    s_barrier
    s_waitcnt lgkmcnt(2)
    v_mfma_f32_32x32x16_bf16 v[16:31], v[84:87], a[16:19], v[16:31]
    ds_read_b128 a[0:3], v4 offset:6144
    v_lshlrev_b32 v88, 16, v164
    v_mul_f32_dpp v97, v110, v164 row_newbcast:1 row_mask:0xf bank_mask:0xf
    v_lshlrev_b32 v89, 16, v165
    v_mul_f32_dpp v99, v110, v165 row_newbcast:3 row_mask:0xf bank_mask:0xf
    buffer_load_dwordx4 v3, s[16:19], s31 offen offset:2048 lds
    v_add_u32 v3, 3072, v3
    v_mfma_f32_32x32x16_bf16 v[32:47], v[84:87], a[20:23], v[32:47]
    ds_read_b128 a[4:7], v5 offset:6144
    v_lshlrev_b32 v90, 16, v166
    v_mul_f32_dpp v101, v110, v166 row_newbcast:5 row_mask:0xf bank_mask:0xf
    v_lshlrev_b32 v91, 16, v167
    v_mul_f32_dpp v103, v110, v167 row_newbcast:7 row_mask:0xf bank_mask:0xf
    s_waitcnt lgkmcnt(2)
    v_mfma_f32_32x32x16_bf16 v[48:63], v[84:87], a[24:27], v[48:63]
    ds_read_b128 a[8:11], v6 offset:6144
    v_mul_f32_dpp v96, v110, v88 row_newbcast:0 row_mask:0xf bank_mask:0xf
    v_mul_f32_dpp v98, v110, v89 row_newbcast:2 row_mask:0xf bank_mask:0xf
    v_mul_f32_dpp v100, v110, v90 row_newbcast:4 row_mask:0xf bank_mask:0xf
    v_mul_f32_dpp v102, v110, v91 row_newbcast:6 row_mask:0xf bank_mask:0xf
    v_mfma_f32_32x32x16_bf16 v[64:79], v[84:87], a[28:31], v[64:79]
    v_cvt_pk_bf16_f32 v80, v96, v97
    v_cvt_pk_bf16_f32 v81, v98, v99
    v_cvt_pk_bf16_f32 v82, v100, v101
    v_cvt_pk_bf16_f32 v83, v102, v103
    ds_read_b128 a[12:15], v7 offset:6144
    s_waitcnt lgkmcnt(2)
    v_mfma_f32_32x32x16_bf16 v[16:31], v[80:83], a[0:3], v[16:31]
    ds_read_b128 a[16:19], v4 offset:7168
    v_lshlrev_b32 v88, 16, v168
    v_mul_f32_dpp v97, v110, v168 row_newbcast:9 row_mask:0xf bank_mask:0xf
    v_lshlrev_b32 v89, 16, v169
    v_mul_f32_dpp v99, v110, v169 row_newbcast:11 row_mask:0xf bank_mask:0xf
    s_add_u32 m0, s30, 12288
    v_mfma_f32_32x32x16_bf16 v[32:47], v[80:83], a[4:7], v[32:47]
    ds_read_b128 a[20:23], v5 offset:7168
    v_lshlrev_b32 v90, 16, v170
    v_mul_f32_dpp v101, v110, v170 row_newbcast:13 row_mask:0xf bank_mask:0xf
    v_lshlrev_b32 v91, 16, v171
    v_mul_f32_dpp v103, v110, v171 row_newbcast:15 row_mask:0xf bank_mask:0xf
    s_waitcnt lgkmcnt(2)
    v_mfma_f32_32x32x16_bf16 v[48:63], v[80:83], a[8:11], v[48:63]
    ds_read_b128 a[24:27], v6 offset:7168
    v_mul_f32_dpp v96, v110, v88 row_newbcast:8 row_mask:0xf bank_mask:0xf
    v_mul_f32_dpp v98, v110, v89 row_newbcast:10 row_mask:0xf bank_mask:0xf
    v_mul_f32_dpp v100, v110, v90 row_newbcast:12 row_mask:0xf bank_mask:0xf
    v_mul_f32_dpp v102, v110, v91 row_newbcast:14 row_mask:0xf bank_mask:0xf
    buffer_load_dwordx4 v[188:191], v3, s[16:19], s32 offen offset:0
    v_mfma_f32_32x32x16_bf16 v[64:79], v[80:83], a[12:15], v[64:79]
    buffer_load_dwordx4 v3, s[16:19], s31 offen offset:0 lds
    v_cvt_pk_bf16_f32 v84, v96, v97
    v_cvt_pk_bf16_f32 v85, v98, v99
    v_cvt_pk_bf16_f32 v86, v100, v101
    v_cvt_pk_bf16_f32 v87, v102, v103
    ds_read_b128 a[28:31], v7 offset:7168
    s_waitcnt lgkmcnt(2)
    v_mfma_f32_32x32x16_bf16 v[16:31], v[84:87], a[16:19], v[16:31]
    ds_read_b128 a[0:3], v4 offset:8192
    v_lshlrev_b32 v88, 16, v172
    v_mul_f32_dpp v97, v112, v172 row_newbcast:1 row_mask:0xf bank_mask:0xf
    v_lshlrev_b32 v89, 16, v173
    v_mul_f32_dpp v99, v112, v173 row_newbcast:3 row_mask:0xf bank_mask:0xf
    buffer_load_dwordx4 v[192:195], v3, s[16:19], s32 offen offset:1024
    v_mfma_f32_32x32x16_bf16 v[32:47], v[84:87], a[20:23], v[32:47]
    ds_read_b128 a[4:7], v5 offset:8192
    v_lshlrev_b32 v90, 16, v174
    v_mul_f32_dpp v101, v112, v174 row_newbcast:5 row_mask:0xf bank_mask:0xf
    v_lshlrev_b32 v91, 16, v175
    v_mul_f32_dpp v103, v112, v175 row_newbcast:7 row_mask:0xf bank_mask:0xf
    s_waitcnt lgkmcnt(2)
    v_mfma_f32_32x32x16_bf16 v[48:63], v[84:87], a[24:27], v[48:63]
    ds_read_b128 a[8:11], v6 offset:8192
    v_mul_f32_dpp v96, v112, v88 row_newbcast:0 row_mask:0xf bank_mask:0xf
    v_mul_f32_dpp v98, v112, v89 row_newbcast:2 row_mask:0xf bank_mask:0xf
    v_mul_f32_dpp v100, v112, v90 row_newbcast:4 row_mask:0xf bank_mask:0xf
    v_mul_f32_dpp v102, v112, v91 row_newbcast:6 row_mask:0xf bank_mask:0xf
    buffer_load_dwordx4 v3, s[16:19], s31 offen offset:1024 lds
    v_mfma_f32_32x32x16_bf16 v[64:79], v[84:87], a[28:31], v[64:79]
    buffer_load_dwordx4 v[196:199], v3, s[16:19], s32 offen offset:2048
    v_cvt_pk_bf16_f32 v80, v96, v97
    v_cvt_pk_bf16_f32 v81, v98, v99
    v_cvt_pk_bf16_f32 v82, v100, v101
    v_cvt_pk_bf16_f32 v83, v102, v103
    ds_read_b128 a[12:15], v7 offset:8192
    s_waitcnt vmcnt(5)
    s_barrier
    s_waitcnt lgkmcnt(2)
    v_mfma_f32_32x32x16_bf16 v[16:31], v[80:83], a[0:3], v[16:31]
    ds_read_b128 a[16:19], v4 offset:9216
    v_lshlrev_b32 v88, 16, v176
    v_mul_f32_dpp v97, v112, v176 row_newbcast:9 row_mask:0xf bank_mask:0xf
    v_lshlrev_b32 v89, 16, v177
    v_mul_f32_dpp v99, v112, v177 row_newbcast:11 row_mask:0xf bank_mask:0xf
    buffer_load_dwordx4 v3, s[16:19], s31 offen offset:2048 lds
    v_add_u32 v3, 3072, v3
    v_mfma_f32_32x32x16_bf16 v[32:47], v[80:83], a[4:7], v[32:47]
    ds_read_b128 a[20:23], v5 offset:9216
    v_lshlrev_b32 v90, 16, v178
    v_mul_f32_dpp v101, v112, v178 row_newbcast:13 row_mask:0xf bank_mask:0xf
    v_lshlrev_b32 v91, 16, v179
    v_mul_f32_dpp v103, v112, v179 row_newbcast:15 row_mask:0xf bank_mask:0xf
    s_waitcnt lgkmcnt(2)
    v_mfma_f32_32x32x16_bf16 v[48:63], v[80:83], a[8:11], v[48:63]
    ds_read_b128 a[24:27], v6 offset:9216
    v_mul_f32_dpp v96, v112, v88 row_newbcast:8 row_mask:0xf bank_mask:0xf
    v_mul_f32_dpp v98, v112, v89 row_newbcast:10 row_mask:0xf bank_mask:0xf
    v_mul_f32_dpp v100, v112, v90 row_newbcast:12 row_mask:0xf bank_mask:0xf
    v_mul_f32_dpp v102, v112, v91 row_newbcast:14 row_mask:0xf bank_mask:0xf
    v_mfma_f32_32x32x16_bf16 v[64:79], v[80:83], a[12:15], v[64:79]
    v_cvt_pk_bf16_f32 v84, v96, v97
    v_cvt_pk_bf16_f32 v85, v98, v99
    v_cvt_pk_bf16_f32 v86, v100, v101
    v_cvt_pk_bf16_f32 v87, v102, v103
    ds_read_b128 a[28:31], v7 offset:9216
    s_waitcnt lgkmcnt(2)
    v_mfma_f32_32x32x16_bf16 v[16:31], v[84:87], a[16:19], v[16:31]
    ds_read_b128 a[0:3], v4 offset:10240
    v_lshlrev_b32 v88, 16, v180
    v_mul_f32_dpp v97, v114, v180 row_newbcast:1 row_mask:0xf bank_mask:0xf
    v_lshlrev_b32 v89, 16, v181
    v_mul_f32_dpp v99, v114, v181 row_newbcast:3 row_mask:0xf bank_mask:0xf
    s_add_u32 m0, s30, 15360
    v_mfma_f32_32x32x16_bf16 v[32:47], v[84:87], a[20:23], v[32:47]
    ds_read_b128 a[4:7], v5 offset:10240
    v_lshlrev_b32 v90, 16, v182
    v_mul_f32_dpp v101, v114, v182 row_newbcast:5 row_mask:0xf bank_mask:0xf
    v_lshlrev_b32 v91, 16, v183
    v_mul_f32_dpp v103, v114, v183 row_newbcast:7 row_mask:0xf bank_mask:0xf
    s_waitcnt lgkmcnt(2)
    v_mfma_f32_32x32x16_bf16 v[48:63], v[84:87], a[24:27], v[48:63]
    ds_read_b128 a[8:11], v6 offset:10240
    v_mul_f32_dpp v96, v114, v88 row_newbcast:0 row_mask:0xf bank_mask:0xf
    v_mul_f32_dpp v98, v114, v89 row_newbcast:2 row_mask:0xf bank_mask:0xf
    v_mul_f32_dpp v100, v114, v90 row_newbcast:4 row_mask:0xf bank_mask:0xf
    v_mul_f32_dpp v102, v114, v91 row_newbcast:6 row_mask:0xf bank_mask:0xf
    buffer_load_dwordx4 v[200:203], v3, s[16:19], s32 offen offset:0
    v_mfma_f32_32x32x16_bf16 v[64:79], v[84:87], a[28:31], v[64:79]
    buffer_load_dwordx4 v3, s[16:19], s31 offen offset:0 lds
    v_cvt_pk_bf16_f32 v80, v96, v97
    v_cvt_pk_bf16_f32 v81, v98, v99
    v_cvt_pk_bf16_f32 v82, v100, v101
    v_cvt_pk_bf16_f32 v83, v102, v103
    ds_read_b128 a[12:15], v7 offset:10240
    s_waitcnt lgkmcnt(2)
    v_mfma_f32_32x32x16_bf16 v[16:31], v[80:83], a[0:3], v[16:31]
    ds_read_b128 a[16:19], v4 offset:11264
    v_lshlrev_b32 v88, 16, v184
    v_mul_f32_dpp v97, v114, v184 row_newbcast:9 row_mask:0xf bank_mask:0xf
    v_lshlrev_b32 v89, 16, v185
    v_mul_f32_dpp v99, v114, v185 row_newbcast:11 row_mask:0xf bank_mask:0xf
    buffer_load_dwordx4 v[204:207], v3, s[16:19], s32 offen offset:1024
    v_mfma_f32_32x32x16_bf16 v[32:47], v[80:83], a[4:7], v[32:47]
    ds_read_b128 a[20:23], v5 offset:11264
    v_lshlrev_b32 v90, 16, v186
    v_mul_f32_dpp v101, v114, v186 row_newbcast:13 row_mask:0xf bank_mask:0xf
    v_lshlrev_b32 v91, 16, v187
    v_mul_f32_dpp v103, v114, v187 row_newbcast:15 row_mask:0xf bank_mask:0xf
    s_waitcnt lgkmcnt(2)
    v_mfma_f32_32x32x16_bf16 v[48:63], v[80:83], a[8:11], v[48:63]
    ds_read_b128 a[24:27], v6 offset:11264
    v_mul_f32_dpp v96, v114, v88 row_newbcast:8 row_mask:0xf bank_mask:0xf
    v_mul_f32_dpp v98, v114, v89 row_newbcast:10 row_mask:0xf bank_mask:0xf
    v_mul_f32_dpp v100, v114, v90 row_newbcast:12 row_mask:0xf bank_mask:0xf
    v_mul_f32_dpp v102, v114, v91 row_newbcast:14 row_mask:0xf bank_mask:0xf
    buffer_load_dwordx4 v3, s[16:19], s31 offen offset:1024 lds
    v_mfma_f32_32x32x16_bf16 v[64:79], v[80:83], a[12:15], v[64:79]
    buffer_load_dwordx4 v[208:211], v3, s[16:19], s32 offen offset:2048
    v_cvt_pk_bf16_f32 v84, v96, v97
    v_cvt_pk_bf16_f32 v85, v98, v99
    v_cvt_pk_bf16_f32 v86, v100, v101
    v_cvt_pk_bf16_f32 v87, v102, v103
    ds_read_b128 a[28:31], v7 offset:11264
    s_waitcnt vmcnt(5)
    s_barrier
    s_waitcnt lgkmcnt(2)
    v_mfma_f32_32x32x16_bf16 v[16:31], v[84:87], a[16:19], v[16:31]
    ds_read_b128 a[0:3], v4 offset:12288
    v_lshlrev_b32 v88, 16, v188
    v_mul_f32_dpp v97, v116, v188 row_newbcast:1 row_mask:0xf bank_mask:0xf
    v_lshlrev_b32 v89, 16, v189
    v_mul_f32_dpp v99, v116, v189 row_newbcast:3 row_mask:0xf bank_mask:0xf
    buffer_load_dwordx4 v3, s[16:19], s31 offen offset:2048 lds
    v_add_u32 v3, 3072, v3
    v_mfma_f32_32x32x16_bf16 v[32:47], v[84:87], a[20:23], v[32:47]
    ds_read_b128 a[4:7], v5 offset:12288
    v_lshlrev_b32 v90, 16, v190
    v_mul_f32_dpp v101, v116, v190 row_newbcast:5 row_mask:0xf bank_mask:0xf
    v_lshlrev_b32 v91, 16, v191
    v_mul_f32_dpp v103, v116, v191 row_newbcast:7 row_mask:0xf bank_mask:0xf
    s_waitcnt lgkmcnt(2)
    v_mfma_f32_32x32x16_bf16 v[48:63], v[84:87], a[24:27], v[48:63]
    ds_read_b128 a[8:11], v6 offset:12288
    v_mul_f32_dpp v96, v116, v88 row_newbcast:0 row_mask:0xf bank_mask:0xf
    v_mul_f32_dpp v98, v116, v89 row_newbcast:2 row_mask:0xf bank_mask:0xf
    v_mul_f32_dpp v100, v116, v90 row_newbcast:4 row_mask:0xf bank_mask:0xf
    v_mul_f32_dpp v102, v116, v91 row_newbcast:6 row_mask:0xf bank_mask:0xf
    v_mfma_f32_32x32x16_bf16 v[64:79], v[84:87], a[28:31], v[64:79]
    v_cvt_pk_bf16_f32 v80, v96, v97
    v_cvt_pk_bf16_f32 v81, v98, v99
    v_cvt_pk_bf16_f32 v82, v100, v101
    v_cvt_pk_bf16_f32 v83, v102, v103
    ds_read_b128 a[12:15], v7 offset:12288
    s_waitcnt lgkmcnt(2)
    v_mfma_f32_32x32x16_bf16 v[16:31], v[80:83], a[0:3], v[16:31]
    ds_read_b128 a[16:19], v4 offset:13312
    v_lshlrev_b32 v88, 16, v192
    v_mul_f32_dpp v97, v116, v192 row_newbcast:9 row_mask:0xf bank_mask:0xf
    v_lshlrev_b32 v89, 16, v193
    v_mul_f32_dpp v99, v116, v193 row_newbcast:11 row_mask:0xf bank_mask:0xf
    v_mfma_f32_32x32x16_bf16 v[32:47], v[80:83], a[4:7], v[32:47]
    ds_read_b128 a[20:23], v5 offset:13312
    v_lshlrev_b32 v90, 16, v194
    v_mul_f32_dpp v101, v116, v194 row_newbcast:13 row_mask:0xf bank_mask:0xf
    v_lshlrev_b32 v91, 16, v195
    v_mul_f32_dpp v103, v116, v195 row_newbcast:15 row_mask:0xf bank_mask:0xf
    s_waitcnt lgkmcnt(2)
    v_mfma_f32_32x32x16_bf16 v[48:63], v[80:83], a[8:11], v[48:63]
    ds_read_b128 a[24:27], v6 offset:13312
    v_mul_f32_dpp v96, v116, v88 row_newbcast:8 row_mask:0xf bank_mask:0xf
    v_mul_f32_dpp v98, v116, v89 row_newbcast:10 row_mask:0xf bank_mask:0xf
    v_mul_f32_dpp v100, v116, v90 row_newbcast:12 row_mask:0xf bank_mask:0xf
    v_mul_f32_dpp v102, v116, v91 row_newbcast:14 row_mask:0xf bank_mask:0xf
    v_mfma_f32_32x32x16_bf16 v[64:79], v[80:83], a[12:15], v[64:79]
    v_cvt_pk_bf16_f32 v84, v96, v97
    v_cvt_pk_bf16_f32 v85, v98, v99
    v_cvt_pk_bf16_f32 v86, v100, v101
    v_cvt_pk_bf16_f32 v87, v102, v103
    ds_read_b128 a[28:31], v7 offset:13312
    s_waitcnt lgkmcnt(2)
    v_mfma_f32_32x32x16_bf16 v[16:31], v[84:87], a[16:19], v[16:31]
    ds_read_b128 a[0:3], v4 offset:14336
    v_lshlrev_b32 v88, 16, v196
    v_mul_f32_dpp v97, v118, v196 row_newbcast:1 row_mask:0xf bank_mask:0xf
    v_lshlrev_b32 v89, 16, v197
    v_mul_f32_dpp v99, v118, v197 row_newbcast:3 row_mask:0xf bank_mask:0xf
    v_mfma_f32_32x32x16_bf16 v[32:47], v[84:87], a[20:23], v[32:47]
    ds_read_b128 a[4:7], v5 offset:14336
    v_lshlrev_b32 v90, 16, v198
    v_mul_f32_dpp v101, v118, v198 row_newbcast:5 row_mask:0xf bank_mask:0xf
    v_lshlrev_b32 v91, 16, v199
    v_mul_f32_dpp v103, v118, v199 row_newbcast:7 row_mask:0xf bank_mask:0xf
    s_waitcnt lgkmcnt(2)
    v_mfma_f32_32x32x16_bf16 v[48:63], v[84:87], a[24:27], v[48:63]
    ds_read_b128 a[8:11], v6 offset:14336
    v_mul_f32_dpp v96, v118, v88 row_newbcast:0 row_mask:0xf bank_mask:0xf
    v_mul_f32_dpp v98, v118, v89 row_newbcast:2 row_mask:0xf bank_mask:0xf
    v_mul_f32_dpp v100, v118, v90 row_newbcast:4 row_mask:0xf bank_mask:0xf
    v_mul_f32_dpp v102, v118, v91 row_newbcast:6 row_mask:0xf bank_mask:0xf
    v_mfma_f32_32x32x16_bf16 v[64:79], v[84:87], a[28:31], v[64:79]
    v_cvt_pk_bf16_f32 v80, v96, v97
    v_cvt_pk_bf16_f32 v81, v98, v99
    v_cvt_pk_bf16_f32 v82, v100, v101
    v_cvt_pk_bf16_f32 v83, v102, v103
    ds_read_b128 a[12:15], v7 offset:14336
    s_waitcnt vmcnt(0)
    s_barrier
    s_waitcnt lgkmcnt(2)
    v_mfma_f32_32x32x16_bf16 v[16:31], v[80:83], a[0:3], v[16:31]
    ds_read_b128 a[16:19], v4 offset:15360
    v_lshlrev_b32 v88, 16, v200
    v_mul_f32_dpp v97, v118, v200 row_newbcast:9 row_mask:0xf bank_mask:0xf
    v_lshlrev_b32 v89, 16, v201
    v_mul_f32_dpp v99, v118, v201 row_newbcast:11 row_mask:0xf bank_mask:0xf
    v_mfma_f32_32x32x16_bf16 v[32:47], v[80:83], a[4:7], v[32:47]
    ds_read_b128 a[20:23], v5 offset:15360
    v_lshlrev_b32 v90, 16, v202
    v_mul_f32_dpp v101, v118, v202 row_newbcast:13 row_mask:0xf bank_mask:0xf
    v_lshlrev_b32 v91, 16, v203
    v_mul_f32_dpp v103, v118, v203 row_newbcast:15 row_mask:0xf bank_mask:0xf
    s_waitcnt lgkmcnt(2)
    v_mfma_f32_32x32x16_bf16 v[48:63], v[80:83], a[8:11], v[48:63]
    ds_read_b128 a[24:27], v6 offset:15360
    v_mul_f32_dpp v96, v118, v88 row_newbcast:8 row_mask:0xf bank_mask:0xf
    v_mul_f32_dpp v98, v118, v89 row_newbcast:10 row_mask:0xf bank_mask:0xf
    v_mul_f32_dpp v100, v118, v90 row_newbcast:12 row_mask:0xf bank_mask:0xf
    v_mul_f32_dpp v102, v118, v91 row_newbcast:14 row_mask:0xf bank_mask:0xf
    v_mfma_f32_32x32x16_bf16 v[64:79], v[80:83], a[12:15], v[64:79]
    v_cvt_pk_bf16_f32 v84, v96, v97
    v_cvt_pk_bf16_f32 v85, v98, v99
    v_cvt_pk_bf16_f32 v86, v100, v101
    v_cvt_pk_bf16_f32 v87, v102, v103
    ds_read_b128 a[28:31], v7 offset:15360
    s_waitcnt lgkmcnt(2)
    v_mfma_f32_32x32x16_bf16 v[16:31], v[84:87], a[16:19], v[16:31]
    ds_read_b128 a[0:3], v4 offset:16384
    v_lshlrev_b32 v88, 16, v204
    v_mul_f32_dpp v97, v120, v204 row_newbcast:1 row_mask:0xf bank_mask:0xf
    v_lshlrev_b32 v89, 16, v205
    v_mul_f32_dpp v99, v120, v205 row_newbcast:3 row_mask:0xf bank_mask:0xf
    v_mfma_f32_32x32x16_bf16 v[32:47], v[84:87], a[20:23], v[32:47]
    ds_read_b128 a[4:7], v5 offset:16384
    v_lshlrev_b32 v90, 16, v206
    v_mul_f32_dpp v101, v120, v206 row_newbcast:5 row_mask:0xf bank_mask:0xf
    v_lshlrev_b32 v91, 16, v207
    v_mul_f32_dpp v103, v120, v207 row_newbcast:7 row_mask:0xf bank_mask:0xf
    s_waitcnt lgkmcnt(2)
    v_mfma_f32_32x32x16_bf16 v[48:63], v[84:87], a[24:27], v[48:63]
    ds_read_b128 a[8:11], v6 offset:16384
    v_mul_f32_dpp v96, v120, v88 row_newbcast:0 row_mask:0xf bank_mask:0xf
    v_mul_f32_dpp v98, v120, v89 row_newbcast:2 row_mask:0xf bank_mask:0xf
    v_mul_f32_dpp v100, v120, v90 row_newbcast:4 row_mask:0xf bank_mask:0xf
    v_mul_f32_dpp v102, v120, v91 row_newbcast:6 row_mask:0xf bank_mask:0xf
    v_mfma_f32_32x32x16_bf16 v[64:79], v[84:87], a[28:31], v[64:79]
    v_cvt_pk_bf16_f32 v80, v96, v97
    v_cvt_pk_bf16_f32 v81, v98, v99
    v_cvt_pk_bf16_f32 v82, v100, v101
    v_cvt_pk_bf16_f32 v83, v102, v103
    ds_read_b128 a[12:15], v7 offset:16384
    s_waitcnt lgkmcnt(2)
    v_mfma_f32_32x32x16_bf16 v[16:31], v[80:83], a[0:3], v[16:31]
    ds_read_b128 a[16:19], v4 offset:17408
    v_lshlrev_b32 v88, 16, v208
    v_mul_f32_dpp v97, v120, v208 row_newbcast:9 row_mask:0xf bank_mask:0xf
    v_lshlrev_b32 v89, 16, v209
    v_mul_f32_dpp v99, v120, v209 row_newbcast:11 row_mask:0xf bank_mask:0xf
    v_mfma_f32_32x32x16_bf16 v[32:47], v[80:83], a[4:7], v[32:47]
    ds_read_b128 a[20:23], v5 offset:17408
    v_lshlrev_b32 v90, 16, v210
    v_mul_f32_dpp v101, v120, v210 row_newbcast:13 row_mask:0xf bank_mask:0xf
    v_lshlrev_b32 v91, 16, v211
    v_mul_f32_dpp v103, v120, v211 row_newbcast:15 row_mask:0xf bank_mask:0xf
    s_waitcnt lgkmcnt(2)
    v_mfma_f32_32x32x16_bf16 v[48:63], v[80:83], a[8:11], v[48:63]
    ds_read_b128 a[24:27], v6 offset:17408
    v_mul_f32_dpp v96, v120, v88 row_newbcast:8 row_mask:0xf bank_mask:0xf
    v_mul_f32_dpp v98, v120, v89 row_newbcast:10 row_mask:0xf bank_mask:0xf
    v_mul_f32_dpp v100, v120, v90 row_newbcast:12 row_mask:0xf bank_mask:0xf
    v_mul_f32_dpp v102, v120, v91 row_newbcast:14 row_mask:0xf bank_mask:0xf
    v_mfma_f32_32x32x16_bf16 v[64:79], v[80:83], a[12:15], v[64:79]
    v_cvt_pk_bf16_f32 v84, v96, v97
    v_cvt_pk_bf16_f32 v85, v98, v99
    v_cvt_pk_bf16_f32 v86, v100, v101
    v_cvt_pk_bf16_f32 v87, v102, v103
    ds_read_b128 a[28:31], v7 offset:17408
    s_waitcnt lgkmcnt(2)
    v_mfma_f32_32x32x16_bf16 v[16:31], v[84:87], a[16:19], v[16:31]
    v_mfma_f32_32x32x16_bf16 v[32:47], v[84:87], a[20:23], v[32:47]
    s_waitcnt lgkmcnt(0)
    v_mfma_f32_32x32x16_bf16 v[48:63], v[84:87], a[24:27], v[48:63]
    v_mfma_f32_32x32x16_bf16 v[64:79], v[84:87], a[28:31], v[64:79]
    s_nop 10
    ds_write_b128 v9, v[48:51] offset:0
    ds_write_b128 v9, v[52:55] offset:1024
    ds_write_b128 v9, v[56:59] offset:2048
    ds_write_b128 v9, v[60:63] offset:3072
    ds_write_b128 v9, v[64:67] offset:4096
    ds_write_b128 v9, v[68:71] offset:5120
    ds_write_b128 v9, v[72:75] offset:6144
    ds_write_b128 v9, v[76:79] offset:7168
    s_waitcnt lgkmcnt(0)
    s_barrier
    ds_read_b128 v[48:51], v10 offset:0
    ds_read_b128 v[52:55], v10 offset:1024
    ds_read_b128 v[56:59], v10 offset:2048
    ds_read_b128 v[60:63], v10 offset:3072
    ds_read_b128 v[64:67], v10 offset:4096
    ds_read_b128 v[68:71], v10 offset:5120
    ds_read_b128 v[72:75], v10 offset:6144
    ds_read_b128 v[76:79], v10 offset:7168
    s_waitcnt lgkmcnt(7)
    v_add_f32 v16, v16, v48
    v_add_f32 v17, v17, v49
    v_add_f32 v18, v18, v50
    v_add_f32 v19, v19, v51
    s_waitcnt lgkmcnt(6)
    v_add_f32 v20, v20, v52
    v_add_f32 v21, v21, v53
    v_add_f32 v22, v22, v54
    v_add_f32 v23, v23, v55
    s_waitcnt lgkmcnt(5)
    v_add_f32 v24, v24, v56
    v_add_f32 v25, v25, v57
    v_add_f32 v26, v26, v58
    v_add_f32 v27, v27, v59
    s_waitcnt lgkmcnt(4)
    v_add_f32 v28, v28, v60
    v_add_f32 v29, v29, v61
    v_add_f32 v30, v30, v62
    v_add_f32 v31, v31, v63
    s_waitcnt lgkmcnt(3)
    v_add_f32 v32, v32, v64
    v_add_f32 v33, v33, v65
    v_add_f32 v34, v34, v66
    v_add_f32 v35, v35, v67
    s_waitcnt lgkmcnt(2)
    v_add_f32 v36, v36, v68
    v_add_f32 v37, v37, v69
    v_add_f32 v38, v38, v70
    v_add_f32 v39, v39, v71
    s_waitcnt lgkmcnt(1)
    v_add_f32 v40, v40, v72
    v_add_f32 v41, v41, v73
    v_add_f32 v42, v42, v74
    v_add_f32 v43, v43, v75
    s_waitcnt lgkmcnt(0)
    v_add_f32 v44, v44, v76
    v_add_f32 v45, v45, v77
    v_add_f32 v46, v46, v78
    v_add_f32 v47, v47, v79
    s_cmp_ge_u32 s9, 54
    s_cbranch_scc1 K2_END
    v_and_b32 v9, 31, v1
    s_sub_u32 s10, s9, 36
    s_lshl_b32 s10, s10, 5
    v_add_u32 v9, s10, v9
    v_lshrrev_b32 v10, 5, v1
    v_mul_u32_u24 v10, 288, v10
    s_mul_i32 s11, s8, 1152
    s_add_u32 s11, s11, 0xb00000
    v_add_u32 v11, 0, v9
    v_mul_u32_u24 v12, 3641, v11
    v_lshrrev_b32 v12, 16, v12
    v_mul_u32_u24 v13, 18, v12
    v_sub_u32 v13, v11, v13
    v_mul_u32_u24 v12, 73728, v12
    v_lshl_add_u32 v12, v13, 4, v12
    v_add_u32 v148, v12, v10
    v_cvt_pk_bf16_f32 v140, v16, v17
    v_cvt_pk_bf16_f32 v141, v18, v19
    v_cvt_pk_bf16_f32 v142, v20, v21
    v_cvt_pk_bf16_f32 v143, v22, v23
    v_cvt_pk_bf16_f32 v144, v24, v25
    v_cvt_pk_bf16_f32 v145, v26, v27
    v_cvt_pk_bf16_f32 v146, v28, v29
    v_cvt_pk_bf16_f32 v147, v30, v31
    buffer_store_dwordx4 v[140:143], v148, s[16:19], s11 offen
    buffer_store_dwordx4 v[144:147], v148, s[16:19], s11 offen offset:576
    v_add_u32 v11, 32, v9
    v_mul_u32_u24 v12, 3641, v11
    v_lshrrev_b32 v12, 16, v12
    v_mul_u32_u24 v13, 18, v12
    v_sub_u32 v13, v11, v13
    v_mul_u32_u24 v12, 73728, v12
    v_lshl_add_u32 v12, v13, 4, v12
    v_add_u32 v164, v12, v10
    v_cvt_pk_bf16_f32 v156, v32, v33
    v_cvt_pk_bf16_f32 v157, v34, v35
    v_cvt_pk_bf16_f32 v158, v36, v37
    v_cvt_pk_bf16_f32 v159, v38, v39
    v_cvt_pk_bf16_f32 v160, v40, v41
    v_cvt_pk_bf16_f32 v161, v42, v43
    v_cvt_pk_bf16_f32 v162, v44, v45
    v_cvt_pk_bf16_f32 v163, v46, v47
    buffer_store_dwordx4 v[156:159], v164, s[16:19], s11 offen
    buffer_store_dwordx4 v[160:163], v164, s[16:19], s11 offen offset:576
    s_branch K2_END
K2_BIAS:
    s_sub_u32 s6, s2, 224
    s_lshl_b32 s6, s6, 1
    s_add_u32 s6, s6, s13
    s_cmp_ge_u32 s6, 16
    s_cselect_b32 s7, 16, 0
    s_cmp_ge_u32 s6, 18
    s_cselect_b32 s7, 18, s7
    s_cselect_b32 s10, 1.0, 0x3eae1a93
    s_add_u32 s6, s6, s7
    s_mul_i32 s31, s6, 36864
    s_mul_i32 s7, s12, 9216
    s_add_u32 s31, s31, s7
    s_add_u32 s31, s31, 0x400000
    s_mul_i32 s32, s12, 576
    s_add_u32 s32, s32, 0
    v_lshrrev_b32 v9, 5, v1
    v_lshlrev_b32 v9, 5, v9
    buffer_load_dwordx4 v[140:143], v3, s[16:19], s31 offen offset:0
    buffer_load_dwordx4 v[32:35], v9, s[16:19], s32 offen offset:0
    buffer_load_dwordx4 v[36:39], v9, s[16:19], s32 offen offset:16
    buffer_load_dwordx4 v[144:147], v3, s[16:19], s31 offen offset:1024
    buffer_load_dwordx4 v[40:43], v9, s[16:19], s32 offen offset:64
    buffer_load_dwordx4 v[44:47], v9, s[16:19], s32 offen offset:80
    buffer_load_dwordx4 v[148:151], v3, s[16:19], s31 offen offset:2048
    buffer_load_dwordx4 v[48:51], v9, s[16:19], s32 offen offset:128
    buffer_load_dwordx4 v[52:55], v9, s[16:19], s32 offen offset:144
    buffer_load_dwordx4 v[152:155], v3, s[16:19], s31 offen offset:3072
    buffer_load_dwordx4 v[56:59], v9, s[16:19], s32 offen offset:192
    buffer_load_dwordx4 v[60:63], v9, s[16:19], s32 offen offset:208
    v_add_u32 v3, 4096, v3
    buffer_load_dwordx4 v[156:159], v3, s[16:19], s31 offen offset:0
    buffer_load_dwordx4 v[64:67], v9, s[16:19], s32 offen offset:256
    buffer_load_dwordx4 v[68:71], v9, s[16:19], s32 offen offset:272
    buffer_load_dwordx4 v[160:163], v3, s[16:19], s31 offen offset:1024
    buffer_load_dwordx4 v[72:75], v9, s[16:19], s32 offen offset:320
    buffer_load_dwordx4 v[76:79], v9, s[16:19], s32 offen offset:336
    buffer_load_dwordx4 v[164:167], v3, s[16:19], s31 offen offset:2048
    buffer_load_dwordx4 v[80:83], v9, s[16:19], s32 offen offset:384
    buffer_load_dwordx4 v[84:87], v9, s[16:19], s32 offen offset:400
    buffer_load_dwordx4 v[168:171], v3, s[16:19], s31 offen offset:3072
    buffer_load_dwordx4 v[88:91], v9, s[16:19], s32 offen offset:448
    buffer_load_dwordx4 v[92:95], v9, s[16:19], s32 offen offset:464
    v_add_u32 v3, 4096, v3
    buffer_load_dwordx4 v[172:175], v3, s[16:19], s31 offen offset:0
    buffer_load_dwordx4 v[96:99], v9, s[16:19], s32 offen offset:512
    buffer_load_dwordx4 v[100:103], v9, s[16:19], s32 offen offset:528
    s_mov_b32 s36, 0x07060302
    s_waitcnt vmcnt(24)
    v_perm_b32 v32, v33, v32, s36
    v_perm_b32 v33, v35, v34, s36
    v_perm_b32 v34, v37, v36, s36
    v_perm_b32 v35, v39, v38, s36
    s_nop 1
    v_mfma_f32_32x32x16_bf16 v[16:31], v[32:35], v[140:143], 0
    s_waitcnt vmcnt(21)
    v_perm_b32 v40, v41, v40, s36
    v_perm_b32 v41, v43, v42, s36
    v_perm_b32 v42, v45, v44, s36
    v_perm_b32 v43, v47, v46, s36
    s_nop 1
    v_mfma_f32_32x32x16_bf16 v[16:31], v[40:43], v[144:147], v[16:31]
    s_waitcnt vmcnt(18)
    v_perm_b32 v48, v49, v48, s36
    v_perm_b32 v49, v51, v50, s36
    v_perm_b32 v50, v53, v52, s36
    v_perm_b32 v51, v55, v54, s36
    s_nop 1
    v_mfma_f32_32x32x16_bf16 v[16:31], v[48:51], v[148:151], v[16:31]
    s_waitcnt vmcnt(15)
    v_perm_b32 v56, v57, v56, s36
    v_perm_b32 v57, v59, v58, s36
    v_perm_b32 v58, v61, v60, s36
    v_perm_b32 v59, v63, v62, s36
    s_nop 1
    v_mfma_f32_32x32x16_bf16 v[16:31], v[56:59], v[152:155], v[16:31]
    s_waitcnt vmcnt(12)
    v_perm_b32 v64, v65, v64, s36
    v_perm_b32 v65, v67, v66, s36
    v_perm_b32 v66, v69, v68, s36
    v_perm_b32 v67, v71, v70, s36
    s_nop 1
    v_mfma_f32_32x32x16_bf16 v[16:31], v[64:67], v[156:159], v[16:31]
    s_waitcnt vmcnt(9)
    v_perm_b32 v72, v73, v72, s36
    v_perm_b32 v73, v75, v74, s36
    v_perm_b32 v74, v77, v76, s36
    v_perm_b32 v75, v79, v78, s36
    s_nop 1
    v_mfma_f32_32x32x16_bf16 v[16:31], v[72:75], v[160:163], v[16:31]
    s_waitcnt vmcnt(6)
    v_perm_b32 v80, v81, v80, s36
    v_perm_b32 v81, v83, v82, s36
    v_perm_b32 v82, v85, v84, s36
    v_perm_b32 v83, v87, v86, s36
    s_nop 1
    v_mfma_f32_32x32x16_bf16 v[16:31], v[80:83], v[164:167], v[16:31]
    s_waitcnt vmcnt(3)
    v_perm_b32 v88, v89, v88, s36
    v_perm_b32 v89, v91, v90, s36
    v_perm_b32 v90, v93, v92, s36
    v_perm_b32 v91, v95, v94, s36
    s_nop 1
    v_mfma_f32_32x32x16_bf16 v[16:31], v[88:91], v[168:171], v[16:31]
    s_waitcnt vmcnt(0)
    v_perm_b32 v96, v97, v96, s36
    v_perm_b32 v97, v99, v98, s36
    v_perm_b32 v98, v101, v100, s36
    v_perm_b32 v99, v103, v102, s36
    s_nop 1
    v_mfma_f32_32x32x16_bf16 v[16:31], v[96:99], v[172:175], v[16:31]
    v_lshlrev_b32 v9, 2, v0
    s_nop 10
    ds_write_b32 v9, v16
    s_waitcnt lgkmcnt(0)
    s_barrier
    s_cmp_lg_u32 s12, 0
    s_cbranch_scc1 K2_END
    ds_read2st64_b32 v[10:11], v9 offset0:0 offset1:1
    ds_read2st64_b32 v[12:13], v9 offset0:2 offset1:3
    s_lshl_b32 s6, s6, 7
    s_add_u32 s6, s6, 28672
    v_lshlrev_b32 v9, 2, v1
    s_waitcnt lgkmcnt(0)
    v_add_f32 v10, v10, v11
    v_add_f32 v12, v12, v13
    v_add_f32 v10, v10, v12
    v_mul_f32 v10, s10, v10
    s_mov_b32 exec_hi, 0
    buffer_store_dword v10, v9, s[16:19], s6 offen
K2_END:
K2_EXIT:
    s_endpgm
k2_kernel_end:
.globl k3_kernel
.p2align 8
.type k3_kernel,@function
k3_kernel:
    s_cmp_ge_u32 s2, 256
    s_cbranch_scc1 K3_EXIT
    s_load_dwordx2 s[4:5], s[0:1], 88
    v_lshrrev_b32 v1, 6, v0
    s_nop 0
    v_readfirstlane_b32 s3, v1
    v_and_b32 v4, 63, v0
    v_lshlrev_b32 v1, 4, v4
    s_and_b32 s6, s2, 7
    s_lshl_b32 s6, s6, 2
    s_bfe_u32 s7, s2, 0x20003
    s_add_u32 s6, s6, s7
    s_lshr_b32 s7, s2, 5
    v_mov_b32 v8, 0
    v_mov_b32 v9, 0
    ds_write_b64 v8, v[8:9]
    s_cmp_ge_u32 s3, 8
    s_cbranch_scc1 K3_SIDE
    s_setprio 3
    s_and_b32 s8, s3, 3
    s_lshl_b32 s9, s7, 3
    s_lshl_b32 s8, s8, 1
    s_add_u32 s8, s8, s9
    s_lshr_b32 s9, s3, 2
    s_lshl_b32 s10, s6, 16
    s_lshl_b32 s11, s8, 10
    s_add_u32 s11, s11, s10
    s_add_u32 s11, s11, 0x600000
    s_lshl_b32 s12, s6, 13
    s_lshl_b32 s13, s8, 7
    s_add_u32 s13, s13, s12
    s_add_u32 s13, s13, 0xa00000
    s_add_u32 s28, s10, 0x800000
    s_add_u32 s29, s12, 0xa40000
    s_lshl_b32 s23, s6, 8
    s_add_u32 s23, s23, 0x9000
    s_mov_b32 s27, 0xb000
    s_lshl_b32 s20, s9, 15
    s_add_u32 s20, s20, s28
    s_lshl_b32 s21, s9, 12
    s_add_u32 s21, s21, s29
    s_mul_i32 s22, s6, 73728
    s_mul_i32 s14, s9, 36864
    s_add_u32 s22, s22, s14
    s_add_u32 s22, s22, 0xb00000
    s_mov_b32 s24, 0x3ffff
    s_mov_b32 s25, 0x3ffff
    v_lshlrev_b32 v5, 2, v4
    v_and_b32 v6, 31, v4
    v_lshlrev_b32 v2, 2, v6
    v_lshrrev_b32 v7, 5, v4
    v_mul_u32_u24 v3, 18, v7
    v_add_u32 v3, v3, v6
    v_lshlrev_b32 v3, 4, v3
    v_mov_b32 v18, 0x3f803f80
    v_cmp_eq_u32 vcc, 18, v6
    v_mov_b32 v137, v18
    v_mov_b32 v143, v18
    v_mov_b32 v17, 0
    v_cndmask_b32 v18, 0, v18, vcc
    v_mov_b32 v144, v18
    v_mov_b32 v145, v18
    v_mov_b32 v146, v18
    v_mov_b32 v147, v18
    v_mov_b32 v148, v18
    v_mov_b32 v149, v18
    v_mov_b32 v150, v18
    v_mov_b32 v151, v18
    v_mov_b32 v152, v18
    v_mov_b32 v153, v18
    v_mov_b32 v154, v18
    v_mov_b32 v155, v18
    v_mov_b32 v156, v18
    v_mov_b32 v157, v18
    v_mov_b32 v158, v18
    v_mov_b32 v159, v18
    s_waitcnt lgkmcnt(0)
    s_barrier
    s_mov_b32 s16, s4
    s_mov_b32 s17, s5
    s_mov_b32 s18, 0x5000000
    s_mov_b32 s19, 0x00020000
    v_lshlrev_b32 v19, 4, v7
    s_lshl_b32 s14, s6, 6
    s_add_u32 s14, s14, 28672
    s_lshl_b32 s15, s6, 3
    s_add_u32 s15, s15, 32768
    buffer_load_dwordx2 v[60:61], off, s[16:19], s15
    buffer_load_dwordx4 v[52:55], v19, s[16:19], s14 offen
    buffer_load_dwordx4 v[56:59], v19, s[16:19], s14 offen offset:32
    buffer_load_dword v16, v5, s[16:19], s13 offen
    buffer_load_dword v136, v2, s[16:19], s21 offen
    buffer_load_dwordx4 v[8:11], v1, s[16:19], s11 offen
    buffer_load_dwordx4 v[12:15], v1, s[16:19], s11 offen offset:1024
    buffer_load_dwordx4 v[132:135], v1, s[16:19], s20 offen
    buffer_load_dword v84, v5, s[16:19], s23 offen
    buffer_load_dword v85, v5, s[16:19], s27 offen
    buffer_load_dword v142, v2, s[16:19], s21 offen offset:128
    buffer_load_dwordx4 v[138:141], v1, s[16:19], s20 offen offset:1024
    s_mov_b64 exec, s[24:25]
    buffer_load_dwordx4 v[144:147], v3, s[16:19], s22 offen
    buffer_load_dwordx4 v[148:151], v3, s[16:19], s22 offen offset:576
    s_mov_b64 exec, -1
    v_mov_b32 v100, 0
    v_mov_b32 v101, 0
    v_mov_b32 v102, 0
    v_mov_b32 v103, 0
    v_mov_b32 v104, 0
    v_mov_b32 v105, 0
    v_mov_b32 v106, 0
    v_mov_b32 v107, 0
    v_mov_b32 v108, 0
    v_mov_b32 v109, 0
    v_mov_b32 v110, 0
    v_mov_b32 v111, 0
    v_mov_b32 v112, 0
    v_mov_b32 v113, 0
    v_mov_b32 v114, 0
    v_mov_b32 v115, 0
    v_mov_b32 v116, 0
    v_mov_b32 v117, 0
    v_mov_b32 v118, 0
    v_mov_b32 v119, 0
    v_mov_b32 v120, 0
    v_mov_b32 v121, 0
    v_mov_b32 v122, 0
    v_mov_b32 v123, 0
    v_mov_b32 v124, 0
    v_mov_b32 v125, 0
    v_mov_b32 v126, 0
    v_mov_b32 v127, 0
    v_mov_b32 v128, 0
    v_mov_b32 v129, 0
    v_mov_b32 v130, 0
    v_mov_b32 v131, 0
    s_waitcnt vmcnt(9)
    v_lshlrev_b32 v62, 16, v16
    v_and_b32 v63, 0xffff0000, v16
    v_add_f32 v62, v62, v60
    v_add_f32 v63, v63, v61
    v_cvt_pk_bf16_f32 v16, v62, v63
    s_nop 1
    v_mfma_f32_32x32x4_2b_bf16 v[20:51], v[136:137], v[16:17], 0
    s_waitcnt vmcnt(7)
    v_lshlrev_b32 v64, 16, v8
    v_lshlrev_b32 v66, 16, v9
    v_lshlrev_b32 v68, 16, v10
    v_lshlrev_b32 v70, 16, v11
    v_lshlrev_b32 v72, 16, v12
    v_lshlrev_b32 v74, 16, v13
    v_lshlrev_b32 v76, 16, v14
    v_lshlrev_b32 v78, 16, v15
    v_and_b32 v65, 0xffff0000, v8
    v_and_b32 v67, 0xffff0000, v9
    v_and_b32 v69, 0xffff0000, v10
    v_and_b32 v71, 0xffff0000, v11
    v_and_b32 v73, 0xffff0000, v12
    v_and_b32 v75, 0xffff0000, v13
    v_and_b32 v77, 0xffff0000, v14
    v_and_b32 v79, 0xffff0000, v15
    v_add_f32 v64, v64, v52
    v_add_f32 v66, v66, v54
    v_add_f32 v68, v68, v56
    v_add_f32 v70, v70, v58
    v_add_f32 v72, v72, v52
    v_add_f32 v74, v74, v54
    v_add_f32 v76, v76, v56
    v_add_f32 v78, v78, v58
    v_add_f32 v65, v65, v53
    v_add_f32 v67, v67, v55
    v_add_f32 v69, v69, v57
    v_add_f32 v71, v71, v59
    v_add_f32 v73, v73, v53
    v_add_f32 v75, v75, v55
    v_add_f32 v77, v77, v57
    v_add_f32 v79, v79, v59
    v_cvt_pk_bf16_f32 v8, v64, v65
    v_cvt_pk_bf16_f32 v9, v66, v67
    v_cvt_pk_bf16_f32 v10, v68, v69
    v_cvt_pk_bf16_f32 v11, v70, v71
    v_cvt_pk_bf16_f32 v12, v72, v73
    v_cvt_pk_bf16_f32 v13, v74, v75
    v_cvt_pk_bf16_f32 v14, v76, v77
    v_cvt_pk_bf16_f32 v15, v78, v79
    s_waitcnt vmcnt(4)
    v_dot2_f32_bf16 v86, v8, v8, 0
    v_dot2_f32_bf16 v87, v12, v12, 0
    v_dot2_f32_bf16 v86, v9, v9, v86
    v_dot2_f32_bf16 v87, v13, v13, v87
    v_dot2_f32_bf16 v86, v10, v10, v86
    v_dot2_f32_bf16 v87, v14, v14, v87
    v_dot2_f32_bf16 v86, v11, v11, v86
    v_dot2_f32_bf16 v87, v15, v15, v87
    v_dot2_f32_bf16 v88, v16, v16, 0
    v_max_f32_dpp v84, v84, v84 quad_perm:[1,0,3,2] row_mask:0xf bank_mask:0xf
    v_max_f32_dpp v85, v85, v85 quad_perm:[1,0,3,2] row_mask:0xf bank_mask:0xf
    s_nop 0
    v_max_f32_dpp v84, v84, v84 quad_perm:[2,3,0,1] row_mask:0xf bank_mask:0xf
    v_max_f32_dpp v85, v85, v85 quad_perm:[2,3,0,1] row_mask:0xf bank_mask:0xf
    s_nop 0
    v_max_f32_dpp v84, v84, v84 row_half_mirror row_mask:0xf bank_mask:0xf
    v_max_f32_dpp v85, v85, v85 row_half_mirror row_mask:0xf bank_mask:0xf
    s_nop 0
    v_max_f32_dpp v84, v84, v84 row_mirror row_mask:0xf bank_mask:0xf
    v_max_f32_dpp v85, v85, v85 row_mirror row_mask:0xf bank_mask:0xf
    v_mov_b32 v89, v84
    v_mov_b32 v90, v85
    s_nop 0
    v_permlane16_swap_b32 v84, v89
    v_permlane16_swap_b32 v85, v90
    v_max_f32 v84, v84, v89
    v_max_f32 v85, v85, v90
    v_mfma_f32_32x32x16_bf16 v[20:35], v[132:135], v[8:11], v[20:35]
    v_mfma_f32_32x32x16_bf16 v[36:51], v[132:135], v[12:15], v[36:51]
    v_mov_b32 v89, v84
    v_mov_b32 v90, v85
    v_permlane32_swap_b32 v86, v87
    v_permlane32_swap_b32 v84, v89
    v_permlane32_swap_b32 v85, v90
    v_max_f32 v84, v84, v89
    v_max_f32 v85, v85, v90
    v_add_f32 v86, v86, v87
    v_mul_f32 v86, v86, v84
    v_mul_f32 v88, v88, v85
    v_sqrt_f32 v86, v86
    v_sqrt_f32 v88, v88
    s_nop 0
    v_add_f32 v86, v86, v88
    v_mov_b32 v87, 0x426b4b4b
    v_cmp_nle_f32 vcc, v86, v87
    s_cbranch_vccz K3_FAST
    s_nop 15
    v_mov_b32 v57, 0x3f803f80
    v_mov_b32 v86, 0xff7fffff
    v_mov_b32 v87, 0xff7fffff
    s_mov_b32 s26, 64
K3_MAXL:
    buffer_load_dwordx4 v[52:55], v1, s[16:19], s28 offen
    buffer_load_dword v56, v2, s[16:19], s29 offen
    s_add_u32 s28, s28, 1024
    s_add_u32 s29, s29, 128
    s_waitcnt vmcnt(0)
    v_mfma_f32_32x32x4_2b_bf16 v[20:51], v[56:57], v[16:17], 0
    s_nop 15
    s_nop 1
    v_mfma_f32_32x32x16_bf16 v[20:35], v[52:55], v[8:11], v[20:35]
    v_mfma_f32_32x32x16_bf16 v[36:51], v[52:55], v[12:15], v[36:51]
    s_nop 10
    v_max3_f32 v86, v20, v21, v86
    v_max3_f32 v86, v22, v23, v86
    v_max3_f32 v86, v24, v25, v86
    v_max3_f32 v86, v26, v27, v86
    v_max3_f32 v86, v28, v29, v86
    v_max3_f32 v86, v30, v31, v86
    v_max3_f32 v86, v32, v33, v86
    v_max3_f32 v86, v34, v35, v86
    v_max3_f32 v87, v36, v37, v87
    v_max3_f32 v87, v38, v39, v87
    v_max3_f32 v87, v40, v41, v87
    v_max3_f32 v87, v42, v43, v87
    v_max3_f32 v87, v44, v45, v87
    v_max3_f32 v87, v46, v47, v87
    v_max3_f32 v87, v48, v49, v87
    v_max3_f32 v87, v50, v51, v87
    s_sub_u32 s26, s26, 1
    s_cmp_lg_u32 s26, 0
    s_cbranch_scc1 K3_MAXL
    v_permlane32_swap_b32 v86, v87
    v_max_f32 v86, v86, v87
    v_sub_f32 v86, 0, v86
    v_cvt_pk_bf16_f32 v87, v86, v86
    v_and_b32 v87, 0xffff0000, v87
    v_sub_f32 v88, v86, v87
    v_cvt_pk_bf16_f32 v17, v87, v88
    s_nop 1
    v_mfma_f32_32x32x4_2b_bf16 v[20:51], v[136:137], v[16:17], 0
    s_nop 15
    s_nop 1
    v_mfma_f32_32x32x16_bf16 v[20:35], v[132:135], v[8:11], v[20:35]
    v_mfma_f32_32x32x16_bf16 v[36:51], v[132:135], v[12:15], v[36:51]
K3_FAST:
    v_mov_b32 v19, v1
    s_lshl_b32 s10, s9, 15
    v_add_u32 v1, s10, v1
    s_lshl_b32 s10, s9, 12
    s_add_u32 s10, s10, 65536
    v_add_u32 v2, s10, v2
    s_mul_i32 s10, s9, 36864
    s_add_u32 s10, s10, 73728
    v_add_u32 v3, s10, v3
    s_mov_b32 s26, 0
    v_mov_b32 v5, 0
    s_cmp_eq_u32 s9, 0
    s_cselect_b32 s31, 99, 6
    v_mov_b32 v96, 0
    v_mov_b32 v97, 0
    v_mov_b32 v98, 0
    v_mov_b32 v82, 0
    v_mov_b32 v83, 0
    s_cmp_eq_u32 s9, 0
    s_cbranch_scc1 K3_P1
    s_setprio 2
    s_branch K3_P2
K3_P1:
    s_setprio 1
K3_P2:
    s_waitcnt vmcnt(0)
K3_LOOP:
    v_exp_f32 v20, v20
    v_cvt_pk_bf16_f32 v99, v82, v83
    v_exp_f32 v21, v21
    v_exp_f32 v22, v22
    v_mfma_f32_32x32x16_bf16 v[116:131], v[156:159], v[96:99], v[116:131]
    v_cvt_pk_bf16_f32 v84, v20, v21
    v_exp_f32 v23, v23
    s_waitcnt lgkmcnt(0)
    v_exp_f32 v24, v24
    v_cvt_pk_bf16_f32 v85, v22, v23
    v_mfma_f32_32x32x4_2b_bf16 v[52:83], v[142:143], v[16:17], 0
    v_exp_f32 v25, v25
    s_cmp_gt_u32 s26, 1
    v_exp_f32 v26, v26
    v_cvt_pk_bf16_f32 v86, v24, v25
    s_cbranch_scc1 K3_NA
K3_WA:
    ds_read_b32 v18, v5
    s_waitcnt lgkmcnt(0)
    v_readfirstlane_b32 s30, v18
    s_nop 0
    s_cmp_lt_u32 s30, 4
    s_cbranch_scc1 K3_WA
    v_mov_b32 v5, 4
K3_NA:
    v_exp_f32 v27, v27
    ds_read_b128 v[132:135], v1 offset:2048
    v_exp_f32 v28, v28
    v_cvt_pk_bf16_f32 v87, v26, v27
    v_exp_f32 v29, v29
    ds_read_b32 v136, v2 offset:256
    v_exp_f32 v30, v30
    v_cvt_pk_bf16_f32 v88, v28, v29
    v_mfma_f32_32x32x16_bf16 v[100:115], v[144:147], v[84:87], v[100:115]
    v_exp_f32 v31, v31
    v_exp_f32 v32, v32
    v_cvt_pk_bf16_f32 v89, v30, v31
    v_exp_f32 v33, v33
    v_exp_f32 v34, v34
    v_cvt_pk_bf16_f32 v90, v32, v33
    s_mov_b64 exec, s[24:25]
    ds_read_b128 v[152:155], v3 offset:1152
    ds_read_b128 v[156:159], v3 offset:1728
    s_mov_b64 exec, -1
    v_exp_f32 v35, v35
    v_exp_f32 v36, v36
    v_cvt_pk_bf16_f32 v91, v34, v35
    v_exp_f32 v37, v37
    v_exp_f32 v38, v38
    v_cvt_pk_bf16_f32 v92, v36, v37
    v_mfma_f32_32x32x16_bf16 v[100:115], v[148:151], v[88:91], v[100:115]
    v_exp_f32 v39, v39
    v_exp_f32 v40, v40
    v_cvt_pk_bf16_f32 v93, v38, v39
    v_exp_f32 v41, v41
    v_exp_f32 v42, v42
    v_cvt_pk_bf16_f32 v94, v40, v41
    v_mfma_f32_32x32x16_bf16 v[52:67], v[138:141], v[8:11], v[52:67]
    v_exp_f32 v43, v43
    v_exp_f32 v44, v44
    v_cvt_pk_bf16_f32 v95, v42, v43
    v_exp_f32 v45, v45
    v_exp_f32 v46, v46
    v_cvt_pk_bf16_f32 v96, v44, v45
    v_mfma_f32_32x32x16_bf16 v[116:131], v[144:147], v[92:95], v[116:131]
    v_exp_f32 v47, v47
    v_exp_f32 v48, v48
    v_cvt_pk_bf16_f32 v97, v46, v47
    v_exp_f32 v49, v49
    v_mfma_f32_32x32x16_bf16 v[68:83], v[138:141], v[12:15], v[68:83]
    v_exp_f32 v50, v50
    v_cvt_pk_bf16_f32 v98, v48, v49
    v_exp_f32 v51, v51
    v_exp_f32 v52, v52
    v_cvt_pk_bf16_f32 v99, v50, v51
    v_exp_f32 v53, v53
    v_exp_f32 v54, v54
    v_mfma_f32_32x32x16_bf16 v[116:131], v[148:151], v[96:99], v[116:131]
    v_cvt_pk_bf16_f32 v84, v52, v53
    v_exp_f32 v55, v55
    s_waitcnt lgkmcnt(0)
    v_exp_f32 v56, v56
    v_cvt_pk_bf16_f32 v85, v54, v55
    v_mfma_f32_32x32x4_2b_bf16 v[20:51], v[136:137], v[16:17], 0
    v_exp_f32 v57, v57
    v_exp_f32 v58, v58
    v_cvt_pk_bf16_f32 v86, v56, v57
    v_exp_f32 v59, v59
    ds_read_b128 v[138:141], v1 offset:3072
    v_exp_f32 v60, v60
    v_cvt_pk_bf16_f32 v87, v58, v59
    v_exp_f32 v61, v61
    ds_read_b32 v142, v2 offset:384
    v_exp_f32 v62, v62
    v_cvt_pk_bf16_f32 v88, v60, v61
    v_mfma_f32_32x32x16_bf16 v[100:115], v[152:155], v[84:87], v[100:115]
    v_exp_f32 v63, v63
    v_exp_f32 v64, v64
    v_cvt_pk_bf16_f32 v89, v62, v63
    v_exp_f32 v65, v65
    v_exp_f32 v66, v66
    v_cvt_pk_bf16_f32 v90, v64, v65
    s_mov_b64 exec, s[24:25]
    ds_read_b128 v[144:147], v3 offset:2304
    ds_read_b128 v[148:151], v3 offset:2880
    s_mov_b64 exec, -1
    v_exp_f32 v67, v67
    v_exp_f32 v68, v68
    v_cvt_pk_bf16_f32 v91, v66, v67
    v_exp_f32 v69, v69
    v_exp_f32 v70, v70
    v_cvt_pk_bf16_f32 v92, v68, v69
    v_mfma_f32_32x32x16_bf16 v[100:115], v[156:159], v[88:91], v[100:115]
    v_exp_f32 v71, v71
    v_exp_f32 v72, v72
    v_cvt_pk_bf16_f32 v93, v70, v71
    v_exp_f32 v73, v73
    v_exp_f32 v74, v74
    v_cvt_pk_bf16_f32 v94, v72, v73
    v_mfma_f32_32x32x16_bf16 v[20:35], v[132:135], v[8:11], v[20:35]
    v_exp_f32 v75, v75
    v_exp_f32 v76, v76
    v_cvt_pk_bf16_f32 v95, v74, v75
    s_cmp_lg_u32 s26, s31
    v_exp_f32 v77, v77
    s_cbranch_scc1 K3_NP
    s_setprio 0
K3_NP:
    v_exp_f32 v78, v78
    v_cvt_pk_bf16_f32 v96, v76, v77
    v_mfma_f32_32x32x16_bf16 v[116:131], v[152:155], v[92:95], v[116:131]
    v_exp_f32 v79, v79
    v_exp_f32 v80, v80
    v_cvt_pk_bf16_f32 v97, v78, v79
    v_exp_f32 v81, v81
    v_mfma_f32_32x32x16_bf16 v[36:51], v[132:135], v[12:15], v[36:51]
    v_exp_f32 v82, v82
    v_cvt_pk_bf16_f32 v98, v80, v81
    v_exp_f32 v83, v83
    v_exp_f32 v20, v20
    v_cvt_pk_bf16_f32 v99, v82, v83
    v_exp_f32 v21, v21
    v_exp_f32 v22, v22
    v_mfma_f32_32x32x16_bf16 v[116:131], v[156:159], v[96:99], v[116:131]
    v_cvt_pk_bf16_f32 v84, v20, v21
    v_exp_f32 v23, v23
    s_waitcnt lgkmcnt(0)
    v_exp_f32 v24, v24
    v_cvt_pk_bf16_f32 v85, v22, v23
    v_mfma_f32_32x32x4_2b_bf16 v[52:83], v[142:143], v[16:17], 0
    v_exp_f32 v25, v25
    v_exp_f32 v26, v26
    v_cvt_pk_bf16_f32 v86, v24, v25
    v_exp_f32 v27, v27
    ds_read_b128 v[132:135], v1 offset:4096
    v_exp_f32 v28, v28
    v_cvt_pk_bf16_f32 v87, v26, v27
    v_exp_f32 v29, v29
    ds_read_b32 v136, v2 offset:512
    v_exp_f32 v30, v30
    v_cvt_pk_bf16_f32 v88, v28, v29
    v_mfma_f32_32x32x16_bf16 v[100:115], v[144:147], v[84:87], v[100:115]
    v_exp_f32 v31, v31
    v_exp_f32 v32, v32
    v_cvt_pk_bf16_f32 v89, v30, v31
    v_exp_f32 v33, v33
    v_exp_f32 v34, v34
    v_cvt_pk_bf16_f32 v90, v32, v33
    s_mov_b64 exec, s[24:25]
    ds_read_b128 v[152:155], v3 offset:3456
    ds_read_b128 v[156:159], v3 offset:4032
    s_mov_b64 exec, -1
    v_exp_f32 v35, v35
    v_exp_f32 v36, v36
    v_cvt_pk_bf16_f32 v91, v34, v35
    v_exp_f32 v37, v37
    v_exp_f32 v38, v38
    v_cvt_pk_bf16_f32 v92, v36, v37
    v_mfma_f32_32x32x16_bf16 v[100:115], v[148:151], v[88:91], v[100:115]
    v_exp_f32 v39, v39
    v_exp_f32 v40, v40
    v_cvt_pk_bf16_f32 v93, v38, v39
    v_exp_f32 v41, v41
    v_exp_f32 v42, v42
    v_cvt_pk_bf16_f32 v94, v40, v41
    v_mfma_f32_32x32x16_bf16 v[52:67], v[138:141], v[8:11], v[52:67]
    v_exp_f32 v43, v43
    v_exp_f32 v44, v44
    v_cvt_pk_bf16_f32 v95, v42, v43
    v_exp_f32 v45, v45
    v_exp_f32 v46, v46
    v_cvt_pk_bf16_f32 v96, v44, v45
    v_mfma_f32_32x32x16_bf16 v[116:131], v[144:147], v[92:95], v[116:131]
    v_exp_f32 v47, v47
    v_exp_f32 v48, v48
    v_cvt_pk_bf16_f32 v97, v46, v47
    v_exp_f32 v49, v49
    v_mfma_f32_32x32x16_bf16 v[68:83], v[138:141], v[12:15], v[68:83]
    v_exp_f32 v50, v50
    v_cvt_pk_bf16_f32 v98, v48, v49
    v_exp_f32 v51, v51
    v_exp_f32 v52, v52
    v_cvt_pk_bf16_f32 v99, v50, v51
    v_exp_f32 v53, v53
    v_exp_f32 v54, v54
    v_mfma_f32_32x32x16_bf16 v[116:131], v[148:151], v[96:99], v[116:131]
    v_cvt_pk_bf16_f32 v84, v52, v53
    v_exp_f32 v55, v55
    s_waitcnt lgkmcnt(0)
    v_exp_f32 v56, v56
    v_cvt_pk_bf16_f32 v85, v54, v55
    v_mfma_f32_32x32x4_2b_bf16 v[20:51], v[136:137], v[16:17], 0
    v_exp_f32 v57, v57
    v_exp_f32 v58, v58
    v_cvt_pk_bf16_f32 v86, v56, v57
    v_exp_f32 v59, v59
    ds_read_b128 v[138:141], v1 offset:5120
    v_exp_f32 v60, v60
    v_cvt_pk_bf16_f32 v87, v58, v59
    v_exp_f32 v61, v61
    ds_read_b32 v142, v2 offset:640
    v_exp_f32 v62, v62
    v_cvt_pk_bf16_f32 v88, v60, v61
    v_mfma_f32_32x32x16_bf16 v[100:115], v[152:155], v[84:87], v[100:115]
    v_exp_f32 v63, v63
    v_exp_f32 v64, v64
    v_cvt_pk_bf16_f32 v89, v62, v63
    v_exp_f32 v65, v65
    v_exp_f32 v66, v66
    v_cvt_pk_bf16_f32 v90, v64, v65
    s_mov_b64 exec, s[24:25]
    ds_read_b128 v[144:147], v3 offset:4608
    ds_read_b128 v[148:151], v3 offset:5184
    s_mov_b64 exec, -1
    v_exp_f32 v67, v67
    v_exp_f32 v68, v68
    v_cvt_pk_bf16_f32 v91, v66, v67
    v_exp_f32 v69, v69
    v_add_u32 v1, 4096, v1
    v_exp_f32 v70, v70
    v_cvt_pk_bf16_f32 v92, v68, v69
    v_mfma_f32_32x32x16_bf16 v[100:115], v[156:159], v[88:91], v[100:115]
    v_exp_f32 v71, v71
    v_add_u32 v2, 512, v2
    v_exp_f32 v72, v72
    v_cvt_pk_bf16_f32 v93, v70, v71
    v_exp_f32 v73, v73
    v_add_u32 v3, 4608, v3
    v_exp_f32 v74, v74
    v_cvt_pk_bf16_f32 v94, v72, v73
    v_mfma_f32_32x32x16_bf16 v[20:35], v[132:135], v[8:11], v[20:35]
    v_exp_f32 v75, v75
    v_exp_f32 v76, v76
    v_cvt_pk_bf16_f32 v95, v74, v75
    v_exp_f32 v77, v77
    v_exp_f32 v78, v78
    v_cvt_pk_bf16_f32 v96, v76, v77
    v_mfma_f32_32x32x16_bf16 v[116:131], v[152:155], v[92:95], v[116:131]
    v_exp_f32 v79, v79
    v_exp_f32 v80, v80
    v_cvt_pk_bf16_f32 v97, v78, v79
    v_exp_f32 v81, v81
    v_mfma_f32_32x32x16_bf16 v[36:51], v[132:135], v[12:15], v[36:51]
    v_exp_f32 v82, v82
    v_cvt_pk_bf16_f32 v98, v80, v81
    v_exp_f32 v83, v83
    s_add_u32 s26, s26, 1
    s_cmp_lg_u32 s26, 8
    s_cbranch_scc1 K3_LOOP
    v_cvt_pk_bf16_f32 v99, v82, v83
    v_mov_b32 v1, v19
    s_nop 0
    v_mfma_f32_32x32x16_bf16 v[116:131], v[156:159], v[96:99], v[116:131]
    s_waitcnt lgkmcnt(0)
    s_barrier
    s_mul_i32 s10, s3, 3072
    s_xor_b32 s11, s3, 4
    s_mul_i32 s11, s11, 3072
    v_add_u32 v5, s10, v1
    v_add_u32 v6, s11, v1
    s_cmp_eq_u32 s9, 0
    s_cbranch_scc1 K3_M0
    ds_write_b128 v5, v[100:103] offset:0
    ds_write_b128 v5, v[104:107] offset:1024
    ds_write_b128 v5, v[108:111] offset:2048
    v_mov_b32 v100, v116
    v_mov_b32 v101, v117
    v_mov_b32 v102, v118
    v_mov_b32 v103, v119
    v_mov_b32 v104, v120
    v_mov_b32 v105, v121
    v_mov_b32 v106, v122
    v_mov_b32 v107, v123
    v_mov_b32 v108, v124
    v_mov_b32 v109, v125
    v_mov_b32 v110, v126
    s_branch K3_M1
K3_M0:
    s_nop 2
    ds_write_b128 v5, v[116:119] offset:0
    ds_write_b128 v5, v[120:123] offset:1024
    ds_write_b128 v5, v[124:127] offset:2048
K3_M1:
    s_waitcnt lgkmcnt(0)
    s_barrier
    ds_read_b128 v[20:23], v6 offset:0
    ds_read_b128 v[24:27], v6 offset:1024
    ds_read_b128 v[28:31], v6 offset:2048
    s_mul_i32 s14, s6, 72
    s_add_u32 s14, s14, 33280
    v_lshlrev_b32 v7, 4, v7
    buffer_load_dwordx4 v[32:35], v7, s[16:19], s14 offen
    buffer_load_dwordx4 v[36:39], v7, s[16:19], s14 offen offset:32
    buffer_load_dwordx2 v[40:41], off, s[16:19], s14 offset:64
    s_add_u32 s8, s8, s9
    s_mul_i32 s10, s8, 36864
    s_add_u32 s10, s10, 0xe00000
    s_lshl_b32 s11, s6, 10
    s_add_u32 s11, s11, s10
    s_lshr_b32 s12, s6, 3
    s_add_u32 s12, s12, 32
    s_lshl_b32 s12, s12, 10
    s_add_u32 s12, s12, s10
    s_bfe_u32 s13, s6, 0x10002
    s_lshl_b32 s13, s13, 9
    s_add_u32 s12, s12, s13
    s_and_b32 s13, s6, 3
    s_lshl_b32 s13, s13, 2
    s_add_u32 s12, s12, s13
    s_waitcnt lgkmcnt(0)
    v_add_f32 v110, v110, v30
    v_add_f32 v100, v100, v20
    v_add_f32 v101, v101, v21
    v_add_f32 v102, v102, v22
    v_add_f32 v103, v103, v23
    v_add_f32 v104, v104, v24
    v_add_f32 v105, v105, v25
    v_add_f32 v106, v106, v26
    v_add_f32 v107, v107, v27
    v_add_f32 v108, v108, v28
    v_add_f32 v109, v109, v29
    v_mov_b32 v52, v110
    s_nop 1
    v_permlane32_swap_b32 v110, v52
    v_rcp_f32 v52, v110
    s_waitcnt vmcnt(0)
    v_fma_f32 v100, v100, v52, v32
    v_fma_f32 v101, v101, v52, v33
    v_fma_f32 v102, v102, v52, v34
    v_fma_f32 v103, v103, v52, v35
    v_fma_f32 v104, v104, v52, v36
    v_fma_f32 v105, v105, v52, v37
    v_fma_f32 v106, v106, v52, v38
    v_fma_f32 v107, v107, v52, v39
    v_fma_f32 v108, v108, v52, v40
    v_fma_f32 v109, v109, v52, v41
    v_cvt_pk_bf16_f32 v84, v100, v101
    v_cvt_pk_bf16_f32 v85, v102, v103
    v_cvt_pk_bf16_f32 v86, v104, v105
    v_cvt_pk_bf16_f32 v87, v106, v107
    v_cvt_pk_bf16_f32 v88, v108, v109
    buffer_store_dwordx4 v[84:87], v1, s[16:19], s11 offen
    s_mov_b32 exec_hi, 0
    buffer_store_dword v88, v1, s[16:19], s12 offen
    s_branch K3_END
K3_SIDE:
    s_waitcnt lgkmcnt(0)
    s_barrier
    s_mov_b32 s16, s4
    s_mov_b32 s17, s5
    s_mov_b32 s18, 0x5000000
    s_mov_b32 s19, 0x00020000
    v_mov_b32 v5, 0
    v_mov_b32 v6, 1
    s_sub_u32 s20, s3, 8
    s_lshl_b32 s10, s6, 16
    s_add_u32 s10, s10, 0x800000
    s_lshl_b32 s11, s6, 13
    s_add_u32 s11, s11, 0xa40000
    s_mul_i32 s12, s6, 73728
    s_add_u32 s12, s12, 0xb00000
    s_cmp_lg_u32 s20, 0
    s_cbranch_scc1 K3_LD1
    s_mov_b32 m0, 65536
    s_add_u32 s13, s11, 0
    buffer_load_dwordx4 v1, s[16:19], s13 offen lds
    s_mov_b32 m0, 2048
    s_add_u32 s13, s10, 2048
    buffer_load_dwordx4 v1, s[16:19], s13 offen lds
    s_mov_b32 m0, 3072
    s_add_u32 s13, s10, 3072
    buffer_load_dwordx4 v1, s[16:19], s13 offen lds
    s_mov_b32 m0, 4096
    s_add_u32 s13, s10, 4096
    buffer_load_dwordx4 v1, s[16:19], s13 offen lds
    s_mov_b32 m0, 5120
    s_add_u32 s13, s10, 5120
    buffer_load_dwordx4 v1, s[16:19], s13 offen lds
    s_mov_b32 m0, 6144
    s_add_u32 s13, s10, 6144
    buffer_load_dwordx4 v1, s[16:19], s13 offen lds
    s_mov_b32 m0, 7168
    s_add_u32 s13, s10, 7168
    buffer_load_dwordx4 v1, s[16:19], s13 offen lds
    s_mov_b32 m0, 66560
    s_add_u32 s13, s11, 1024
    buffer_load_dwordx4 v1, s[16:19], s13 offen lds
    s_mov_b32 m0, 81920
    s_add_u32 s13, s12, 8192
    buffer_load_dwordx4 v1, s[16:19], s13 offen lds
    s_mov_b32 m0, 82944
    s_add_u32 s13, s12, 9216
    buffer_load_dwordx4 v1, s[16:19], s13 offen lds
    s_mov_b32 m0, 10240
    s_add_u32 s13, s10, 10240
    buffer_load_dwordx4 v1, s[16:19], s13 offen lds
    s_waitcnt vmcnt(6)
    s_mov_b64 exec, 1
    ds_add_u32 v5, v6 offset:0
    s_mov_b64 exec, -1
    s_mov_b32 m0, 11264
    s_add_u32 s13, s10, 11264
    buffer_load_dwordx4 v1, s[16:19], s13 offen lds
    s_mov_b32 m0, 12288
    s_add_u32 s13, s10, 12288
    buffer_load_dwordx4 v1, s[16:19], s13 offen lds
    s_mov_b32 m0, 13312
    s_add_u32 s13, s10, 13312
    buffer_load_dwordx4 v1, s[16:19], s13 offen lds
    s_mov_b32 m0, 14336
    s_add_u32 s13, s10, 14336
    buffer_load_dwordx4 v1, s[16:19], s13 offen lds
    s_mov_b32 m0, 15360
    s_add_u32 s13, s10, 15360
    buffer_load_dwordx4 v1, s[16:19], s13 offen lds
    s_mov_b32 m0, 67584
    s_add_u32 s13, s11, 2048
    buffer_load_dwordx4 v1, s[16:19], s13 offen lds
    s_mov_b32 m0, 91136
    s_add_u32 s13, s12, 17408
    buffer_load_dwordx4 v1, s[16:19], s13 offen lds
    s_mov_b32 m0, 92160
    s_add_u32 s13, s12, 18432
    buffer_load_dwordx4 v1, s[16:19], s13 offen lds
    s_mov_b32 m0, 18432
    s_add_u32 s13, s10, 18432
    buffer_load_dwordx4 v1, s[16:19], s13 offen lds
    s_mov_b32 m0, 19456
    s_add_u32 s13, s10, 19456
    buffer_load_dwordx4 v1, s[16:19], s13 offen lds
    s_mov_b32 m0, 20480
    s_add_u32 s13, s10, 20480
    buffer_load_dwordx4 v1, s[16:19], s13 offen lds
    s_mov_b32 m0, 21504
    s_add_u32 s13, s10, 21504
    buffer_load_dwordx4 v1, s[16:19], s13 offen lds
    s_mov_b32 m0, 22528
    s_add_u32 s13, s10, 22528
    buffer_load_dwordx4 v1, s[16:19], s13 offen lds
    s_mov_b32 m0, 23552
    s_add_u32 s13, s10, 23552
    buffer_load_dwordx4 v1, s[16:19], s13 offen lds
    s_mov_b32 m0, 68608
    s_add_u32 s13, s11, 3072
    buffer_load_dwordx4 v1, s[16:19], s13 offen lds
    s_mov_b32 m0, 100352
    s_add_u32 s13, s12, 26624
    buffer_load_dwordx4 v1, s[16:19], s13 offen lds
    s_mov_b32 m0, 101376
    s_add_u32 s13, s12, 27648
    buffer_load_dwordx4 v1, s[16:19], s13 offen lds
    s_mov_b32 m0, 26624
    s_add_u32 s13, s10, 26624
    buffer_load_dwordx4 v1, s[16:19], s13 offen lds
    s_mov_b32 m0, 27648
    s_add_u32 s13, s10, 27648
    buffer_load_dwordx4 v1, s[16:19], s13 offen lds
    s_mov_b32 m0, 28672
    s_add_u32 s13, s10, 28672
    buffer_load_dwordx4 v1, s[16:19], s13 offen lds
    s_mov_b32 m0, 29696
    s_add_u32 s13, s10, 29696
    buffer_load_dwordx4 v1, s[16:19], s13 offen lds
    s_mov_b32 m0, 30720
    s_add_u32 s13, s10, 30720
    buffer_load_dwordx4 v1, s[16:19], s13 offen lds
    s_mov_b32 m0, 31744
    s_add_u32 s13, s10, 31744
    buffer_load_dwordx4 v1, s[16:19], s13 offen lds
    s_mov_b32 m0, 109568
    s_add_u32 s13, s12, 35840
    buffer_load_dwordx4 v1, s[16:19], s13 offen lds
    s_branch K3_LD4
K3_LD1:
    s_cmp_lg_u32 s20, 1
    s_cbranch_scc1 K3_LD2
    s_mov_b32 m0, 69632
    s_add_u32 s13, s11, 4096
    buffer_load_dwordx4 v1, s[16:19], s13 offen lds
    s_mov_b32 m0, 34816
    s_add_u32 s13, s10, 34816
    buffer_load_dwordx4 v1, s[16:19], s13 offen lds
    s_mov_b32 m0, 35840
    s_add_u32 s13, s10, 35840
    buffer_load_dwordx4 v1, s[16:19], s13 offen lds
    s_mov_b32 m0, 36864
    s_add_u32 s13, s10, 36864
    buffer_load_dwordx4 v1, s[16:19], s13 offen lds
    s_mov_b32 m0, 37888
    s_add_u32 s13, s10, 37888
    buffer_load_dwordx4 v1, s[16:19], s13 offen lds
    s_mov_b32 m0, 38912
    s_add_u32 s13, s10, 38912
    buffer_load_dwordx4 v1, s[16:19], s13 offen lds
    s_mov_b32 m0, 39936
    s_add_u32 s13, s10, 39936
    buffer_load_dwordx4 v1, s[16:19], s13 offen lds
    s_mov_b32 m0, 70656
    s_add_u32 s13, s11, 5120
    buffer_load_dwordx4 v1, s[16:19], s13 offen lds
    s_mov_b32 m0, 118784
    s_add_u32 s13, s12, 45056
    buffer_load_dwordx4 v1, s[16:19], s13 offen lds
    s_mov_b32 m0, 83968
    s_add_u32 s13, s12, 10240
    buffer_load_dwordx4 v1, s[16:19], s13 offen lds
    s_mov_b32 m0, 43008
    s_add_u32 s13, s10, 43008
    buffer_load_dwordx4 v1, s[16:19], s13 offen lds
    s_waitcnt vmcnt(6)
    s_mov_b64 exec, 1
    ds_add_u32 v5, v6 offset:0
    s_mov_b64 exec, -1
    s_mov_b32 m0, 44032
    s_add_u32 s13, s10, 44032
    buffer_load_dwordx4 v1, s[16:19], s13 offen lds
    s_mov_b32 m0, 45056
    s_add_u32 s13, s10, 45056
    buffer_load_dwordx4 v1, s[16:19], s13 offen lds
    s_mov_b32 m0, 46080
    s_add_u32 s13, s10, 46080
    buffer_load_dwordx4 v1, s[16:19], s13 offen lds
    s_mov_b32 m0, 47104
    s_add_u32 s13, s10, 47104
    buffer_load_dwordx4 v1, s[16:19], s13 offen lds
    s_mov_b32 m0, 48128
    s_add_u32 s13, s10, 48128
    buffer_load_dwordx4 v1, s[16:19], s13 offen lds
    s_mov_b32 m0, 71680
    s_add_u32 s13, s11, 6144
    buffer_load_dwordx4 v1, s[16:19], s13 offen lds
    s_mov_b32 m0, 128000
    s_add_u32 s13, s12, 54272
    buffer_load_dwordx4 v1, s[16:19], s13 offen lds
    s_mov_b32 m0, 93184
    s_add_u32 s13, s12, 19456
    buffer_load_dwordx4 v1, s[16:19], s13 offen lds
    s_mov_b32 m0, 51200
    s_add_u32 s13, s10, 51200
    buffer_load_dwordx4 v1, s[16:19], s13 offen lds
    s_mov_b32 m0, 52224
    s_add_u32 s13, s10, 52224
    buffer_load_dwordx4 v1, s[16:19], s13 offen lds
    s_mov_b32 m0, 53248
    s_add_u32 s13, s10, 53248
    buffer_load_dwordx4 v1, s[16:19], s13 offen lds
    s_mov_b32 m0, 54272
    s_add_u32 s13, s10, 54272
    buffer_load_dwordx4 v1, s[16:19], s13 offen lds
    s_mov_b32 m0, 55296
    s_add_u32 s13, s10, 55296
    buffer_load_dwordx4 v1, s[16:19], s13 offen lds
    s_mov_b32 m0, 56320
    s_add_u32 s13, s10, 56320
    buffer_load_dwordx4 v1, s[16:19], s13 offen lds
    s_mov_b32 m0, 72704
    s_add_u32 s13, s11, 7168
    buffer_load_dwordx4 v1, s[16:19], s13 offen lds
    s_mov_b32 m0, 137216
    s_add_u32 s13, s12, 63488
    buffer_load_dwordx4 v1, s[16:19], s13 offen lds
    s_mov_b32 m0, 102400
    s_add_u32 s13, s12, 28672
    buffer_load_dwordx4 v1, s[16:19], s13 offen lds
    s_mov_b32 m0, 59392
    s_add_u32 s13, s10, 59392
    buffer_load_dwordx4 v1, s[16:19], s13 offen lds
    s_mov_b32 m0, 60416
    s_add_u32 s13, s10, 60416
    buffer_load_dwordx4 v1, s[16:19], s13 offen lds
    s_mov_b32 m0, 61440
    s_add_u32 s13, s10, 61440
    buffer_load_dwordx4 v1, s[16:19], s13 offen lds
    s_mov_b32 m0, 62464
    s_add_u32 s13, s10, 62464
    buffer_load_dwordx4 v1, s[16:19], s13 offen lds
    s_mov_b32 m0, 63488
    s_add_u32 s13, s10, 63488
    buffer_load_dwordx4 v1, s[16:19], s13 offen lds
    s_mov_b32 m0, 64512
    s_add_u32 s13, s10, 64512
    buffer_load_dwordx4 v1, s[16:19], s13 offen lds
    s_mov_b32 m0, 146432
    s_add_u32 s13, s12, 72704
    buffer_load_dwordx4 v1, s[16:19], s13 offen lds
    s_branch K3_LD4
K3_LD2:
    s_cmp_lg_u32 s20, 2
    s_cbranch_scc1 K3_LD3
    s_mov_b32 m0, 74752
    s_add_u32 s13, s12, 1024
    buffer_load_dwordx4 v1, s[16:19], s13 offen lds
    s_mov_b32 m0, 75776
    s_add_u32 s13, s12, 2048
    buffer_load_dwordx4 v1, s[16:19], s13 offen lds
    s_mov_b32 m0, 76800
    s_add_u32 s13, s12, 3072
    buffer_load_dwordx4 v1, s[16:19], s13 offen lds
    s_mov_b32 m0, 77824
    s_add_u32 s13, s12, 4096
    buffer_load_dwordx4 v1, s[16:19], s13 offen lds
    s_mov_b32 m0, 78848
    s_add_u32 s13, s12, 5120
    buffer_load_dwordx4 v1, s[16:19], s13 offen lds
    s_mov_b32 m0, 79872
    s_add_u32 s13, s12, 6144
    buffer_load_dwordx4 v1, s[16:19], s13 offen lds
    s_mov_b32 m0, 80896
    s_add_u32 s13, s12, 7168
    buffer_load_dwordx4 v1, s[16:19], s13 offen lds
    s_mov_b32 m0, 8192
    s_add_u32 s13, s10, 8192
    buffer_load_dwordx4 v1, s[16:19], s13 offen lds
    s_mov_b32 m0, 9216
    s_add_u32 s13, s10, 9216
    buffer_load_dwordx4 v1, s[16:19], s13 offen lds
    s_mov_b32 m0, 119808
    s_add_u32 s13, s12, 46080
    buffer_load_dwordx4 v1, s[16:19], s13 offen lds
    s_mov_b32 m0, 84992
    s_add_u32 s13, s12, 11264
    buffer_load_dwordx4 v1, s[16:19], s13 offen lds
    s_waitcnt vmcnt(6)
    s_mov_b64 exec, 1
    ds_add_u32 v5, v6 offset:0
    s_mov_b64 exec, -1
    s_mov_b32 m0, 86016
    s_add_u32 s13, s12, 12288
    buffer_load_dwordx4 v1, s[16:19], s13 offen lds
    s_mov_b32 m0, 87040
    s_add_u32 s13, s12, 13312
    buffer_load_dwordx4 v1, s[16:19], s13 offen lds
    s_mov_b32 m0, 88064
    s_add_u32 s13, s12, 14336
    buffer_load_dwordx4 v1, s[16:19], s13 offen lds
    s_mov_b32 m0, 89088
    s_add_u32 s13, s12, 15360
    buffer_load_dwordx4 v1, s[16:19], s13 offen lds
    s_mov_b32 m0, 90112
    s_add_u32 s13, s12, 16384
    buffer_load_dwordx4 v1, s[16:19], s13 offen lds
    s_mov_b32 m0, 16384
    s_add_u32 s13, s10, 16384
    buffer_load_dwordx4 v1, s[16:19], s13 offen lds
    s_mov_b32 m0, 17408
    s_add_u32 s13, s10, 17408
    buffer_load_dwordx4 v1, s[16:19], s13 offen lds
    s_mov_b32 m0, 129024
    s_add_u32 s13, s12, 55296
    buffer_load_dwordx4 v1, s[16:19], s13 offen lds
    s_mov_b32 m0, 94208
    s_add_u32 s13, s12, 20480
    buffer_load_dwordx4 v1, s[16:19], s13 offen lds
    s_mov_b32 m0, 95232
    s_add_u32 s13, s12, 21504
    buffer_load_dwordx4 v1, s[16:19], s13 offen lds
    s_mov_b32 m0, 96256
    s_add_u32 s13, s12, 22528
    buffer_load_dwordx4 v1, s[16:19], s13 offen lds
    s_mov_b32 m0, 97280
    s_add_u32 s13, s12, 23552
    buffer_load_dwordx4 v1, s[16:19], s13 offen lds
    s_mov_b32 m0, 98304
    s_add_u32 s13, s12, 24576
    buffer_load_dwordx4 v1, s[16:19], s13 offen lds
    s_mov_b32 m0, 99328
    s_add_u32 s13, s12, 25600
    buffer_load_dwordx4 v1, s[16:19], s13 offen lds
    s_mov_b32 m0, 24576
    s_add_u32 s13, s10, 24576
    buffer_load_dwordx4 v1, s[16:19], s13 offen lds
    s_mov_b32 m0, 25600
    s_add_u32 s13, s10, 25600
    buffer_load_dwordx4 v1, s[16:19], s13 offen lds
    s_mov_b32 m0, 138240
    s_add_u32 s13, s12, 64512
    buffer_load_dwordx4 v1, s[16:19], s13 offen lds
    s_mov_b32 m0, 103424
    s_add_u32 s13, s12, 29696
    buffer_load_dwordx4 v1, s[16:19], s13 offen lds
    s_mov_b32 m0, 104448
    s_add_u32 s13, s12, 30720
    buffer_load_dwordx4 v1, s[16:19], s13 offen lds
    s_mov_b32 m0, 105472
    s_add_u32 s13, s12, 31744
    buffer_load_dwordx4 v1, s[16:19], s13 offen lds
    s_mov_b32 m0, 106496
    s_add_u32 s13, s12, 32768
    buffer_load_dwordx4 v1, s[16:19], s13 offen lds
    s_mov_b32 m0, 107520
    s_add_u32 s13, s12, 33792
    buffer_load_dwordx4 v1, s[16:19], s13 offen lds
    s_mov_b32 m0, 108544
    s_add_u32 s13, s12, 34816
    buffer_load_dwordx4 v1, s[16:19], s13 offen lds
    s_mov_b32 m0, 109568
    s_add_u32 s13, s12, 35840
    buffer_load_dwordx4 v1, s[16:19], s13 offen lds
    s_branch K3_LD4
K3_LD3:
    s_mov_b32 m0, 111616
    s_add_u32 s13, s12, 37888
    buffer_load_dwordx4 v1, s[16:19], s13 offen lds
    s_mov_b32 m0, 112640
    s_add_u32 s13, s12, 38912
    buffer_load_dwordx4 v1, s[16:19], s13 offen lds
    s_mov_b32 m0, 113664
    s_add_u32 s13, s12, 39936
    buffer_load_dwordx4 v1, s[16:19], s13 offen lds
    s_mov_b32 m0, 114688
    s_add_u32 s13, s12, 40960
    buffer_load_dwordx4 v1, s[16:19], s13 offen lds
    s_mov_b32 m0, 115712
    s_add_u32 s13, s12, 41984
    buffer_load_dwordx4 v1, s[16:19], s13 offen lds
    s_mov_b32 m0, 116736
    s_add_u32 s13, s12, 43008
    buffer_load_dwordx4 v1, s[16:19], s13 offen lds
    s_mov_b32 m0, 117760
    s_add_u32 s13, s12, 44032
    buffer_load_dwordx4 v1, s[16:19], s13 offen lds
    s_mov_b32 m0, 40960
    s_add_u32 s13, s10, 40960
    buffer_load_dwordx4 v1, s[16:19], s13 offen lds
    s_mov_b32 m0, 41984
    s_add_u32 s13, s10, 41984
    buffer_load_dwordx4 v1, s[16:19], s13 offen lds
    s_mov_b32 m0, 120832
    s_add_u32 s13, s12, 47104
    buffer_load_dwordx4 v1, s[16:19], s13 offen lds
    s_mov_b32 m0, 121856
    s_add_u32 s13, s12, 48128
    buffer_load_dwordx4 v1, s[16:19], s13 offen lds
    s_waitcnt vmcnt(6)
    s_mov_b64 exec, 1
    ds_add_u32 v5, v6 offset:0
    s_mov_b64 exec, -1
    s_mov_b32 m0, 122880
    s_add_u32 s13, s12, 49152
    buffer_load_dwordx4 v1, s[16:19], s13 offen lds
    s_mov_b32 m0, 123904
    s_add_u32 s13, s12, 50176
    buffer_load_dwordx4 v1, s[16:19], s13 offen lds
    s_mov_b32 m0, 124928
    s_add_u32 s13, s12, 51200
    buffer_load_dwordx4 v1, s[16:19], s13 offen lds
    s_mov_b32 m0, 125952
    s_add_u32 s13, s12, 52224
    buffer_load_dwordx4 v1, s[16:19], s13 offen lds
    s_mov_b32 m0, 126976
    s_add_u32 s13, s12, 53248
    buffer_load_dwordx4 v1, s[16:19], s13 offen lds
    s_mov_b32 m0, 49152
    s_add_u32 s13, s10, 49152
    buffer_load_dwordx4 v1, s[16:19], s13 offen lds
    s_mov_b32 m0, 50176
    s_add_u32 s13, s10, 50176
    buffer_load_dwordx4 v1, s[16:19], s13 offen lds
    s_mov_b32 m0, 130048
    s_add_u32 s13, s12, 56320
    buffer_load_dwordx4 v1, s[16:19], s13 offen lds
    s_mov_b32 m0, 131072
    s_add_u32 s13, s12, 57344
    buffer_load_dwordx4 v1, s[16:19], s13 offen lds
    s_mov_b32 m0, 132096
    s_add_u32 s13, s12, 58368
    buffer_load_dwordx4 v1, s[16:19], s13 offen lds
    s_mov_b32 m0, 133120
    s_add_u32 s13, s12, 59392
    buffer_load_dwordx4 v1, s[16:19], s13 offen lds
    s_mov_b32 m0, 134144
    s_add_u32 s13, s12, 60416
    buffer_load_dwordx4 v1, s[16:19], s13 offen lds
    s_mov_b32 m0, 135168
    s_add_u32 s13, s12, 61440
    buffer_load_dwordx4 v1, s[16:19], s13 offen lds
    s_mov_b32 m0, 136192
    s_add_u32 s13, s12, 62464
    buffer_load_dwordx4 v1, s[16:19], s13 offen lds
    s_mov_b32 m0, 57344
    s_add_u32 s13, s10, 57344
    buffer_load_dwordx4 v1, s[16:19], s13 offen lds
    s_mov_b32 m0, 58368
    s_add_u32 s13, s10, 58368
    buffer_load_dwordx4 v1, s[16:19], s13 offen lds
    s_mov_b32 m0, 139264
    s_add_u32 s13, s12, 65536
    buffer_load_dwordx4 v1, s[16:19], s13 offen lds
    s_mov_b32 m0, 140288
    s_add_u32 s13, s12, 66560
    buffer_load_dwordx4 v1, s[16:19], s13 offen lds
    s_mov_b32 m0, 141312
    s_add_u32 s13, s12, 67584
    buffer_load_dwordx4 v1, s[16:19], s13 offen lds
    s_mov_b32 m0, 142336
    s_add_u32 s13, s12, 68608
    buffer_load_dwordx4 v1, s[16:19], s13 offen lds
    s_mov_b32 m0, 143360
    s_add_u32 s13, s12, 69632
    buffer_load_dwordx4 v1, s[16:19], s13 offen lds
    s_mov_b32 m0, 144384
    s_add_u32 s13, s12, 70656
    buffer_load_dwordx4 v1, s[16:19], s13 offen lds
    s_mov_b32 m0, 145408
    s_add_u32 s13, s12, 71680
    buffer_load_dwordx4 v1, s[16:19], s13 offen lds
    s_mov_b32 m0, 146432
    s_add_u32 s13, s12, 72704
    buffer_load_dwordx4 v1, s[16:19], s13 offen lds
K3_LD4:
    s_waitcnt vmcnt(0)
    s_mov_b64 exec, 1
    ds_add_u32 v5, v6 offset:4
    s_mov_b64 exec, -1
    s_setprio 0
    v_subrev_u32 v2, 512, v0
    s_getpc_b64 s[44:45]
PF_k4_kernel_1128:
    s_add_u32 s44, s44, k4_kernel-PF_k4_kernel_1128
    s_addc_u32 s45, s45, 0
    s_mov_b32 s46, k4_kernel_end-k4_kernel
    s_mov_b32 s47, 0x00020000
    v_lshlrev_b32 v3, 7, v2
    buffer_load_dword v159, v3, s[44:47], 0 offen
    v_add_u32 v3, 32768, v3
    buffer_load_dword v159, v3, s[44:47], 0 offen
    v_add_u32 v3, 32768, v3
    buffer_load_dword v159, v3, s[44:47], 0 offen
    s_lshl_b32 s21, s2, 2
    s_add_u32 s21, s21, s20
    s_load_dwordx2 s[8:9], s[0:1], 0
    v_and_b32 v2, 31, v4
    v_mul_u32_u24 v2, 1152, v2
    v_lshrrev_b32 v3, 5, v4
    v_lshl_add_u32 v2, v3, 3, v2
    s_waitcnt lgkmcnt(0)
    s_mov_b32 s28, s8
    s_mov_b32 s29, s9
    s_mov_b32 s30, 0x240000
    s_mov_b32 s31, 0x00020000
    s_add_u32 s22, s21, 0
    s_mul_i32 s23, s22, 1821
    s_lshr_b32 s23, s23, 16
    s_mul_i32 s24, s23, 36
    s_sub_u32 s24, s22, s24
    s_mul_i32 s23, s23, 36864
    s_lshl_b32 s24, s24, 5
    s_add_u32 s23, s23, s24
    buffer_load_dwordx2 v[12:13], v2, s[28:31], s23 offen offset:0 nt
    buffer_load_dwordx2 v[14:15], v2, s[28:31], s23 offen offset:16 nt
    s_add_u32 s22, s21, 1024
    s_mul_i32 s23, s22, 1821
    s_lshr_b32 s23, s23, 16
    s_mul_i32 s24, s23, 36
    s_sub_u32 s24, s22, s24
    s_mul_i32 s23, s23, 36864
    s_lshl_b32 s24, s24, 5
    s_add_u32 s23, s23, s24
    buffer_load_dwordx2 v[16:17], v2, s[28:31], s23 offen offset:0 nt
    buffer_load_dwordx2 v[18:19], v2, s[28:31], s23 offen offset:16 nt
    s_add_u32 s22, s21, 2048
    s_mul_i32 s23, s22, 1821
    s_lshr_b32 s23, s23, 16
    s_mul_i32 s24, s23, 36
    s_sub_u32 s24, s22, s24
    s_mul_i32 s23, s23, 36864
    s_lshl_b32 s24, s24, 5
    s_add_u32 s23, s23, s24
    buffer_load_dwordx2 v[20:21], v2, s[28:31], s23 offen offset:0 nt
    buffer_load_dwordx2 v[22:23], v2, s[28:31], s23 offen offset:16 nt
    s_lshl_b32 s22, s20, 12
    s_add_u32 s22, s22, 147456
    v_lshrrev_b32 v5, 3, v4
    v_and_b32 v6, 7, v4
    v_lshlrev_b32 v6, 4, v6
    v_bfe_u32 v7, v4, 2, 2
    v_lshlrev_b32 v7, 7, v7
    v_and_b32 v8, 3, v4
    v_lshl_add_u32 v7, v8, 3, v7
    v_add_u32 v7, s22, v7
    v_add_u32 v8, s22, v1
    v_lshrrev_b32 v9, 5, v4
    v_bfe_u32 v10, v4, 4, 1
    s_cmp_ge_u32 s21, 648
    s_cbranch_scc1 K3_SD
    s_load_dwordx4 s[8:11], s[0:1], 32
    s_mul_i32 s23, s21, 7282
    s_lshr_b32 s23, s23, 16
    s_mul_i32 s24, s23, 9
    s_sub_u32 s24, s21, s24
    v_mul_u32_u24 v11, 9216, v5
    v_add_u32 v11, v11, v6
    s_mul_i32 s25, s24, 589824
    s_lshl_b32 s26, s23, 7
    s_add_u32 s25, s25, s26
    v_and_b32 v156, 31, v4
    v_mov_b32 v157, 9216
    v_mov_b32 v158, 6912
    v_cmp_eq_u32 vcc, 1, v156
    s_nop 1
    v_cndmask_b32 v157, v157, v158, vcc
    v_mov_b32 v158, 0x7f000000
    v_cmp_lt_u32 vcc, 1, v156
    s_nop 1
    v_cndmask_b32 v157, v157, v158, vcc
    v_lshl_add_u32 v157, v9, 4, v157
    s_lshl_b32 s27, s24, 8
    buffer_load_dwordx4 v[120:123], v157, s[16:19], s27 offen offset:0
    buffer_load_dwordx4 v[124:127], v157, s[16:19], s27 offen offset:32
    buffer_load_dwordx4 v[128:131], v157, s[16:19], s27 offen offset:64
    buffer_load_dwordx4 v[132:135], v157, s[16:19], s27 offen offset:96
    buffer_load_dwordx4 v[136:139], v157, s[16:19], s27 offen offset:128
    buffer_load_dwordx4 v[140:143], v157, s[16:19], s27 offen offset:160
    buffer_load_dwordx4 v[144:147], v157, s[16:19], s27 offen offset:192
    buffer_load_dwordx4 v[148:151], v157, s[16:19], s27 offen offset:224
    s_waitcnt lgkmcnt(0)
    s_mov_b32 s28, s8
    s_mov_b32 s29, s9
    s_mov_b32 s30, 0x510000
    s_mov_b32 s31, 0x00020000
    s_mov_b32 s32, s10
    s_mov_b32 s33, s11
    s_mov_b32 s34, 0x510000
    s_mov_b32 s35, 0x00020000
    s_add_u32 s26, s25, 0
    buffer_load_dwordx4 v[24:27], v11, s[28:31], s26 offen nt
    s_add_u32 s26, s25, 73728
    buffer_load_dwordx4 v[28:31], v11, s[28:31], s26 offen nt
    s_add_u32 s26, s25, 0
    buffer_load_dwordx4 v[32:35], v11, s[32:35], s26 offen nt
    s_add_u32 s26, s25, 73728
    buffer_load_dwordx4 v[36:39], v11, s[32:35], s26 offen nt
    s_add_u32 s26, s25, 147456
    buffer_load_dwordx4 v[40:43], v11, s[28:31], s26 offen nt
    s_add_u32 s26, s25, 221184
    buffer_load_dwordx4 v[44:47], v11, s[28:31], s26 offen nt
    s_add_u32 s26, s25, 147456
    buffer_load_dwordx4 v[48:51], v11, s[32:35], s26 offen nt
    s_add_u32 s26, s25, 221184
    buffer_load_dwordx4 v[52:55], v11, s[32:35], s26 offen nt
    s_add_u32 s26, s25, 294912
    buffer_load_dwordx4 v[56:59], v11, s[28:31], s26 offen nt
    s_add_u32 s26, s25, 368640
    buffer_load_dwordx4 v[60:63], v11, s[28:31], s26 offen nt
    s_add_u32 s26, s25, 294912
    buffer_load_dwordx4 v[64:67], v11, s[32:35], s26 offen nt
    s_add_u32 s26, s25, 368640
    buffer_load_dwordx4 v[68:71], v11, s[32:35], s26 offen nt
    s_add_u32 s26, s25, 442368
    buffer_load_dwordx4 v[72:75], v11, s[28:31], s26 offen nt
    s_add_u32 s26, s25, 516096
    buffer_load_dwordx4 v[76:79], v11, s[28:31], s26 offen nt
    s_add_u32 s26, s25, 442368
    buffer_load_dwordx4 v[80:83], v11, s[32:35], s26 offen nt
    s_add_u32 s26, s25, 516096
    buffer_load_dwordx4 v[84:87], v11, s[32:35], s26 offen nt
    s_lshl_b32 s44, s2, 2
    s_add_u32 s44, s44, s20
    s_lshl_b32 s45, s44, 10
    s_add_u32 s45, s45, 0x4500000
    s_add_u32 s46, s45, 0x100000
    s_add_u32 s47, s45, 0x200000
    s_cmp_ge_u32 s44, 256
    s_cselect_b32 s47, 0x7f000000, s47
    s_waitcnt vmcnt(24)
    buffer_store_dwordx4 v[12:15], v1, s[16:19], s45 offen sc1
    buffer_store_dwordx4 v[16:19], v1, s[16:19], s46 offen sc1
    buffer_store_dwordx4 v[20:23], v1, s[16:19], s47 offen sc1
    s_waitcnt vmcnt(19)
    v_lshl_add_u32 v7, v9, 9, v7
    v_lshl_add_u32 v7, v10, 11, v7
    s_mov_b32 s36, 0x07060302
    s_lshl_b32 s26, s23, 2
    s_mul_i32 s26, s26, 36
    s_lshl_b32 s37, s24, 2
    s_add_u32 s26, s26, s37
    s_lshl_b32 s26, s26, 10
    s_add_u32 s26, s26, 0x1800000
    s_add_u32 s40, s26, 0
    s_add_u32 s41, s26, 36864
    s_add_u32 s42, s26, 73728
    s_add_u32 s43, s26, 110592
    v_perm_b32 v104, v121, v120, s36
    v_perm_b32 v105, v123, v122, s36
    v_perm_b32 v106, v125, v124, s36
    v_perm_b32 v107, v127, v126, s36
    v_perm_b32 v108, v129, v128, s36
    v_perm_b32 v109, v131, v130, s36
    v_perm_b32 v110, v133, v132, s36
    v_perm_b32 v111, v135, v134, s36
    v_perm_b32 v112, v137, v136, s36
    v_perm_b32 v113, v139, v138, s36
    v_perm_b32 v114, v141, v140, s36
    v_perm_b32 v115, v143, v142, s36
    v_perm_b32 v116, v145, v144, s36
    v_perm_b32 v117, v147, v146, s36
    v_perm_b32 v118, v149, v148, s36
    v_perm_b32 v119, v151, v150, s36
    s_waitcnt vmcnt(15)
    ds_write_b128 v8, v[24:27] offset:0
    ds_write_b128 v8, v[28:31] offset:1024
    ds_write_b128 v8, v[32:35] offset:2048
    ds_write_b128 v8, v[36:39] offset:3072
    s_waitcnt lgkmcnt(0)
    ds_read_b64_tr_b16 v[88:89], v7 offset:0
    ds_read_b64_tr_b16 v[90:91], v7 offset:1024
    ds_read_b64_tr_b16 v[92:93], v7 offset:32
    ds_read_b64_tr_b16 v[94:95], v7 offset:1056
    ds_read_b64_tr_b16 v[96:97], v7 offset:64
    ds_read_b64_tr_b16 v[98:99], v7 offset:1088
    ds_read_b64_tr_b16 v[100:101], v7 offset:96
    ds_read_b64_tr_b16 v[102:103], v7 offset:1120
    s_waitcnt lgkmcnt(0)
    buffer_store_dwordx4 v[88:91], v1, s[16:19], s40 offen offset:0 sc1
    buffer_store_dwordx4 v[92:95], v1, s[16:19], s41 offen offset:0 sc1
    buffer_store_dwordx4 v[96:99], v1, s[16:19], s42 offen offset:0 sc1
    buffer_store_dwordx4 v[100:103], v1, s[16:19], s43 offen offset:0 sc1
    s_waitcnt vmcnt(15)
    ds_write_b128 v8, v[40:43] offset:0
    ds_write_b128 v8, v[44:47] offset:1024
    ds_write_b128 v8, v[48:51] offset:2048
    ds_write_b128 v8, v[52:55] offset:3072
    s_waitcnt lgkmcnt(0)
    ds_read_b64_tr_b16 v[24:25], v7 offset:0
    ds_read_b64_tr_b16 v[26:27], v7 offset:1024
    ds_read_b64_tr_b16 v[28:29], v7 offset:32
    ds_read_b64_tr_b16 v[30:31], v7 offset:1056
    ds_read_b64_tr_b16 v[32:33], v7 offset:64
    ds_read_b64_tr_b16 v[34:35], v7 offset:1088
    ds_read_b64_tr_b16 v[36:37], v7 offset:96
    ds_read_b64_tr_b16 v[38:39], v7 offset:1120
    s_waitcnt lgkmcnt(0)
    buffer_store_dwordx4 v[24:27], v1, s[16:19], s40 offen offset:1024 sc1
    buffer_store_dwordx4 v[28:31], v1, s[16:19], s41 offen offset:1024 sc1
    buffer_store_dwordx4 v[32:35], v1, s[16:19], s42 offen offset:1024 sc1
    buffer_store_dwordx4 v[36:39], v1, s[16:19], s43 offen offset:1024 sc1
    s_waitcnt vmcnt(15)
    ds_write_b128 v8, v[56:59] offset:0
    ds_write_b128 v8, v[60:63] offset:1024
    ds_write_b128 v8, v[64:67] offset:2048
    ds_write_b128 v8, v[68:71] offset:3072
    s_waitcnt lgkmcnt(0)
    ds_read_b64_tr_b16 v[40:41], v7 offset:0
    ds_read_b64_tr_b16 v[42:43], v7 offset:1024
    ds_read_b64_tr_b16 v[44:45], v7 offset:32
    ds_read_b64_tr_b16 v[46:47], v7 offset:1056
    ds_read_b64_tr_b16 v[48:49], v7 offset:64
    ds_read_b64_tr_b16 v[50:51], v7 offset:1088
    ds_read_b64_tr_b16 v[52:53], v7 offset:96
    ds_read_b64_tr_b16 v[54:55], v7 offset:1120
    s_waitcnt lgkmcnt(0)
    buffer_store_dwordx4 v[40:43], v1, s[16:19], s40 offen offset:2048 sc1
    buffer_store_dwordx4 v[44:47], v1, s[16:19], s41 offen offset:2048 sc1
    buffer_store_dwordx4 v[48:51], v1, s[16:19], s42 offen offset:2048 sc1
    buffer_store_dwordx4 v[52:55], v1, s[16:19], s43 offen offset:2048 sc1
    s_waitcnt vmcnt(15)
    ds_write_b128 v8, v[72:75] offset:0
    ds_write_b128 v8, v[76:79] offset:1024
    ds_write_b128 v8, v[80:83] offset:2048
    ds_write_b128 v8, v[84:87] offset:3072
    s_waitcnt lgkmcnt(0)
    ds_read_b64_tr_b16 v[56:57], v7 offset:0
    ds_read_b64_tr_b16 v[58:59], v7 offset:1024
    ds_read_b64_tr_b16 v[60:61], v7 offset:32
    ds_read_b64_tr_b16 v[62:63], v7 offset:1056
    ds_read_b64_tr_b16 v[64:65], v7 offset:64
    ds_read_b64_tr_b16 v[66:67], v7 offset:1088
    ds_read_b64_tr_b16 v[68:69], v7 offset:96
    ds_read_b64_tr_b16 v[70:71], v7 offset:1120
    s_waitcnt lgkmcnt(0)
    buffer_store_dwordx4 v[56:59], v1, s[16:19], s40 offen offset:3072 sc1
    buffer_store_dwordx4 v[60:63], v1, s[16:19], s41 offen offset:3072 sc1
    buffer_store_dwordx4 v[64:67], v1, s[16:19], s42 offen offset:3072 sc1
    buffer_store_dwordx4 v[68:71], v1, s[16:19], s43 offen offset:3072 sc1
    s_mul_i32 s26, s24, 73728
    s_lshl_b32 s37, s23, 10
    s_add_u32 s26, s26, s37
    s_add_u32 s26, s26, 0x3c00000
    v_lshlrev_b32 v156, 3, v4
    v_mfma_f32_32x32x16_bf16 v[120:135], v[104:107], v[88:91], 0
    v_mfma_f32_32x32x16_bf16 v[120:135], v[108:111], v[24:27], v[120:135]
    v_mfma_f32_32x32x16_bf16 v[120:135], v[112:115], v[40:43], v[120:135]
    v_mfma_f32_32x32x16_bf16 v[120:135], v[116:119], v[56:59], v[120:135]
    v_mfma_f32_32x32x16_bf16 v[136:151], v[104:107], v[92:95], 0
    v_mfma_f32_32x32x16_bf16 v[136:151], v[108:111], v[28:31], v[136:151]
    v_mfma_f32_32x32x16_bf16 v[136:151], v[112:115], v[44:47], v[136:151]
    v_mfma_f32_32x32x16_bf16 v[136:151], v[116:119], v[60:63], v[136:151]
    s_nop 7
    v_mov_b32 v12, v120
    v_mov_b32 v13, v121
    s_nop 1
    v_mov_b32 v14, v136
    v_mov_b32 v15, v137
    v_mfma_f32_32x32x16_bf16 v[120:135], v[104:107], v[96:99], 0
    v_mfma_f32_32x32x16_bf16 v[120:135], v[108:111], v[32:35], v[120:135]
    v_mfma_f32_32x32x16_bf16 v[120:135], v[112:115], v[48:51], v[120:135]
    v_mfma_f32_32x32x16_bf16 v[120:135], v[116:119], v[64:67], v[120:135]
    v_mfma_f32_32x32x16_bf16 v[136:151], v[104:107], v[100:103], 0
    v_mfma_f32_32x32x16_bf16 v[136:151], v[108:111], v[36:39], v[136:151]
    v_mfma_f32_32x32x16_bf16 v[136:151], v[112:115], v[52:55], v[136:151]
    v_mfma_f32_32x32x16_bf16 v[136:151], v[116:119], v[68:71], v[136:151]
    s_nop 7
    v_mov_b32 v16, v120
    v_mov_b32 v17, v121
    s_nop 1
    v_mov_b32 v18, v136
    v_mov_b32 v19, v137
    s_mov_b32 exec_hi, 0
    buffer_store_dwordx2 v[12:13], v156, s[16:19], s26 offen offset:0 sc1
    buffer_store_dwordx2 v[14:15], v156, s[16:19], s26 offen offset:256 sc1
    buffer_store_dwordx2 v[16:17], v156, s[16:19], s26 offen offset:512 sc1
    buffer_store_dwordx2 v[18:19], v156, s[16:19], s26 offen offset:768 sc1
    s_branch K3_END
K3_SD:
    s_cmp_ge_u32 s21, 972
    s_cbranch_scc1 K3_SO
    s_load_dwordx2 s[8:9], s[0:1], 48
    s_sub_u32 s21, s21, 648
    s_mul_i32 s23, s21, 7282
    s_lshr_b32 s23, s23, 16
    s_mul_i32 s24, s23, 9
    s_sub_u32 s24, s21, s24
    v_mul_u32_u24 v11, 1152, v5
    v_add_u32 v11, v11, v6
    s_mul_i32 s25, s23, 147456
    s_lshl_b32 s26, s24, 7
    s_add_u32 s25, s25, s26
    s_waitcnt lgkmcnt(0)
    s_mov_b32 s28, s8
    s_mov_b32 s29, s9
    s_mov_b32 s30, 0x510000
    s_mov_b32 s31, 0x00020000
    s_add_u32 s26, s25, 0
    buffer_load_dwordx4 v[24:27], v11, s[28:31], s26 offen nt
    s_add_u32 s26, s25, 9216
    buffer_load_dwordx4 v[28:31], v11, s[28:31], s26 offen nt
    s_add_u32 s26, s25, 18432
    buffer_load_dwordx4 v[32:35], v11, s[28:31], s26 offen nt
    s_add_u32 s26, s25, 27648
    buffer_load_dwordx4 v[36:39], v11, s[28:31], s26 offen nt
    s_add_u32 s26, s25, 36864
    buffer_load_dwordx4 v[40:43], v11, s[28:31], s26 offen nt
    s_add_u32 s26, s25, 46080
    buffer_load_dwordx4 v[44:47], v11, s[28:31], s26 offen nt
    s_add_u32 s26, s25, 55296
    buffer_load_dwordx4 v[48:51], v11, s[28:31], s26 offen nt
    s_add_u32 s26, s25, 64512
    buffer_load_dwordx4 v[52:55], v11, s[28:31], s26 offen nt
    s_add_u32 s26, s25, 73728
    buffer_load_dwordx4 v[56:59], v11, s[28:31], s26 offen nt
    s_add_u32 s26, s25, 82944
    buffer_load_dwordx4 v[60:63], v11, s[28:31], s26 offen nt
    s_add_u32 s26, s25, 92160
    buffer_load_dwordx4 v[64:67], v11, s[28:31], s26 offen nt
    s_add_u32 s26, s25, 101376
    buffer_load_dwordx4 v[68:71], v11, s[28:31], s26 offen nt
    s_add_u32 s26, s25, 110592
    buffer_load_dwordx4 v[72:75], v11, s[28:31], s26 offen nt
    s_add_u32 s26, s25, 119808
    buffer_load_dwordx4 v[76:79], v11, s[28:31], s26 offen nt
    s_add_u32 s26, s25, 129024
    buffer_load_dwordx4 v[80:83], v11, s[28:31], s26 offen nt
    s_add_u32 s26, s25, 138240
    buffer_load_dwordx4 v[84:87], v11, s[28:31], s26 offen nt
    s_lshl_b32 s44, s2, 2
    s_add_u32 s44, s44, s20
    s_lshl_b32 s45, s44, 10
    s_add_u32 s45, s45, 0x4500000
    s_add_u32 s46, s45, 0x100000
    s_add_u32 s47, s45, 0x200000
    s_cmp_ge_u32 s44, 256
    s_cselect_b32 s47, 0x7f000000, s47
    s_waitcnt vmcnt(16)
    buffer_store_dwordx4 v[12:15], v1, s[16:19], s45 offen sc1
    buffer_store_dwordx4 v[16:19], v1, s[16:19], s46 offen sc1
    buffer_store_dwordx4 v[20:23], v1, s[16:19], s47 offen sc1
    v_lshl_add_u32 v7, v9, 11, v7
    v_lshl_add_u32 v7, v10, 9, v7
    s_mul_i32 s26, s24, 576
    s_lshl_b32 s37, s23, 2
    s_add_u32 s26, s26, s37
    s_lshl_b32 s26, s26, 10
    s_add_u32 s26, s26, 0x2300000
    s_add_u32 s40, s26, 0
    s_add_u32 s41, s26, 147456
    s_add_u32 s42, s26, 294912
    s_add_u32 s43, s26, 442368
    s_waitcnt vmcnt(15)
    ds_write_b128 v8, v[24:27] offset:0
    ds_write_b128 v8, v[28:31] offset:1024
    ds_write_b128 v8, v[32:35] offset:2048
    ds_write_b128 v8, v[36:39] offset:3072
    s_waitcnt lgkmcnt(0)
    ds_read_b64_tr_b16 v[88:89], v7 offset:0
    ds_read_b64_tr_b16 v[90:91], v7 offset:1024
    ds_read_b64_tr_b16 v[92:93], v7 offset:32
    ds_read_b64_tr_b16 v[94:95], v7 offset:1056
    ds_read_b64_tr_b16 v[96:97], v7 offset:64
    ds_read_b64_tr_b16 v[98:99], v7 offset:1088
    ds_read_b64_tr_b16 v[100:101], v7 offset:96
    ds_read_b64_tr_b16 v[102:103], v7 offset:1120
    s_waitcnt lgkmcnt(0)
    buffer_store_dwordx4 v[88:91], v1, s[16:19], s40 offen offset:0 sc1
    buffer_store_dwordx4 v[92:95], v1, s[16:19], s41 offen offset:0 sc1
    buffer_store_dwordx4 v[96:99], v1, s[16:19], s42 offen offset:0 sc1
    buffer_store_dwordx4 v[100:103], v1, s[16:19], s43 offen offset:0 sc1
    s_waitcnt vmcnt(15)
    ds_write_b128 v8, v[40:43] offset:0
    ds_write_b128 v8, v[44:47] offset:1024
    ds_write_b128 v8, v[48:51] offset:2048
    ds_write_b128 v8, v[52:55] offset:3072
    s_waitcnt lgkmcnt(0)
    ds_read_b64_tr_b16 v[104:105], v7 offset:0
    ds_read_b64_tr_b16 v[106:107], v7 offset:1024
    ds_read_b64_tr_b16 v[108:109], v7 offset:32
    ds_read_b64_tr_b16 v[110:111], v7 offset:1056
    ds_read_b64_tr_b16 v[112:113], v7 offset:64
    ds_read_b64_tr_b16 v[114:115], v7 offset:1088
    ds_read_b64_tr_b16 v[116:117], v7 offset:96
    ds_read_b64_tr_b16 v[118:119], v7 offset:1120
    s_waitcnt lgkmcnt(0)
    buffer_store_dwordx4 v[104:107], v1, s[16:19], s40 offen offset:1024 sc1
    buffer_store_dwordx4 v[108:111], v1, s[16:19], s41 offen offset:1024 sc1
    buffer_store_dwordx4 v[112:115], v1, s[16:19], s42 offen offset:1024 sc1
    buffer_store_dwordx4 v[116:119], v1, s[16:19], s43 offen offset:1024 sc1
    s_waitcnt vmcnt(15)
    ds_write_b128 v8, v[56:59] offset:0
    ds_write_b128 v8, v[60:63] offset:1024
    ds_write_b128 v8, v[64:67] offset:2048
    ds_write_b128 v8, v[68:71] offset:3072
    s_waitcnt lgkmcnt(0)
    ds_read_b64_tr_b16 v[120:121], v7 offset:0
    ds_read_b64_tr_b16 v[122:123], v7 offset:1024
    ds_read_b64_tr_b16 v[124:125], v7 offset:32
    ds_read_b64_tr_b16 v[126:127], v7 offset:1056
    ds_read_b64_tr_b16 v[128:129], v7 offset:64
    ds_read_b64_tr_b16 v[130:131], v7 offset:1088
    ds_read_b64_tr_b16 v[132:133], v7 offset:96
    ds_read_b64_tr_b16 v[134:135], v7 offset:1120
    s_waitcnt lgkmcnt(0)
    buffer_store_dwordx4 v[120:123], v1, s[16:19], s40 offen offset:2048 sc1
    buffer_store_dwordx4 v[124:127], v1, s[16:19], s41 offen offset:2048 sc1
    buffer_store_dwordx4 v[128:131], v1, s[16:19], s42 offen offset:2048 sc1
    buffer_store_dwordx4 v[132:135], v1, s[16:19], s43 offen offset:2048 sc1
    s_waitcnt vmcnt(15)
    ds_write_b128 v8, v[72:75] offset:0
    ds_write_b128 v8, v[76:79] offset:1024
    ds_write_b128 v8, v[80:83] offset:2048
    ds_write_b128 v8, v[84:87] offset:3072
    s_waitcnt lgkmcnt(0)
    ds_read_b64_tr_b16 v[136:137], v7 offset:0
    ds_read_b64_tr_b16 v[138:139], v7 offset:1024
    ds_read_b64_tr_b16 v[140:141], v7 offset:32
    ds_read_b64_tr_b16 v[142:143], v7 offset:1056
    ds_read_b64_tr_b16 v[144:145], v7 offset:64
    ds_read_b64_tr_b16 v[146:147], v7 offset:1088
    ds_read_b64_tr_b16 v[148:149], v7 offset:96
    ds_read_b64_tr_b16 v[150:151], v7 offset:1120
    s_waitcnt lgkmcnt(0)
    buffer_store_dwordx4 v[136:139], v1, s[16:19], s40 offen offset:3072 sc1
    buffer_store_dwordx4 v[140:143], v1, s[16:19], s41 offen offset:3072 sc1
    buffer_store_dwordx4 v[144:147], v1, s[16:19], s42 offen offset:3072 sc1
    buffer_store_dwordx4 v[148:151], v1, s[16:19], s43 offen offset:3072 sc1
    s_branch K3_END
K3_SO:
    s_cmp_ge_u32 s21, 1017
    s_cbranch_scc1 K3_SX
    s_load_dwordx2 s[8:9], s[0:1], 16
    s_sub_u32 s21, s21, 972
    s_mul_i32 s23, s21, 7282
    s_lshr_b32 s23, s23, 16
    s_mul_i32 s24, s23, 9
    s_sub_u32 s24, s21, s24
    s_lshl_b32 s25, s24, 7
    s_waitcnt lgkmcnt(0)
    s_mov_b32 s28, s8
    s_mov_b32 s29, s9
    s_mov_b32 s30, 0xa2000
    s_mov_b32 s31, 0x00020000
    s_cmp_eq_u32 s23, 4
    s_cbranch_scc1 K3_SOR
    v_mul_u32_u24 v11, 1152, v5
    v_add_u32 v11, v11, v6
    s_mul_i32 s26, s23, 165888
    s_add_u32 s25, s25, s26
    s_add_u32 s26, s25, 0
    buffer_load_dwordx4 v[24:27], v11, s[28:31], s26 offen nt
    s_add_u32 s26, s25, 9216
    buffer_load_dwordx4 v[28:31], v11, s[28:31], s26 offen nt
    s_add_u32 s26, s25, 20736
    buffer_load_dwordx4 v[32:35], v11, s[28:31], s26 offen nt
    s_add_u32 s26, s25, 29952
    buffer_load_dwordx4 v[36:39], v11, s[28:31], s26 offen nt
    s_add_u32 s26, s25, 41472
    buffer_load_dwordx4 v[40:43], v11, s[28:31], s26 offen nt
    s_add_u32 s26, s25, 50688
    buffer_load_dwordx4 v[44:47], v11, s[28:31], s26 offen nt
    s_add_u32 s26, s25, 62208
    buffer_load_dwordx4 v[48:51], v11, s[28:31], s26 offen nt
    s_add_u32 s26, s25, 71424
    buffer_load_dwordx4 v[52:55], v11, s[28:31], s26 offen nt
    s_add_u32 s26, s25, 82944
    buffer_load_dwordx4 v[56:59], v11, s[28:31], s26 offen nt
    s_add_u32 s26, s25, 92160
    buffer_load_dwordx4 v[60:63], v11, s[28:31], s26 offen nt
    s_add_u32 s26, s25, 103680
    buffer_load_dwordx4 v[64:67], v11, s[28:31], s26 offen nt
    s_add_u32 s26, s25, 112896
    buffer_load_dwordx4 v[68:71], v11, s[28:31], s26 offen nt
    s_add_u32 s26, s25, 124416
    buffer_load_dwordx4 v[72:75], v11, s[28:31], s26 offen nt
    s_add_u32 s26, s25, 133632
    buffer_load_dwordx4 v[76:79], v11, s[28:31], s26 offen nt
    s_add_u32 s26, s25, 145152
    buffer_load_dwordx4 v[80:83], v11, s[28:31], s26 offen nt
    s_add_u32 s26, s25, 154368
    buffer_load_dwordx4 v[84:87], v11, s[28:31], s26 offen nt
    s_branch K3_SO2
K3_SOR:
    v_lshrrev_b32 v156, 2, v5
    v_lshlrev_b32 v156, 2, v156
    v_bfe_u32 v157, v5, 1, 1
    v_add_u32 v156, v156, v157
    v_mul_u32_u24 v156, 18, v156
    v_and_b32 v157, 1, v5
    v_add_u32 v156, v156, v157
    v_mul_u32_u24 v11, 1152, v156
    v_add_u32 v11, v11, v6
    s_add_u32 s26, s25, 18432
    buffer_load_dwordx4 v[24:27], v11, s[28:31], s26 offen nt
    s_add_u32 s26, s25, 59904
    buffer_load_dwordx4 v[28:31], v11, s[28:31], s26 offen nt
    s_add_u32 s26, s25, 184320
    buffer_load_dwordx4 v[32:35], v11, s[28:31], s26 offen nt
    s_add_u32 s26, s25, 225792
    buffer_load_dwordx4 v[36:39], v11, s[28:31], s26 offen nt
    s_add_u32 s26, s25, 350208
    buffer_load_dwordx4 v[40:43], v11, s[28:31], s26 offen nt
    s_add_u32 s26, s25, 391680
    buffer_load_dwordx4 v[44:47], v11, s[28:31], s26 offen nt
    s_add_u32 s26, s25, 516096
    buffer_load_dwordx4 v[48:51], v11, s[28:31], s26 offen nt
    s_add_u32 s26, s25, 557568
    buffer_load_dwordx4 v[52:55], v11, s[28:31], s26 offen nt
    s_add_u32 s26, s25, 18432
    buffer_load_dwordx4 v[56:59], v11, s[28:31], s26 offen nt
    s_add_u32 s26, s25, 59904
    buffer_load_dwordx4 v[60:63], v11, s[28:31], s26 offen nt
    s_add_u32 s26, s25, 184320
    buffer_load_dwordx4 v[64:67], v11, s[28:31], s26 offen nt
    s_add_u32 s26, s25, 225792
    buffer_load_dwordx4 v[68:71], v11, s[28:31], s26 offen nt
    s_add_u32 s26, s25, 350208
    buffer_load_dwordx4 v[72:75], v11, s[28:31], s26 offen nt
    s_add_u32 s26, s25, 391680
    buffer_load_dwordx4 v[76:79], v11, s[28:31], s26 offen nt
    s_add_u32 s26, s25, 516096
    buffer_load_dwordx4 v[80:83], v11, s[28:31], s26 offen nt
    s_add_u32 s26, s25, 557568
    buffer_load_dwordx4 v[84:87], v11, s[28:31], s26 offen nt
K3_SO2:
    s_lshl_b32 s44, s2, 2
    s_add_u32 s44, s44, s20
    s_lshl_b32 s45, s44, 10
    s_add_u32 s45, s45, 0x4500000
    s_add_u32 s46, s45, 0x100000
    s_add_u32 s47, s45, 0x200000
    s_cmp_ge_u32 s44, 256
    s_cselect_b32 s47, 0x7f000000, s47
    s_waitcnt vmcnt(16)
    buffer_store_dwordx4 v[12:15], v1, s[16:19], s45 offen sc1
    buffer_store_dwordx4 v[16:19], v1, s[16:19], s46 offen sc1
    buffer_store_dwordx4 v[20:23], v1, s[16:19], s47 offen sc1
    v_lshl_add_u32 v7, v9, 9, v7
    v_lshl_add_u32 v7, v10, 5, v7
    s_mul_i32 s26, s24, 72
    s_lshl_b32 s37, s23, 3
    s_add_u32 s26, s26, s37
    s_lshl_b32 s26, s26, 10
    s_add_u32 s40, s26, 0x1100000
    s_add_u32 s41, s40, 36864
    s_add_u32 s42, s40, 4096
    s_add_u32 s43, s41, 4096
    s_waitcnt vmcnt(15)
    ds_write_b128 v8, v[24:27] offset:0
    ds_write_b128 v8, v[28:31] offset:1024
    ds_write_b128 v8, v[32:35] offset:2048
    ds_write_b128 v8, v[36:39] offset:3072
    s_waitcnt lgkmcnt(0)
    ds_read_b64_tr_b16 v[88:89], v7 offset:0
    ds_read_b64_tr_b16 v[90:91], v7 offset:1024
    ds_read_b64_tr_b16 v[92:93], v7 offset:64
    ds_read_b64_tr_b16 v[94:95], v7 offset:1088
    ds_read_b64_tr_b16 v[96:97], v7 offset:2048
    ds_read_b64_tr_b16 v[98:99], v7 offset:3072
    ds_read_b64_tr_b16 v[100:101], v7 offset:2112
    ds_read_b64_tr_b16 v[102:103], v7 offset:3136
    s_waitcnt lgkmcnt(0)
    buffer_store_dwordx4 v[88:91], v1, s[16:19], s40 offen offset:0 sc1
    buffer_store_dwordx4 v[92:95], v1, s[16:19], s41 offen offset:0 sc1
    buffer_store_dwordx4 v[96:99], v1, s[16:19], s40 offen offset:1024 sc1
    buffer_store_dwordx4 v[100:103], v1, s[16:19], s41 offen offset:1024 sc1
    s_waitcnt vmcnt(15)
    ds_write_b128 v8, v[40:43] offset:0
    ds_write_b128 v8, v[44:47] offset:1024
    ds_write_b128 v8, v[48:51] offset:2048
    ds_write_b128 v8, v[52:55] offset:3072
    s_waitcnt lgkmcnt(0)
    ds_read_b64_tr_b16 v[104:105], v7 offset:0
    ds_read_b64_tr_b16 v[106:107], v7 offset:1024
    ds_read_b64_tr_b16 v[108:109], v7 offset:64
    ds_read_b64_tr_b16 v[110:111], v7 offset:1088
    ds_read_b64_tr_b16 v[112:113], v7 offset:2048
    ds_read_b64_tr_b16 v[114:115], v7 offset:3072
    ds_read_b64_tr_b16 v[116:117], v7 offset:2112
    ds_read_b64_tr_b16 v[118:119], v7 offset:3136
    s_waitcnt lgkmcnt(0)
    buffer_store_dwordx4 v[104:107], v1, s[16:19], s40 offen offset:2048 sc1
    buffer_store_dwordx4 v[108:111], v1, s[16:19], s41 offen offset:2048 sc1
    buffer_store_dwordx4 v[112:115], v1, s[16:19], s40 offen offset:3072 sc1
    buffer_store_dwordx4 v[116:119], v1, s[16:19], s41 offen offset:3072 sc1
    s_cmp_eq_u32 s23, 4
    s_cbranch_scc1 K3_END
    s_waitcnt vmcnt(15)
    ds_write_b128 v8, v[56:59] offset:0
    ds_write_b128 v8, v[60:63] offset:1024
    ds_write_b128 v8, v[64:67] offset:2048
    ds_write_b128 v8, v[68:71] offset:3072
    s_waitcnt lgkmcnt(0)
    ds_read_b64_tr_b16 v[120:121], v7 offset:0
    ds_read_b64_tr_b16 v[122:123], v7 offset:1024
    ds_read_b64_tr_b16 v[124:125], v7 offset:64
    ds_read_b64_tr_b16 v[126:127], v7 offset:1088
    ds_read_b64_tr_b16 v[128:129], v7 offset:2048
    ds_read_b64_tr_b16 v[130:131], v7 offset:3072
    ds_read_b64_tr_b16 v[132:133], v7 offset:2112
    ds_read_b64_tr_b16 v[134:135], v7 offset:3136
    s_waitcnt lgkmcnt(0)
    buffer_store_dwordx4 v[120:123], v1, s[16:19], s42 offen offset:0 sc1
    buffer_store_dwordx4 v[124:127], v1, s[16:19], s43 offen offset:0 sc1
    buffer_store_dwordx4 v[128:131], v1, s[16:19], s42 offen offset:1024 sc1
    buffer_store_dwordx4 v[132:135], v1, s[16:19], s43 offen offset:1024 sc1
    s_waitcnt vmcnt(15)
    ds_write_b128 v8, v[72:75] offset:0
    ds_write_b128 v8, v[76:79] offset:1024
    ds_write_b128 v8, v[80:83] offset:2048
    ds_write_b128 v8, v[84:87] offset:3072
    s_waitcnt lgkmcnt(0)
    ds_read_b64_tr_b16 v[136:137], v7 offset:0
    ds_read_b64_tr_b16 v[138:139], v7 offset:1024
    ds_read_b64_tr_b16 v[140:141], v7 offset:64
    ds_read_b64_tr_b16 v[142:143], v7 offset:1088
    ds_read_b64_tr_b16 v[144:145], v7 offset:2048
    ds_read_b64_tr_b16 v[146:147], v7 offset:3072
    ds_read_b64_tr_b16 v[148:149], v7 offset:2112
    ds_read_b64_tr_b16 v[150:151], v7 offset:3136
    s_waitcnt lgkmcnt(0)
    buffer_store_dwordx4 v[136:139], v1, s[16:19], s42 offen offset:2048 sc1
    buffer_store_dwordx4 v[140:143], v1, s[16:19], s43 offen offset:2048 sc1
    buffer_store_dwordx4 v[144:147], v1, s[16:19], s42 offen offset:3072 sc1
    buffer_store_dwordx4 v[148:151], v1, s[16:19], s43 offen offset:3072 sc1
    s_branch K3_END
K3_SX:
    s_lshl_b32 s44, s2, 2
    s_add_u32 s44, s44, s20
    s_lshl_b32 s45, s44, 10
    s_add_u32 s45, s45, 0x4500000
    s_add_u32 s46, s45, 0x100000
    s_add_u32 s47, s45, 0x200000
    s_cmp_ge_u32 s44, 256
    s_cselect_b32 s47, 0x7f000000, s47
    s_waitcnt vmcnt(0)
    buffer_store_dwordx4 v[12:15], v1, s[16:19], s45 offen sc1
    buffer_store_dwordx4 v[16:19], v1, s[16:19], s46 offen sc1
    buffer_store_dwordx4 v[20:23], v1, s[16:19], s47 offen sc1
    s_branch K3_END
K3_END:
K3_EXIT:
    s_endpgm
k3_kernel_end:
.globl k4_kernel
.p2align 8
.type k4_kernel,@function
k4_kernel:
    s_cmp_ge_u32 s2, 256
    s_cbranch_scc1 K456_EXIT
    s_load_dwordx2 s[4:5], s[0:1], 88
    s_load_dwordx2 s[6:7], s[0:1], 72
    v_lshrrev_b32 v1, 6, v0
    s_nop 0
    v_readfirstlane_b32 s3, v1
    v_and_b32 v4, 63, v0
    v_lshlrev_b32 v1, 4, v4
    s_and_b32 s8, s2, 7
    s_lshl_b32 s8, s8, 2
    s_bfe_u32 s9, s2, 0x20003
    s_add_u32 s8, s8, s9
    s_lshr_b32 s9, s2, 5
    s_and_b32 s25, s3, 1
    s_lshr_b32 s26, s3, 1
    s_mul_i32 s10, s3, 9216
    s_lshl_b32 s27, s8, 1
    s_add_u32 s27, s27, s25
    s_xor_b32 s11, s27, 1
    s_mul_i32 s20, s27, 36864
    s_mul_i32 s21, s11, 36864
    s_add_u32 s11, s10, 0xe00000
    s_add_u32 s20, s20, s11
    s_add_u32 s21, s21, s11
    s_mul_i32 s11, s9, 110592
    s_add_u32 s11, s11, s10
    s_add_u32 s22, s11, 0x1100000
    s_add_u32 s23, s22, 36864
    s_add_u32 s24, s23, 36864
    s_lshl_b32 s11, s26, 8
    v_xor_b32 v5, s11, v1
    v_add_u32 v2, 4096, v1
    v_add_u32 v6, 4096, v5
    v_add_u32 v3, 8192, v1
    v_add_u32 v7, 8192, v5
    s_waitcnt lgkmcnt(0)
    s_mov_b32 s16, s4
    s_mov_b32 s17, s5
    s_mov_b32 s18, 0x5000000
    s_mov_b32 s19, 0x00020000
    s_cmp_ge_u32 s2, 192
    s_cbranch_scc1 K456_NOA
    buffer_load_dwordx4 v[40:43], v1, s[16:19], s20 offen offset:0
    buffer_load_dwordx4 v[48:51], v5, s[16:19], s22 offen offset:0
    buffer_load_dwordx4 v[52:55], v5, s[16:19], s23 offen offset:0
    buffer_load_dwordx4 v[56:59], v5, s[16:19], s24 offen offset:0
    buffer_load_dwordx4 v[44:47], v1, s[16:19], s21 offen offset:0
    buffer_load_dwordx4 v[60:63], v1, s[16:19], s20 offen offset:1024
    buffer_load_dwordx4 v[68:71], v5, s[16:19], s22 offen offset:1024
    buffer_load_dwordx4 v[72:75], v5, s[16:19], s23 offen offset:1024
    buffer_load_dwordx4 v[76:79], v5, s[16:19], s24 offen offset:1024
    buffer_load_dwordx4 v[64:67], v1, s[16:19], s21 offen offset:1024
    buffer_load_dwordx4 v[80:83], v1, s[16:19], s20 offen offset:2048
    buffer_load_dwordx4 v[88:91], v5, s[16:19], s22 offen offset:2048
    buffer_load_dwordx4 v[92:95], v5, s[16:19], s23 offen offset:2048
    buffer_load_dwordx4 v[96:99], v5, s[16:19], s24 offen offset:2048
    buffer_load_dwordx4 v[84:87], v1, s[16:19], s21 offen offset:2048
    s_mul_i32 s28, s9, 6
    s_add_u32 s28, s28, s26
    s_mul_i32 s29, s27, 36
    s_add_u32 s29, s29, s28
    s_lshl_b32 s29, s29, 10
    s_add_u32 s44, s29, 0x1500000
    s_add_u32 s45, s29, 0x1200000
    s_add_u32 s46, s29, 0x4500000
    v_and_b32 v8, 31, v4
    v_lshrrev_b32 v9, 5, v4
    v_and_b32 v10, 3, v4
    v_bfe_u32 v11, v4, 2, 1
    v_lshl_add_u32 v10, v11, 3, v10
    v_lshl_add_u32 v10, v9, 2, v10
    v_bfe_u32 v11, v4, 3, 1
    v_lshl_add_u32 v10, v11, 5, v10
    v_lshlrev_b32 v10, 2, v10
    s_lshl_b32 s47, s28, 6
    s_add_u32 s48, s47, 9216
    s_add_u32 s47, s47, 4608
    s_xor_b32 s36, s3, 1
    s_mul_i32 s36, s36, 18432
    s_add_u32 s36, s36, 73728
    v_add_u32 v13, s36, v1
    s_xor_b32 s36, s3, 2
    s_mul_i32 s36, s36, 18432
    s_add_u32 s36, s36, 79872
    v_add_u32 v14, s36, v1
    s_xor_b32 s36, s3, 3
    s_mul_i32 s36, s36, 18432
    s_add_u32 s36, s36, 86016
    v_add_u32 v15, s36, v1
    s_mul_i32 s36, s3, 18432
    s_add_u32 s36, s36, 73728
    v_add_u32 v16, s36, v1
    s_and_b32 s12, s2, 1
    s_lshl_b32 s12, s12, 2
    s_bfe_u32 s13, s2, 0x20003
    s_add_u32 s12, s12, s13
    s_bfe_u32 s13, s2, 0x20001
    s_lshl_b32 s13, s13, 3
    s_lshr_b32 s14, s2, 5
    s_add_u32 s13, s13, s14
    s_mul_i32 s41, s13, 9
    s_mul_i32 s15, s41, 36864
    s_add_u32 s15, s15, 0x1800000
    s_lshl_b32 s30, s3, 12
    s_add_u32 s31, s15, s30
    s_lshl_b32 s34, s3, 10
    s_add_u32 s35, s15, s34
    s_lshl_b32 s38, s41, 8
    s_add_u32 s38, s38, 0x3c00000
    v_lshlrev_b32 v28, 3, v0
    v_and_b32 v29, 31, v0
    v_lshlrev_b32 v31, 4, v29
    v_lshlrev_b32 v29, 3, v29
    v_add_u32 v29, 2048, v29
    v_lshrrev_b32 v30, 5, v0
    v_lshl_add_u32 v30, v30, 10, v31
    v_add_u32 v30, 147456, v30
    v_add_u32 v31, 155648, v31
    v_mov_b32 v242, 1
    v_min_u32 v241, 1, v4
    v_lshlrev_b32 v241, 30, v241
    s_waitcnt vmcnt(13)
    v_mfma_f32_32x32x16_bf16 a[0:15], v[48:51], v[40:43], 0
    s_waitcnt vmcnt(12)
    v_mfma_f32_32x32x16_bf16 a[16:31], v[52:55], v[40:43], 0
    s_waitcnt vmcnt(11)
    v_mfma_f32_32x32x16_bf16 a[32:47], v[56:59], v[40:43], 0
    buffer_load_dwordx4 v[100:103], v1, s[16:19], s20 offen offset:3072
    buffer_load_dwordx4 v[108:111], v5, s[16:19], s22 offen offset:3072
    buffer_load_dwordx4 v[112:115], v5, s[16:19], s23 offen offset:3072
    buffer_load_dwordx4 v[116:119], v5, s[16:19], s24 offen offset:3072
    buffer_load_dwordx4 v[104:107], v1, s[16:19], s21 offen offset:3072
    s_waitcnt vmcnt(15)
    v_mfma_f32_32x32x16_bf16 a[48:63], v[48:51], v[44:47], 0
    v_mfma_f32_32x32x16_bf16 a[64:79], v[52:55], v[44:47], 0
    v_mfma_f32_32x32x16_bf16 a[80:95], v[56:59], v[44:47], 0
    s_waitcnt vmcnt(13)
    v_mfma_f32_32x32x16_bf16 a[0:15], v[68:71], v[60:63], a[0:15]
    s_waitcnt vmcnt(12)
    v_mfma_f32_32x32x16_bf16 a[16:31], v[72:75], v[60:63], a[16:31]
    s_waitcnt vmcnt(11)
    v_mfma_f32_32x32x16_bf16 a[32:47], v[76:79], v[60:63], a[32:47]
    buffer_load_dwordx4 v[120:123], v2, s[16:19], s20 offen offset:0
    buffer_load_dwordx4 v[128:131], v6, s[16:19], s22 offen offset:0
    buffer_load_dwordx4 v[132:135], v6, s[16:19], s23 offen offset:0
    buffer_load_dwordx4 v[136:139], v6, s[16:19], s24 offen offset:0
    buffer_load_dwordx4 v[124:127], v2, s[16:19], s21 offen offset:0
    s_waitcnt vmcnt(15)
    v_mfma_f32_32x32x16_bf16 a[48:63], v[68:71], v[64:67], a[48:63]
    v_mfma_f32_32x32x16_bf16 a[64:79], v[72:75], v[64:67], a[64:79]
    v_mfma_f32_32x32x16_bf16 a[80:95], v[76:79], v[64:67], a[80:95]
    s_waitcnt vmcnt(13)
    v_mfma_f32_32x32x16_bf16 a[0:15], v[88:91], v[80:83], a[0:15]
    s_waitcnt vmcnt(12)
    v_mfma_f32_32x32x16_bf16 a[16:31], v[92:95], v[80:83], a[16:31]
    s_waitcnt vmcnt(11)
    v_mfma_f32_32x32x16_bf16 a[32:47], v[96:99], v[80:83], a[32:47]
    buffer_load_dwordx4 v[140:143], v2, s[16:19], s20 offen offset:1024
    buffer_load_dwordx4 v[148:151], v6, s[16:19], s22 offen offset:1024
    buffer_load_dwordx4 v[152:155], v6, s[16:19], s23 offen offset:1024
    buffer_load_dwordx4 v[156:159], v6, s[16:19], s24 offen offset:1024
    buffer_load_dwordx4 v[144:147], v2, s[16:19], s21 offen offset:1024
    s_waitcnt vmcnt(15)
    v_mfma_f32_32x32x16_bf16 a[48:63], v[88:91], v[84:87], a[48:63]
    v_mfma_f32_32x32x16_bf16 a[64:79], v[92:95], v[84:87], a[64:79]
    v_mfma_f32_32x32x16_bf16 a[80:95], v[96:99], v[84:87], a[80:95]
    s_waitcnt vmcnt(13)
    v_mfma_f32_32x32x16_bf16 a[0:15], v[108:111], v[100:103], a[0:15]
    s_waitcnt vmcnt(12)
    v_mfma_f32_32x32x16_bf16 a[16:31], v[112:115], v[100:103], a[16:31]
    s_waitcnt vmcnt(11)
    v_mfma_f32_32x32x16_bf16 a[32:47], v[116:119], v[100:103], a[32:47]
    buffer_load_dwordx4 v[160:163], v2, s[16:19], s20 offen offset:2048
    buffer_load_dwordx4 v[168:171], v6, s[16:19], s22 offen offset:2048
    buffer_load_dwordx4 v[172:175], v6, s[16:19], s23 offen offset:2048
    buffer_load_dwordx4 v[176:179], v6, s[16:19], s24 offen offset:2048
    buffer_load_dwordx4 v[164:167], v2, s[16:19], s21 offen offset:2048
    s_waitcnt vmcnt(15)
    v_mfma_f32_32x32x16_bf16 a[48:63], v[108:111], v[104:107], a[48:63]
    v_mfma_f32_32x32x16_bf16 a[64:79], v[112:115], v[104:107], a[64:79]
    v_mfma_f32_32x32x16_bf16 a[80:95], v[116:119], v[104:107], a[80:95]
    s_waitcnt vmcnt(13)
    v_mfma_f32_32x32x16_bf16 a[0:15], v[128:131], v[120:123], a[0:15]
    s_waitcnt vmcnt(12)
    v_mfma_f32_32x32x16_bf16 a[16:31], v[132:135], v[120:123], a[16:31]
    s_waitcnt vmcnt(11)
    v_mfma_f32_32x32x16_bf16 a[32:47], v[136:139], v[120:123], a[32:47]
    buffer_load_dwordx4 v[180:183], v2, s[16:19], s20 offen offset:3072
    buffer_load_dwordx4 v[188:191], v6, s[16:19], s22 offen offset:3072
    buffer_load_dwordx4 v[192:195], v6, s[16:19], s23 offen offset:3072
    buffer_load_dwordx4 v[196:199], v6, s[16:19], s24 offen offset:3072
    buffer_load_dwordx4 v[184:187], v2, s[16:19], s21 offen offset:3072
    s_waitcnt vmcnt(15)
    v_mfma_f32_32x32x16_bf16 a[48:63], v[128:131], v[124:127], a[48:63]
    v_mfma_f32_32x32x16_bf16 a[64:79], v[132:135], v[124:127], a[64:79]
    v_mfma_f32_32x32x16_bf16 a[80:95], v[136:139], v[124:127], a[80:95]
    s_waitcnt vmcnt(13)
    v_mfma_f32_32x32x16_bf16 a[0:15], v[148:151], v[140:143], a[0:15]
    s_waitcnt vmcnt(12)
    v_mfma_f32_32x32x16_bf16 a[16:31], v[152:155], v[140:143], a[16:31]
    s_waitcnt vmcnt(11)
    v_mfma_f32_32x32x16_bf16 a[32:47], v[156:159], v[140:143], a[32:47]
    buffer_load_dwordx4 v[200:203], v3, s[16:19], s20 offen offset:0
    buffer_load_dwordx4 v[208:211], v7, s[16:19], s22 offen offset:0
    buffer_load_dwordx4 v[212:215], v7, s[16:19], s23 offen offset:0
    buffer_load_dwordx4 v[216:219], v7, s[16:19], s24 offen offset:0
    buffer_load_dwordx4 v[204:207], v3, s[16:19], s21 offen offset:0
    s_waitcnt vmcnt(15)
    v_mfma_f32_32x32x16_bf16 a[48:63], v[148:151], v[144:147], a[48:63]
    v_mfma_f32_32x32x16_bf16 a[64:79], v[152:155], v[144:147], a[64:79]
    v_mfma_f32_32x32x16_bf16 a[80:95], v[156:159], v[144:147], a[80:95]
    s_waitcnt vmcnt(13)
    v_mfma_f32_32x32x16_bf16 a[0:15], v[168:171], v[160:163], a[0:15]
    s_waitcnt vmcnt(12)
    v_mfma_f32_32x32x16_bf16 a[16:31], v[172:175], v[160:163], a[16:31]
    s_waitcnt vmcnt(11)
    v_mfma_f32_32x32x16_bf16 a[32:47], v[176:179], v[160:163], a[32:47]
    buffer_load_dwordx4 v[220:223], v1, s[16:19], s46 offen offset:0
    buffer_load_dwordx4 v[224:227], v1, s[16:19], s46 offen offset:2048
    buffer_load_dwordx4 v[228:231], v2, s[16:19], s46 offen offset:0
    buffer_load_dword v232, v10, s[16:19], s47 offen offset:0
    buffer_load_dword v233, v10, s[16:19], s47 offen offset:256
    buffer_load_dword v234, v10, s[16:19], s48 offen offset:0
    buffer_load_dword v235, v10, s[16:19], s48 offen offset:256
    s_waitcnt vmcnt(17)
    v_mfma_f32_32x32x16_bf16 a[48:63], v[168:171], v[164:167], a[48:63]
    v_mfma_f32_32x32x16_bf16 a[64:79], v[172:175], v[164:167], a[64:79]
    v_mfma_f32_32x32x16_bf16 a[80:95], v[176:179], v[164:167], a[80:95]
    s_waitcnt vmcnt(15)
    v_mfma_f32_32x32x16_bf16 a[0:15], v[188:191], v[180:183], a[0:15]
    s_waitcnt vmcnt(14)
    v_mfma_f32_32x32x16_bf16 a[16:31], v[192:195], v[180:183], a[16:31]
    s_waitcnt vmcnt(13)
    v_mfma_f32_32x32x16_bf16 a[32:47], v[196:199], v[180:183], a[32:47]
    s_waitcnt vmcnt(12)
    v_mfma_f32_32x32x16_bf16 a[48:63], v[188:191], v[184:187], a[48:63]
    v_mfma_f32_32x32x16_bf16 a[64:79], v[192:195], v[184:187], a[64:79]
    v_mfma_f32_32x32x16_bf16 a[80:95], v[196:199], v[184:187], a[80:95]
    s_waitcnt vmcnt(10)
    v_mfma_f32_32x32x16_bf16 a[0:15], v[208:211], v[200:203], a[0:15]
    s_waitcnt vmcnt(9)
    v_mfma_f32_32x32x16_bf16 a[16:31], v[212:215], v[200:203], a[16:31]
    s_waitcnt vmcnt(8)
    v_mfma_f32_32x32x16_bf16 a[32:47], v[216:219], v[200:203], a[32:47]
    s_add_u32 s39, s38, 0
    buffer_load_dwordx2 a[96:97], v28, s[16:19], s39 offen
    buffer_load_dwordx2 a[114:115], v29, s[16:19], s39 offen
    s_add_u32 s39, s38, 73728
    buffer_load_dwordx2 a[98:99], v28, s[16:19], s39 offen
    buffer_load_dwordx2 a[116:117], v29, s[16:19], s39 offen
    s_add_u32 s39, s38, 147456
    buffer_load_dwordx2 a[100:101], v28, s[16:19], s39 offen
    buffer_load_dwordx2 a[118:119], v29, s[16:19], s39 offen
    s_add_u32 s39, s38, 221184
    buffer_load_dwordx2 a[102:103], v28, s[16:19], s39 offen
    buffer_load_dwordx2 a[120:121], v29, s[16:19], s39 offen
    s_add_u32 s39, s38, 294912
    buffer_load_dwordx2 a[104:105], v28, s[16:19], s39 offen
    buffer_load_dwordx2 a[122:123], v29, s[16:19], s39 offen
    s_add_u32 s39, s38, 368640
    buffer_load_dwordx2 a[106:107], v28, s[16:19], s39 offen
    buffer_load_dwordx2 a[124:125], v29, s[16:19], s39 offen
    s_add_u32 s39, s38, 442368
    buffer_load_dwordx2 a[108:109], v28, s[16:19], s39 offen
    buffer_load_dwordx2 a[126:127], v29, s[16:19], s39 offen
    s_add_u32 s39, s38, 516096
    buffer_load_dwordx2 a[110:111], v28, s[16:19], s39 offen
    buffer_load_dwordx2 a[128:129], v29, s[16:19], s39 offen
    s_add_u32 s39, s38, 589824
    buffer_load_dwordx2 a[112:113], v28, s[16:19], s39 offen
    buffer_load_dwordx2 a[130:131], v29, s[16:19], s39 offen
    s_waitcnt vmcnt(25)
    v_mfma_f32_32x32x16_bf16 a[48:63], v[208:211], v[204:207], a[48:63]
    v_mfma_f32_32x32x16_bf16 a[64:79], v[212:215], v[204:207], a[64:79]
    v_mfma_f32_32x32x16_bf16 a[80:95], v[216:219], v[204:207], a[80:95]
    ds_write_b128 v14, a[8:11] offset:0
    ds_write_b128 v14, a[12:15] offset:1024
    ds_write_b128 v14, a[24:27] offset:2048
    ds_write_b128 v14, a[28:31] offset:3072
    ds_write_b128 v14, a[40:43] offset:4096
    ds_write_b128 v14, a[44:47] offset:5120
    s_waitcnt lgkmcnt(6)
    s_nop 2
    ds_write_b128 v13, a[48:51] offset:0
    ds_write_b128 v13, a[52:55] offset:1024
    ds_write_b128 v13, a[64:67] offset:2048
    ds_write_b128 v13, a[68:71] offset:3072
    ds_write_b128 v13, a[80:83] offset:4096
    ds_write_b128 v13, a[84:87] offset:5120
    s_waitcnt lgkmcnt(6)
    ds_write_b128 v15, a[56:59] offset:0
    ds_write_b128 v15, a[60:63] offset:1024
    ds_write_b128 v15, a[72:75] offset:2048
    ds_write_b128 v15, a[76:79] offset:3072
    ds_write_b128 v15, a[88:91] offset:4096
    ds_write_b128 v15, a[92:95] offset:5120
    v_accvgpr_read_b32 v40, a0
    v_accvgpr_read_b32 v41, a1
    v_accvgpr_read_b32 v42, a2
    v_accvgpr_read_b32 v43, a3
    v_accvgpr_read_b32 v44, a4
    v_accvgpr_read_b32 v45, a5
    v_accvgpr_read_b32 v46, a6
    v_accvgpr_read_b32 v47, a7
    v_accvgpr_read_b32 v48, a16
    v_accvgpr_read_b32 v49, a17
    v_accvgpr_read_b32 v50, a18
    v_accvgpr_read_b32 v51, a19
    v_accvgpr_read_b32 v52, a20
    v_accvgpr_read_b32 v53, a21
    v_accvgpr_read_b32 v54, a22
    v_accvgpr_read_b32 v55, a23
    v_accvgpr_read_b32 v56, a32
    v_accvgpr_read_b32 v57, a33
    v_accvgpr_read_b32 v58, a34
    v_accvgpr_read_b32 v59, a35
    v_accvgpr_read_b32 v60, a36
    v_accvgpr_read_b32 v61, a37
    v_accvgpr_read_b32 v62, a38
    v_accvgpr_read_b32 v63, a39
    s_waitcnt lgkmcnt(0)
    s_barrier
    ds_read_b128 v[64:67], v16 offset:0
    ds_read_b128 v[68:71], v16 offset:1024
    ds_read_b128 v[72:75], v16 offset:2048
    ds_read_b128 v[76:79], v16 offset:3072
    ds_read_b128 v[80:83], v16 offset:4096
    ds_read_b128 v[84:87], v16 offset:5120
    ds_read_b128 v[88:91], v16 offset:6144
    ds_read_b128 v[92:95], v16 offset:7168
    ds_read_b128 v[96:99], v16 offset:8192
    ds_read_b128 v[100:103], v16 offset:9216
    ds_read_b128 v[104:107], v16 offset:10240
    ds_read_b128 v[108:111], v16 offset:11264
    s_waitcnt lgkmcnt(6)
    v_add_f32 v40, v40, v64
    v_add_f32 v41, v41, v65
    v_add_f32 v42, v42, v66
    v_add_f32 v43, v43, v67
    v_add_f32 v44, v44, v68
    v_add_f32 v45, v45, v69
    v_add_f32 v46, v46, v70
    v_add_f32 v47, v47, v71
    v_add_f32 v48, v48, v72
    v_add_f32 v49, v49, v73
    v_add_f32 v50, v50, v74
    v_add_f32 v51, v51, v75
    v_add_f32 v52, v52, v76
    v_add_f32 v53, v53, v77
    v_add_f32 v54, v54, v78
    v_add_f32 v55, v55, v79
    v_add_f32 v56, v56, v80
    v_add_f32 v57, v57, v81
    v_add_f32 v58, v58, v82
    v_add_f32 v59, v59, v83
    v_add_f32 v60, v60, v84
    v_add_f32 v61, v61, v85
    v_add_f32 v62, v62, v86
    v_add_f32 v63, v63, v87
    ds_read_b128 v[112:115], v16 offset:12288
    ds_read_b128 v[116:119], v16 offset:13312
    ds_read_b128 v[120:123], v16 offset:14336
    ds_read_b128 v[124:127], v16 offset:15360
    ds_read_b128 v[128:131], v16 offset:16384
    ds_read_b128 v[132:135], v16 offset:17408
    s_waitcnt vmcnt(18)
    v_lshlrev_b32 v140, 16, v220
    v_and_b32 v141, 0xffff0000, v220
    v_lshlrev_b32 v142, 16, v221
    v_and_b32 v143, 0xffff0000, v221
    v_lshlrev_b32 v144, 16, v222
    v_and_b32 v145, 0xffff0000, v222
    v_lshlrev_b32 v146, 16, v223
    v_and_b32 v147, 0xffff0000, v223
    v_lshlrev_b32 v148, 16, v224
    v_and_b32 v149, 0xffff0000, v224
    v_lshlrev_b32 v150, 16, v225
    v_and_b32 v151, 0xffff0000, v225
    v_lshlrev_b32 v152, 16, v226
    v_and_b32 v153, 0xffff0000, v226
    v_lshlrev_b32 v154, 16, v227
    v_and_b32 v155, 0xffff0000, v227
    v_lshlrev_b32 v156, 16, v228
    v_and_b32 v157, 0xffff0000, v228
    v_lshlrev_b32 v158, 16, v229
    v_and_b32 v159, 0xffff0000, v229
    v_lshlrev_b32 v160, 16, v230
    v_and_b32 v161, 0xffff0000, v230
    v_lshlrev_b32 v162, 16, v231
    v_and_b32 v163, 0xffff0000, v231
    s_waitcnt lgkmcnt(0)
    s_barrier
    v_add_f32 v88, v88, v112
    v_add_f32 v89, v89, v113
    v_add_f32 v90, v90, v114
    v_add_f32 v91, v91, v115
    v_add_f32 v92, v92, v116
    v_add_f32 v93, v93, v117
    v_add_f32 v94, v94, v118
    v_add_f32 v95, v95, v119
    v_add_f32 v96, v96, v120
    v_add_f32 v97, v97, v121
    v_add_f32 v98, v98, v122
    v_add_f32 v99, v99, v123
    v_add_f32 v100, v100, v124
    v_add_f32 v101, v101, v125
    v_add_f32 v102, v102, v126
    v_add_f32 v103, v103, v127
    v_add_f32 v104, v104, v128
    v_add_f32 v105, v105, v129
    v_add_f32 v106, v106, v130
    v_add_f32 v107, v107, v131
    v_add_f32 v108, v108, v132
    v_add_f32 v109, v109, v133
    v_add_f32 v110, v110, v134
    v_add_f32 v111, v111, v135
    v_add_f32 v40, v40, v88
    v_add_f32 v41, v41, v89
    v_add_f32 v42, v42, v90
    v_add_f32 v43, v43, v91
    v_add_f32 v44, v44, v92
    v_add_f32 v45, v45, v93
    v_add_f32 v46, v46, v94
    v_add_f32 v47, v47, v95
    v_add_f32 v48, v48, v96
    v_add_f32 v49, v49, v97
    v_add_f32 v50, v50, v98
    v_add_f32 v51, v51, v99
    v_add_f32 v52, v52, v100
    v_add_f32 v53, v53, v101
    v_add_f32 v54, v54, v102
    v_add_f32 v55, v55, v103
    v_add_f32 v56, v56, v104
    v_add_f32 v57, v57, v105
    v_add_f32 v58, v58, v106
    v_add_f32 v59, v59, v107
    v_add_f32 v60, v60, v108
    v_add_f32 v61, v61, v109
    v_add_f32 v62, v62, v110
    v_add_f32 v63, v63, v111
    v_fmac_f32_dpp v140, v232, v40 row_newbcast:0 row_mask:0xf bank_mask:0xf
    v_fmac_f32_dpp v141, v232, v41 row_newbcast:1 row_mask:0xf bank_mask:0xf
    v_fmac_f32_dpp v142, v232, v42 row_newbcast:2 row_mask:0xf bank_mask:0xf
    v_fmac_f32_dpp v143, v232, v43 row_newbcast:3 row_mask:0xf bank_mask:0xf
    v_fmac_f32_dpp v144, v232, v44 row_newbcast:4 row_mask:0xf bank_mask:0xf
    v_fmac_f32_dpp v145, v232, v45 row_newbcast:5 row_mask:0xf bank_mask:0xf
    v_fmac_f32_dpp v146, v232, v46 row_newbcast:6 row_mask:0xf bank_mask:0xf
    v_fmac_f32_dpp v147, v232, v47 row_newbcast:7 row_mask:0xf bank_mask:0xf
    v_fmac_f32_dpp v148, v232, v48 row_newbcast:8 row_mask:0xf bank_mask:0xf
    v_fmac_f32_dpp v149, v232, v49 row_newbcast:9 row_mask:0xf bank_mask:0xf
    v_fmac_f32_dpp v150, v232, v50 row_newbcast:10 row_mask:0xf bank_mask:0xf
    v_fmac_f32_dpp v151, v232, v51 row_newbcast:11 row_mask:0xf bank_mask:0xf
    v_fmac_f32_dpp v152, v232, v52 row_newbcast:12 row_mask:0xf bank_mask:0xf
    v_fmac_f32_dpp v153, v232, v53 row_newbcast:13 row_mask:0xf bank_mask:0xf
    v_fmac_f32_dpp v154, v232, v54 row_newbcast:14 row_mask:0xf bank_mask:0xf
    v_fmac_f32_dpp v155, v232, v55 row_newbcast:15 row_mask:0xf bank_mask:0xf
    v_fmac_f32_dpp v156, v233, v56 row_newbcast:0 row_mask:0xf bank_mask:0xf
    v_fmac_f32_dpp v157, v233, v57 row_newbcast:1 row_mask:0xf bank_mask:0xf
    v_fmac_f32_dpp v158, v233, v58 row_newbcast:2 row_mask:0xf bank_mask:0xf
    v_fmac_f32_dpp v159, v233, v59 row_newbcast:3 row_mask:0xf bank_mask:0xf
    v_fmac_f32_dpp v160, v233, v60 row_newbcast:4 row_mask:0xf bank_mask:0xf
    v_fmac_f32_dpp v161, v233, v61 row_newbcast:5 row_mask:0xf bank_mask:0xf
    v_fmac_f32_dpp v162, v233, v62 row_newbcast:6 row_mask:0xf bank_mask:0xf
    v_fmac_f32_dpp v163, v233, v63 row_newbcast:7 row_mask:0xf bank_mask:0xf
    v_cvt_pk_bf16_f32 v188, v140, v141
    v_cvt_pk_bf16_f32 v189, v142, v143
    v_cvt_pk_bf16_f32 v190, v144, v145
    v_cvt_pk_bf16_f32 v191, v146, v147
    v_cvt_pk_bf16_f32 v192, v148, v149
    v_cvt_pk_bf16_f32 v193, v150, v151
    v_cvt_pk_bf16_f32 v194, v152, v153
    v_cvt_pk_bf16_f32 v195, v154, v155
    v_cvt_pk_bf16_f32 v196, v156, v157
    v_cvt_pk_bf16_f32 v197, v158, v159
    v_cvt_pk_bf16_f32 v198, v160, v161
    v_cvt_pk_bf16_f32 v199, v162, v163
    v_lshlrev_b32 v140, 16, v188
    v_and_b32 v141, 0xffff0000, v188
    v_lshlrev_b32 v142, 16, v189
    v_and_b32 v143, 0xffff0000, v189
    v_lshlrev_b32 v144, 16, v190
    v_and_b32 v145, 0xffff0000, v190
    v_lshlrev_b32 v146, 16, v191
    v_and_b32 v147, 0xffff0000, v191
    v_lshlrev_b32 v148, 16, v192
    v_and_b32 v149, 0xffff0000, v192
    v_lshlrev_b32 v150, 16, v193
    v_and_b32 v151, 0xffff0000, v193
    v_lshlrev_b32 v152, 16, v194
    v_and_b32 v153, 0xffff0000, v194
    v_lshlrev_b32 v154, 16, v195
    v_and_b32 v155, 0xffff0000, v195
    v_lshlrev_b32 v156, 16, v196
    v_and_b32 v157, 0xffff0000, v196
    v_lshlrev_b32 v158, 16, v197
    v_and_b32 v159, 0xffff0000, v197
    v_lshlrev_b32 v160, 16, v198
    v_and_b32 v161, 0xffff0000, v198
    v_lshlrev_b32 v162, 16, v199
    v_and_b32 v163, 0xffff0000, v199
    v_mul_f32_dpp v164, v234, v140 row_newbcast:0 row_mask:0xf bank_mask:0xf
    v_mul_f32_dpp v165, v234, v141 row_newbcast:1 row_mask:0xf bank_mask:0xf
    v_mul_f32_dpp v166, v234, v142 row_newbcast:2 row_mask:0xf bank_mask:0xf
    v_mul_f32_dpp v167, v234, v143 row_newbcast:3 row_mask:0xf bank_mask:0xf
    v_mul_f32_dpp v168, v234, v144 row_newbcast:4 row_mask:0xf bank_mask:0xf
    v_mul_f32_dpp v169, v234, v145 row_newbcast:5 row_mask:0xf bank_mask:0xf
    v_mul_f32_dpp v170, v234, v146 row_newbcast:6 row_mask:0xf bank_mask:0xf
    v_mul_f32_dpp v171, v234, v147 row_newbcast:7 row_mask:0xf bank_mask:0xf
    v_mul_f32_dpp v172, v234, v148 row_newbcast:8 row_mask:0xf bank_mask:0xf
    v_mul_f32_dpp v173, v234, v149 row_newbcast:9 row_mask:0xf bank_mask:0xf
    v_mul_f32_dpp v174, v234, v150 row_newbcast:10 row_mask:0xf bank_mask:0xf
    v_mul_f32_dpp v175, v234, v151 row_newbcast:11 row_mask:0xf bank_mask:0xf
    v_mul_f32_dpp v176, v234, v152 row_newbcast:12 row_mask:0xf bank_mask:0xf
    v_mul_f32_dpp v177, v234, v153 row_newbcast:13 row_mask:0xf bank_mask:0xf
    v_mul_f32_dpp v178, v234, v154 row_newbcast:14 row_mask:0xf bank_mask:0xf
    v_mul_f32_dpp v179, v234, v155 row_newbcast:15 row_mask:0xf bank_mask:0xf
    v_mul_f32_dpp v180, v235, v156 row_newbcast:0 row_mask:0xf bank_mask:0xf
    v_mul_f32_dpp v181, v235, v157 row_newbcast:1 row_mask:0xf bank_mask:0xf
    v_mul_f32_dpp v182, v235, v158 row_newbcast:2 row_mask:0xf bank_mask:0xf
    v_mul_f32_dpp v183, v235, v159 row_newbcast:3 row_mask:0xf bank_mask:0xf
    v_mul_f32_dpp v184, v235, v160 row_newbcast:4 row_mask:0xf bank_mask:0xf
    v_mul_f32_dpp v185, v235, v161 row_newbcast:5 row_mask:0xf bank_mask:0xf
    v_mul_f32_dpp v186, v235, v162 row_newbcast:6 row_mask:0xf bank_mask:0xf
    v_mul_f32_dpp v187, v235, v163 row_newbcast:7 row_mask:0xf bank_mask:0xf
    v_cvt_pk_bf16_f32 v200, v164, v165
    v_cvt_pk_bf16_f32 v201, v166, v167
    v_cvt_pk_bf16_f32 v202, v168, v169
    v_cvt_pk_bf16_f32 v203, v170, v171
    buffer_store_dwordx4 v[200:203], v1, s[16:19], s45 offen offset:0 sc1
    v_cvt_pk_bf16_f32 v204, v172, v173
    v_cvt_pk_bf16_f32 v205, v174, v175
    v_cvt_pk_bf16_f32 v206, v176, v177
    v_cvt_pk_bf16_f32 v207, v178, v179
    buffer_store_dwordx4 v[204:207], v1, s[16:19], s45 offen offset:2048 sc1
    v_cvt_pk_bf16_f32 v208, v180, v181
    v_cvt_pk_bf16_f32 v209, v182, v183
    v_cvt_pk_bf16_f32 v210, v184, v185
    v_cvt_pk_bf16_f32 v211, v186, v187
    buffer_store_dwordx4 v[208:211], v2, s[16:19], s45 offen offset:0 sc1
    v_add_f32 v16, v140, v141
    v_mul_f32 v17, v140, v140
    v_add_f32 v18, v142, v143
    v_mul_f32 v19, v141, v141
    v_fmac_f32 v17, v142, v142
    v_fmac_f32 v19, v143, v143
    v_add_f32 v16, v16, v144
    v_fmac_f32 v17, v144, v144
    v_add_f32 v18, v18, v145
    v_fmac_f32 v19, v145, v145
    v_add_f32 v16, v16, v146
    v_fmac_f32 v17, v146, v146
    v_add_f32 v18, v18, v147
    v_fmac_f32 v19, v147, v147
    v_add_f32 v16, v16, v148
    v_fmac_f32 v17, v148, v148
    v_add_f32 v18, v18, v149
    v_fmac_f32 v19, v149, v149
    v_add_f32 v16, v16, v150
    v_fmac_f32 v17, v150, v150
    v_add_f32 v18, v18, v151
    v_fmac_f32 v19, v151, v151
    v_add_f32 v16, v16, v152
    v_fmac_f32 v17, v152, v152
    v_add_f32 v18, v18, v153
    v_fmac_f32 v19, v153, v153
    v_add_f32 v16, v16, v154
    v_fmac_f32 v17, v154, v154
    v_add_f32 v18, v18, v155
    v_fmac_f32 v19, v155, v155
    v_add_f32 v16, v16, v156
    v_fmac_f32 v17, v156, v156
    v_add_f32 v18, v18, v157
    v_fmac_f32 v19, v157, v157
    v_add_f32 v16, v16, v158
    v_fmac_f32 v17, v158, v158
    v_add_f32 v18, v18, v159
    v_fmac_f32 v19, v159, v159
    v_add_f32 v16, v16, v160
    v_fmac_f32 v17, v160, v160
    v_add_f32 v18, v18, v161
    v_fmac_f32 v19, v161, v161
    v_add_f32 v16, v16, v162
    v_fmac_f32 v17, v162, v162
    v_add_f32 v18, v18, v163
    v_fmac_f32 v19, v163, v163
    v_add_f32 v16, v16, v18
    v_add_f32 v17, v17, v19
    v_mov_b32 v18, v16
    v_mov_b32 v19, v17
    v_lshlrev_b32 v20, 3, v8
    s_mul_i32 s29, s27, 3072
    s_lshl_b32 s36, s9, 1
    s_add_u32 s36, s36, s26
    s_lshl_b32 s36, s36, 8
    s_add_u32 s29, s29, s36
    s_add_u32 s29, s29, 0x30000
    v_permlane32_swap_b32 v16, v18
    v_permlane32_swap_b32 v17, v19
    v_add_f32 v16, v16, v18
    v_add_f32 v17, v17, v19
    s_mov_b32 exec_hi, 0
    buffer_store_dwordx2 v[16:17], v20, s[16:19], s29 offen sc1
    s_mov_b32 exec_hi, -1
    s_mul_i32 s36, s8, 6
    s_add_u32 s36, s36, s9
    s_lshl_b32 s36, s36, 2
    s_add_u32 s36, s36, s3
    s_lshl_b32 s36, s36, 7
    s_add_u32 s45, s36, 0xa0000
    v_mov_b32 v212, v188
    v_mov_b32 v213, v189
    v_mov_b32 v214, v190
    v_mov_b32 v215, v191
    v_mov_b32 v216, v192
    v_mov_b32 v217, v193
    v_mov_b32 v218, v194
    v_mov_b32 v219, v195
    v_mov_b32 v220, v196
    v_mov_b32 v221, v197
    v_mov_b32 v222, v198
    v_mov_b32 v223, v199
    s_branch K456_B
K456_NOA:
    s_and_b32 s12, s2, 1
    s_lshl_b32 s12, s12, 2
    s_bfe_u32 s13, s2, 0x20003
    s_add_u32 s12, s12, s13
    s_bfe_u32 s13, s2, 0x20001
    s_lshl_b32 s13, s13, 3
    s_lshr_b32 s14, s2, 5
    s_add_u32 s13, s13, s14
    s_mul_i32 s41, s13, 9
    s_mul_i32 s15, s41, 36864
    s_add_u32 s15, s15, 0x1800000
    s_lshl_b32 s30, s3, 12
    s_add_u32 s31, s15, s30
    s_lshl_b32 s34, s3, 10
    s_add_u32 s35, s15, s34
    s_lshl_b32 s38, s41, 8
    s_add_u32 s38, s38, 0x3c00000
    v_lshlrev_b32 v28, 3, v0
    v_and_b32 v29, 31, v0
    v_lshlrev_b32 v31, 4, v29
    v_lshlrev_b32 v29, 3, v29
    v_add_u32 v29, 2048, v29
    v_lshrrev_b32 v30, 5, v0
    v_lshl_add_u32 v30, v30, 10, v31
    v_add_u32 v30, 147456, v30
    v_add_u32 v31, 155648, v31
    v_mov_b32 v242, 1
    v_min_u32 v241, 1, v4
    v_lshlrev_b32 v241, 30, v241
    s_mov_b32 s45, 0x7f000000
    s_mov_b32 s44, 0x7f000000
    s_add_u32 s39, s38, 0
    buffer_load_dwordx2 a[96:97], v28, s[16:19], s39 offen
    buffer_load_dwordx2 a[114:115], v29, s[16:19], s39 offen
    s_add_u32 s39, s38, 73728
    buffer_load_dwordx2 a[98:99], v28, s[16:19], s39 offen
    buffer_load_dwordx2 a[116:117], v29, s[16:19], s39 offen
    s_add_u32 s39, s38, 147456
    buffer_load_dwordx2 a[100:101], v28, s[16:19], s39 offen
    buffer_load_dwordx2 a[118:119], v29, s[16:19], s39 offen
    s_add_u32 s39, s38, 221184
    buffer_load_dwordx2 a[102:103], v28, s[16:19], s39 offen
    buffer_load_dwordx2 a[120:121], v29, s[16:19], s39 offen
    s_add_u32 s39, s38, 294912
    buffer_load_dwordx2 a[104:105], v28, s[16:19], s39 offen
    buffer_load_dwordx2 a[122:123], v29, s[16:19], s39 offen
    s_add_u32 s39, s38, 368640
    buffer_load_dwordx2 a[106:107], v28, s[16:19], s39 offen
    buffer_load_dwordx2 a[124:125], v29, s[16:19], s39 offen
    s_add_u32 s39, s38, 442368
    buffer_load_dwordx2 a[108:109], v28, s[16:19], s39 offen
    buffer_load_dwordx2 a[126:127], v29, s[16:19], s39 offen
    s_add_u32 s39, s38, 516096
    buffer_load_dwordx2 a[110:111], v28, s[16:19], s39 offen
    buffer_load_dwordx2 a[128:129], v29, s[16:19], s39 offen
    s_add_u32 s39, s38, 589824
    buffer_load_dwordx2 a[112:113], v28, s[16:19], s39 offen
    buffer_load_dwordx2 a[130:131], v29, s[16:19], s39 offen
    buffer_store_dword v242, v241, s[16:19], s45 offen
    buffer_store_dword v242, v241, s[16:19], s45 offen
    buffer_store_dword v242, v241, s[16:19], s45 offen
    buffer_store_dword v242, v241, s[16:19], s45 offen
K456_B:
    s_lshl_b32 s8, s12, 3
    s_lshl_b32 s9, s3, 1
    s_add_u32 s8, s8, s9
    s_mul_i32 s36, s8, 36864
    s_add_u32 s36, s36, 0x1200000
    s_add_u32 s37, s36, 36864
    s_mul_i32 s32, s8, 3072
    s_add_u32 s32, s32, 0x30000
    s_mul_i32 s42, s8, 1536
    s_add_u32 s42, s42, 0xa0000
    v_and_b32 v5, 31, v4
    v_lshrrev_b32 v6, 5, v4
    v_lshlrev_b32 v7, 3, v5
    v_mul_u32_u24 v10, 1536, v6
    v_add_u32 v7, v7, v10
    v_min_u32 v11, 23, v4
    v_lshlrev_b32 v11, 7, v11
    v_add_u32 v12, 0, v1
    v_add_u32 v13, 36864, v1
    v_add_u32 v14, 73728, v1
    v_add_u32 v15, 110592, v1
    v_add_u32 v3, 147456, v1
    v_lshrrev_b32 v10, 4, v5
    v_mul_u32_u24 v8, 147456, v10
    v_lshl_add_u32 v8, v6, 8, v8
    v_and_b32 v10, 15, v5
    v_lshl_add_u32 v8, v10, 4, v8
    v_add_u32 v9, -1, v6
    s_mov_b32 s40, 0x409d30fc
    v_mov_b32 v2, v1
    s_bfe_u32 s59, s2, 0x20001
    s_and_b32 s60, s2, 1
    s_lshl_b32 s60, s60, 3
    s_bfe_u32 s61, s2, 0x30003
    s_add_u32 s60, s60, s61
    s_lshr_b32 s61, s2, 6
    s_mul_i32 s20, s59, 36864
    s_mul_i32 s21, s61, 1327104
    s_add_u32 s21, s21, s20
    s_mul_i32 s22, s3, 9216
    s_add_u32 s21, s21, s22
    s_add_u32 s21, s21, 0x2300000
    s_mul_i32 s22, s59, 294912
    s_add_u32 s22, s22, s21
    s_add_u32 s23, s21, 1327104
    s_add_u32 s22, s22, 442368
    s_sub_u32 s24, s22, 1327104
    s_cmp_ge_u32 s22, s23
    s_cselect_b32 s50, s24, s22
    s_add_u32 s22, s50, 147456
    s_sub_u32 s24, s22, 1327104
    s_cmp_ge_u32 s22, s23
    s_cselect_b32 s51, s24, s22
    s_add_u32 s22, s51, 147456
    s_sub_u32 s24, s22, 1327104
    s_cmp_ge_u32 s22, s23
    s_cselect_b32 s52, s24, s22
    s_add_u32 s22, s52, 147456
    s_sub_u32 s24, s22, 1327104
    s_cmp_ge_u32 s22, s23
    s_cselect_b32 s53, s24, s22
    s_add_u32 s22, s53, 147456
    s_sub_u32 s24, s22, 1327104
    s_cmp_ge_u32 s22, s23
    s_cselect_b32 s54, s24, s22
    s_add_u32 s22, s54, 147456
    s_sub_u32 s24, s22, 1327104
    s_cmp_ge_u32 s22, s23
    s_cselect_b32 s55, s24, s22
    s_add_u32 s22, s55, 147456
    s_sub_u32 s24, s22, 1327104
    s_cmp_ge_u32 s22, s23
    s_cselect_b32 s56, s24, s22
    s_add_u32 s22, s56, 147456
    s_sub_u32 s24, s22, 1327104
    s_cmp_ge_u32 s22, s23
    s_cselect_b32 s57, s24, s22
    s_add_u32 s22, s57, 147456
    s_sub_u32 s24, s22, 1327104
    s_cmp_ge_u32 s22, s23
    s_cselect_b32 s58, s24, s22
    s_sub_u32 s51, s51, 1024
    s_sub_u32 s52, s52, 2048
    s_sub_u32 s53, s53, 3072
    s_sub_u32 s55, s55, 1024
    s_lshl_b32 s62, s3, 13
    s_cmp_eq_u32 s59, 0
    s_cselect_b32 s24, 0, 2
    s_lshl_b32 s24, s24, 10
    s_sub_u32 s56, s56, s24
    s_cmp_eq_u32 s59, 0
    s_cselect_b32 s24, 1, 0
    s_lshl_b32 s24, s24, 10
    s_sub_u32 s57, s57, s24
    s_cmp_eq_u32 s59, 0
    s_cselect_b32 s24, 2, 1
    s_lshl_b32 s24, s24, 10
    s_sub_u32 s58, s58, s24
    s_cmp_eq_u32 s59, 0
    s_cselect_b32 s63, 0x7f000000, s56
    v_mov_b32 v240, v1
    s_lshl_b32 s24, s60, 2
    s_add_u32 s24, s24, s3
    s_mul_i32 s46, s24, 294912
    s_add_u32 s46, s46, s20
    s_add_u32 s46, s46, 0x2900000
    s_lshr_b32 s24, s24, 1
    s_lshl_b32 s47, s24, 12
    s_lshl_b32 s22, s59, 10
    s_add_u32 s47, s47, s22
    s_add_u32 s47, s47, 0x80000
    s_mul_i32 s24, s24, 3072
    s_add_u32 s24, s24, 0xa0010
    v_add_u32 v244, 0, v1
    v_add_u32 v245, 9216, v1
    v_add_u32 v246, 18432, v1
    v_add_u32 v247, 27648, v1
    v_and_b32 v236, 7, v4
    v_lshlrev_b32 v236, 7, v236
    v_min_u32 v237, 31, v4
    v_subrev_u32 v237, 8, v237
    v_lshl_add_u32 v237, v237, 7, s24
    v_add_u32 v238, s47, v236
    v_cmp_gt_u32 vcc, 8, v4
    s_nop 1
    v_cndmask_b32 v237, v237, v238, vcc
    s_lshl_b32 s29, s12, 2
    s_add_u32 s29, s29, s3
    s_lshl_b32 s29, s29, 5
    s_add_u32 s29, s29, s13
    s_lshl_b32 s29, s29, 7
    s_add_u32 s29, s29, 0x80000
    s_waitcnt vmcnt(4)
    v_accvgpr_read_b32 v40, a96
    v_accvgpr_read_b32 v41, a97
    v_accvgpr_read_b32 v42, a98
    v_accvgpr_read_b32 v43, a99
    v_accvgpr_read_b32 v44, a100
    v_accvgpr_read_b32 v45, a101
    v_accvgpr_read_b32 v46, a102
    v_accvgpr_read_b32 v47, a103
    v_accvgpr_read_b32 v48, a104
    v_accvgpr_read_b32 v49, a105
    v_accvgpr_read_b32 v50, a106
    v_accvgpr_read_b32 v51, a107
    v_accvgpr_read_b32 v52, a108
    v_accvgpr_read_b32 v53, a109
    v_accvgpr_read_b32 v54, a110
    v_accvgpr_read_b32 v55, a111
    v_accvgpr_read_b32 v56, a112
    v_accvgpr_read_b32 v57, a113
    v_accvgpr_read_b32 v58, a114
    v_accvgpr_read_b32 v59, a115
    v_accvgpr_read_b32 v60, a116
    v_accvgpr_read_b32 v61, a117
    v_accvgpr_read_b32 v62, a118
    v_accvgpr_read_b32 v63, a119
    v_accvgpr_read_b32 v64, a120
    v_accvgpr_read_b32 v65, a121
    v_accvgpr_read_b32 v66, a122
    v_accvgpr_read_b32 v67, a123
    v_accvgpr_read_b32 v68, a124
    v_accvgpr_read_b32 v69, a125
    v_accvgpr_read_b32 v70, a126
    v_accvgpr_read_b32 v71, a127
    v_accvgpr_read_b32 v72, a128
    v_accvgpr_read_b32 v73, a129
    v_accvgpr_read_b32 v74, a130
    v_accvgpr_read_b32 v75, a131
    v_add_f32 v40, v40, v42
    v_add_f32 v41, v41, v43
    v_add_f32 v58, v58, v60
    v_add_f32 v59, v59, v61
    v_add_f32 v40, v40, v44
    v_add_f32 v41, v41, v45
    v_add_f32 v58, v58, v62
    v_add_f32 v59, v59, v63
    v_add_f32 v40, v40, v46
    v_add_f32 v41, v41, v47
    v_add_f32 v58, v58, v64
    v_add_f32 v59, v59, v65
    v_add_f32 v40, v40, v48
    v_add_f32 v41, v41, v49
    v_add_f32 v58, v58, v66
    v_add_f32 v59, v59, v67
    v_add_f32 v40, v40, v50
    v_add_f32 v41, v41, v51
    v_add_f32 v58, v58, v68
    v_add_f32 v59, v59, v69
    v_add_f32 v40, v40, v52
    v_add_f32 v41, v41, v53
    v_add_f32 v58, v58, v70
    v_add_f32 v59, v59, v71
    v_add_f32 v40, v40, v54
    v_add_f32 v41, v41, v55
    v_add_f32 v58, v58, v72
    v_add_f32 v59, v59, v73
    v_add_f32 v40, v40, v56
    v_add_f32 v41, v41, v57
    v_add_f32 v58, v58, v74
    v_add_f32 v59, v59, v75
    v_cvt_pk_bf16_f32 v42, v40, v40
    v_cvt_pk_bf16_f32 v43, v41, v41
    v_and_b32 v42, 0xffff0000, v42
    v_and_b32 v43, 0xffff0000, v43
    v_sub_f32 v40, v40, v42
    v_sub_f32 v41, v41, v43
    v_cvt_pk_bf16_f32 v44, v42, v40
    v_cvt_pk_bf16_f32 v45, v42, v43
    v_cvt_pk_bf16_f32 v46, v41, v43
    v_mov_b32 v47, 0
    v_mov_b32 v48, 0
    v_mov_b32 v49, 0
    v_mov_b32 v50, 0
    v_mov_b32 v51, 0
    ds_write_b128 v30, v[44:47]
    ds_write_b128 v30, v[48:51] offset:512
    v_cvt_pk_bf16_f32 v60, v58, v58
    v_cvt_pk_bf16_f32 v61, v59, v59
    v_and_b32 v60, 0xffff0000, v60
    v_and_b32 v61, 0xffff0000, v61
    v_sub_f32 v58, v58, v60
    v_sub_f32 v59, v59, v61
    v_cvt_pk_bf16_f32 v62, v60, v58
    v_cvt_pk_bf16_f32 v63, v60, v61
    v_cvt_pk_bf16_f32 v64, v59, v61
    v_mov_b32 v65, 0
    v_mov_b32 v66, 0
    v_mov_b32 v67, 0
    v_mov_b32 v68, 0
    v_mov_b32 v69, 0
    ds_write_b128 v31, v[62:65]
    ds_write_b128 v31, v[66:69] offset:512
    s_waitcnt vmcnt(0)
    buffer_store_dword v242, v241, s[16:19], s45 offen sc1
    s_add_u32 m0, s30, 0
    s_add_u32 s33, s31, 0
    buffer_load_dwordx4 v1, s[16:19], s33 offen offset:0 lds
    buffer_load_dwordx4 v1, s[16:19], s33 offen offset:1024 lds
    buffer_load_dwordx4 v1, s[16:19], s33 offen offset:2048 lds
    buffer_load_dwordx4 v1, s[16:19], s33 offen offset:3072 lds
    s_add_u32 m0, s30, 16384
    s_add_u32 s33, s31, 16384
    buffer_load_dwordx4 v1, s[16:19], s33 offen offset:0 lds
    buffer_load_dwordx4 v1, s[16:19], s33 offen offset:1024 lds
    buffer_load_dwordx4 v1, s[16:19], s33 offen offset:2048 lds
    buffer_load_dwordx4 v1, s[16:19], s33 offen offset:3072 lds
    s_add_u32 m0, s34, 32768
    s_add_u32 s33, s35, 32768
    buffer_load_dwordx4 v1, s[16:19], s33 offen lds
    s_add_u32 m0, s30, 36864
    s_add_u32 s33, s31, 36864
    buffer_load_dwordx4 v1, s[16:19], s33 offen offset:0 lds
    buffer_load_dwordx4 v1, s[16:19], s33 offen offset:1024 lds
    buffer_load_dwordx4 v1, s[16:19], s33 offen offset:2048 lds
    buffer_load_dwordx4 v1, s[16:19], s33 offen offset:3072 lds
    s_add_u32 m0, s30, 53248
    s_add_u32 s33, s31, 53248
    buffer_load_dwordx4 v1, s[16:19], s33 offen offset:0 lds
    buffer_load_dwordx4 v1, s[16:19], s33 offen offset:1024 lds
    buffer_load_dword v243, v11, s[16:19], s42 offen sc1
    buffer_load_dwordx4 v1, s[16:19], s33 offen offset:2048 lds
    buffer_load_dwordx4 v1, s[16:19], s33 offen offset:3072 lds
    s_add_u32 m0, s34, 69632
    s_add_u32 s33, s35, 69632
    buffer_load_dwordx4 v1, s[16:19], s33 offen lds
    s_add_u32 m0, s30, 73728
    s_add_u32 s33, s31, 73728
    buffer_load_dwordx4 v1, s[16:19], s33 offen offset:0 lds
    buffer_load_dwordx4 v1, s[16:19], s33 offen offset:1024 lds
    buffer_load_dwordx4 v1, s[16:19], s33 offen offset:2048 lds
    buffer_load_dwordx4 v1, s[16:19], s33 offen offset:3072 lds
    s_add_u32 m0, s30, 90112
    s_add_u32 s33, s31, 90112
    buffer_load_dwordx4 v1, s[16:19], s33 offen offset:0 lds
    buffer_load_dwordx4 v1, s[16:19], s33 offen offset:1024 lds
    buffer_load_dwordx4 v1, s[16:19], s33 offen offset:2048 lds
    buffer_load_dwordx4 v1, s[16:19], s33 offen offset:3072 lds
    s_add_u32 m0, s34, 106496
    s_add_u32 s33, s35, 106496
    buffer_load_dwordx4 v1, s[16:19], s33 offen lds
    s_waitcnt vmcnt(12)
    s_mov_b32 s10, 262144
K456_P1:
    v_cmp_ne_u32 vcc, 0, v243
    s_nop 0
    s_cmp_eq_u64 vcc, -1
    s_cbranch_scc1 K456_P1_X
    buffer_load_dword v243, v11, s[16:19], s42 offen offset:0 sc1
    s_waitcnt vmcnt(0)
    s_sub_u32 s10, s10, 1
    s_cbranch_scc0 K456_P1
K456_P1_X:
    s_mul_i32 s43, s8, 294912
    s_lshl_b32 s11, s41, 9
    s_add_u32 s43, s43, s11
    s_add_u32 s43, s43, 0x2900000
    buffer_load_dwordx4 a[0:3], v2, s[16:19], s36 offen offset:0 sc1
    buffer_load_dwordx4 a[4:7], v2, s[16:19], s37 offen offset:0 sc1
    buffer_load_dwordx4 a[8:11], v2, s[16:19], s36 offen offset:1024 sc1
    buffer_load_dwordx4 a[12:15], v2, s[16:19], s37 offen offset:1024 sc1
    buffer_load_dwordx4 a[16:19], v2, s[16:19], s36 offen offset:2048 sc1
    buffer_load_dwordx4 a[20:23], v2, s[16:19], s37 offen offset:2048 sc1
    buffer_load_dwordx4 a[24:27], v2, s[16:19], s36 offen offset:3072 sc1
    buffer_load_dwordx4 a[28:31], v2, s[16:19], s37 offen offset:3072 sc1
    v_add_u32 v2, 4096, v2
    buffer_load_dwordx4 a[32:35], v2, s[16:19], s36 offen offset:0 sc1
    buffer_load_dwordx4 a[36:39], v2, s[16:19], s37 offen offset:0 sc1
    buffer_load_dwordx4 a[40:43], v2, s[16:19], s36 offen offset:1024 sc1
    buffer_load_dwordx4 a[44:47], v2, s[16:19], s37 offen offset:1024 sc1
    buffer_load_dwordx4 a[48:51], v2, s[16:19], s36 offen offset:2048 sc1
    buffer_load_dwordx4 a[52:55], v2, s[16:19], s37 offen offset:2048 sc1
    buffer_load_dwordx4 a[56:59], v2, s[16:19], s36 offen offset:3072 sc1
    buffer_load_dwordx4 a[60:63], v2, s[16:19], s37 offen offset:3072 sc1
    v_add_u32 v2, 4096, v2
    s_waitcnt vmcnt(16)
    s_waitcnt lgkmcnt(0)
    s_barrier
    ds_read_b128 v[184:187], v12 offset:0
    ds_read_b128 v[188:191], v13 offset:0
    ds_read_b128 v[192:195], v14 offset:0
    ds_read_b128 v[196:199], v12 offset:1024
    s_waitcnt vmcnt(14)
    s_waitcnt lgkmcnt(3)
    v_mfma_f32_32x32x16_bf16 v[56:71], v[184:187], a[0:3], 0
    ds_read_b128 v[200:203], v13 offset:1024
    v_mfma_f32_32x32x16_bf16 v[72:87], v[184:187], a[4:7], 0
    buffer_load_dwordx4 a[64:67], v2, s[16:19], s36 offen offset:0 sc1
    s_waitcnt lgkmcnt(3)
    v_mfma_f32_32x32x16_bf16 v[88:103], v[188:191], a[0:3], 0
    ds_read_b128 v[204:207], v14 offset:1024
    v_mfma_f32_32x32x16_bf16 v[104:119], v[188:191], a[4:7], 0
    buffer_load_dwordx4 a[68:71], v2, s[16:19], s37 offen offset:0 sc1
    s_waitcnt lgkmcnt(3)
    v_mfma_f32_32x32x16_bf16 v[120:135], v[192:195], a[0:3], 0
    ds_read_b128 v[184:187], v12 offset:2048
    v_mfma_f32_32x32x16_bf16 v[136:151], v[192:195], a[4:7], 0
    buffer_load_dwordx4 a[72:75], v2, s[16:19], s36 offen offset:1024 sc1
    s_waitcnt vmcnt(15)
    s_waitcnt lgkmcnt(3)
    v_mfma_f32_32x32x16_bf16 v[56:71], v[196:199], a[8:11], v[56:71]
    ds_read_b128 v[188:191], v13 offset:2048
    v_mfma_f32_32x32x16_bf16 v[72:87], v[196:199], a[12:15], v[72:87]
    buffer_load_dwordx4 a[76:79], v2, s[16:19], s37 offen offset:1024 sc1
    s_waitcnt lgkmcnt(3)
    v_mfma_f32_32x32x16_bf16 v[88:103], v[200:203], a[8:11], v[88:103]
    ds_read_b128 v[192:195], v14 offset:2048
    v_mfma_f32_32x32x16_bf16 v[104:119], v[200:203], a[12:15], v[104:119]
    buffer_load_dwordx4 a[80:83], v2, s[16:19], s36 offen offset:2048 sc1
    s_waitcnt lgkmcnt(3)
    v_mfma_f32_32x32x16_bf16 v[120:135], v[204:207], a[8:11], v[120:135]
    ds_read_b128 v[196:199], v12 offset:3072
    v_mfma_f32_32x32x16_bf16 v[136:151], v[204:207], a[12:15], v[136:151]
    buffer_load_dwordx4 a[84:87], v2, s[16:19], s37 offen offset:2048 sc1
    s_waitcnt vmcnt(16)
    s_waitcnt lgkmcnt(3)
    v_mfma_f32_32x32x16_bf16 v[56:71], v[184:187], a[16:19], v[56:71]
    ds_read_b128 v[200:203], v13 offset:3072
    v_mfma_f32_32x32x16_bf16 v[72:87], v[184:187], a[20:23], v[72:87]
    buffer_load_dwordx4 a[88:91], v2, s[16:19], s36 offen offset:3072 sc1
    s_waitcnt lgkmcnt(3)
    v_mfma_f32_32x32x16_bf16 v[88:103], v[188:191], a[16:19], v[88:103]
    ds_read_b128 v[204:207], v14 offset:3072
    v_mfma_f32_32x32x16_bf16 v[104:119], v[188:191], a[20:23], v[104:119]
    buffer_load_dwordx4 a[92:95], v2, s[16:19], s37 offen offset:3072 sc1
    v_add_u32 v2, 4096, v2
    s_waitcnt lgkmcnt(3)
    v_mfma_f32_32x32x16_bf16 v[120:135], v[192:195], a[16:19], v[120:135]
    ds_read_b128 v[184:187], v12 offset:4096
    v_mfma_f32_32x32x16_bf16 v[136:151], v[192:195], a[20:23], v[136:151]
    s_waitcnt vmcnt(16)
    s_waitcnt lgkmcnt(3)
    v_mfma_f32_32x32x16_bf16 v[56:71], v[196:199], a[24:27], v[56:71]
    ds_read_b128 v[188:191], v13 offset:4096
    v_mfma_f32_32x32x16_bf16 v[72:87], v[196:199], a[28:31], v[72:87]
    s_waitcnt lgkmcnt(3)
    v_mfma_f32_32x32x16_bf16 v[88:103], v[200:203], a[24:27], v[88:103]
    ds_read_b128 v[192:195], v14 offset:4096
    v_mfma_f32_32x32x16_bf16 v[104:119], v[200:203], a[28:31], v[104:119]
    s_waitcnt lgkmcnt(3)
    v_mfma_f32_32x32x16_bf16 v[120:135], v[204:207], a[24:27], v[120:135]
    ds_read_b128 v[196:199], v12 offset:5120
    v_mfma_f32_32x32x16_bf16 v[136:151], v[204:207], a[28:31], v[136:151]
    s_waitcnt vmcnt(14)
    s_waitcnt lgkmcnt(3)
    v_mfma_f32_32x32x16_bf16 v[56:71], v[184:187], a[32:35], v[56:71]
    ds_read_b128 v[200:203], v13 offset:5120
    v_mfma_f32_32x32x16_bf16 v[72:87], v[184:187], a[36:39], v[72:87]
    buffer_load_dwordx4 a[96:99], v2, s[16:19], s36 offen offset:0 sc1
    s_waitcnt lgkmcnt(3)
    v_mfma_f32_32x32x16_bf16 v[88:103], v[188:191], a[32:35], v[88:103]
    ds_read_b128 v[204:207], v14 offset:5120
    v_mfma_f32_32x32x16_bf16 v[104:119], v[188:191], a[36:39], v[104:119]
    buffer_load_dwordx4 a[100:103], v2, s[16:19], s37 offen offset:0 sc1
    s_waitcnt lgkmcnt(3)
    v_mfma_f32_32x32x16_bf16 v[120:135], v[192:195], a[32:35], v[120:135]
    ds_read_b128 v[184:187], v12 offset:6144
    v_mfma_f32_32x32x16_bf16 v[136:151], v[192:195], a[36:39], v[136:151]
    buffer_load_dwordx4 a[104:107], v2, s[16:19], s36 offen offset:1024 sc1
    s_waitcnt vmcnt(15)
    s_waitcnt lgkmcnt(3)
    v_mfma_f32_32x32x16_bf16 v[56:71], v[196:199], a[40:43], v[56:71]
    ds_read_b128 v[188:191], v13 offset:6144
    v_mfma_f32_32x32x16_bf16 v[72:87], v[196:199], a[44:47], v[72:87]
    buffer_load_dwordx4 a[108:111], v2, s[16:19], s37 offen offset:1024 sc1
    s_waitcnt lgkmcnt(3)
    v_mfma_f32_32x32x16_bf16 v[88:103], v[200:203], a[40:43], v[88:103]
    ds_read_b128 v[192:195], v14 offset:6144
    v_mfma_f32_32x32x16_bf16 v[104:119], v[200:203], a[44:47], v[104:119]
    buffer_load_dwordx4 a[112:115], v2, s[16:19], s36 offen offset:2048 sc1
    s_waitcnt lgkmcnt(3)
    v_mfma_f32_32x32x16_bf16 v[120:135], v[204:207], a[40:43], v[120:135]
    ds_read_b128 v[196:199], v12 offset:7168
    v_mfma_f32_32x32x16_bf16 v[136:151], v[204:207], a[44:47], v[136:151]
    buffer_load_dwordx4 a[116:119], v2, s[16:19], s37 offen offset:2048 sc1
    s_waitcnt vmcnt(16)
    s_waitcnt lgkmcnt(3)
    v_mfma_f32_32x32x16_bf16 v[56:71], v[184:187], a[48:51], v[56:71]
    ds_read_b128 v[200:203], v13 offset:7168
    v_mfma_f32_32x32x16_bf16 v[72:87], v[184:187], a[52:55], v[72:87]
    buffer_load_dwordx4 a[120:123], v2, s[16:19], s36 offen offset:3072 sc1
    s_waitcnt lgkmcnt(3)
    v_mfma_f32_32x32x16_bf16 v[88:103], v[188:191], a[48:51], v[88:103]
    ds_read_b128 v[204:207], v14 offset:7168
    v_mfma_f32_32x32x16_bf16 v[104:119], v[188:191], a[52:55], v[104:119]
    buffer_load_dwordx4 a[124:127], v2, s[16:19], s37 offen offset:3072 sc1
    v_add_u32 v2, 4096, v2
    s_waitcnt lgkmcnt(3)
    v_mfma_f32_32x32x16_bf16 v[120:135], v[192:195], a[48:51], v[120:135]
    ds_read_b128 v[184:187], v12 offset:8192
    v_mfma_f32_32x32x16_bf16 v[136:151], v[192:195], a[52:55], v[136:151]
    s_waitcnt vmcnt(16)
    s_waitcnt lgkmcnt(3)
    v_mfma_f32_32x32x16_bf16 v[56:71], v[196:199], a[56:59], v[56:71]
    ds_read_b128 v[188:191], v13 offset:8192
    v_mfma_f32_32x32x16_bf16 v[72:87], v[196:199], a[60:63], v[72:87]
    s_waitcnt lgkmcnt(3)
    v_mfma_f32_32x32x16_bf16 v[88:103], v[200:203], a[56:59], v[88:103]
    ds_read_b128 v[192:195], v14 offset:8192
    v_mfma_f32_32x32x16_bf16 v[104:119], v[200:203], a[60:63], v[104:119]
    s_waitcnt lgkmcnt(3)
    v_mfma_f32_32x32x16_bf16 v[120:135], v[204:207], a[56:59], v[120:135]
    ds_read_b128 v[196:199], v12 offset:9216
    v_mfma_f32_32x32x16_bf16 v[136:151], v[204:207], a[60:63], v[136:151]
    s_waitcnt vmcnt(14)
    s_waitcnt lgkmcnt(3)
    v_mfma_f32_32x32x16_bf16 v[56:71], v[184:187], a[64:67], v[56:71]
    ds_read_b128 v[200:203], v13 offset:9216
    v_mfma_f32_32x32x16_bf16 v[72:87], v[184:187], a[68:71], v[72:87]
    buffer_load_dwordx4 a[128:131], v2, s[16:19], s36 offen offset:0 sc1
    s_waitcnt lgkmcnt(3)
    v_mfma_f32_32x32x16_bf16 v[88:103], v[188:191], a[64:67], v[88:103]
    ds_read_b128 v[204:207], v14 offset:9216
    v_mfma_f32_32x32x16_bf16 v[104:119], v[188:191], a[68:71], v[104:119]
    buffer_load_dwordx4 a[132:135], v2, s[16:19], s37 offen offset:0 sc1
    s_waitcnt lgkmcnt(3)
    v_mfma_f32_32x32x16_bf16 v[120:135], v[192:195], a[64:67], v[120:135]
    ds_read_b128 v[184:187], v12 offset:10240
    v_mfma_f32_32x32x16_bf16 v[136:151], v[192:195], a[68:71], v[136:151]
    buffer_load_dwordx4 a[136:139], v2, s[16:19], s36 offen offset:1024 sc1
    s_waitcnt vmcnt(15)
    s_waitcnt lgkmcnt(3)
    v_mfma_f32_32x32x16_bf16 v[56:71], v[196:199], a[72:75], v[56:71]
    ds_read_b128 v[188:191], v13 offset:10240
    v_mfma_f32_32x32x16_bf16 v[72:87], v[196:199], a[76:79], v[72:87]
    buffer_load_dwordx4 a[140:143], v2, s[16:19], s37 offen offset:1024 sc1
    s_waitcnt lgkmcnt(3)
    v_mfma_f32_32x32x16_bf16 v[88:103], v[200:203], a[72:75], v[88:103]
    ds_read_b128 v[192:195], v14 offset:10240
    v_mfma_f32_32x32x16_bf16 v[104:119], v[200:203], a[76:79], v[104:119]
    buffer_load_dwordx4 a[144:147], v2, s[16:19], s36 offen offset:2048 sc1
    s_waitcnt lgkmcnt(3)
    v_mfma_f32_32x32x16_bf16 v[120:135], v[204:207], a[72:75], v[120:135]
    ds_read_b128 v[196:199], v12 offset:11264
    v_mfma_f32_32x32x16_bf16 v[136:151], v[204:207], a[76:79], v[136:151]
    buffer_load_dwordx4 a[148:151], v2, s[16:19], s37 offen offset:2048 sc1
    s_waitcnt vmcnt(16)
    s_waitcnt lgkmcnt(3)
    v_mfma_f32_32x32x16_bf16 v[56:71], v[184:187], a[80:83], v[56:71]
    ds_read_b128 v[200:203], v13 offset:11264
    v_mfma_f32_32x32x16_bf16 v[72:87], v[184:187], a[84:87], v[72:87]
    buffer_load_dwordx4 a[152:155], v2, s[16:19], s36 offen offset:3072 sc1
    s_waitcnt lgkmcnt(3)
    v_mfma_f32_32x32x16_bf16 v[88:103], v[188:191], a[80:83], v[88:103]
    ds_read_b128 v[204:207], v14 offset:11264
    v_mfma_f32_32x32x16_bf16 v[104:119], v[188:191], a[84:87], v[104:119]
    buffer_load_dwordx4 a[156:159], v2, s[16:19], s37 offen offset:3072 sc1
    v_add_u32 v2, 4096, v2
    s_waitcnt lgkmcnt(3)
    v_mfma_f32_32x32x16_bf16 v[120:135], v[192:195], a[80:83], v[120:135]
    ds_read_b128 v[184:187], v12 offset:12288
    v_mfma_f32_32x32x16_bf16 v[136:151], v[192:195], a[84:87], v[136:151]
    s_waitcnt vmcnt(16)
    s_waitcnt lgkmcnt(3)
    v_mfma_f32_32x32x16_bf16 v[56:71], v[196:199], a[88:91], v[56:71]
    ds_read_b128 v[188:191], v13 offset:12288
    v_mfma_f32_32x32x16_bf16 v[72:87], v[196:199], a[92:95], v[72:87]
    s_waitcnt lgkmcnt(3)
    v_mfma_f32_32x32x16_bf16 v[88:103], v[200:203], a[88:91], v[88:103]
    ds_read_b128 v[192:195], v14 offset:12288
    v_mfma_f32_32x32x16_bf16 v[104:119], v[200:203], a[92:95], v[104:119]
    s_waitcnt lgkmcnt(3)
    v_mfma_f32_32x32x16_bf16 v[120:135], v[204:207], a[88:91], v[120:135]
    ds_read_b128 v[196:199], v12 offset:13312
    v_mfma_f32_32x32x16_bf16 v[136:151], v[204:207], a[92:95], v[136:151]
    s_waitcnt vmcnt(14)
    s_waitcnt lgkmcnt(3)
    v_mfma_f32_32x32x16_bf16 v[56:71], v[184:187], a[96:99], v[56:71]
    ds_read_b128 v[200:203], v13 offset:13312
    v_mfma_f32_32x32x16_bf16 v[72:87], v[184:187], a[100:103], v[72:87]
    buffer_load_dwordx4 a[160:163], v2, s[16:19], s36 offen offset:0 sc1
    s_waitcnt lgkmcnt(3)
    v_mfma_f32_32x32x16_bf16 v[88:103], v[188:191], a[96:99], v[88:103]
    ds_read_b128 v[204:207], v14 offset:13312
    v_mfma_f32_32x32x16_bf16 v[104:119], v[188:191], a[100:103], v[104:119]
    buffer_load_dwordx4 a[164:167], v2, s[16:19], s37 offen offset:0 sc1
    s_waitcnt lgkmcnt(3)
    v_mfma_f32_32x32x16_bf16 v[120:135], v[192:195], a[96:99], v[120:135]
    ds_read_b128 v[184:187], v12 offset:14336
    v_mfma_f32_32x32x16_bf16 v[136:151], v[192:195], a[100:103], v[136:151]
    buffer_load_dwordx4 a[168:171], v2, s[16:19], s36 offen offset:1024 sc1
    s_waitcnt vmcnt(15)
    s_waitcnt lgkmcnt(3)
    v_mfma_f32_32x32x16_bf16 v[56:71], v[196:199], a[104:107], v[56:71]
    ds_read_b128 v[188:191], v13 offset:14336
    v_mfma_f32_32x32x16_bf16 v[72:87], v[196:199], a[108:111], v[72:87]
    buffer_load_dwordx4 a[172:175], v2, s[16:19], s37 offen offset:1024 sc1
    s_waitcnt lgkmcnt(3)
    v_mfma_f32_32x32x16_bf16 v[88:103], v[200:203], a[104:107], v[88:103]
    ds_read_b128 v[192:195], v14 offset:14336
    v_mfma_f32_32x32x16_bf16 v[104:119], v[200:203], a[108:111], v[104:119]
    buffer_load_dwordx4 a[176:179], v2, s[16:19], s36 offen offset:2048 sc1
    s_waitcnt lgkmcnt(3)
    v_mfma_f32_32x32x16_bf16 v[120:135], v[204:207], a[104:107], v[120:135]
    ds_read_b128 v[196:199], v12 offset:15360
    v_mfma_f32_32x32x16_bf16 v[136:151], v[204:207], a[108:111], v[136:151]
    buffer_load_dwordx4 a[180:183], v2, s[16:19], s37 offen offset:2048 sc1
    s_waitcnt vmcnt(16)
    s_waitcnt lgkmcnt(3)
    v_mfma_f32_32x32x16_bf16 v[56:71], v[184:187], a[112:115], v[56:71]
    ds_read_b128 v[200:203], v13 offset:15360
    v_mfma_f32_32x32x16_bf16 v[72:87], v[184:187], a[116:119], v[72:87]
    buffer_load_dwordx4 a[184:187], v2, s[16:19], s36 offen offset:3072 sc1
    s_waitcnt lgkmcnt(3)
    v_mfma_f32_32x32x16_bf16 v[88:103], v[188:191], a[112:115], v[88:103]
    ds_read_b128 v[204:207], v14 offset:15360
    v_mfma_f32_32x32x16_bf16 v[104:119], v[188:191], a[116:119], v[104:119]
    buffer_load_dwordx4 a[188:191], v2, s[16:19], s37 offen offset:3072 sc1
    v_add_u32 v2, 4096, v2
    s_waitcnt lgkmcnt(3)
    v_mfma_f32_32x32x16_bf16 v[120:135], v[192:195], a[112:115], v[120:135]
    ds_read_b128 v[184:187], v12 offset:16384
    v_mfma_f32_32x32x16_bf16 v[136:151], v[192:195], a[116:119], v[136:151]
    buffer_load_dwordx2 v[152:153], v7, s[16:19], s32 offen offset:0 sc1
    s_waitcnt vmcnt(17)
    s_waitcnt lgkmcnt(3)
    v_mfma_f32_32x32x16_bf16 v[56:71], v[196:199], a[120:123], v[56:71]
    ds_read_b128 v[188:191], v13 offset:16384
    v_mfma_f32_32x32x16_bf16 v[72:87], v[196:199], a[124:127], v[72:87]
    buffer_load_dwordx2 v[154:155], v7, s[16:19], s32 offen offset:256 sc1
    s_waitcnt lgkmcnt(3)
    v_mfma_f32_32x32x16_bf16 v[88:103], v[200:203], a[120:123], v[88:103]
    ds_read_b128 v[192:195], v14 offset:16384
    v_mfma_f32_32x32x16_bf16 v[104:119], v[200:203], a[124:127], v[104:119]
    buffer_load_dwordx2 v[156:157], v7, s[16:19], s32 offen offset:512 sc1
    s_waitcnt lgkmcnt(3)
    v_mfma_f32_32x32x16_bf16 v[120:135], v[204:207], a[120:123], v[120:135]
    ds_read_b128 v[196:199], v12 offset:17408
    v_mfma_f32_32x32x16_bf16 v[136:151], v[204:207], a[124:127], v[136:151]
    buffer_load_dwordx2 v[158:159], v7, s[16:19], s32 offen offset:768 sc1
    s_waitcnt vmcnt(18)
    s_waitcnt lgkmcnt(3)
    v_mfma_f32_32x32x16_bf16 v[56:71], v[184:187], a[128:131], v[56:71]
    ds_read_b128 v[200:203], v13 offset:17408
    v_mfma_f32_32x32x16_bf16 v[72:87], v[184:187], a[132:135], v[72:87]
    buffer_load_dwordx2 v[160:161], v7, s[16:19], s32 offen offset:1024 sc1
    s_waitcnt lgkmcnt(3)
    v_mfma_f32_32x32x16_bf16 v[88:103], v[188:191], a[128:131], v[88:103]
    ds_read_b128 v[204:207], v14 offset:17408
    v_mfma_f32_32x32x16_bf16 v[104:119], v[188:191], a[132:135], v[104:119]
    buffer_load_dwordx2 v[162:163], v7, s[16:19], s32 offen offset:1280 sc1
    v_add_u32 v7, 3072, v7
    s_waitcnt lgkmcnt(3)
    v_mfma_f32_32x32x16_bf16 v[120:135], v[192:195], a[128:131], v[120:135]
    ds_read_b128 v[184:187], v12 offset:18432
    v_mfma_f32_32x32x16_bf16 v[136:151], v[192:195], a[132:135], v[136:151]
    buffer_load_dwordx2 v[164:165], v7, s[16:19], s32 offen offset:0 sc1
    s_waitcnt vmcnt(19)
    s_waitcnt lgkmcnt(3)
    v_mfma_f32_32x32x16_bf16 v[56:71], v[196:199], a[136:139], v[56:71]
    ds_read_b128 v[188:191], v13 offset:18432
    v_mfma_f32_32x32x16_bf16 v[72:87], v[196:199], a[140:143], v[72:87]
    buffer_load_dwordx2 v[166:167], v7, s[16:19], s32 offen offset:256 sc1
    s_waitcnt lgkmcnt(3)
    v_mfma_f32_32x32x16_bf16 v[88:103], v[200:203], a[136:139], v[88:103]
    ds_read_b128 v[192:195], v14 offset:18432
    v_mfma_f32_32x32x16_bf16 v[104:119], v[200:203], a[140:143], v[104:119]
    buffer_load_dwordx2 v[168:169], v7, s[16:19], s32 offen offset:512 sc1
    s_waitcnt lgkmcnt(3)
    v_mfma_f32_32x32x16_bf16 v[120:135], v[204:207], a[136:139], v[120:135]
    ds_read_b128 v[196:199], v12 offset:19456
    v_mfma_f32_32x32x16_bf16 v[136:151], v[204:207], a[140:143], v[136:151]
    buffer_load_dwordx2 v[170:171], v7, s[16:19], s32 offen offset:768 sc1
    s_waitcnt vmcnt(20)
    s_waitcnt lgkmcnt(3)
    v_mfma_f32_32x32x16_bf16 v[56:71], v[184:187], a[144:147], v[56:71]
    ds_read_b128 v[200:203], v13 offset:19456
    v_mfma_f32_32x32x16_bf16 v[72:87], v[184:187], a[148:151], v[72:87]
    buffer_load_dwordx2 v[172:173], v7, s[16:19], s32 offen offset:1024 sc1
    s_waitcnt lgkmcnt(3)
    v_mfma_f32_32x32x16_bf16 v[88:103], v[188:191], a[144:147], v[88:103]
    ds_read_b128 v[204:207], v14 offset:19456
    v_mfma_f32_32x32x16_bf16 v[104:119], v[188:191], a[148:151], v[104:119]
    buffer_load_dwordx2 v[174:175], v7, s[16:19], s32 offen offset:1280 sc1
    s_waitcnt lgkmcnt(3)
    v_mfma_f32_32x32x16_bf16 v[120:135], v[192:195], a[144:147], v[120:135]
    ds_read_b128 v[184:187], v12 offset:20480
    v_mfma_f32_32x32x16_bf16 v[136:151], v[192:195], a[148:151], v[136:151]
    buffer_load_dwordx4 a[192:195], v2, s[16:19], s36 offen offset:0 sc1
    s_waitcnt vmcnt(21)
    s_waitcnt lgkmcnt(3)
    v_mfma_f32_32x32x16_bf16 v[56:71], v[196:199], a[152:155], v[56:71]
    ds_read_b128 v[188:191], v13 offset:20480
    v_mfma_f32_32x32x16_bf16 v[72:87], v[196:199], a[156:159], v[72:87]
    buffer_load_dwordx4 a[196:199], v2, s[16:19], s37 offen offset:0 sc1
    s_waitcnt lgkmcnt(3)
    v_mfma_f32_32x32x16_bf16 v[88:103], v[200:203], a[152:155], v[88:103]
    ds_read_b128 v[192:195], v14 offset:20480
    v_mfma_f32_32x32x16_bf16 v[104:119], v[200:203], a[156:159], v[104:119]
    buffer_load_dwordx4 a[200:203], v2, s[16:19], s36 offen offset:1024 sc1
    s_waitcnt lgkmcnt(3)
    v_mfma_f32_32x32x16_bf16 v[120:135], v[204:207], a[152:155], v[120:135]
    ds_read_b128 v[196:199], v12 offset:21504
    v_mfma_f32_32x32x16_bf16 v[136:151], v[204:207], a[156:159], v[136:151]
    buffer_load_dwordx4 a[204:207], v2, s[16:19], s37 offen offset:1024 sc1
    s_waitcnt vmcnt(22)
    s_waitcnt lgkmcnt(3)
    v_mfma_f32_32x32x16_bf16 v[56:71], v[184:187], a[160:163], v[56:71]
    ds_read_b128 v[200:203], v13 offset:21504
    s_waitcnt vmcnt(4)
    v_add_f32 v152, v152, v154
    v_add_f32 v164, v164, v166
    v_mfma_f32_32x32x16_bf16 v[72:87], v[184:187], a[164:167], v[72:87]
    buffer_load_dwordx4 a[208:211], v2, s[16:19], s36 offen offset:2048 sc1
    v_add_f32 v153, v153, v155
    v_add_f32 v165, v165, v167
    v_add_f32 v152, v152, v156
    s_waitcnt lgkmcnt(3)
    v_mfma_f32_32x32x16_bf16 v[88:103], v[188:191], a[160:163], v[88:103]
    ds_read_b128 v[204:207], v14 offset:21504
    v_add_f32 v164, v164, v168
    v_add_f32 v153, v153, v157
    v_add_f32 v165, v165, v169
    v_mfma_f32_32x32x16_bf16 v[104:119], v[188:191], a[164:167], v[104:119]
    buffer_load_dwordx4 a[212:215], v2, s[16:19], s37 offen offset:2048 sc1
    v_add_f32 v152, v152, v158
    v_add_f32 v164, v164, v170
    v_add_f32 v153, v153, v159
    s_waitcnt lgkmcnt(3)
    v_mfma_f32_32x32x16_bf16 v[120:135], v[192:195], a[160:163], v[120:135]
    ds_read_b128 v[184:187], v12 offset:22528
    v_add_f32 v165, v165, v171
    v_add_f32 v152, v152, v160
    v_add_f32 v164, v164, v172
    v_mfma_f32_32x32x16_bf16 v[136:151], v[192:195], a[164:167], v[136:151]
    buffer_load_dwordx4 a[216:219], v2, s[16:19], s36 offen offset:3072 sc1
    v_add_f32 v153, v153, v161
    v_add_f32 v165, v165, v173
    v_add_f32 v152, v152, v162
    s_waitcnt lgkmcnt(3)
    v_mfma_f32_32x32x16_bf16 v[56:71], v[196:199], a[168:171], v[56:71]
    ds_read_b128 v[188:191], v13 offset:22528
    v_add_f32 v164, v164, v174
    v_add_f32 v153, v153, v163
    v_add_f32 v165, v165, v175
    v_mfma_f32_32x32x16_bf16 v[72:87], v[196:199], a[172:175], v[72:87]
    buffer_load_dwordx4 a[220:223], v2, s[16:19], s37 offen offset:3072 sc1
    v_add_u32 v2, 4096, v2
    v_mov_b32 v154, v152
    v_mov_b32 v166, v164
    v_mov_b32 v155, v153
    s_waitcnt lgkmcnt(3)
    v_mfma_f32_32x32x16_bf16 v[88:103], v[200:203], a[168:171], v[88:103]
    ds_read_b128 v[192:195], v14 offset:22528
    v_mov_b32 v167, v165
    v_permlane32_swap_b32 v152, v154
    v_mfma_f32_32x32x16_bf16 v[104:119], v[200:203], a[172:175], v[104:119]
    buffer_load_dwordx4 a[224:227], v2, s[16:19], s36 offen offset:0 sc1
    v_permlane32_swap_b32 v164, v166
    s_waitcnt lgkmcnt(3)
    v_mfma_f32_32x32x16_bf16 v[120:135], v[204:207], a[168:171], v[120:135]
    ds_read_b128 v[196:199], v12 offset:23552
    v_permlane32_swap_b32 v153, v155
    v_mfma_f32_32x32x16_bf16 v[136:151], v[204:207], a[172:175], v[136:151]
    buffer_load_dwordx4 a[228:231], v2, s[16:19], s37 offen offset:0 sc1
    v_permlane32_swap_b32 v165, v167
    v_add_f32 v152, v152, v154
    s_waitcnt lgkmcnt(3)
    v_mfma_f32_32x32x16_bf16 v[56:71], v[184:187], a[176:179], v[56:71]
    ds_read_b128 v[200:203], v13 offset:23552
    v_add_f32 v164, v164, v166
    v_add_f32 v153, v153, v155
    v_add_f32 v165, v165, v167
    v_mfma_f32_32x32x16_bf16 v[72:87], v[184:187], a[180:183], v[72:87]
    buffer_load_dwordx4 a[232:235], v2, s[16:19], s36 offen offset:1024 sc1
    v_mul_f32 v152, 0xbae38e39, v152
    v_mul_f32 v164, 0xbae38e39, v164
    v_mul_f32 v153, 0x3ae38e39, v153
    s_waitcnt lgkmcnt(3)
    v_mfma_f32_32x32x16_bf16 v[88:103], v[188:191], a[176:179], v[88:103]
    ds_read_b128 v[204:207], v14 offset:23552
    v_mul_f32 v165, 0x3ae38e39, v165
    v_fma_f32 v153, -v152, v152, v153
    v_fma_f32 v165, -v164, v164, v165
    v_mfma_f32_32x32x16_bf16 v[104:119], v[188:191], a[180:183], v[104:119]
    buffer_load_dwordx4 a[236:239], v2, s[16:19], s37 offen offset:1024 sc1
    v_max_f32 v153, 0, v153
    v_max_f32 v165, 0, v165
    v_add_f32 v153, 0x3727c5ac, v153
    s_waitcnt lgkmcnt(3)
    v_mfma_f32_32x32x16_bf16 v[120:135], v[192:195], a[176:179], v[120:135]
    ds_read_b128 v[184:187], v12 offset:24576
    v_add_f32 v165, 0x3727c5ac, v165
    v_rsq_f32 v154, v153
    v_mfma_f32_32x32x16_bf16 v[136:151], v[192:195], a[180:183], v[136:151]
    buffer_load_dwordx4 a[240:243], v2, s[16:19], s36 offen offset:2048 sc1
    v_rsq_f32 v166, v165
    v_cvt_pk_bf16_f32 v156, v152, v152
    s_waitcnt lgkmcnt(3)
    v_mfma_f32_32x32x16_bf16 v[56:71], v[196:199], a[184:187], v[56:71]
    ds_read_b128 v[188:191], v13 offset:24576
    v_cvt_pk_bf16_f32 v168, v164, v164
    v_mul_f32 v153, v153, v154
    v_mul_f32 v165, v165, v166
    v_mfma_f32_32x32x16_bf16 v[72:87], v[196:199], a[188:191], v[72:87]
    buffer_load_dwordx4 a[244:247], v2, s[16:19], s37 offen offset:2048 sc1
    v_mul_f32 v232, 0x3eeff558, v154
    v_mul_f32 v233, 0x3eeff558, v166
    v_and_b32 v157, 0xffff0000, v156
    s_waitcnt lgkmcnt(3)
    v_mfma_f32_32x32x16_bf16 v[88:103], v[200:203], a[184:187], v[88:103]
    ds_read_b128 v[192:195], v14 offset:24576
    v_and_b32 v169, 0xffff0000, v168
    v_cvt_pk_bf16_f32 v158, v153, v153
    v_cvt_pk_bf16_f32 v170, v165, v165
    v_mfma_f32_32x32x16_bf16 v[104:119], v[200:203], a[188:191], v[104:119]
    buffer_load_dwordx4 a[248:251], v2, s[16:19], s36 offen offset:3072 sc1
    v_mul_f32 v234, 0x3eeff558, v153
    v_mul_f32 v235, 0x3eeff558, v165
    v_sub_f32 v152, v152, v157
    s_waitcnt lgkmcnt(3)
    v_mfma_f32_32x32x16_bf16 v[120:135], v[204:207], a[184:187], v[120:135]
    ds_read_b128 v[196:199], v12 offset:25600
    v_sub_f32 v164, v164, v169
    v_and_b32 v158, 0xffff0000, v158
    v_and_b32 v170, 0xffff0000, v170
    v_mfma_f32_32x32x16_bf16 v[136:151], v[204:207], a[188:191], v[136:151]
    buffer_load_dwordx4 a[252:255], v2, s[16:19], s37 offen offset:3072 sc1
    v_add_u32 v2, 4096, v2
    v_sub_f32 v153, v153, v158
    v_sub_f32 v165, v165, v170
    v_and_b32 v48, v9, v156
    s_waitcnt vmcnt(14)
    s_waitcnt lgkmcnt(3)
    v_mfma_f32_32x32x16_bf16 v[56:71], v[184:187], a[192:195], v[56:71]
    ds_read_b128 v[200:203], v13 offset:25600
    v_and_b32 v52, v9, v168
    v_cvt_pk_bf16_f32 v159, v152, v158
    v_cvt_pk_bf16_f32 v171, v164, v170
    v_mfma_f32_32x32x16_bf16 v[72:87], v[184:187], a[196:199], v[72:87]
    buffer_load_dwordx4 v[16:19], v2, s[16:19], s36 offen offset:0 sc1
    v_cvt_pk_bf16_f32 v160, v158, v153
    v_cvt_pk_bf16_f32 v172, v170, v165
    v_and_b32 v49, v9, v159
    s_waitcnt lgkmcnt(3)
    v_mfma_f32_32x32x16_bf16 v[88:103], v[188:191], a[192:195], v[88:103]
    ds_read_b128 v[204:207], v14 offset:25600
    v_and_b32 v53, v9, v171
    v_and_b32 v50, v9, v160
    v_and_b32 v54, v9, v172
    v_mfma_f32_32x32x16_bf16 v[104:119], v[188:191], a[196:199], v[104:119]
    buffer_load_dwordx4 v[20:23], v2, s[16:19], s37 offen offset:0 sc1
    v_mov_b32 v51, 0
    v_mov_b32 v55, 0
    s_waitcnt lgkmcnt(3)
    v_mfma_f32_32x32x16_bf16 v[120:135], v[192:195], a[192:195], v[120:135]
    ds_read_b128 v[184:187], v12 offset:26624
    v_mfma_f32_32x32x16_bf16 v[136:151], v[192:195], a[196:199], v[136:151]
    buffer_load_dwordx4 v[24:27], v2, s[16:19], s36 offen offset:1024 sc1
    s_waitcnt vmcnt(15)
    s_waitcnt lgkmcnt(3)
    v_mfma_f32_32x32x16_bf16 v[56:71], v[196:199], a[200:203], v[56:71]
    ds_read_b128 v[188:191], v13 offset:26624
    v_mfma_f32_32x32x16_bf16 v[72:87], v[196:199], a[204:207], v[72:87]
    buffer_load_dwordx4 v[28:31], v2, s[16:19], s37 offen offset:1024 sc1
    s_waitcnt lgkmcnt(3)
    v_mfma_f32_32x32x16_bf16 v[88:103], v[200:203], a[200:203], v[88:103]
    ds_read_b128 v[192:195], v14 offset:26624
    v_mfma_f32_32x32x16_bf16 v[104:119], v[200:203], a[204:207], v[104:119]
    buffer_load_dwordx4 v[32:35], v2, s[16:19], s36 offen offset:2048 sc1
    s_waitcnt lgkmcnt(3)
    v_mfma_f32_32x32x16_bf16 v[120:135], v[204:207], a[200:203], v[120:135]
    ds_read_b128 v[196:199], v12 offset:27648
    v_mfma_f32_32x32x16_bf16 v[136:151], v[204:207], a[204:207], v[136:151]
    buffer_load_dwordx4 v[36:39], v2, s[16:19], s37 offen offset:2048 sc1
    s_waitcnt vmcnt(16)
    s_waitcnt lgkmcnt(3)
    v_mfma_f32_32x32x16_bf16 v[56:71], v[184:187], a[208:211], v[56:71]
    ds_read_b128 v[200:203], v13 offset:27648
    v_mfma_f32_32x32x16_bf16 v[72:87], v[184:187], a[212:215], v[72:87]
    buffer_load_dwordx4 v[40:43], v2, s[16:19], s36 offen offset:3072 sc1
    s_waitcnt lgkmcnt(3)
    v_mfma_f32_32x32x16_bf16 v[88:103], v[188:191], a[208:211], v[88:103]
    ds_read_b128 v[204:207], v14 offset:27648
    v_mfma_f32_32x32x16_bf16 v[104:119], v[188:191], a[212:215], v[104:119]
    buffer_load_dwordx4 v[44:47], v2, s[16:19], s37 offen offset:3072 sc1
    v_add_u32 v2, 4096, v2
    s_waitcnt lgkmcnt(3)
    v_mfma_f32_32x32x16_bf16 v[120:135], v[192:195], a[208:211], v[120:135]
    ds_read_b128 v[184:187], v12 offset:28672
    v_mfma_f32_32x32x16_bf16 v[136:151], v[192:195], a[212:215], v[136:151]
    s_waitcnt vmcnt(16)
    s_waitcnt lgkmcnt(3)
    v_mfma_f32_32x32x16_bf16 v[56:71], v[196:199], a[216:219], v[56:71]
    ds_read_b128 v[188:191], v13 offset:28672
    v_mfma_f32_32x32x16_bf16 v[72:87], v[196:199], a[220:223], v[72:87]
    s_waitcnt lgkmcnt(3)
    v_mfma_f32_32x32x16_bf16 v[88:103], v[200:203], a[216:219], v[88:103]
    ds_read_b128 v[192:195], v14 offset:28672
    v_mfma_f32_32x32x16_bf16 v[104:119], v[200:203], a[220:223], v[104:119]
    s_waitcnt lgkmcnt(3)
    v_mfma_f32_32x32x16_bf16 v[120:135], v[204:207], a[216:219], v[120:135]
    ds_read_b128 v[196:199], v12 offset:29696
    v_mfma_f32_32x32x16_bf16 v[136:151], v[204:207], a[220:223], v[136:151]
    s_waitcnt vmcnt(14)
    s_waitcnt lgkmcnt(3)
    v_mfma_f32_32x32x16_bf16 v[56:71], v[184:187], a[224:227], v[56:71]
    ds_read_b128 v[200:203], v13 offset:29696
    s_add_u32 s33, s44, 0
    v_mfma_f32_32x32x16_bf16 v[72:87], v[184:187], a[228:231], v[72:87]
    buffer_store_dwordx4 v[212:215], v1, s[16:19], s33 offen sc1
    s_add_u32 s33, s44, 2048
    s_waitcnt lgkmcnt(3)
    v_mfma_f32_32x32x16_bf16 v[88:103], v[188:191], a[224:227], v[88:103]
    ds_read_b128 v[204:207], v14 offset:29696
    v_mfma_f32_32x32x16_bf16 v[104:119], v[188:191], a[228:231], v[104:119]
    buffer_store_dwordx4 v[216:219], v1, s[16:19], s33 offen sc1
    s_add_u32 s33, s44, 4096
    s_waitcnt lgkmcnt(3)
    v_mfma_f32_32x32x16_bf16 v[120:135], v[192:195], a[224:227], v[120:135]
    ds_read_b128 v[184:187], v12 offset:30720
    v_mfma_f32_32x32x16_bf16 v[136:151], v[192:195], a[228:231], v[136:151]
    buffer_store_dwordx4 v[220:223], v1, s[16:19], s33 offen sc1
    s_add_u32 m0, s30, 110592
    s_add_u32 s33, s31, 110592
    s_waitcnt vmcnt(15)
    s_waitcnt lgkmcnt(3)
    v_mfma_f32_32x32x16_bf16 v[56:71], v[196:199], a[232:235], v[56:71]
    ds_read_b128 v[188:191], v13 offset:30720
    v_mfma_f32_32x32x16_bf16 v[72:87], v[196:199], a[236:239], v[72:87]
    buffer_load_dwordx4 v1, s[16:19], s33 offen offset:0 lds
    s_waitcnt lgkmcnt(3)
    v_mfma_f32_32x32x16_bf16 v[88:103], v[200:203], a[232:235], v[88:103]
    ds_read_b128 v[192:195], v14 offset:30720
    v_mfma_f32_32x32x16_bf16 v[104:119], v[200:203], a[236:239], v[104:119]
    buffer_load_dwordx4 v1, s[16:19], s33 offen offset:1024 lds
    s_waitcnt lgkmcnt(3)
    v_mfma_f32_32x32x16_bf16 v[120:135], v[204:207], a[232:235], v[120:135]
    ds_read_b128 v[196:199], v12 offset:31744
    v_mfma_f32_32x32x16_bf16 v[136:151], v[204:207], a[236:239], v[136:151]
    buffer_load_dwordx4 v1, s[16:19], s33 offen offset:2048 lds
    s_waitcnt vmcnt(16)
    s_waitcnt lgkmcnt(3)
    v_mfma_f32_32x32x16_bf16 v[56:71], v[184:187], a[240:243], v[56:71]
    ds_read_b128 v[200:203], v13 offset:31744
    v_mfma_f32_32x32x16_bf16 v[72:87], v[184:187], a[244:247], v[72:87]
    buffer_load_dwordx4 v1, s[16:19], s33 offen offset:3072 lds
    s_add_u32 m0, s30, 126976
    s_add_u32 s33, s31, 126976
    s_waitcnt lgkmcnt(3)
    v_mfma_f32_32x32x16_bf16 v[88:103], v[188:191], a[240:243], v[88:103]
    ds_read_b128 v[204:207], v14 offset:31744
    v_mfma_f32_32x32x16_bf16 v[104:119], v[188:191], a[244:247], v[104:119]
    buffer_load_dwordx4 v1, s[16:19], s33 offen offset:0 lds
    s_waitcnt lgkmcnt(3)
    v_mfma_f32_32x32x16_bf16 v[120:135], v[192:195], a[240:243], v[120:135]
    ds_read_b128 v[184:187], v12 offset:32768
    v_mfma_f32_32x32x16_bf16 v[136:151], v[192:195], a[244:247], v[136:151]
    buffer_load_dwordx4 v1, s[16:19], s33 offen offset:1024 lds
    s_waitcnt vmcnt(17)
    s_waitcnt lgkmcnt(3)
    v_mfma_f32_32x32x16_bf16 v[56:71], v[196:199], a[248:251], v[56:71]
    ds_read_b128 v[188:191], v13 offset:32768
    v_mfma_f32_32x32x16_bf16 v[72:87], v[196:199], a[252:255], v[72:87]
    buffer_load_dwordx4 v1, s[16:19], s33 offen offset:2048 lds
    s_waitcnt lgkmcnt(3)
    v_mfma_f32_32x32x16_bf16 v[88:103], v[200:203], a[248:251], v[88:103]
    ds_read_b128 v[192:195], v14 offset:32768
    v_mfma_f32_32x32x16_bf16 v[104:119], v[200:203], a[252:255], v[104:119]
    buffer_load_dwordx4 v1, s[16:19], s33 offen offset:3072 lds
    s_add_u32 m0, s34, 143360
    s_add_u32 s33, s35, 143360
    s_waitcnt lgkmcnt(3)
    v_mfma_f32_32x32x16_bf16 v[120:135], v[204:207], a[248:251], v[120:135]
    ds_read_b128 v[196:199], v12 offset:33792
    v_mfma_f32_32x32x16_bf16 v[136:151], v[204:207], a[252:255], v[136:151]
    buffer_load_dwordx4 v1, s[16:19], s33 offen lds
    s_waitcnt vmcnt(18)
    s_waitcnt lgkmcnt(3)
    v_mfma_f32_32x32x16_bf16 v[56:71], v[184:187], v[16:19], v[56:71]
    ds_read_b128 v[200:203], v13 offset:33792
    v_mfma_f32_32x32x16_bf16 v[72:87], v[184:187], v[20:23], v[72:87]
    s_waitcnt lgkmcnt(3)
    v_mfma_f32_32x32x16_bf16 v[88:103], v[188:191], v[16:19], v[88:103]
    ds_read_b128 v[204:207], v14 offset:33792
    v_mfma_f32_32x32x16_bf16 v[104:119], v[188:191], v[20:23], v[104:119]
    s_waitcnt lgkmcnt(3)
    v_mfma_f32_32x32x16_bf16 v[120:135], v[192:195], v[16:19], v[120:135]
    ds_read_b128 v[184:187], v12 offset:34816
    v_mfma_f32_32x32x16_bf16 v[136:151], v[192:195], v[20:23], v[136:151]
    s_waitcnt vmcnt(16)
    s_waitcnt lgkmcnt(3)
    v_mfma_f32_32x32x16_bf16 v[56:71], v[196:199], v[24:27], v[56:71]
    ds_read_b128 v[188:191], v13 offset:34816
    v_mfma_f32_32x32x16_bf16 v[72:87], v[196:199], v[28:31], v[72:87]
    s_waitcnt lgkmcnt(3)
    v_mfma_f32_32x32x16_bf16 v[88:103], v[200:203], v[24:27], v[88:103]
    ds_read_b128 v[192:195], v14 offset:34816
    v_mfma_f32_32x32x16_bf16 v[104:119], v[200:203], v[28:31], v[104:119]
    s_waitcnt lgkmcnt(3)
    v_mfma_f32_32x32x16_bf16 v[120:135], v[204:207], v[24:27], v[120:135]
    ds_read_b128 v[196:199], v12 offset:35840
    v_mfma_f32_32x32x16_bf16 v[136:151], v[204:207], v[28:31], v[136:151]
    s_waitcnt vmcnt(14)
    s_waitcnt lgkmcnt(3)
    v_mfma_f32_32x32x16_bf16 v[56:71], v[184:187], v[32:35], v[56:71]
    ds_read_b128 v[200:203], v13 offset:35840
    v_mfma_f32_32x32x16_bf16 v[72:87], v[184:187], v[36:39], v[72:87]
    s_waitcnt lgkmcnt(3)
    v_mfma_f32_32x32x16_bf16 v[88:103], v[188:191], v[32:35], v[88:103]
    ds_read_b128 v[204:207], v14 offset:35840
    v_mfma_f32_32x32x16_bf16 v[104:119], v[188:191], v[36:39], v[104:119]
    s_waitcnt lgkmcnt(3)
    v_mfma_f32_32x32x16_bf16 v[120:135], v[192:195], v[32:35], v[120:135]
    ds_read_b128 v[184:187], v3 offset:0
    v_mfma_f32_32x32x16_bf16 v[136:151], v[192:195], v[36:39], v[136:151]
    s_waitcnt vmcnt(12)
    s_waitcnt lgkmcnt(3)
    v_mfma_f32_32x32x16_bf16 v[56:71], v[196:199], v[40:43], v[56:71]
    ds_read_b128 v[188:191], v3 offset:1024
    v_mfma_f32_32x32x16_bf16 v[72:87], v[196:199], v[44:47], v[72:87]
    s_waitcnt lgkmcnt(3)
    v_mfma_f32_32x32x16_bf16 v[88:103], v[200:203], v[40:43], v[88:103]
    ds_read_b128 v[192:195], v3 offset:2048
    v_mfma_f32_32x32x16_bf16 v[104:119], v[200:203], v[44:47], v[104:119]
    s_waitcnt lgkmcnt(3)
    v_mfma_f32_32x32x16_bf16 v[120:135], v[204:207], v[40:43], v[120:135]
    s_waitcnt vmcnt(0)
    s_barrier
    buffer_store_dword v242, v241, s[16:19], s45 offen offset:16 sc1
    ds_read_b128 v[196:199], v15 offset:0
    v_mfma_f32_32x32x16_bf16 v[136:151], v[204:207], v[44:47], v[136:151]
    s_waitcnt lgkmcnt(3)
    v_mfma_f32_32x32x16_bf16 v[56:71], v[184:187], v[48:51], v[56:71]
    ds_read_b128 v[200:203], v15 offset:1024
    v_mfma_f32_32x32x16_bf16 v[72:87], v[184:187], v[52:55], v[72:87]
    s_waitcnt lgkmcnt(3)
    v_mfma_f32_32x32x16_bf16 v[88:103], v[188:191], v[48:51], v[88:103]
    ds_read_b128 v[204:207], v15 offset:2048
    v_mfma_f32_32x32x16_bf16 v[104:119], v[188:191], v[52:55], v[104:119]
    s_waitcnt lgkmcnt(3)
    v_mfma_f32_32x32x16_bf16 v[120:135], v[192:195], v[48:51], v[120:135]
    ds_read_b128 v[184:187], v15 offset:3072
    v_mfma_f32_32x32x16_bf16 v[136:151], v[192:195], v[52:55], v[136:151]
    s_waitcnt lgkmcnt(3)
    v_mfma_f32_32x32x16_bf16 v[152:167], v[196:199], a[0:3], 0
    ds_read_b128 v[188:191], v15 offset:4096
    v_mul_f32 v56, v232, v56
    v_mul_f32 v57, v232, v57
    v_mul_f32 v58, v232, v58
    v_mul_f32 v59, v232, v59
    v_mul_f32 v60, v232, v60
    v_mfma_f32_32x32x16_bf16 v[168:183], v[196:199], a[4:7], 0
    v_mul_f32 v61, v232, v61
    v_mul_f32 v62, v232, v62
    v_mul_f32 v63, v232, v63
    v_fma_f32 v208, v56, v56, s40
    v_fma_f32 v209, v57, v57, s40
    s_waitcnt lgkmcnt(3)
    v_mfma_f32_32x32x16_bf16 v[152:167], v[200:203], a[8:11], v[152:167]
    ds_read_b128 v[192:195], v15 offset:5120
    v_fma_f32 v210, v58, v58, s40
    v_fma_f32 v211, v59, v59, s40
    v_fma_f32 v212, v60, v60, s40
    v_fma_f32 v213, v61, v61, s40
    v_fma_f32 v214, v62, v62, s40
    v_mfma_f32_32x32x16_bf16 v[168:183], v[200:203], a[12:15], v[168:183]
    v_fma_f32 v215, v63, v63, s40
    v_mul_f32 v208, v208, v56
    v_mul_f32 v209, v209, v57
    v_mul_f32 v210, v210, v58
    v_mul_f32 v211, v211, v59
    s_waitcnt lgkmcnt(3)
    v_mfma_f32_32x32x16_bf16 v[152:167], v[204:207], a[16:19], v[152:167]
    ds_read_b128 v[196:199], v15 offset:6144
    v_mul_f32 v212, v212, v60
    v_mul_f32 v213, v213, v61
    v_mul_f32 v214, v214, v62
    v_mul_f32 v215, v215, v63
    v_mfma_f32_32x32x16_bf16 v[168:183], v[204:207], a[20:23], v[168:183]
    v_exp_f32_e64 v208, -v208
    v_mul_f32 v56, v56, v64
    v_exp_f32_e64 v209, -v209
    s_waitcnt lgkmcnt(3)
    v_mfma_f32_32x32x16_bf16 v[152:167], v[184:187], a[24:27], v[152:167]
    ds_read_b128 v[200:203], v15 offset:7168
    v_mul_f32 v57, v57, v65
    v_exp_f32_e64 v210, -v210
    v_mul_f32 v58, v58, v66
    v_mfma_f32_32x32x16_bf16 v[168:183], v[184:187], a[28:31], v[168:183]
    v_exp_f32_e64 v211, -v211
    v_mul_f32 v59, v59, v67
    v_exp_f32_e64 v212, -v212
    s_waitcnt lgkmcnt(3)
    v_mfma_f32_32x32x16_bf16 v[152:167], v[188:191], a[32:35], v[152:167]
    s_barrier
    ds_read_b128 v[204:207], v15 offset:8192
    v_mul_f32 v60, v60, v68
    v_exp_f32_e64 v213, -v213
    v_mul_f32 v61, v61, v69
    v_mfma_f32_32x32x16_bf16 v[168:183], v[188:191], a[36:39], v[168:183]
    s_add_u32 m0, s30, 0
    s_add_u32 s33, s31, 147456
    v_exp_f32_e64 v214, -v214
    v_mul_f32 v62, v62, v70
    s_waitcnt lgkmcnt(3)
    v_mfma_f32_32x32x16_bf16 v[152:167], v[192:195], a[40:43], v[152:167]
    ds_read_b128 v[184:187], v15 offset:9216
    v_exp_f32_e64 v215, -v215
    v_mul_f32 v63, v63, v71
    v_fma_f32 v208, v208, v234, v234
    v_fma_f32 v209, v209, v234, v234
    v_mfma_f32_32x32x16_bf16 v[168:183], v[192:195], a[44:47], v[168:183]
    buffer_load_dwordx4 v1, s[16:19], s33 offen offset:0 lds
    v_fma_f32 v210, v210, v234, v234
    v_fma_f32 v211, v211, v234, v234
    v_fma_f32 v212, v212, v234, v234
    v_fma_f32 v213, v213, v234, v234
    s_waitcnt lgkmcnt(3)
    v_mfma_f32_32x32x16_bf16 v[152:167], v[196:199], a[48:51], v[152:167]
    ds_read_b128 v[188:191], v15 offset:10240
    v_fma_f32 v214, v214, v234, v234
    v_fma_f32 v215, v215, v234, v234
    v_rcp_f32 v208, v208
    v_mfma_f32_32x32x16_bf16 v[168:183], v[196:199], a[52:55], v[168:183]
    buffer_load_dwordx4 v1, s[16:19], s33 offen offset:1024 lds
    v_rcp_f32 v209, v209
    v_rcp_f32 v210, v210
    s_waitcnt lgkmcnt(3)
    v_mfma_f32_32x32x16_bf16 v[152:167], v[200:203], a[56:59], v[152:167]
    ds_read_b128 v[192:195], v15 offset:11264
    v_rcp_f32 v211, v211
    v_rcp_f32 v212, v212
    v_mfma_f32_32x32x16_bf16 v[168:183], v[200:203], a[60:63], v[168:183]
    buffer_load_dwordx4 v1, s[16:19], s33 offen offset:2048 lds
    v_rcp_f32 v213, v213
    v_rcp_f32 v214, v214
    s_waitcnt lgkmcnt(3)
    v_mfma_f32_32x32x16_bf16 v[152:167], v[204:207], a[64:67], v[152:167]
    ds_read_b128 v[196:199], v15 offset:12288
    v_rcp_f32 v215, v215
    v_mul_f32 v56, v56, v208
    v_mul_f32 v57, v57, v209
    v_mul_f32 v58, v58, v210
    v_mfma_f32_32x32x16_bf16 v[168:183], v[204:207], a[68:71], v[168:183]
    buffer_load_dwordx4 v1, s[16:19], s33 offen offset:3072 lds
    v_mul_f32 v59, v59, v211
    v_mul_f32 v60, v60, v212
    v_mul_f32 v61, v61, v213
    v_mul_f32 v62, v62, v214
    s_waitcnt lgkmcnt(3)
    v_mfma_f32_32x32x16_bf16 v[152:167], v[184:187], a[72:75], v[152:167]
    ds_read_b128 v[200:203], v15 offset:13312
    v_mul_f32 v63, v63, v215
    v_cvt_pk_bf16_f32 v224, v56, v57
    v_cvt_pk_bf16_f32 v225, v58, v59
    v_cvt_pk_bf16_f32 v226, v60, v61
    v_cvt_pk_bf16_f32 v227, v62, v63
    v_mfma_f32_32x32x16_bf16 v[168:183], v[184:187], a[76:79], v[168:183]
    s_add_u32 m0, s30, 16384
    s_add_u32 s33, s31, 163840
    s_add_u32 s42, s43, 0
    buffer_store_dwordx4 v[224:227], v8, s[16:19], s42 offen sc1
    v_mul_f32 v72, v233, v72
    s_waitcnt lgkmcnt(3)
    v_mfma_f32_32x32x16_bf16 v[152:167], v[188:191], a[80:83], v[152:167]
    ds_read_b128 v[204:207], v15 offset:14336
    v_mul_f32 v73, v233, v73
    v_mul_f32 v74, v233, v74
    v_mul_f32 v75, v233, v75
    v_mul_f32 v76, v233, v76
    v_mul_f32 v77, v233, v77
    v_mfma_f32_32x32x16_bf16 v[168:183], v[188:191], a[84:87], v[168:183]
    buffer_load_dwordx4 v1, s[16:19], s33 offen offset:0 lds
    v_mul_f32 v78, v233, v78
    v_mul_f32 v79, v233, v79
    v_fma_f32 v216, v72, v72, s40
    v_fma_f32 v217, v73, v73, s40
    s_waitcnt lgkmcnt(3)
    v_mfma_f32_32x32x16_bf16 v[152:167], v[192:195], a[88:91], v[152:167]
    ds_read_b128 v[184:187], v15 offset:15360
    v_fma_f32 v218, v74, v74, s40
    v_fma_f32 v219, v75, v75, s40
    v_fma_f32 v220, v76, v76, s40
    v_fma_f32 v221, v77, v77, s40
    v_fma_f32 v222, v78, v78, s40
    v_mfma_f32_32x32x16_bf16 v[168:183], v[192:195], a[92:95], v[168:183]
    buffer_load_dwordx4 v1, s[16:19], s33 offen offset:1024 lds
    v_fma_f32 v223, v79, v79, s40
    v_mul_f32 v216, v216, v72
    v_mul_f32 v217, v217, v73
    v_mul_f32 v218, v218, v74
    s_waitcnt lgkmcnt(3)
    v_mfma_f32_32x32x16_bf16 v[152:167], v[196:199], a[96:99], v[152:167]
    ds_read_b128 v[188:191], v15 offset:16384
    v_mul_f32 v219, v219, v75
    v_mul_f32 v220, v220, v76
    v_mul_f32 v221, v221, v77
    v_mul_f32 v222, v222, v78
    v_mul_f32 v223, v223, v79
    v_mfma_f32_32x32x16_bf16 v[168:183], v[196:199], a[100:103], v[168:183]
    buffer_load_dwordx4 v1, s[16:19], s33 offen offset:2048 lds
    v_exp_f32_e64 v216, -v216
    v_mul_f32 v72, v72, v80
    s_waitcnt lgkmcnt(3)
    v_mfma_f32_32x32x16_bf16 v[152:167], v[200:203], a[104:107], v[152:167]
    ds_read_b128 v[192:195], v15 offset:17408
    v_exp_f32_e64 v217, -v217
    v_mul_f32 v73, v73, v81
    v_exp_f32_e64 v218, -v218
    v_mfma_f32_32x32x16_bf16 v[168:183], v[200:203], a[108:111], v[168:183]
    buffer_load_dwordx4 v1, s[16:19], s33 offen offset:3072 lds
    v_mul_f32 v74, v74, v82
    v_exp_f32_e64 v219, -v219
    v_mul_f32 v75, v75, v83
    s_waitcnt lgkmcnt(3)
    v_mfma_f32_32x32x16_bf16 v[152:167], v[204:207], a[112:115], v[152:167]
    ds_read_b128 v[196:199], v15 offset:18432
    v_exp_f32_e64 v220, -v220
    v_mul_f32 v76, v76, v84
    v_exp_f32_e64 v221, -v221
    v_mfma_f32_32x32x16_bf16 v[168:183], v[204:207], a[116:119], v[168:183]
    s_add_u32 m0, s34, 32768
    s_add_u32 s33, s35, 180224
    v_mul_f32 v77, v77, v85
    v_exp_f32_e64 v222, -v222
    s_waitcnt lgkmcnt(3)
    v_mfma_f32_32x32x16_bf16 v[152:167], v[184:187], a[120:123], v[152:167]
    ds_read_b128 v[200:203], v15 offset:19456
    v_mul_f32 v78, v78, v86
    v_exp_f32_e64 v223, -v223
    v_mul_f32 v79, v79, v87
    v_fma_f32 v216, v216, v235, v235
    v_mfma_f32_32x32x16_bf16 v[168:183], v[184:187], a[124:127], v[168:183]
    buffer_load_dwordx4 v1, s[16:19], s33 offen lds
    v_fma_f32 v217, v217, v235, v235
    v_fma_f32 v218, v218, v235, v235
    v_fma_f32 v219, v219, v235, v235
    v_fma_f32 v220, v220, v235, v235
    s_waitcnt lgkmcnt(3)
    v_mfma_f32_32x32x16_bf16 v[152:167], v[188:191], a[128:131], v[152:167]
    ds_read_b128 v[204:207], v15 offset:20480
    v_fma_f32 v221, v221, v235, v235
    v_fma_f32 v222, v222, v235, v235
    v_fma_f32 v223, v223, v235, v235
    v_rcp_f32 v216, v216
    v_mfma_f32_32x32x16_bf16 v[168:183], v[188:191], a[132:135], v[168:183]
    s_add_u32 m0, s30, 36864
    s_add_u32 s33, s31, 184320
    v_rcp_f32 v217, v217
    s_waitcnt lgkmcnt(3)
    v_mfma_f32_32x32x16_bf16 v[152:167], v[192:195], a[136:139], v[152:167]
    ds_read_b128 v[184:187], v15 offset:21504
    v_rcp_f32 v218, v218
    v_rcp_f32 v219, v219
    v_mfma_f32_32x32x16_bf16 v[168:183], v[192:195], a[140:143], v[168:183]
    buffer_load_dwordx4 v1, s[16:19], s33 offen offset:0 lds
    v_rcp_f32 v220, v220
    v_rcp_f32 v221, v221
    s_waitcnt lgkmcnt(3)
    v_mfma_f32_32x32x16_bf16 v[152:167], v[196:199], a[144:147], v[152:167]
    ds_read_b128 v[188:191], v15 offset:22528
    v_rcp_f32 v222, v222
    v_rcp_f32 v223, v223
    v_mul_f32 v72, v72, v216
    v_mfma_f32_32x32x16_bf16 v[168:183], v[196:199], a[148:151], v[168:183]
    buffer_load_dwordx4 v1, s[16:19], s33 offen offset:1024 lds
    v_mul_f32 v73, v73, v217
    v_mul_f32 v74, v74, v218
    v_mul_f32 v75, v75, v219
    v_mul_f32 v76, v76, v220
    s_waitcnt lgkmcnt(3)
    v_mfma_f32_32x32x16_bf16 v[152:167], v[200:203], a[152:155], v[152:167]
    ds_read_b128 v[192:195], v15 offset:23552
    v_mul_f32 v77, v77, v221
    v_mul_f32 v78, v78, v222
    v_mul_f32 v79, v79, v223
    v_cvt_pk_bf16_f32 v228, v72, v73
    v_cvt_pk_bf16_f32 v229, v74, v75
    v_mfma_f32_32x32x16_bf16 v[168:183], v[200:203], a[156:159], v[168:183]
    buffer_load_dwordx4 v1, s[16:19], s33 offen offset:2048 lds
    v_cvt_pk_bf16_f32 v230, v76, v77
    v_cvt_pk_bf16_f32 v231, v78, v79
    s_add_u32 s42, s43, 294912
    buffer_store_dwordx4 v[228:231], v8, s[16:19], s42 offen sc1
    s_waitcnt lgkmcnt(3)
    v_mfma_f32_32x32x16_bf16 v[152:167], v[204:207], a[160:163], v[152:167]
    ds_read_b128 v[196:199], v15 offset:24576
    v_mul_f32 v88, v232, v88
    v_mul_f32 v89, v232, v89
    v_mul_f32 v90, v232, v90
    v_mul_f32 v91, v232, v91
    v_mul_f32 v92, v232, v92
    v_mfma_f32_32x32x16_bf16 v[168:183], v[204:207], a[164:167], v[168:183]
    buffer_load_dwordx4 v1, s[16:19], s33 offen offset:3072 lds
    v_mul_f32 v93, v232, v93
    v_mul_f32 v94, v232, v94
    v_mul_f32 v95, v232, v95
    v_fma_f32 v208, v88, v88, s40
    s_waitcnt lgkmcnt(3)
    v_mfma_f32_32x32x16_bf16 v[152:167], v[184:187], a[168:171], v[152:167]
    ds_read_b128 v[200:203], v15 offset:25600
    v_fma_f32 v209, v89, v89, s40
    v_fma_f32 v210, v90, v90, s40
    v_fma_f32 v211, v91, v91, s40
    v_fma_f32 v212, v92, v92, s40
    v_fma_f32 v213, v93, v93, s40
    v_mfma_f32_32x32x16_bf16 v[168:183], v[184:187], a[172:175], v[168:183]
    s_add_u32 m0, s30, 53248
    s_add_u32 s33, s31, 200704
    v_fma_f32 v214, v94, v94, s40
    v_fma_f32 v215, v95, v95, s40
    v_mul_f32 v208, v208, v88
    s_waitcnt lgkmcnt(3)
    v_mfma_f32_32x32x16_bf16 v[152:167], v[188:191], a[176:179], v[152:167]
    ds_read_b128 v[204:207], v15 offset:26624
    v_mul_f32 v209, v209, v89
    v_mul_f32 v210, v210, v90
    v_mul_f32 v211, v211, v91
    v_mul_f32 v212, v212, v92
    v_mul_f32 v213, v213, v93
    v_mfma_f32_32x32x16_bf16 v[168:183], v[188:191], a[180:183], v[168:183]
    buffer_load_dwordx4 v1, s[16:19], s33 offen offset:0 lds
    v_mul_f32 v214, v214, v94
    v_mul_f32 v215, v215, v95
    v_exp_f32_e64 v208, -v208
    s_waitcnt lgkmcnt(3)
    v_mfma_f32_32x32x16_bf16 v[152:167], v[192:195], a[184:187], v[152:167]
    ds_read_b128 v[184:187], v15 offset:27648
    v_mul_f32 v88, v88, v96
    v_exp_f32_e64 v209, -v209
    v_mul_f32 v89, v89, v97
    v_mfma_f32_32x32x16_bf16 v[168:183], v[192:195], a[188:191], v[168:183]
    buffer_load_dwordx4 v1, s[16:19], s33 offen offset:1024 lds
    v_exp_f32_e64 v210, -v210
    v_mul_f32 v90, v90, v98
    s_waitcnt lgkmcnt(3)
    v_mfma_f32_32x32x16_bf16 v[152:167], v[196:199], a[192:195], v[152:167]
    ds_read_b128 v[188:191], v15 offset:28672
    v_exp_f32_e64 v211, -v211
    v_mul_f32 v91, v91, v99
    v_exp_f32_e64 v212, -v212
    v_mfma_f32_32x32x16_bf16 v[168:183], v[196:199], a[196:199], v[168:183]
    buffer_load_dwordx4 v1, s[16:19], s33 offen offset:2048 lds
    v_mul_f32 v92, v92, v100
    v_exp_f32_e64 v213, -v213
    v_mul_f32 v93, v93, v101
    s_waitcnt lgkmcnt(3)
    v_mfma_f32_32x32x16_bf16 v[152:167], v[200:203], a[200:203], v[152:167]
    ds_read_b128 v[192:195], v15 offset:29696
    v_exp_f32_e64 v214, -v214
    v_mul_f32 v94, v94, v102
    v_exp_f32_e64 v215, -v215
    v_mfma_f32_32x32x16_bf16 v[168:183], v[200:203], a[204:207], v[168:183]
    buffer_load_dwordx4 v1, s[16:19], s33 offen offset:3072 lds
    v_mul_f32 v95, v95, v103
    v_fma_f32 v208, v208, v234, v234
    v_fma_f32 v209, v209, v234, v234
    v_fma_f32 v210, v210, v234, v234
    s_waitcnt lgkmcnt(3)
    v_mfma_f32_32x32x16_bf16 v[152:167], v[204:207], a[208:211], v[152:167]
    ds_read_b128 v[196:199], v15 offset:30720
    v_fma_f32 v211, v211, v234, v234
    v_fma_f32 v212, v212, v234, v234
    v_fma_f32 v213, v213, v234, v234
    v_fma_f32 v214, v214, v234, v234
    v_fma_f32 v215, v215, v234, v234
    v_mfma_f32_32x32x16_bf16 v[168:183], v[204:207], a[212:215], v[168:183]
    s_add_u32 m0, s34, 69632
    s_add_u32 s33, s35, 217088
    v_rcp_f32 v208, v208
    s_waitcnt lgkmcnt(3)
    v_mfma_f32_32x32x16_bf16 v[152:167], v[184:187], a[216:219], v[152:167]
    ds_read_b128 v[200:203], v15 offset:31744
    v_rcp_f32 v209, v209
    v_rcp_f32 v210, v210
    v_mfma_f32_32x32x16_bf16 v[168:183], v[184:187], a[220:223], v[168:183]
    buffer_load_dwordx4 v1, s[16:19], s33 offen lds
    v_rcp_f32 v211, v211
    v_rcp_f32 v212, v212
    s_waitcnt lgkmcnt(3)
    v_mfma_f32_32x32x16_bf16 v[152:167], v[188:191], a[224:227], v[152:167]
    ds_read_b128 v[204:207], v15 offset:32768
    v_rcp_f32 v213, v213
    v_rcp_f32 v214, v214
    v_mfma_f32_32x32x16_bf16 v[168:183], v[188:191], a[228:231], v[168:183]
    v_rcp_f32 v215, v215
    v_mul_f32 v88, v88, v208
    v_mul_f32 v89, v89, v209
    v_mul_f32 v90, v90, v210
    s_waitcnt lgkmcnt(3)
    v_mfma_f32_32x32x16_bf16 v[152:167], v[192:195], a[232:235], v[152:167]
    ds_read_b128 v[184:187], v15 offset:33792
    v_mul_f32 v91, v91, v211
    v_mul_f32 v92, v92, v212
    v_mul_f32 v93, v93, v213
    v_mul_f32 v94, v94, v214
    v_mul_f32 v95, v95, v215
    v_mfma_f32_32x32x16_bf16 v[168:183], v[192:195], a[236:239], v[168:183]
    v_cvt_pk_bf16_f32 v224, v88, v89
    v_cvt_pk_bf16_f32 v225, v90, v91
    v_cvt_pk_bf16_f32 v226, v92, v93
    v_cvt_pk_bf16_f32 v227, v94, v95
    s_add_u32 s42, s43, 512
    s_waitcnt lgkmcnt(3)
    v_mfma_f32_32x32x16_bf16 v[152:167], v[196:199], a[240:243], v[152:167]
    ds_read_b128 v[188:191], v15 offset:34816
    buffer_store_dwordx4 v[224:227], v8, s[16:19], s42 offen sc1
    v_mul_f32 v104, v233, v104
    v_mul_f32 v105, v233, v105
    v_mul_f32 v106, v233, v106
    v_mul_f32 v107, v233, v107
    v_mfma_f32_32x32x16_bf16 v[168:183], v[196:199], a[244:247], v[168:183]
    v_mul_f32 v108, v233, v108
    v_mul_f32 v109, v233, v109
    v_mul_f32 v110, v233, v110
    v_mul_f32 v111, v233, v111
    v_fma_f32 v216, v104, v104, s40
    s_waitcnt lgkmcnt(3)
    v_mfma_f32_32x32x16_bf16 v[152:167], v[200:203], a[248:251], v[152:167]
    ds_read_b128 v[192:195], v15 offset:35840
    v_fma_f32 v217, v105, v105, s40
    v_fma_f32 v218, v106, v106, s40
    v_fma_f32 v219, v107, v107, s40
    v_fma_f32 v220, v108, v108, s40
    v_fma_f32 v221, v109, v109, s40
    v_mfma_f32_32x32x16_bf16 v[168:183], v[200:203], a[252:255], v[168:183]
    v_fma_f32 v222, v110, v110, s40
    v_fma_f32 v223, v111, v111, s40
    v_mul_f32 v216, v216, v104
    v_mul_f32 v217, v217, v105
    s_waitcnt lgkmcnt(3)
    v_mfma_f32_32x32x16_bf16 v[152:167], v[204:207], v[16:19], v[152:167]
    ds_read_b128 v[196:199], v3 offset:3072
    v_mul_f32 v218, v218, v106
    v_mul_f32 v219, v219, v107
    v_mul_f32 v220, v220, v108
    v_mul_f32 v221, v221, v109
    v_mfma_f32_32x32x16_bf16 v[168:183], v[204:207], v[20:23], v[168:183]
    v_mul_f32 v222, v222, v110
    v_mul_f32 v223, v223, v111
    v_exp_f32_e64 v216, -v216
    s_waitcnt lgkmcnt(3)
    v_mfma_f32_32x32x16_bf16 v[152:167], v[184:187], v[24:27], v[152:167]
    s_waitcnt vmcnt(11)
    s_barrier
    ds_read_b128 v[200:203], v12 offset:0
    v_mul_f32 v104, v104, v112
    v_exp_f32_e64 v217, -v217
    v_mul_f32 v105, v105, v113
    v_mfma_f32_32x32x16_bf16 v[168:183], v[184:187], v[28:31], v[168:183]
    s_add_u32 m0, s30, 73728
    s_add_u32 s33, s31, 221184
    v_exp_f32_e64 v218, -v218
    s_waitcnt lgkmcnt(3)
    v_mfma_f32_32x32x16_bf16 v[152:167], v[188:191], v[32:35], v[152:167]
    ds_read_b128 v[204:207], v12 offset:1024
    v_mul_f32 v106, v106, v114
    v_exp_f32_e64 v219, -v219
    v_mul_f32 v107, v107, v115
    v_mfma_f32_32x32x16_bf16 v[168:183], v[188:191], v[36:39], v[168:183]
    buffer_load_dwordx4 v1, s[16:19], s33 offen offset:0 lds
    v_exp_f32_e64 v220, -v220
    v_mul_f32 v108, v108, v116
    s_waitcnt lgkmcnt(3)
    v_mfma_f32_32x32x16_bf16 v[152:167], v[192:195], v[40:43], v[152:167]
    ds_read_b128 v[184:187], v12 offset:2048
    v_exp_f32_e64 v221, -v221
    v_mul_f32 v109, v109, v117
    v_mfma_f32_32x32x16_bf16 v[168:183], v[192:195], v[44:47], v[168:183]
    buffer_load_dwordx4 v1, s[16:19], s33 offen offset:1024 lds
    v_exp_f32_e64 v222, -v222
    v_mul_f32 v110, v110, v118
    s_waitcnt lgkmcnt(3)
    v_mfma_f32_32x32x16_bf16 v[152:167], v[196:199], v[48:51], v[152:167]
    ds_read_b128 v[188:191], v12 offset:3072
    v_exp_f32_e64 v223, -v223
    v_mul_f32 v111, v111, v119
    v_fma_f32 v216, v216, v235, v235
    v_mfma_f32_32x32x16_bf16 v[168:183], v[196:199], v[52:55], v[168:183]
    buffer_load_dwordx4 v1, s[16:19], s33 offen offset:2048 lds
    v_fma_f32 v217, v217, v235, v235
    v_fma_f32 v218, v218, v235, v235
    v_fma_f32 v219, v219, v235, v235
    s_waitcnt lgkmcnt(3)
    v_mfma_f32_32x32x16_bf16 v[56:71], v[200:203], a[0:3], 0
    ds_read_b128 v[192:195], v12 offset:4096
    v_fma_f32 v220, v220, v235, v235
    v_fma_f32 v221, v221, v235, v235
    v_fma_f32 v222, v222, v235, v235
    v_fma_f32 v223, v223, v235, v235
    v_mfma_f32_32x32x16_bf16 v[72:87], v[200:203], a[4:7], 0
    buffer_load_dwordx4 v1, s[16:19], s33 offen offset:3072 lds
    v_rcp_f32 v216, v216
    v_rcp_f32 v217, v217
    s_waitcnt lgkmcnt(3)
    v_mfma_f32_32x32x16_bf16 v[56:71], v[204:207], a[8:11], v[56:71]
    ds_read_b128 v[196:199], v12 offset:5120
    v_rcp_f32 v218, v218
    v_rcp_f32 v219, v219
    v_mfma_f32_32x32x16_bf16 v[72:87], v[204:207], a[12:15], v[72:87]
    s_add_u32 m0, s30, 90112
    s_add_u32 s33, s31, 237568
    v_rcp_f32 v220, v220
    s_waitcnt lgkmcnt(3)
    v_mfma_f32_32x32x16_bf16 v[56:71], v[184:187], a[16:19], v[56:71]
    ds_read_b128 v[200:203], v12 offset:6144
    v_rcp_f32 v221, v221
    v_rcp_f32 v222, v222
    v_mfma_f32_32x32x16_bf16 v[72:87], v[184:187], a[20:23], v[72:87]
    buffer_load_dwordx4 v1, s[16:19], s33 offen offset:0 lds
    v_rcp_f32 v223, v223
    v_mul_f32 v104, v104, v216
    v_mul_f32 v105, v105, v217
    s_waitcnt lgkmcnt(3)
    v_mfma_f32_32x32x16_bf16 v[56:71], v[188:191], a[24:27], v[56:71]
    ds_read_b128 v[204:207], v12 offset:7168
    v_mul_f32 v106, v106, v218
    v_mul_f32 v107, v107, v219
    v_mul_f32 v108, v108, v220
    v_mul_f32 v109, v109, v221
    v_mul_f32 v110, v110, v222
    v_mfma_f32_32x32x16_bf16 v[72:87], v[188:191], a[28:31], v[72:87]
    v_mul_f32 v111, v111, v223
    v_cvt_pk_bf16_f32 v228, v104, v105
    v_cvt_pk_bf16_f32 v229, v106, v107
    v_cvt_pk_bf16_f32 v230, v108, v109
    v_cvt_pk_bf16_f32 v231, v110, v111
    s_waitcnt lgkmcnt(3)
    v_mfma_f32_32x32x16_bf16 v[56:71], v[192:195], a[32:35], v[56:71]
    ds_read_b128 v[184:187], v12 offset:8192
    s_add_u32 s42, s43, 295424
    buffer_store_dwordx4 v[228:231], v8, s[16:19], s42 offen sc1
    v_mul_f32 v120, v232, v120
    v_mul_f32 v121, v232, v121
    v_mul_f32 v122, v232, v122
    v_mfma_f32_32x32x16_bf16 v[72:87], v[192:195], a[36:39], v[72:87]
    buffer_load_dwordx4 v1, s[16:19], s33 offen offset:1024 lds
    v_mul_f32 v123, v232, v123
    v_mul_f32 v124, v232, v124
    v_mul_f32 v125, v232, v125
    v_mul_f32 v126, v232, v126
    s_waitcnt lgkmcnt(3)
    v_mfma_f32_32x32x16_bf16 v[56:71], v[196:199], a[40:43], v[56:71]
    ds_read_b128 v[188:191], v12 offset:9216
    v_mul_f32 v127, v232, v127
    v_fma_f32 v208, v120, v120, s40
    v_fma_f32 v209, v121, v121, s40
    v_fma_f32 v210, v122, v122, s40
    v_fma_f32 v211, v123, v123, s40
    v_mfma_f32_32x32x16_bf16 v[72:87], v[196:199], a[44:47], v[72:87]
    v_fma_f32 v212, v124, v124, s40
    v_fma_f32 v213, v125, v125, s40
    v_fma_f32 v214, v126, v126, s40
    v_fma_f32 v215, v127, v127, s40
    v_mul_f32 v208, v208, v120
    s_waitcnt lgkmcnt(3)
    v_mfma_f32_32x32x16_bf16 v[56:71], v[200:203], a[48:51], v[56:71]
    ds_read_b128 v[192:195], v12 offset:10240
    v_mul_f32 v209, v209, v121
    v_mul_f32 v210, v210, v122
    v_mul_f32 v211, v211, v123
    v_mul_f32 v212, v212, v124
    v_mul_f32 v213, v213, v125
    v_mfma_f32_32x32x16_bf16 v[72:87], v[200:203], a[52:55], v[72:87]
    buffer_load_dwordx4 v1, s[16:19], s33 offen offset:2048 lds
    v_mul_f32 v214, v214, v126
    v_mul_f32 v215, v215, v127
    v_exp_f32_e64 v208, -v208
    s_waitcnt lgkmcnt(3)
    v_mfma_f32_32x32x16_bf16 v[56:71], v[204:207], a[56:59], v[56:71]
    ds_read_b128 v[196:199], v12 offset:11264
    v_mul_f32 v120, v120, v128
    v_exp_f32_e64 v209, -v209
    v_mul_f32 v121, v121, v129
    v_mfma_f32_32x32x16_bf16 v[72:87], v[204:207], a[60:63], v[72:87]
    v_exp_f32_e64 v210, -v210
    v_mul_f32 v122, v122, v130
    v_exp_f32_e64 v211, -v211
    s_waitcnt lgkmcnt(3)
    v_mfma_f32_32x32x16_bf16 v[56:71], v[184:187], a[64:67], v[56:71]
    ds_read_b128 v[200:203], v12 offset:12288
    v_mul_f32 v123, v123, v131
    v_exp_f32_e64 v212, -v212
    v_mul_f32 v124, v124, v132
    v_mfma_f32_32x32x16_bf16 v[72:87], v[184:187], a[68:71], v[72:87]
    buffer_load_dwordx4 v1, s[16:19], s33 offen offset:3072 lds
    v_exp_f32_e64 v213, -v213
    v_mul_f32 v125, v125, v133
    s_waitcnt lgkmcnt(3)
    v_mfma_f32_32x32x16_bf16 v[56:71], v[188:191], a[72:75], v[56:71]
    ds_read_b128 v[204:207], v12 offset:13312
    v_exp_f32_e64 v214, -v214
    v_mul_f32 v126, v126, v134
    v_exp_f32_e64 v215, -v215
    v_mfma_f32_32x32x16_bf16 v[72:87], v[188:191], a[76:79], v[72:87]
    s_add_u32 m0, s34, 106496
    s_add_u32 s33, s35, 253952
    v_mul_f32 v127, v127, v135
    v_fma_f32 v208, v208, v234, v234
    v_fma_f32 v209, v209, v234, v234
    s_waitcnt lgkmcnt(3)
    v_mfma_f32_32x32x16_bf16 v[56:71], v[192:195], a[80:83], v[56:71]
    ds_read_b128 v[184:187], v12 offset:14336
    v_fma_f32 v210, v210, v234, v234
    v_fma_f32 v211, v211, v234, v234
    v_fma_f32 v212, v212, v234, v234
    v_fma_f32 v213, v213, v234, v234
    v_fma_f32 v214, v214, v234, v234
    v_mfma_f32_32x32x16_bf16 v[72:87], v[192:195], a[84:87], v[72:87]
    buffer_load_dwordx4 v1, s[16:19], s33 offen lds
    v_fma_f32 v215, v215, v234, v234
    v_rcp_f32 v208, v208
    s_waitcnt lgkmcnt(3)
    v_mfma_f32_32x32x16_bf16 v[56:71], v[196:199], a[88:91], v[56:71]
    ds_read_b128 v[188:191], v12 offset:15360
    v_rcp_f32 v209, v209
    v_rcp_f32 v210, v210
    v_mfma_f32_32x32x16_bf16 v[72:87], v[196:199], a[92:95], v[72:87]
    v_rcp_f32 v211, v211
    v_rcp_f32 v212, v212
    s_waitcnt lgkmcnt(3)
    v_mfma_f32_32x32x16_bf16 v[56:71], v[200:203], a[96:99], v[56:71]
    ds_read_b128 v[192:195], v12 offset:16384
    v_rcp_f32 v213, v213
    v_rcp_f32 v214, v214
    v_mfma_f32_32x32x16_bf16 v[72:87], v[200:203], a[100:103], v[72:87]
    v_rcp_f32 v215, v215
    v_mul_f32 v120, v120, v208
    v_mul_f32 v121, v121, v209
    v_mul_f32 v122, v122, v210
    s_waitcnt lgkmcnt(3)
    v_mfma_f32_32x32x16_bf16 v[56:71], v[204:207], a[104:107], v[56:71]
    ds_read_b128 v[196:199], v12 offset:17408
    v_mul_f32 v123, v123, v211
    v_mul_f32 v124, v124, v212
    v_mul_f32 v125, v125, v213
    v_mul_f32 v126, v126, v214
    v_mul_f32 v127, v127, v215
    v_mfma_f32_32x32x16_bf16 v[72:87], v[204:207], a[108:111], v[72:87]
    v_cvt_pk_bf16_f32 v224, v120, v121
    v_cvt_pk_bf16_f32 v225, v122, v123
    v_cvt_pk_bf16_f32 v226, v124, v125
    v_cvt_pk_bf16_f32 v227, v126, v127
    s_add_u32 s42, s43, 1024
    s_waitcnt lgkmcnt(3)
    v_mfma_f32_32x32x16_bf16 v[56:71], v[184:187], a[112:115], v[56:71]
    ds_read_b128 v[200:203], v12 offset:18432
    buffer_store_dwordx4 v[224:227], v8, s[16:19], s42 offen sc1
    v_mul_f32 v136, v233, v136
    v_mul_f32 v137, v233, v137
    v_mul_f32 v138, v233, v138
    v_mul_f32 v139, v233, v139
    v_mfma_f32_32x32x16_bf16 v[72:87], v[184:187], a[116:119], v[72:87]
    v_mul_f32 v140, v233, v140
    v_mul_f32 v141, v233, v141
    v_mul_f32 v142, v233, v142
    v_mul_f32 v143, v233, v143
    v_fma_f32 v216, v136, v136, s40
    s_waitcnt lgkmcnt(3)
    v_mfma_f32_32x32x16_bf16 v[56:71], v[188:191], a[120:123], v[56:71]
    ds_read_b128 v[204:207], v12 offset:19456
    v_fma_f32 v217, v137, v137, s40
    v_fma_f32 v218, v138, v138, s40
    v_fma_f32 v219, v139, v139, s40
    v_fma_f32 v220, v140, v140, s40
    v_fma_f32 v221, v141, v141, s40
    v_mfma_f32_32x32x16_bf16 v[72:87], v[188:191], a[124:127], v[72:87]
    v_fma_f32 v222, v142, v142, s40
    v_fma_f32 v223, v143, v143, s40
    v_mul_f32 v216, v216, v136
    v_mul_f32 v217, v217, v137
    s_waitcnt lgkmcnt(3)
    v_mfma_f32_32x32x16_bf16 v[56:71], v[192:195], a[128:131], v[56:71]
    ds_read_b128 v[184:187], v12 offset:20480
    v_mul_f32 v218, v218, v138
    v_mul_f32 v219, v219, v139
    v_mul_f32 v220, v220, v140
    v_mul_f32 v221, v221, v141
    v_mfma_f32_32x32x16_bf16 v[72:87], v[192:195], a[132:135], v[72:87]
    v_mul_f32 v222, v222, v142
    v_mul_f32 v223, v223, v143
    v_exp_f32_e64 v216, -v216
    s_waitcnt lgkmcnt(3)
    v_mfma_f32_32x32x16_bf16 v[56:71], v[196:199], a[136:139], v[56:71]
    ds_read_b128 v[188:191], v12 offset:21504
    v_mul_f32 v136, v136, v144
    v_exp_f32_e64 v217, -v217
    v_mul_f32 v137, v137, v145
    v_mfma_f32_32x32x16_bf16 v[72:87], v[196:199], a[140:143], v[72:87]
    v_exp_f32_e64 v218, -v218
    v_mul_f32 v138, v138, v146
    s_waitcnt lgkmcnt(3)
    v_mfma_f32_32x32x16_bf16 v[56:71], v[200:203], a[144:147], v[56:71]
    ds_read_b128 v[192:195], v12 offset:22528
    v_exp_f32_e64 v219, -v219
    v_mul_f32 v139, v139, v147
    v_mfma_f32_32x32x16_bf16 v[72:87], v[200:203], a[148:151], v[72:87]
    v_exp_f32_e64 v220, -v220
    v_mul_f32 v140, v140, v148
    s_waitcnt lgkmcnt(3)
    v_mfma_f32_32x32x16_bf16 v[56:71], v[204:207], a[152:155], v[56:71]
    ds_read_b128 v[196:199], v12 offset:23552
    v_exp_f32_e64 v221, -v221
    v_mul_f32 v141, v141, v149
    v_mfma_f32_32x32x16_bf16 v[72:87], v[204:207], a[156:159], v[72:87]
    v_exp_f32_e64 v222, -v222
    v_mul_f32 v142, v142, v150
    s_waitcnt lgkmcnt(3)
    v_mfma_f32_32x32x16_bf16 v[56:71], v[184:187], a[160:163], v[56:71]
    ds_read_b128 v[200:203], v12 offset:24576
    v_exp_f32_e64 v223, -v223
    v_mul_f32 v143, v143, v151
    v_fma_f32 v216, v216, v235, v235
    v_mfma_f32_32x32x16_bf16 v[72:87], v[184:187], a[164:167], v[72:87]
    v_fma_f32 v217, v217, v235, v235
    v_fma_f32 v218, v218, v235, v235
    v_fma_f32 v219, v219, v235, v235
    v_fma_f32 v220, v220, v235, v235
    s_waitcnt lgkmcnt(3)
    v_mfma_f32_32x32x16_bf16 v[56:71], v[188:191], a[168:171], v[56:71]
    ds_read_b128 v[204:207], v12 offset:25600
    v_fma_f32 v221, v221, v235, v235
    v_fma_f32 v222, v222, v235, v235
    v_fma_f32 v223, v223, v235, v235
    v_mfma_f32_32x32x16_bf16 v[72:87], v[188:191], a[172:175], v[72:87]
    v_rcp_f32 v216, v216
    v_rcp_f32 v217, v217
    s_waitcnt lgkmcnt(3)
    v_mfma_f32_32x32x16_bf16 v[56:71], v[192:195], a[176:179], v[56:71]
    ds_read_b128 v[184:187], v12 offset:26624
    v_rcp_f32 v218, v218
    v_rcp_f32 v219, v219
    v_mfma_f32_32x32x16_bf16 v[72:87], v[192:195], a[180:183], v[72:87]
    v_rcp_f32 v220, v220
    v_rcp_f32 v221, v221
    s_waitcnt lgkmcnt(3)
    v_mfma_f32_32x32x16_bf16 v[56:71], v[196:199], a[184:187], v[56:71]
    ds_read_b128 v[188:191], v12 offset:27648
    v_rcp_f32 v222, v222
    v_rcp_f32 v223, v223
    v_mfma_f32_32x32x16_bf16 v[72:87], v[196:199], a[188:191], v[72:87]
    v_mul_f32 v136, v136, v216
    v_mul_f32 v137, v137, v217
    v_mul_f32 v138, v138, v218
    v_mul_f32 v139, v139, v219
    s_waitcnt lgkmcnt(3)
    v_mfma_f32_32x32x16_bf16 v[56:71], v[200:203], a[192:195], v[56:71]
    ds_read_b128 v[192:195], v12 offset:28672
    v_mul_f32 v140, v140, v220
    v_mul_f32 v141, v141, v221
    v_mul_f32 v142, v142, v222
    v_mul_f32 v143, v143, v223
    v_mfma_f32_32x32x16_bf16 v[72:87], v[200:203], a[196:199], v[72:87]
    v_cvt_pk_bf16_f32 v228, v136, v137
    v_cvt_pk_bf16_f32 v229, v138, v139
    v_cvt_pk_bf16_f32 v230, v140, v141
    v_cvt_pk_bf16_f32 v231, v142, v143
    s_waitcnt lgkmcnt(3)
    v_mfma_f32_32x32x16_bf16 v[56:71], v[204:207], a[200:203], v[56:71]
    ds_read_b128 v[196:199], v12 offset:29696
    s_add_u32 s42, s43, 295936
    buffer_store_dwordx4 v[228:231], v8, s[16:19], s42 offen sc1
    v_mul_f32 v152, v232, v152
    v_mul_f32 v153, v232, v153
    v_mfma_f32_32x32x16_bf16 v[72:87], v[204:207], a[204:207], v[72:87]
    v_mul_f32 v154, v232, v154
    v_mul_f32 v155, v232, v155
    v_mul_f32 v156, v232, v156
    v_mul_f32 v157, v232, v157
    s_waitcnt lgkmcnt(3)
    v_mfma_f32_32x32x16_bf16 v[56:71], v[184:187], a[208:211], v[56:71]
    ds_read_b128 v[200:203], v12 offset:30720
    v_mul_f32 v158, v232, v158
    v_mul_f32 v159, v232, v159
    v_fma_f32 v208, v152, v152, s40
    v_fma_f32 v209, v153, v153, s40
    v_mfma_f32_32x32x16_bf16 v[72:87], v[184:187], a[212:215], v[72:87]
    v_fma_f32 v210, v154, v154, s40
    v_fma_f32 v211, v155, v155, s40
    v_fma_f32 v212, v156, v156, s40
    v_fma_f32 v213, v157, v157, s40
    s_waitcnt lgkmcnt(3)
    v_mfma_f32_32x32x16_bf16 v[56:71], v[188:191], a[216:219], v[56:71]
    ds_read_b128 v[204:207], v12 offset:31744
    v_fma_f32 v214, v158, v158, s40
    v_fma_f32 v215, v159, v159, s40
    v_mul_f32 v208, v208, v152
    v_mul_f32 v209, v209, v153
    v_mfma_f32_32x32x16_bf16 v[72:87], v[188:191], a[220:223], v[72:87]
    v_mul_f32 v210, v210, v154
    v_mul_f32 v211, v211, v155
    v_mul_f32 v212, v212, v156
    v_mul_f32 v213, v213, v157
    s_waitcnt lgkmcnt(3)
    v_mfma_f32_32x32x16_bf16 v[56:71], v[192:195], a[224:227], v[56:71]
    ds_read_b128 v[184:187], v12 offset:32768
    v_mul_f32 v214, v214, v158
    v_mul_f32 v215, v215, v159
    v_exp_f32_e64 v208, -v208
    v_mfma_f32_32x32x16_bf16 v[72:87], v[192:195], a[228:231], v[72:87]
    v_mul_f32 v152, v152, v160
    v_exp_f32_e64 v209, -v209
    v_mul_f32 v153, v153, v161
    s_waitcnt lgkmcnt(3)
    v_mfma_f32_32x32x16_bf16 v[56:71], v[196:199], a[232:235], v[56:71]
    ds_read_b128 v[188:191], v12 offset:33792
    v_exp_f32_e64 v210, -v210
    v_mul_f32 v154, v154, v162
    v_mfma_f32_32x32x16_bf16 v[72:87], v[196:199], a[236:239], v[72:87]
    v_exp_f32_e64 v211, -v211
    v_mul_f32 v155, v155, v163
    s_waitcnt lgkmcnt(3)
    v_mfma_f32_32x32x16_bf16 v[56:71], v[200:203], a[240:243], v[56:71]
    ds_read_b128 v[192:195], v12 offset:34816
    v_exp_f32_e64 v212, -v212
    v_mul_f32 v156, v156, v164
    v_mfma_f32_32x32x16_bf16 v[72:87], v[200:203], a[244:247], v[72:87]
    v_exp_f32_e64 v213, -v213
    v_mul_f32 v157, v157, v165
    s_waitcnt lgkmcnt(3)
    v_mfma_f32_32x32x16_bf16 v[56:71], v[204:207], a[248:251], v[56:71]
    ds_read_b128 v[196:199], v12 offset:35840
    v_exp_f32_e64 v214, -v214
    v_mul_f32 v158, v158, v166
    v_mfma_f32_32x32x16_bf16 v[72:87], v[204:207], a[252:255], v[72:87]
    v_exp_f32_e64 v215, -v215
    v_mul_f32 v159, v159, v167
    v_fma_f32 v208, v208, v234, v234
    s_waitcnt lgkmcnt(3)
    v_mfma_f32_32x32x16_bf16 v[56:71], v[184:187], v[16:19], v[56:71]
    ds_read_b128 v[200:203], v3 offset:4096
    v_fma_f32 v209, v209, v234, v234
    v_fma_f32 v210, v210, v234, v234
    v_fma_f32 v211, v211, v234, v234
    v_fma_f32 v212, v212, v234, v234
    v_mfma_f32_32x32x16_bf16 v[72:87], v[184:187], v[20:23], v[72:87]
    v_fma_f32 v213, v213, v234, v234
    v_fma_f32 v214, v214, v234, v234
    v_fma_f32 v215, v215, v234, v234
    s_waitcnt lgkmcnt(3)
    v_mfma_f32_32x32x16_bf16 v[56:71], v[188:191], v[24:27], v[56:71]
    s_waitcnt vmcnt(13)
    s_barrier
    ds_read_b128 v[204:207], v13 offset:0
    v_rcp_f32 v208, v208
    v_rcp_f32 v209, v209
    v_mfma_f32_32x32x16_bf16 v[72:87], v[188:191], v[28:31], v[72:87]
    s_add_u32 m0, s30, 110592
    s_add_u32 s33, s31, 258048
    v_rcp_f32 v210, v210
    s_waitcnt lgkmcnt(3)
    v_mfma_f32_32x32x16_bf16 v[56:71], v[192:195], v[32:35], v[56:71]
    ds_read_b128 v[184:187], v13 offset:1024
    v_rcp_f32 v211, v211
    v_rcp_f32 v212, v212
    v_mfma_f32_32x32x16_bf16 v[72:87], v[192:195], v[36:39], v[72:87]
    buffer_load_dwordx4 v1, s[16:19], s33 offen offset:0 lds
    v_rcp_f32 v213, v213
    s_waitcnt lgkmcnt(3)
    v_mfma_f32_32x32x16_bf16 v[56:71], v[196:199], v[40:43], v[56:71]
    ds_read_b128 v[188:191], v13 offset:2048
    v_rcp_f32 v214, v214
    v_rcp_f32 v215, v215
    v_mfma_f32_32x32x16_bf16 v[72:87], v[196:199], v[44:47], v[72:87]
    v_mul_f32 v152, v152, v208
    v_mul_f32 v153, v153, v209
    v_mul_f32 v154, v154, v210
    v_mul_f32 v155, v155, v211
    s_waitcnt lgkmcnt(3)
    v_mfma_f32_32x32x16_bf16 v[56:71], v[200:203], v[48:51], v[56:71]
    ds_read_b128 v[192:195], v13 offset:3072
    v_mul_f32 v156, v156, v212
    v_mul_f32 v157, v157, v213
    v_mul_f32 v158, v158, v214
    v_mul_f32 v159, v159, v215
    v_mfma_f32_32x32x16_bf16 v[72:87], v[200:203], v[52:55], v[72:87]
    buffer_load_dwordx4 v1, s[16:19], s33 offen offset:1024 lds
    v_cvt_pk_bf16_f32 v224, v152, v153
    v_cvt_pk_bf16_f32 v225, v154, v155
    v_cvt_pk_bf16_f32 v226, v156, v157
    s_waitcnt lgkmcnt(3)
    v_mfma_f32_32x32x16_bf16 v[88:103], v[204:207], a[0:3], 0
    ds_read_b128 v[196:199], v13 offset:4096
    v_cvt_pk_bf16_f32 v227, v158, v159
    s_add_u32 s42, s43, 1536
    buffer_store_dwordx4 v[224:227], v8, s[16:19], s42 offen sc1
    v_mul_f32 v168, v233, v168
    v_mul_f32 v169, v233, v169
    v_mfma_f32_32x32x16_bf16 v[104:119], v[204:207], a[4:7], 0
    v_mul_f32 v170, v233, v170
    v_mul_f32 v171, v233, v171
    v_mul_f32 v172, v233, v172
    v_mul_f32 v173, v233, v173
    v_mul_f32 v174, v233, v174
    s_waitcnt lgkmcnt(3)
    v_mfma_f32_32x32x16_bf16 v[88:103], v[184:187], a[8:11], v[88:103]
    ds_read_b128 v[200:203], v13 offset:5120
    v_mul_f32 v175, v233, v175
    v_fma_f32 v216, v168, v168, s40
    v_fma_f32 v217, v169, v169, s40
    v_fma_f32 v218, v170, v170, s40
    v_fma_f32 v219, v171, v171, s40
    v_mfma_f32_32x32x16_bf16 v[104:119], v[184:187], a[12:15], v[104:119]
    buffer_load_dwordx4 v1, s[16:19], s33 offen offset:2048 lds
    v_fma_f32 v220, v172, v172, s40
    v_fma_f32 v221, v173, v173, s40
    v_fma_f32 v222, v174, v174, s40
    s_waitcnt lgkmcnt(3)
    v_mfma_f32_32x32x16_bf16 v[88:103], v[188:191], a[16:19], v[88:103]
    ds_read_b128 v[204:207], v13 offset:6144
    v_fma_f32 v223, v175, v175, s40
    v_mul_f32 v216, v216, v168
    v_mul_f32 v217, v217, v169
    v_mul_f32 v218, v218, v170
    v_mfma_f32_32x32x16_bf16 v[104:119], v[188:191], a[20:23], v[104:119]
    v_mul_f32 v219, v219, v171
    v_mul_f32 v220, v220, v172
    v_mul_f32 v221, v221, v173
    v_mul_f32 v222, v222, v174
    s_waitcnt lgkmcnt(3)
    v_mfma_f32_32x32x16_bf16 v[88:103], v[192:195], a[24:27], v[88:103]
    ds_read_b128 v[184:187], v13 offset:7168
    v_mul_f32 v223, v223, v175
    v_exp_f32_e64 v216, -v216
    v_mul_f32 v168, v168, v176
    v_mfma_f32_32x32x16_bf16 v[104:119], v[192:195], a[28:31], v[104:119]
    buffer_load_dwordx4 v1, s[16:19], s33 offen offset:3072 lds
    v_exp_f32_e64 v217, -v217
    v_mul_f32 v169, v169, v177
    s_waitcnt lgkmcnt(3)
    v_mfma_f32_32x32x16_bf16 v[88:103], v[196:199], a[32:35], v[88:103]
    ds_read_b128 v[188:191], v13 offset:8192
    v_exp_f32_e64 v218, -v218
    v_mul_f32 v170, v170, v178
    v_mfma_f32_32x32x16_bf16 v[104:119], v[196:199], a[36:39], v[104:119]
    s_add_u32 m0, s30, 126976
    s_add_u32 s33, s31, 274432
    v_exp_f32_e64 v219, -v219
    s_waitcnt lgkmcnt(3)
    v_mfma_f32_32x32x16_bf16 v[88:103], v[200:203], a[40:43], v[88:103]
    ds_read_b128 v[192:195], v13 offset:9216
    v_mul_f32 v171, v171, v179
    v_exp_f32_e64 v220, -v220
    v_mul_f32 v172, v172, v180
    v_mfma_f32_32x32x16_bf16 v[104:119], v[200:203], a[44:47], v[104:119]
    buffer_load_dwordx4 v1, s[16:19], s33 offen offset:0 lds
    v_exp_f32_e64 v221, -v221
    v_mul_f32 v173, v173, v181
    s_waitcnt lgkmcnt(3)
    v_mfma_f32_32x32x16_bf16 v[88:103], v[204:207], a[48:51], v[88:103]
    ds_read_b128 v[196:199], v13 offset:10240
    v_exp_f32_e64 v222, -v222
    v_mul_f32 v174, v174, v182
    v_mfma_f32_32x32x16_bf16 v[104:119], v[204:207], a[52:55], v[104:119]
    v_exp_f32_e64 v223, -v223
    v_mul_f32 v175, v175, v183
    v_fma_f32 v216, v216, v235, v235
    s_waitcnt lgkmcnt(3)
    v_mfma_f32_32x32x16_bf16 v[88:103], v[184:187], a[56:59], v[88:103]
    ds_read_b128 v[200:203], v13 offset:11264
    v_fma_f32 v217, v217, v235, v235
    v_fma_f32 v218, v218, v235, v235
    v_fma_f32 v219, v219, v235, v235
    v_fma_f32 v220, v220, v235, v235
    v_mfma_f32_32x32x16_bf16 v[104:119], v[184:187], a[60:63], v[104:119]
    buffer_load_dwordx4 v1, s[16:19], s33 offen offset:1024 lds
    v_fma_f32 v221, v221, v235, v235
    v_fma_f32 v222, v222, v235, v235
    v_fma_f32 v223, v223, v235, v235
    s_waitcnt lgkmcnt(3)
    v_mfma_f32_32x32x16_bf16 v[88:103], v[188:191], a[64:67], v[88:103]
    ds_read_b128 v[204:207], v13 offset:12288
    v_rcp_f32 v216, v216
    v_rcp_f32 v217, v217
    v_mfma_f32_32x32x16_bf16 v[104:119], v[188:191], a[68:71], v[104:119]
    v_rcp_f32 v218, v218
    v_rcp_f32 v219, v219
    s_waitcnt lgkmcnt(3)
    v_mfma_f32_32x32x16_bf16 v[88:103], v[192:195], a[72:75], v[88:103]
    ds_read_b128 v[184:187], v13 offset:13312
    v_rcp_f32 v220, v220
    v_rcp_f32 v221, v221
    v_mfma_f32_32x32x16_bf16 v[104:119], v[192:195], a[76:79], v[104:119]
    buffer_load_dwordx4 v1, s[16:19], s33 offen offset:2048 lds
    v_rcp_f32 v222, v222
    s_waitcnt lgkmcnt(3)
    v_mfma_f32_32x32x16_bf16 v[88:103], v[196:199], a[80:83], v[88:103]
    ds_read_b128 v[188:191], v13 offset:14336
    v_rcp_f32 v223, v223
    v_mul_f32 v168, v168, v216
    v_mul_f32 v169, v169, v217
    v_mfma_f32_32x32x16_bf16 v[104:119], v[196:199], a[84:87], v[104:119]
    v_mul_f32 v170, v170, v218
    v_mul_f32 v171, v171, v219
    v_mul_f32 v172, v172, v220
    v_mul_f32 v173, v173, v221
    s_waitcnt lgkmcnt(3)
    v_mfma_f32_32x32x16_bf16 v[88:103], v[200:203], a[88:91], v[88:103]
    ds_read_b128 v[192:195], v13 offset:15360
    v_mul_f32 v174, v174, v222
    v_mul_f32 v175, v175, v223
    v_cvt_pk_bf16_f32 v228, v168, v169
    v_cvt_pk_bf16_f32 v229, v170, v171
    v_mfma_f32_32x32x16_bf16 v[104:119], v[200:203], a[92:95], v[104:119]
    buffer_load_dwordx4 v1, s[16:19], s33 offen offset:3072 lds
    v_cvt_pk_bf16_f32 v230, v172, v173
    v_cvt_pk_bf16_f32 v231, v174, v175
    s_add_u32 s42, s43, 296448
    s_waitcnt lgkmcnt(3)
    v_mfma_f32_32x32x16_bf16 v[88:103], v[204:207], a[96:99], v[88:103]
    ds_read_b128 v[196:199], v13 offset:16384
    buffer_store_dwordx4 v[228:231], v8, s[16:19], s42 offen sc1
    v_mul_f32 v56, v232, v56
    v_mul_f32 v57, v232, v57
    v_mul_f32 v58, v232, v58
    v_mfma_f32_32x32x16_bf16 v[104:119], v[204:207], a[100:103], v[104:119]
    s_add_u32 m0, s34, 143360
    s_add_u32 s33, s35, 290816
    v_mul_f32 v59, v232, v59
    v_mul_f32 v60, v232, v60
    s_waitcnt lgkmcnt(3)
    v_mfma_f32_32x32x16_bf16 v[88:103], v[184:187], a[104:107], v[88:103]
    ds_read_b128 v[200:203], v13 offset:17408
    v_mul_f32 v61, v232, v61
    v_mul_f32 v62, v232, v62
    v_mul_f32 v63, v232, v63
    v_fma_f32 v208, v56, v56, s40
    v_mfma_f32_32x32x16_bf16 v[104:119], v[184:187], a[108:111], v[104:119]
    buffer_load_dwordx4 v1, s[16:19], s33 offen lds
    v_fma_f32 v209, v57, v57, s40
    v_fma_f32 v210, v58, v58, s40
    v_fma_f32 v211, v59, v59, s40
    s_waitcnt lgkmcnt(3)
    v_mfma_f32_32x32x16_bf16 v[88:103], v[188:191], a[112:115], v[88:103]
    ds_read_b128 v[204:207], v13 offset:18432
    v_fma_f32 v212, v60, v60, s40
    v_fma_f32 v213, v61, v61, s40
    v_fma_f32 v214, v62, v62, s40
    v_fma_f32 v215, v63, v63, s40
    v_mfma_f32_32x32x16_bf16 v[104:119], v[188:191], a[116:119], v[104:119]
    v_mul_f32 v208, v208, v56
    v_mul_f32 v209, v209, v57
    v_mul_f32 v210, v210, v58
    v_mul_f32 v211, v211, v59
    s_waitcnt lgkmcnt(3)
    v_mfma_f32_32x32x16_bf16 v[88:103], v[192:195], a[120:123], v[88:103]
    ds_read_b128 v[184:187], v13 offset:19456
    v_mul_f32 v212, v212, v60
    v_mul_f32 v213, v213, v61
    v_mul_f32 v214, v214, v62
    v_mul_f32 v215, v215, v63
    v_mfma_f32_32x32x16_bf16 v[104:119], v[192:195], a[124:127], v[104:119]
    v_exp_f32_e64 v208, -v208
    v_mul_f32 v56, v56, v64
    s_waitcnt lgkmcnt(3)
    v_mfma_f32_32x32x16_bf16 v[88:103], v[196:199], a[128:131], v[88:103]
    ds_read_b128 v[188:191], v13 offset:20480
    v_exp_f32_e64 v209, -v209
    v_mul_f32 v57, v57, v65
    v_mfma_f32_32x32x16_bf16 v[104:119], v[196:199], a[132:135], v[104:119]
    v_exp_f32_e64 v210, -v210
    v_mul_f32 v58, v58, v66
    s_waitcnt lgkmcnt(3)
    v_mfma_f32_32x32x16_bf16 v[88:103], v[200:203], a[136:139], v[88:103]
    ds_read_b128 v[192:195], v13 offset:21504
    v_exp_f32_e64 v211, -v211
    v_mul_f32 v59, v59, v67
    v_mfma_f32_32x32x16_bf16 v[104:119], v[200:203], a[140:143], v[104:119]
    v_exp_f32_e64 v212, -v212
    v_mul_f32 v60, v60, v68
    s_waitcnt lgkmcnt(3)
    v_mfma_f32_32x32x16_bf16 v[88:103], v[204:207], a[144:147], v[88:103]
    ds_read_b128 v[196:199], v13 offset:22528
    v_exp_f32_e64 v213, -v213
    v_mul_f32 v61, v61, v69
    v_mfma_f32_32x32x16_bf16 v[104:119], v[204:207], a[148:151], v[104:119]
    v_exp_f32_e64 v214, -v214
    v_mul_f32 v62, v62, v70
    s_waitcnt lgkmcnt(3)
    v_mfma_f32_32x32x16_bf16 v[88:103], v[184:187], a[152:155], v[88:103]
    ds_read_b128 v[200:203], v13 offset:23552
    v_exp_f32_e64 v215, -v215
    v_mul_f32 v63, v63, v71
    v_fma_f32 v208, v208, v234, v234
    v_mfma_f32_32x32x16_bf16 v[104:119], v[184:187], a[156:159], v[104:119]
    v_fma_f32 v209, v209, v234, v234
    v_fma_f32 v210, v210, v234, v234
    v_fma_f32 v211, v211, v234, v234
    v_fma_f32 v212, v212, v234, v234
    s_waitcnt lgkmcnt(3)
    v_mfma_f32_32x32x16_bf16 v[88:103], v[188:191], a[160:163], v[88:103]
    ds_read_b128 v[204:207], v13 offset:24576
    v_fma_f32 v213, v213, v234, v234
    v_fma_f32 v214, v214, v234, v234
    v_fma_f32 v215, v215, v234, v234
    v_mfma_f32_32x32x16_bf16 v[104:119], v[188:191], a[164:167], v[104:119]
    v_rcp_f32 v208, v208
    v_rcp_f32 v209, v209
    s_waitcnt lgkmcnt(3)
    v_mfma_f32_32x32x16_bf16 v[88:103], v[192:195], a[168:171], v[88:103]
    ds_read_b128 v[184:187], v13 offset:25600
    v_rcp_f32 v210, v210
    v_rcp_f32 v211, v211
    v_mfma_f32_32x32x16_bf16 v[104:119], v[192:195], a[172:175], v[104:119]
    v_rcp_f32 v212, v212
    v_rcp_f32 v213, v213
    s_waitcnt lgkmcnt(3)
    v_mfma_f32_32x32x16_bf16 v[88:103], v[196:199], a[176:179], v[88:103]
    ds_read_b128 v[188:191], v13 offset:26624
    v_rcp_f32 v214, v214
    v_rcp_f32 v215, v215
    v_mfma_f32_32x32x16_bf16 v[104:119], v[196:199], a[180:183], v[104:119]
    v_mul_f32 v56, v56, v208
    v_mul_f32 v57, v57, v209
    v_mul_f32 v58, v58, v210
    v_mul_f32 v59, v59, v211
    s_waitcnt lgkmcnt(3)
    v_mfma_f32_32x32x16_bf16 v[88:103], v[200:203], a[184:187], v[88:103]
    ds_read_b128 v[192:195], v13 offset:27648
    v_mul_f32 v60, v60, v212
    v_mul_f32 v61, v61, v213
    v_mul_f32 v62, v62, v214
    v_mul_f32 v63, v63, v215
    v_mfma_f32_32x32x16_bf16 v[104:119], v[200:203], a[188:191], v[104:119]
    v_cvt_pk_bf16_f32 v224, v56, v57
    v_cvt_pk_bf16_f32 v225, v58, v59
    v_cvt_pk_bf16_f32 v226, v60, v61
    v_cvt_pk_bf16_f32 v227, v62, v63
    s_waitcnt lgkmcnt(3)
    v_mfma_f32_32x32x16_bf16 v[88:103], v[204:207], a[192:195], v[88:103]
    ds_read_b128 v[196:199], v13 offset:28672
    s_add_u32 s42, s43, 2048
    buffer_store_dwordx4 v[224:227], v8, s[16:19], s42 offen sc1
    v_mul_f32 v72, v233, v72
    v_mul_f32 v73, v233, v73
    v_mfma_f32_32x32x16_bf16 v[104:119], v[204:207], a[196:199], v[104:119]
    v_mul_f32 v74, v233, v74
    v_mul_f32 v75, v233, v75
    v_mul_f32 v76, v233, v76
    v_mul_f32 v77, v233, v77
    s_waitcnt lgkmcnt(3)
    v_mfma_f32_32x32x16_bf16 v[88:103], v[184:187], a[200:203], v[88:103]
    ds_read_b128 v[200:203], v13 offset:29696
    v_mul_f32 v78, v233, v78
    v_mul_f32 v79, v233, v79
    v_fma_f32 v216, v72, v72, s40
    v_fma_f32 v217, v73, v73, s40
    v_mfma_f32_32x32x16_bf16 v[104:119], v[184:187], a[204:207], v[104:119]
    v_fma_f32 v218, v74, v74, s40
    v_fma_f32 v219, v75, v75, s40
    v_fma_f32 v220, v76, v76, s40
    v_fma_f32 v221, v77, v77, s40
    s_waitcnt lgkmcnt(3)
    v_mfma_f32_32x32x16_bf16 v[88:103], v[188:191], a[208:211], v[88:103]
    ds_read_b128 v[204:207], v13 offset:30720
    v_fma_f32 v222, v78, v78, s40
    v_fma_f32 v223, v79, v79, s40
    v_mul_f32 v216, v216, v72
    v_mul_f32 v217, v217, v73
    v_mfma_f32_32x32x16_bf16 v[104:119], v[188:191], a[212:215], v[104:119]
    v_mul_f32 v218, v218, v74
    v_mul_f32 v219, v219, v75
    v_mul_f32 v220, v220, v76
    v_mul_f32 v221, v221, v77
    s_waitcnt lgkmcnt(3)
    v_mfma_f32_32x32x16_bf16 v[88:103], v[192:195], a[216:219], v[88:103]
    ds_read_b128 v[184:187], v13 offset:31744
    v_mul_f32 v222, v222, v78
    v_mul_f32 v223, v223, v79
    v_exp_f32_e64 v216, -v216
    v_mfma_f32_32x32x16_bf16 v[104:119], v[192:195], a[220:223], v[104:119]
    v_mul_f32 v72, v72, v80
    v_exp_f32_e64 v217, -v217
    v_mul_f32 v73, v73, v81
    s_waitcnt lgkmcnt(3)
    v_mfma_f32_32x32x16_bf16 v[88:103], v[196:199], a[224:227], v[88:103]
    ds_read_b128 v[188:191], v13 offset:32768
    v_exp_f32_e64 v218, -v218
    v_mul_f32 v74, v74, v82
    v_mfma_f32_32x32x16_bf16 v[104:119], v[196:199], a[228:231], v[104:119]
    v_exp_f32_e64 v219, -v219
    v_mul_f32 v75, v75, v83
    s_waitcnt lgkmcnt(3)
    v_mfma_f32_32x32x16_bf16 v[88:103], v[200:203], a[232:235], v[88:103]
    ds_read_b128 v[192:195], v13 offset:33792
    v_exp_f32_e64 v220, -v220
    v_mul_f32 v76, v76, v84
    v_mfma_f32_32x32x16_bf16 v[104:119], v[200:203], a[236:239], v[104:119]
    v_exp_f32_e64 v221, -v221
    v_mul_f32 v77, v77, v85
    s_waitcnt lgkmcnt(3)
    v_mfma_f32_32x32x16_bf16 v[88:103], v[204:207], a[240:243], v[88:103]
    ds_read_b128 v[196:199], v13 offset:34816
    v_exp_f32_e64 v222, -v222
    v_mul_f32 v78, v78, v86
    v_mfma_f32_32x32x16_bf16 v[104:119], v[204:207], a[244:247], v[104:119]
    v_exp_f32_e64 v223, -v223
    v_mul_f32 v79, v79, v87
    v_fma_f32 v216, v216, v235, v235
    s_waitcnt lgkmcnt(3)
    v_mfma_f32_32x32x16_bf16 v[88:103], v[184:187], a[248:251], v[88:103]
    ds_read_b128 v[200:203], v13 offset:35840
    v_fma_f32 v217, v217, v235, v235
    v_fma_f32 v218, v218, v235, v235
    v_fma_f32 v219, v219, v235, v235
    v_fma_f32 v220, v220, v235, v235
    v_mfma_f32_32x32x16_bf16 v[104:119], v[184:187], a[252:255], v[104:119]
    v_fma_f32 v221, v221, v235, v235
    v_fma_f32 v222, v222, v235, v235
    v_fma_f32 v223, v223, v235, v235
    s_waitcnt lgkmcnt(3)
    v_mfma_f32_32x32x16_bf16 v[88:103], v[188:191], v[16:19], v[88:103]
    ds_read_b128 v[204:207], v3 offset:5120
    v_rcp_f32 v216, v216
    v_rcp_f32 v217, v217
    v_mfma_f32_32x32x16_bf16 v[104:119], v[188:191], v[20:23], v[104:119]
    v_rcp_f32 v218, v218
    v_rcp_f32 v219, v219
    s_waitcnt lgkmcnt(3)
    v_mfma_f32_32x32x16_bf16 v[88:103], v[192:195], v[24:27], v[88:103]
    s_waitcnt vmcnt(14)
    s_barrier
    ds_read_b128 v[184:187], v14 offset:0
    v_rcp_f32 v220, v220
    v_rcp_f32 v221, v221
    v_mfma_f32_32x32x16_bf16 v[104:119], v[192:195], v[28:31], v[104:119]
    s_add_u32 m0, s30, 0
    s_add_u32 s33, s31, 294912
    v_rcp_f32 v222, v222
    s_waitcnt lgkmcnt(3)
    v_mfma_f32_32x32x16_bf16 v[88:103], v[196:199], v[32:35], v[88:103]
    ds_read_b128 v[188:191], v14 offset:1024
    v_rcp_f32 v223, v223
    v_mul_f32 v72, v72, v216
    v_mul_f32 v73, v73, v217
    v_mfma_f32_32x32x16_bf16 v[104:119], v[196:199], v[36:39], v[104:119]
    v_mul_f32 v74, v74, v218
    v_mul_f32 v75, v75, v219
    v_mul_f32 v76, v76, v220
    v_mul_f32 v77, v77, v221
    s_waitcnt lgkmcnt(3)
    v_mfma_f32_32x32x16_bf16 v[88:103], v[200:203], v[40:43], v[88:103]
    ds_read_b128 v[192:195], v14 offset:2048
    v_mul_f32 v78, v78, v222
    v_mul_f32 v79, v79, v223
    v_cvt_pk_bf16_f32 v228, v72, v73
    v_cvt_pk_bf16_f32 v229, v74, v75
    v_mfma_f32_32x32x16_bf16 v[104:119], v[200:203], v[44:47], v[104:119]
    buffer_load_dwordx4 v1, s[16:19], s33 offen offset:0 lds
    v_cvt_pk_bf16_f32 v230, v76, v77
    v_cvt_pk_bf16_f32 v231, v78, v79
    s_add_u32 s42, s43, 296960
    s_waitcnt lgkmcnt(3)
    v_mfma_f32_32x32x16_bf16 v[88:103], v[204:207], v[48:51], v[88:103]
    ds_read_b128 v[196:199], v14 offset:3072
    buffer_store_dwordx4 v[228:231], v8, s[16:19], s42 offen sc1
    v_mfma_f32_32x32x16_bf16 v[104:119], v[204:207], v[52:55], v[104:119]
    s_waitcnt lgkmcnt(3)
    v_mfma_f32_32x32x16_bf16 v[120:135], v[184:187], a[0:3], 0
    ds_read_b128 v[200:203], v14 offset:4096
    s_nop 5
    v_mul_f32 v88, v232, v88
    v_mul_f32 v89, v232, v89
    v_mul_f32 v90, v232, v90
    v_mul_f32 v91, v232, v91
    v_mfma_f32_32x32x16_bf16 v[136:151], v[184:187], a[4:7], 0
    buffer_load_dwordx4 v1, s[16:19], s33 offen offset:1024 lds
    v_mul_f32 v92, v232, v92
    v_mul_f32 v93, v232, v93
    v_mul_f32 v94, v232, v94
    s_waitcnt lgkmcnt(3)
    v_mfma_f32_32x32x16_bf16 v[120:135], v[188:191], a[8:11], v[120:135]
    ds_read_b128 v[204:207], v14 offset:5120
    v_mul_f32 v95, v232, v95
    v_fma_f32 v208, v88, v88, s40
    v_fma_f32 v209, v89, v89, s40
    v_fma_f32 v210, v90, v90, s40
    v_mfma_f32_32x32x16_bf16 v[136:151], v[188:191], a[12:15], v[136:151]
    v_fma_f32 v211, v91, v91, s40
    v_fma_f32 v212, v92, v92, s40
    v_fma_f32 v213, v93, v93, s40
    v_fma_f32 v214, v94, v94, s40
    s_waitcnt lgkmcnt(3)
    v_mfma_f32_32x32x16_bf16 v[120:135], v[192:195], a[16:19], v[120:135]
    ds_read_b128 v[184:187], v14 offset:6144
    v_fma_f32 v215, v95, v95, s40
    v_mul_f32 v208, v208, v88
    v_mul_f32 v209, v209, v89
    v_mul_f32 v210, v210, v90
    v_mfma_f32_32x32x16_bf16 v[136:151], v[192:195], a[20:23], v[136:151]
    buffer_load_dwordx4 v1, s[16:19], s33 offen offset:2048 lds
    v_mul_f32 v211, v211, v91
    v_mul_f32 v212, v212, v92
    v_mul_f32 v213, v213, v93
    s_waitcnt lgkmcnt(3)
    v_mfma_f32_32x32x16_bf16 v[120:135], v[196:199], a[24:27], v[120:135]
    ds_read_b128 v[188:191], v14 offset:7168
    v_mul_f32 v214, v214, v94
    v_mul_f32 v215, v215, v95
    v_exp_f32_e64 v208, -v208
    v_mfma_f32_32x32x16_bf16 v[136:151], v[196:199], a[28:31], v[136:151]
    v_mul_f32 v88, v88, v96
    v_exp_f32_e64 v209, -v209
    v_mul_f32 v89, v89, v97
    s_waitcnt lgkmcnt(3)
    v_mfma_f32_32x32x16_bf16 v[120:135], v[200:203], a[32:35], v[120:135]
    ds_read_b128 v[192:195], v14 offset:8192
    v_exp_f32_e64 v210, -v210
    v_mul_f32 v90, v90, v98
    v_mfma_f32_32x32x16_bf16 v[136:151], v[200:203], a[36:39], v[136:151]
    buffer_load_dwordx4 v1, s[16:19], s33 offen offset:3072 lds
    v_exp_f32_e64 v211, -v211
    v_mul_f32 v91, v91, v99
    s_waitcnt lgkmcnt(3)
    v_mfma_f32_32x32x16_bf16 v[120:135], v[204:207], a[40:43], v[120:135]
    ds_read_b128 v[196:199], v14 offset:9216
    v_exp_f32_e64 v212, -v212
    v_mul_f32 v92, v92, v100
    v_mfma_f32_32x32x16_bf16 v[136:151], v[204:207], a[44:47], v[136:151]
    s_add_u32 m0, s30, 16384
    s_add_u32 s33, s31, 311296
    v_exp_f32_e64 v213, -v213
    s_waitcnt lgkmcnt(3)
    v_mfma_f32_32x32x16_bf16 v[120:135], v[184:187], a[48:51], v[120:135]
    ds_read_b128 v[200:203], v14 offset:10240
    v_mul_f32 v93, v93, v101
    v_exp_f32_e64 v214, -v214
    v_mul_f32 v94, v94, v102
    v_mfma_f32_32x32x16_bf16 v[136:151], v[184:187], a[52:55], v[136:151]
    buffer_load_dwordx4 v1, s[16:19], s33 offen offset:0 lds
    v_exp_f32_e64 v215, -v215
    v_mul_f32 v95, v95, v103
    s_waitcnt lgkmcnt(3)
    v_mfma_f32_32x32x16_bf16 v[120:135], v[188:191], a[56:59], v[120:135]
    ds_read_b128 v[204:207], v14 offset:11264
    v_fma_f32 v208, v208, v234, v234
    v_fma_f32 v209, v209, v234, v234
    v_fma_f32 v210, v210, v234, v234
    v_fma_f32 v211, v211, v234, v234
    v_mfma_f32_32x32x16_bf16 v[136:151], v[188:191], a[60:63], v[136:151]
    v_fma_f32 v212, v212, v234, v234
    v_fma_f32 v213, v213, v234, v234
    v_fma_f32 v214, v214, v234, v234
    v_fma_f32 v215, v215, v234, v234
    s_waitcnt lgkmcnt(3)
    v_mfma_f32_32x32x16_bf16 v[120:135], v[192:195], a[64:67], v[120:135]
    ds_read_b128 v[184:187], v14 offset:12288
    v_rcp_f32 v208, v208
    v_rcp_f32 v209, v209
    v_mfma_f32_32x32x16_bf16 v[136:151], v[192:195], a[68:71], v[136:151]
    buffer_load_dwordx4 v1, s[16:19], s33 offen offset:1024 lds
    v_rcp_f32 v210, v210
    s_waitcnt lgkmcnt(3)
    v_mfma_f32_32x32x16_bf16 v[120:135], v[196:199], a[72:75], v[120:135]
    ds_read_b128 v[188:191], v14 offset:13312
    v_rcp_f32 v211, v211
    v_rcp_f32 v212, v212
    v_mfma_f32_32x32x16_bf16 v[136:151], v[196:199], a[76:79], v[136:151]
    v_rcp_f32 v213, v213
    v_rcp_f32 v214, v214
    s_waitcnt lgkmcnt(3)
    v_mfma_f32_32x32x16_bf16 v[120:135], v[200:203], a[80:83], v[120:135]
    ds_read_b128 v[192:195], v14 offset:14336
    v_rcp_f32 v215, v215
    v_mul_f32 v88, v88, v208
    v_mul_f32 v89, v89, v209
    v_mfma_f32_32x32x16_bf16 v[136:151], v[200:203], a[84:87], v[136:151]
    buffer_load_dwordx4 v1, s[16:19], s33 offen offset:2048 lds
    v_mul_f32 v90, v90, v210
    v_mul_f32 v91, v91, v211
    v_mul_f32 v92, v92, v212
    s_waitcnt lgkmcnt(3)
    v_mfma_f32_32x32x16_bf16 v[120:135], v[204:207], a[88:91], v[120:135]
    ds_read_b128 v[196:199], v14 offset:15360
    v_mul_f32 v93, v93, v213
    v_mul_f32 v94, v94, v214
    v_mul_f32 v95, v95, v215
    v_cvt_pk_bf16_f32 v224, v88, v89
    v_mfma_f32_32x32x16_bf16 v[136:151], v[204:207], a[92:95], v[136:151]
    v_cvt_pk_bf16_f32 v225, v90, v91
    v_cvt_pk_bf16_f32 v226, v92, v93
    v_cvt_pk_bf16_f32 v227, v94, v95
    s_add_u32 s42, s43, 2560
    s_waitcnt lgkmcnt(3)
    v_mfma_f32_32x32x16_bf16 v[120:135], v[184:187], a[96:99], v[120:135]
    ds_read_b128 v[200:203], v14 offset:16384
    buffer_store_dwordx4 v[224:227], v8, s[16:19], s42 offen sc1
    v_mul_f32 v104, v233, v104
    v_mul_f32 v105, v233, v105
    v_mul_f32 v106, v233, v106
    v_mfma_f32_32x32x16_bf16 v[136:151], v[184:187], a[100:103], v[136:151]
    buffer_load_dwordx4 v1, s[16:19], s33 offen offset:3072 lds
    v_mul_f32 v107, v233, v107
    v_mul_f32 v108, v233, v108
    v_mul_f32 v109, v233, v109
    s_waitcnt lgkmcnt(3)
    v_mfma_f32_32x32x16_bf16 v[120:135], v[188:191], a[104:107], v[120:135]
    ds_read_b128 v[204:207], v14 offset:17408
    v_mul_f32 v110, v233, v110
    v_mul_f32 v111, v233, v111
    v_fma_f32 v216, v104, v104, s40
    v_fma_f32 v217, v105, v105, s40
    v_mfma_f32_32x32x16_bf16 v[136:151], v[188:191], a[108:111], v[136:151]
    s_add_u32 m0, s34, 32768
    s_add_u32 s33, s35, 327680
    v_fma_f32 v218, v106, v106, s40
    v_fma_f32 v219, v107, v107, s40
    s_waitcnt lgkmcnt(3)
    v_mfma_f32_32x32x16_bf16 v[120:135], v[192:195], a[112:115], v[120:135]
    ds_read_b128 v[184:187], v14 offset:18432
    v_fma_f32 v220, v108, v108, s40
    v_fma_f32 v221, v109, v109, s40
    v_fma_f32 v222, v110, v110, s40
    v_fma_f32 v223, v111, v111, s40
    v_mfma_f32_32x32x16_bf16 v[136:151], v[192:195], a[116:119], v[136:151]
    buffer_load_dwordx4 v1, s[16:19], s33 offen lds
    v_mul_f32 v216, v216, v104
    v_mul_f32 v217, v217, v105
    v_mul_f32 v218, v218, v106
    s_waitcnt lgkmcnt(3)
    v_mfma_f32_32x32x16_bf16 v[120:135], v[196:199], a[120:123], v[120:135]
    ds_read_b128 v[188:191], v14 offset:19456
    v_mul_f32 v219, v219, v107
    v_mul_f32 v220, v220, v108
    v_mul_f32 v221, v221, v109
    v_mul_f32 v222, v222, v110
    v_mfma_f32_32x32x16_bf16 v[136:151], v[196:199], a[124:127], v[136:151]
    v_mul_f32 v223, v223, v111
    v_exp_f32_e64 v216, -v216
    v_mul_f32 v104, v104, v112
    s_waitcnt lgkmcnt(3)
    v_mfma_f32_32x32x16_bf16 v[120:135], v[200:203], a[128:131], v[120:135]
    ds_read_b128 v[192:195], v14 offset:20480
    v_exp_f32_e64 v217, -v217
    v_mul_f32 v105, v105, v113
    v_mfma_f32_32x32x16_bf16 v[136:151], v[200:203], a[132:135], v[136:151]
    v_exp_f32_e64 v218, -v218
    v_mul_f32 v106, v106, v114
    s_waitcnt lgkmcnt(3)
    v_mfma_f32_32x32x16_bf16 v[120:135], v[204:207], a[136:139], v[120:135]
    ds_read_b128 v[196:199], v14 offset:21504
    v_exp_f32_e64 v219, -v219
    v_mul_f32 v107, v107, v115
    v_mfma_f32_32x32x16_bf16 v[136:151], v[204:207], a[140:143], v[136:151]
    v_exp_f32_e64 v220, -v220
    v_mul_f32 v108, v108, v116
    s_waitcnt lgkmcnt(3)
    v_mfma_f32_32x32x16_bf16 v[120:135], v[184:187], a[144:147], v[120:135]
    ds_read_b128 v[200:203], v14 offset:22528
    v_exp_f32_e64 v221, -v221
    v_mul_f32 v109, v109, v117
    v_mfma_f32_32x32x16_bf16 v[136:151], v[184:187], a[148:151], v[136:151]
    v_exp_f32_e64 v222, -v222
    v_mul_f32 v110, v110, v118
    s_waitcnt lgkmcnt(3)
    v_mfma_f32_32x32x16_bf16 v[120:135], v[188:191], a[152:155], v[120:135]
    ds_read_b128 v[204:207], v14 offset:23552
    v_exp_f32_e64 v223, -v223
    v_mul_f32 v111, v111, v119
    v_fma_f32 v216, v216, v235, v235
    v_mfma_f32_32x32x16_bf16 v[136:151], v[188:191], a[156:159], v[136:151]
    v_fma_f32 v217, v217, v235, v235
    v_fma_f32 v218, v218, v235, v235
    v_fma_f32 v219, v219, v235, v235
    v_fma_f32 v220, v220, v235, v235
    s_waitcnt lgkmcnt(3)
    v_mfma_f32_32x32x16_bf16 v[120:135], v[192:195], a[160:163], v[120:135]
    ds_read_b128 v[184:187], v14 offset:24576
    v_fma_f32 v221, v221, v235, v235
    v_fma_f32 v222, v222, v235, v235
    v_fma_f32 v223, v223, v235, v235
    v_mfma_f32_32x32x16_bf16 v[136:151], v[192:195], a[164:167], v[136:151]
    v_rcp_f32 v216, v216
    v_rcp_f32 v217, v217
    s_waitcnt lgkmcnt(3)
    v_mfma_f32_32x32x16_bf16 v[120:135], v[196:199], a[168:171], v[120:135]
    ds_read_b128 v[188:191], v14 offset:25600
    v_rcp_f32 v218, v218
    v_rcp_f32 v219, v219
    v_mfma_f32_32x32x16_bf16 v[136:151], v[196:199], a[172:175], v[136:151]
    v_rcp_f32 v220, v220
    v_rcp_f32 v221, v221
    s_waitcnt lgkmcnt(3)
    v_mfma_f32_32x32x16_bf16 v[120:135], v[200:203], a[176:179], v[120:135]
    ds_read_b128 v[192:195], v14 offset:26624
    v_rcp_f32 v222, v222
    v_rcp_f32 v223, v223
    v_mfma_f32_32x32x16_bf16 v[136:151], v[200:203], a[180:183], v[136:151]
    v_mul_f32 v104, v104, v216
    v_mul_f32 v105, v105, v217
    v_mul_f32 v106, v106, v218
    v_mul_f32 v107, v107, v219
    s_waitcnt lgkmcnt(3)
    v_mfma_f32_32x32x16_bf16 v[120:135], v[204:207], a[184:187], v[120:135]
    ds_read_b128 v[196:199], v14 offset:27648
    v_mul_f32 v108, v108, v220
    v_mul_f32 v109, v109, v221
    v_mul_f32 v110, v110, v222
    v_mul_f32 v111, v111, v223
    v_mfma_f32_32x32x16_bf16 v[136:151], v[204:207], a[188:191], v[136:151]
    v_cvt_pk_bf16_f32 v228, v104, v105
    v_cvt_pk_bf16_f32 v229, v106, v107
    v_cvt_pk_bf16_f32 v230, v108, v109
    v_cvt_pk_bf16_f32 v231, v110, v111
    s_waitcnt lgkmcnt(3)
    v_mfma_f32_32x32x16_bf16 v[120:135], v[184:187], a[192:195], v[120:135]
    ds_read_b128 v[200:203], v14 offset:28672
    s_add_u32 s42, s43, 297472
    buffer_store_dwordx4 v[228:231], v8, s[16:19], s42 offen sc1
    v_mfma_f32_32x32x16_bf16 v[136:151], v[184:187], a[196:199], v[136:151]
    s_waitcnt lgkmcnt(3)
    v_mfma_f32_32x32x16_bf16 v[120:135], v[188:191], a[200:203], v[120:135]
    ds_read_b128 v[204:207], v14 offset:29696
    v_mfma_f32_32x32x16_bf16 v[136:151], v[188:191], a[204:207], v[136:151]
    s_waitcnt lgkmcnt(3)
    v_mfma_f32_32x32x16_bf16 v[120:135], v[192:195], a[208:211], v[120:135]
    ds_read_b128 v[184:187], v14 offset:30720
    v_mfma_f32_32x32x16_bf16 v[136:151], v[192:195], a[212:215], v[136:151]
    s_waitcnt lgkmcnt(3)
    v_mfma_f32_32x32x16_bf16 v[120:135], v[196:199], a[216:219], v[120:135]
    ds_read_b128 v[188:191], v14 offset:31744
    v_mfma_f32_32x32x16_bf16 v[136:151], v[196:199], a[220:223], v[136:151]
    s_waitcnt lgkmcnt(3)
    v_mfma_f32_32x32x16_bf16 v[120:135], v[200:203], a[224:227], v[120:135]
    ds_read_b128 v[192:195], v14 offset:32768
    v_mfma_f32_32x32x16_bf16 v[136:151], v[200:203], a[228:231], v[136:151]
    s_waitcnt lgkmcnt(3)
    v_mfma_f32_32x32x16_bf16 v[120:135], v[204:207], a[232:235], v[120:135]
    ds_read_b128 v[196:199], v14 offset:33792
    v_mfma_f32_32x32x16_bf16 v[136:151], v[204:207], a[236:239], v[136:151]
    s_waitcnt lgkmcnt(3)
    v_mfma_f32_32x32x16_bf16 v[120:135], v[184:187], a[240:243], v[120:135]
    ds_read_b128 v[200:203], v14 offset:34816
    v_mfma_f32_32x32x16_bf16 v[136:151], v[184:187], a[244:247], v[136:151]
    s_waitcnt lgkmcnt(3)
    v_mfma_f32_32x32x16_bf16 v[120:135], v[188:191], a[248:251], v[120:135]
    ds_read_b128 v[204:207], v14 offset:35840
    v_mfma_f32_32x32x16_bf16 v[136:151], v[188:191], a[252:255], v[136:151]
    s_waitcnt lgkmcnt(3)
    v_mfma_f32_32x32x16_bf16 v[120:135], v[192:195], v[16:19], v[120:135]
    ds_read_b128 v[184:187], v3 offset:6144
    v_mfma_f32_32x32x16_bf16 v[136:151], v[192:195], v[20:23], v[136:151]
    s_waitcnt lgkmcnt(3)
    v_mfma_f32_32x32x16_bf16 v[120:135], v[196:199], v[24:27], v[120:135]
    s_waitcnt vmcnt(13)
    s_barrier
    ds_read_b128 v[188:191], v15 offset:0
    v_mfma_f32_32x32x16_bf16 v[136:151], v[196:199], v[28:31], v[136:151]
    s_waitcnt lgkmcnt(3)
    v_mfma_f32_32x32x16_bf16 v[120:135], v[200:203], v[32:35], v[120:135]
    ds_read_b128 v[192:195], v15 offset:1024
    v_mfma_f32_32x32x16_bf16 v[136:151], v[200:203], v[36:39], v[136:151]
    s_waitcnt lgkmcnt(3)
    v_mfma_f32_32x32x16_bf16 v[120:135], v[204:207], v[40:43], v[120:135]
    ds_read_b128 v[196:199], v15 offset:2048
    v_mfma_f32_32x32x16_bf16 v[136:151], v[204:207], v[44:47], v[136:151]
    s_waitcnt lgkmcnt(3)
    v_mfma_f32_32x32x16_bf16 v[120:135], v[184:187], v[48:51], v[120:135]
    ds_read_b128 v[200:203], v15 offset:3072
    v_mfma_f32_32x32x16_bf16 v[136:151], v[184:187], v[52:55], v[136:151]
    s_waitcnt lgkmcnt(3)
    v_mfma_f32_32x32x16_bf16 v[152:167], v[188:191], a[0:3], 0
    ds_read_b128 v[204:207], v15 offset:4096
    s_nop 6
    v_mul_f32 v120, v232, v120
    v_mul_f32 v121, v232, v121
    v_mul_f32 v122, v232, v122
    v_mul_f32 v123, v232, v123
    v_mfma_f32_32x32x16_bf16 v[168:183], v[188:191], a[4:7], 0
    v_mul_f32 v124, v232, v124
    v_mul_f32 v125, v232, v125
    v_mul_f32 v126, v232, v126
    v_mul_f32 v127, v232, v127
    s_waitcnt lgkmcnt(3)
    v_mfma_f32_32x32x16_bf16 v[152:167], v[192:195], a[8:11], v[152:167]
    ds_read_b128 v[184:187], v15 offset:5120
    v_fma_f32 v208, v120, v120, s40
    v_fma_f32 v209, v121, v121, s40
    v_fma_f32 v210, v122, v122, s40
    v_fma_f32 v211, v123, v123, s40
    v_mfma_f32_32x32x16_bf16 v[168:183], v[192:195], a[12:15], v[168:183]
    v_fma_f32 v212, v124, v124, s40
    v_fma_f32 v213, v125, v125, s40
    v_fma_f32 v214, v126, v126, s40
    v_fma_f32 v215, v127, v127, s40
    s_waitcnt lgkmcnt(3)
    v_mfma_f32_32x32x16_bf16 v[152:167], v[196:199], a[16:19], v[152:167]
    ds_read_b128 v[188:191], v15 offset:6144
    v_mul_f32 v208, v208, v120
    v_mul_f32 v209, v209, v121
    v_mul_f32 v210, v210, v122
    v_mul_f32 v211, v211, v123
    v_mfma_f32_32x32x16_bf16 v[168:183], v[196:199], a[20:23], v[168:183]
    v_mul_f32 v212, v212, v124
    v_mul_f32 v213, v213, v125
    v_mul_f32 v214, v214, v126
    v_mul_f32 v215, v215, v127
    s_waitcnt lgkmcnt(3)
    v_mfma_f32_32x32x16_bf16 v[152:167], v[200:203], a[24:27], v[152:167]
    ds_read_b128 v[192:195], v15 offset:7168
    v_exp_f32_e64 v208, -v208
    v_mul_f32 v120, v120, v128
    v_mfma_f32_32x32x16_bf16 v[168:183], v[200:203], a[28:31], v[168:183]
    v_exp_f32_e64 v209, -v209
    v_mul_f32 v121, v121, v129
    s_waitcnt lgkmcnt(3)
    v_mfma_f32_32x32x16_bf16 v[152:167], v[204:207], a[32:35], v[152:167]
    ds_read_b128 v[196:199], v15 offset:8192
    v_exp_f32_e64 v210, -v210
    v_mul_f32 v122, v122, v130
    v_mfma_f32_32x32x16_bf16 v[168:183], v[204:207], a[36:39], v[168:183]
    v_exp_f32_e64 v211, -v211
    v_mul_f32 v123, v123, v131
    s_waitcnt lgkmcnt(3)
    v_mfma_f32_32x32x16_bf16 v[152:167], v[184:187], a[40:43], v[152:167]
    ds_read_b128 v[200:203], v15 offset:9216
    v_exp_f32_e64 v212, -v212
    v_mul_f32 v124, v124, v132
    v_mfma_f32_32x32x16_bf16 v[168:183], v[184:187], a[44:47], v[168:183]
    v_exp_f32_e64 v213, -v213
    v_mul_f32 v125, v125, v133
    s_waitcnt lgkmcnt(3)
    v_mfma_f32_32x32x16_bf16 v[152:167], v[188:191], a[48:51], v[152:167]
    ds_read_b128 v[204:207], v15 offset:10240
    v_exp_f32_e64 v214, -v214
    v_mul_f32 v126, v126, v134
    v_mfma_f32_32x32x16_bf16 v[168:183], v[188:191], a[52:55], v[168:183]
    v_exp_f32_e64 v215, -v215
    v_mul_f32 v127, v127, v135
    v_fma_f32 v208, v208, v234, v234
    s_waitcnt lgkmcnt(3)
    v_mfma_f32_32x32x16_bf16 v[152:167], v[192:195], a[56:59], v[152:167]
    ds_read_b128 v[184:187], v15 offset:11264
    v_fma_f32 v209, v209, v234, v234
    v_fma_f32 v210, v210, v234, v234
    v_fma_f32 v211, v211, v234, v234
    v_fma_f32 v212, v212, v234, v234
    v_mfma_f32_32x32x16_bf16 v[168:183], v[192:195], a[60:63], v[168:183]
    v_fma_f32 v213, v213, v234, v234
    v_fma_f32 v214, v214, v234, v234
    v_fma_f32 v215, v215, v234, v234
    s_waitcnt lgkmcnt(3)
    v_mfma_f32_32x32x16_bf16 v[152:167], v[196:199], a[64:67], v[152:167]
    ds_read_b128 v[188:191], v15 offset:12288
    v_rcp_f32 v208, v208
    v_rcp_f32 v209, v209
    v_mfma_f32_32x32x16_bf16 v[168:183], v[196:199], a[68:71], v[168:183]
    v_rcp_f32 v210, v210
    v_rcp_f32 v211, v211
    s_waitcnt lgkmcnt(3)
    v_mfma_f32_32x32x16_bf16 v[152:167], v[200:203], a[72:75], v[152:167]
    ds_read_b128 v[192:195], v15 offset:13312
    v_rcp_f32 v212, v212
    v_rcp_f32 v213, v213
    v_mfma_f32_32x32x16_bf16 v[168:183], v[200:203], a[76:79], v[168:183]
    v_rcp_f32 v214, v214
    v_rcp_f32 v215, v215
    s_waitcnt lgkmcnt(3)
    v_mfma_f32_32x32x16_bf16 v[152:167], v[204:207], a[80:83], v[152:167]
    ds_read_b128 v[196:199], v15 offset:14336
    v_mul_f32 v120, v120, v208
    v_mul_f32 v121, v121, v209
    v_mul_f32 v122, v122, v210
    v_mul_f32 v123, v123, v211
    v_mfma_f32_32x32x16_bf16 v[168:183], v[204:207], a[84:87], v[168:183]
    v_mul_f32 v124, v124, v212
    v_mul_f32 v125, v125, v213
    v_mul_f32 v126, v126, v214
    v_mul_f32 v127, v127, v215
    s_waitcnt lgkmcnt(3)
    v_mfma_f32_32x32x16_bf16 v[152:167], v[184:187], a[88:91], v[152:167]
    ds_read_b128 v[200:203], v15 offset:15360
    v_cvt_pk_bf16_f32 v224, v120, v121
    v_cvt_pk_bf16_f32 v225, v122, v123
    v_cvt_pk_bf16_f32 v226, v124, v125
    v_cvt_pk_bf16_f32 v227, v126, v127
    v_mfma_f32_32x32x16_bf16 v[168:183], v[184:187], a[92:95], v[168:183]
    s_add_u32 s42, s43, 3072
    buffer_store_dwordx4 v[224:227], v8, s[16:19], s42 offen sc1
    v_mul_f32 v136, v233, v136
    v_mul_f32 v137, v233, v137
    s_waitcnt lgkmcnt(3)
    v_mfma_f32_32x32x16_bf16 v[152:167], v[188:191], a[96:99], v[152:167]
    ds_read_b128 v[204:207], v15 offset:16384
    v_mul_f32 v138, v233, v138
    v_mul_f32 v139, v233, v139
    v_mul_f32 v140, v233, v140
    v_mul_f32 v141, v233, v141
    v_mfma_f32_32x32x16_bf16 v[168:183], v[188:191], a[100:103], v[168:183]
    v_mul_f32 v142, v233, v142
    v_mul_f32 v143, v233, v143
    v_fma_f32 v216, v136, v136, s40
    v_fma_f32 v217, v137, v137, s40
    s_waitcnt lgkmcnt(3)
    v_mfma_f32_32x32x16_bf16 v[152:167], v[192:195], a[104:107], v[152:167]
    ds_read_b128 v[184:187], v15 offset:17408
    v_fma_f32 v218, v138, v138, s40
    v_fma_f32 v219, v139, v139, s40
    v_fma_f32 v220, v140, v140, s40
    v_fma_f32 v221, v141, v141, s40
    v_mfma_f32_32x32x16_bf16 v[168:183], v[192:195], a[108:111], v[168:183]
    v_fma_f32 v222, v142, v142, s40
    v_fma_f32 v223, v143, v143, s40
    v_mul_f32 v216, v216, v136
    v_mul_f32 v217, v217, v137
    s_waitcnt lgkmcnt(3)
    v_mfma_f32_32x32x16_bf16 v[152:167], v[196:199], a[112:115], v[152:167]
    ds_read_b128 v[188:191], v15 offset:18432
    v_mul_f32 v218, v218, v138
    v_mul_f32 v219, v219, v139
    v_mul_f32 v220, v220, v140
    v_mul_f32 v221, v221, v141
    v_mfma_f32_32x32x16_bf16 v[168:183], v[196:199], a[116:119], v[168:183]
    v_mul_f32 v222, v222, v142
    v_mul_f32 v223, v223, v143
    v_exp_f32_e64 v216, -v216
    s_waitcnt lgkmcnt(3)
    v_mfma_f32_32x32x16_bf16 v[152:167], v[200:203], a[120:123], v[152:167]
    ds_read_b128 v[192:195], v15 offset:19456
    v_mul_f32 v136, v136, v144
    v_exp_f32_e64 v217, -v217
    v_mul_f32 v137, v137, v145
    v_mfma_f32_32x32x16_bf16 v[168:183], v[200:203], a[124:127], v[168:183]
    v_exp_f32_e64 v218, -v218
    v_mul_f32 v138, v138, v146
    s_waitcnt lgkmcnt(3)
    v_mfma_f32_32x32x16_bf16 v[152:167], v[204:207], a[128:131], v[152:167]
    ds_read_b128 v[196:199], v15 offset:20480
    v_exp_f32_e64 v219, -v219
    v_mul_f32 v139, v139, v147
    v_mfma_f32_32x32x16_bf16 v[168:183], v[204:207], a[132:135], v[168:183]
    v_exp_f32_e64 v220, -v220
    v_mul_f32 v140, v140, v148
    s_waitcnt lgkmcnt(3)
    v_mfma_f32_32x32x16_bf16 v[152:167], v[184:187], a[136:139], v[152:167]
    ds_read_b128 v[200:203], v15 offset:21504
    v_exp_f32_e64 v221, -v221
    v_mul_f32 v141, v141, v149
    v_mfma_f32_32x32x16_bf16 v[168:183], v[184:187], a[140:143], v[168:183]
    v_exp_f32_e64 v222, -v222
    v_mul_f32 v142, v142, v150
    s_waitcnt lgkmcnt(3)
    v_mfma_f32_32x32x16_bf16 v[152:167], v[188:191], a[144:147], v[152:167]
    ds_read_b128 v[204:207], v15 offset:22528
    v_exp_f32_e64 v223, -v223
    v_mul_f32 v143, v143, v151
    v_fma_f32 v216, v216, v235, v235
    v_mfma_f32_32x32x16_bf16 v[168:183], v[188:191], a[148:151], v[168:183]
    v_fma_f32 v217, v217, v235, v235
    v_fma_f32 v218, v218, v235, v235
    v_fma_f32 v219, v219, v235, v235
    v_fma_f32 v220, v220, v235, v235
    s_waitcnt lgkmcnt(3)
    v_mfma_f32_32x32x16_bf16 v[152:167], v[192:195], a[152:155], v[152:167]
    ds_read_b128 v[184:187], v15 offset:23552
    v_fma_f32 v221, v221, v235, v235
    v_fma_f32 v222, v222, v235, v235
    v_fma_f32 v223, v223, v235, v235
    v_mfma_f32_32x32x16_bf16 v[168:183], v[192:195], a[156:159], v[168:183]
    v_rcp_f32 v216, v216
    v_rcp_f32 v217, v217
    s_waitcnt lgkmcnt(3)
    v_mfma_f32_32x32x16_bf16 v[152:167], v[196:199], a[160:163], v[152:167]
    ds_read_b128 v[188:191], v15 offset:24576
    v_rcp_f32 v218, v218
    v_rcp_f32 v219, v219
    v_mfma_f32_32x32x16_bf16 v[168:183], v[196:199], a[164:167], v[168:183]
    v_rcp_f32 v220, v220
    v_rcp_f32 v221, v221
    s_waitcnt lgkmcnt(3)
    v_mfma_f32_32x32x16_bf16 v[152:167], v[200:203], a[168:171], v[152:167]
    ds_read_b128 v[192:195], v15 offset:25600
    v_rcp_f32 v222, v222
    v_rcp_f32 v223, v223
    v_mfma_f32_32x32x16_bf16 v[168:183], v[200:203], a[172:175], v[168:183]
    v_mul_f32 v136, v136, v216
    v_mul_f32 v137, v137, v217
    v_mul_f32 v138, v138, v218
    v_mul_f32 v139, v139, v219
    s_waitcnt lgkmcnt(3)
    v_mfma_f32_32x32x16_bf16 v[152:167], v[204:207], a[176:179], v[152:167]
    ds_read_b128 v[196:199], v15 offset:26624
    v_mul_f32 v140, v140, v220
    v_mul_f32 v141, v141, v221
    v_mul_f32 v142, v142, v222
    v_mul_f32 v143, v143, v223
    v_mfma_f32_32x32x16_bf16 v[168:183], v[204:207], a[180:183], v[168:183]
    v_cvt_pk_bf16_f32 v228, v136, v137
    v_cvt_pk_bf16_f32 v229, v138, v139
    v_cvt_pk_bf16_f32 v230, v140, v141
    v_cvt_pk_bf16_f32 v231, v142, v143
    s_waitcnt lgkmcnt(3)
    v_mfma_f32_32x32x16_bf16 v[152:167], v[184:187], a[184:187], v[152:167]
    ds_read_b128 v[200:203], v15 offset:27648
    s_add_u32 s42, s43, 297984
    buffer_store_dwordx4 v[228:231], v8, s[16:19], s42 offen sc1
    v_mfma_f32_32x32x16_bf16 v[168:183], v[184:187], a[188:191], v[168:183]
    s_waitcnt lgkmcnt(3)
    v_mfma_f32_32x32x16_bf16 v[152:167], v[188:191], a[192:195], v[152:167]
    ds_read_b128 v[204:207], v15 offset:28672
    v_mfma_f32_32x32x16_bf16 v[168:183], v[188:191], a[196:199], v[168:183]
    s_waitcnt lgkmcnt(3)
    v_mfma_f32_32x32x16_bf16 v[152:167], v[192:195], a[200:203], v[152:167]
    ds_read_b128 v[184:187], v15 offset:29696
    v_mfma_f32_32x32x16_bf16 v[168:183], v[192:195], a[204:207], v[168:183]
    s_waitcnt lgkmcnt(3)
    v_mfma_f32_32x32x16_bf16 v[152:167], v[196:199], a[208:211], v[152:167]
    ds_read_b128 v[188:191], v15 offset:30720
    v_mfma_f32_32x32x16_bf16 v[168:183], v[196:199], a[212:215], v[168:183]
    s_waitcnt lgkmcnt(3)
    v_mfma_f32_32x32x16_bf16 v[152:167], v[200:203], a[216:219], v[152:167]
    ds_read_b128 v[192:195], v15 offset:31744
    v_mfma_f32_32x32x16_bf16 v[168:183], v[200:203], a[220:223], v[168:183]
    s_waitcnt lgkmcnt(3)
    v_mfma_f32_32x32x16_bf16 v[152:167], v[204:207], a[224:227], v[152:167]
    ds_read_b128 v[196:199], v15 offset:32768
    v_mfma_f32_32x32x16_bf16 v[168:183], v[204:207], a[228:231], v[168:183]
    s_waitcnt lgkmcnt(3)
    v_mfma_f32_32x32x16_bf16 v[152:167], v[184:187], a[232:235], v[152:167]
    ds_read_b128 v[200:203], v15 offset:33792
    v_mfma_f32_32x32x16_bf16 v[168:183], v[184:187], a[236:239], v[168:183]
    s_waitcnt lgkmcnt(3)
    v_mfma_f32_32x32x16_bf16 v[152:167], v[188:191], a[240:243], v[152:167]
    ds_read_b128 v[204:207], v15 offset:34816
    v_mfma_f32_32x32x16_bf16 v[168:183], v[188:191], a[244:247], v[168:183]
    s_waitcnt lgkmcnt(3)
    v_mfma_f32_32x32x16_bf16 v[152:167], v[192:195], a[248:251], v[152:167]
    ds_read_b128 v[184:187], v15 offset:35840
    v_mfma_f32_32x32x16_bf16 v[168:183], v[192:195], a[252:255], v[168:183]
    s_waitcnt lgkmcnt(3)
    v_mfma_f32_32x32x16_bf16 v[152:167], v[196:199], v[16:19], v[152:167]
    ds_read_b128 v[188:191], v3 offset:7168
    v_mfma_f32_32x32x16_bf16 v[168:183], v[196:199], v[20:23], v[168:183]
    s_waitcnt lgkmcnt(3)
    v_mfma_f32_32x32x16_bf16 v[152:167], v[200:203], v[24:27], v[152:167]
    s_waitcnt vmcnt(3)
    s_barrier
    ds_read_b128 v[192:195], v12 offset:0
    v_mfma_f32_32x32x16_bf16 v[168:183], v[200:203], v[28:31], v[168:183]
    s_add_u32 m0, s62, 36864
    s_nop 0
    buffer_load_dwordx4 v240, s[16:19], s50 offen offset:0 lds
    s_waitcnt lgkmcnt(3)
    v_mfma_f32_32x32x16_bf16 v[152:167], v[204:207], v[32:35], v[152:167]
    ds_read_b128 v[196:199], v12 offset:1024
    v_mfma_f32_32x32x16_bf16 v[168:183], v[204:207], v[36:39], v[168:183]
    s_waitcnt lgkmcnt(3)
    v_mfma_f32_32x32x16_bf16 v[152:167], v[184:187], v[40:43], v[152:167]
    ds_read_b128 v[200:203], v12 offset:2048
    v_mfma_f32_32x32x16_bf16 v[168:183], v[184:187], v[44:47], v[168:183]
    buffer_load_dwordx4 v240, s[16:19], s51 offen offset:1024 lds
    s_waitcnt lgkmcnt(3)
    v_mfma_f32_32x32x16_bf16 v[152:167], v[188:191], v[48:51], v[152:167]
    ds_read_b128 v[204:207], v12 offset:3072
    v_mfma_f32_32x32x16_bf16 v[168:183], v[188:191], v[52:55], v[168:183]
    s_waitcnt lgkmcnt(2)
    v_mfma_f32_32x32x16_bf16 v[56:71], v[192:195], a[0:3], 0
    ds_read_b128 v[184:187], v12 offset:4096
    buffer_load_dwordx4 v240, s[16:19], s52 offen offset:2048 lds
    s_waitcnt vmcnt(3)
    buffer_store_dword v242, v241, s[16:19], s29 offen offset:32 sc1
    s_nop 3
    v_mul_f32 v152, v232, v152
    v_mfma_f32_32x32x16_bf16 v[56:71], v[196:199], a[8:11], v[56:71]
    ds_read_b128 v[188:191], v12 offset:5120
    v_mul_f32 v153, v232, v153
    v_mul_f32 v154, v232, v154
    v_mul_f32 v155, v232, v155
    v_mul_f32 v156, v232, v156
    s_waitcnt lgkmcnt(2)
    v_mfma_f32_32x32x16_bf16 v[56:71], v[200:203], a[16:19], v[56:71]
    ds_read_b128 v[192:195], v12 offset:6144
    buffer_load_dwordx4 v240, s[16:19], s53 offen offset:3072 lds
    v_mul_f32 v157, v232, v157
    v_mul_f32 v158, v232, v158
    v_mul_f32 v159, v232, v159
    v_mfma_f32_32x32x16_bf16 v[56:71], v[204:207], a[24:27], v[56:71]
    ds_read_b128 v[196:199], v12 offset:7168
    s_add_u32 m0, s62, 40960
    s_nop 0
    buffer_load_dwordx4 v240, s[16:19], s54 offen offset:0 lds
    v_fma_f32 v208, v152, v152, s40
    v_fma_f32 v209, v153, v153, s40
    s_waitcnt lgkmcnt(2)
    v_mfma_f32_32x32x16_bf16 v[56:71], v[184:187], a[32:35], v[56:71]
    ds_read_b128 v[200:203], v12 offset:8192
    buffer_load_dwordx4 v240, s[16:19], s55 offen offset:1024 lds
    v_fma_f32 v210, v154, v154, s40
    v_fma_f32 v211, v155, v155, s40
    v_fma_f32 v212, v156, v156, s40
    v_mfma_f32_32x32x16_bf16 v[56:71], v[188:191], a[40:43], v[56:71]
    ds_read_b128 v[204:207], v12 offset:9216
    v_fma_f32 v213, v157, v157, s40
    v_fma_f32 v214, v158, v158, s40
    v_fma_f32 v215, v159, v159, s40
    v_mul_f32 v208, v208, v152
    s_waitcnt lgkmcnt(2)
    v_mfma_f32_32x32x16_bf16 v[56:71], v[192:195], a[48:51], v[56:71]
    ds_read_b128 v[184:187], v12 offset:10240
    buffer_load_dwordx4 v240, s[16:19], s63 offen offset:2048 lds
    v_mul_f32 v209, v209, v153
    v_mul_f32 v210, v210, v154
    v_mul_f32 v211, v211, v155
    v_mfma_f32_32x32x16_bf16 v[56:71], v[196:199], a[56:59], v[56:71]
    ds_read_b128 v[188:191], v12 offset:11264
    v_add_u32 v240, 1024, v1
    s_add_u32 m0, s62, 73728
    v_mul_f32 v212, v212, v156
    v_mul_f32 v213, v213, v157
    s_waitcnt lgkmcnt(2)
    v_mfma_f32_32x32x16_bf16 v[56:71], v[200:203], a[64:67], v[56:71]
    ds_read_b128 v[192:195], v12 offset:12288
    buffer_load_dwordx4 v240, s[16:19], s50 offen offset:0 lds
    v_mul_f32 v214, v214, v158
    v_mul_f32 v215, v215, v159
    v_mfma_f32_32x32x16_bf16 v[56:71], v[204:207], a[72:75], v[56:71]
    ds_read_b128 v[196:199], v12 offset:13312
    v_exp_f32_e64 v208, -v208
    v_mul_f32 v152, v152, v160
    s_waitcnt lgkmcnt(2)
    v_mfma_f32_32x32x16_bf16 v[56:71], v[184:187], a[80:83], v[56:71]
    ds_read_b128 v[200:203], v12 offset:14336
    buffer_load_dwordx4 v240, s[16:19], s51 offen offset:1024 lds
    v_exp_f32_e64 v209, -v209
    v_mul_f32 v153, v153, v161
    v_mfma_f32_32x32x16_bf16 v[56:71], v[188:191], a[88:91], v[56:71]
    ds_read_b128 v[204:207], v12 offset:15360
    v_exp_f32_e64 v210, -v210
    v_mul_f32 v154, v154, v162
    s_waitcnt lgkmcnt(2)
    v_mfma_f32_32x32x16_bf16 v[56:71], v[192:195], a[96:99], v[56:71]
    ds_read_b128 v[184:187], v12 offset:16384
    buffer_load_dwordx4 v240, s[16:19], s52 offen offset:2048 lds
    v_exp_f32_e64 v211, -v211
    v_mul_f32 v155, v155, v163
    v_mfma_f32_32x32x16_bf16 v[56:71], v[196:199], a[104:107], v[56:71]
    ds_read_b128 v[188:191], v12 offset:17408
    v_exp_f32_e64 v212, -v212
    v_mul_f32 v156, v156, v164
    s_waitcnt lgkmcnt(2)
    v_mfma_f32_32x32x16_bf16 v[56:71], v[200:203], a[112:115], v[56:71]
    ds_read_b128 v[192:195], v12 offset:18432
    buffer_load_dwordx4 v240, s[16:19], s53 offen offset:3072 lds
    v_exp_f32_e64 v213, -v213
    v_mul_f32 v157, v157, v165
    v_mfma_f32_32x32x16_bf16 v[56:71], v[204:207], a[120:123], v[56:71]
    ds_read_b128 v[196:199], v12 offset:19456
    s_add_u32 m0, s62, 77824
    s_nop 0
    buffer_load_dwordx4 v240, s[16:19], s54 offen offset:0 lds
    v_exp_f32_e64 v214, -v214
    s_waitcnt lgkmcnt(2)
    v_mfma_f32_32x32x16_bf16 v[56:71], v[184:187], a[128:131], v[56:71]
    ds_read_b128 v[200:203], v12 offset:20480
    buffer_load_dwordx4 v240, s[16:19], s55 offen offset:1024 lds
    v_mul_f32 v158, v158, v166
    v_exp_f32_e64 v215, -v215
    v_mfma_f32_32x32x16_bf16 v[56:71], v[188:191], a[136:139], v[56:71]
    ds_read_b128 v[204:207], v12 offset:21504
    v_mul_f32 v159, v159, v167
    v_fma_f32 v208, v208, v234, v234
    v_fma_f32 v209, v209, v234, v234
    v_fma_f32 v210, v210, v234, v234
    s_waitcnt lgkmcnt(2)
    v_mfma_f32_32x32x16_bf16 v[56:71], v[192:195], a[144:147], v[56:71]
    ds_read_b128 v[184:187], v12 offset:22528
    buffer_load_dwordx4 v240, s[16:19], s63 offen offset:2048 lds
    v_fma_f32 v211, v211, v234, v234
    v_fma_f32 v212, v212, v234, v234
    v_fma_f32 v213, v213, v234, v234
    v_mfma_f32_32x32x16_bf16 v[56:71], v[196:199], a[152:155], v[56:71]
    ds_read_b128 v[188:191], v12 offset:23552
    v_add_u32 v240, 2048, v1
    v_fma_f32 v214, v214, v234, v234
    v_fma_f32 v215, v215, v234, v234
    s_waitcnt lgkmcnt(2)
    v_mfma_f32_32x32x16_bf16 v[56:71], v[200:203], a[160:163], v[56:71]
    ds_read_b128 v[192:195], v12 offset:24576
    v_rcp_f32 v208, v208
    v_rcp_f32 v209, v209
    v_mfma_f32_32x32x16_bf16 v[56:71], v[204:207], a[168:171], v[56:71]
    ds_read_b128 v[196:199], v12 offset:25600
    v_rcp_f32 v210, v210
    v_rcp_f32 v211, v211
    s_waitcnt lgkmcnt(2)
    v_mfma_f32_32x32x16_bf16 v[56:71], v[184:187], a[176:179], v[56:71]
    ds_read_b128 v[200:203], v12 offset:26624
    v_rcp_f32 v212, v212
    v_rcp_f32 v213, v213
    v_mfma_f32_32x32x16_bf16 v[56:71], v[188:191], a[184:187], v[56:71]
    ds_read_b128 v[204:207], v12 offset:27648
    v_rcp_f32 v214, v214
    v_rcp_f32 v215, v215
    s_waitcnt lgkmcnt(2)
    v_mfma_f32_32x32x16_bf16 v[56:71], v[192:195], a[192:195], v[56:71]
    ds_read_b128 v[184:187], v12 offset:28672
    v_mul_f32 v152, v152, v208
    v_mul_f32 v153, v153, v209
    v_mul_f32 v154, v154, v210
    v_mul_f32 v155, v155, v211
    v_mfma_f32_32x32x16_bf16 v[56:71], v[196:199], a[200:203], v[56:71]
    ds_read_b128 v[188:191], v12 offset:29696
    v_mul_f32 v156, v156, v212
    v_mul_f32 v157, v157, v213
    v_mul_f32 v158, v158, v214
    v_mul_f32 v159, v159, v215
    s_waitcnt lgkmcnt(2)
    v_mfma_f32_32x32x16_bf16 v[56:71], v[200:203], a[208:211], v[56:71]
    ds_read_b128 v[192:195], v12 offset:30720
    v_cvt_pk_bf16_f32 v224, v152, v153
    v_cvt_pk_bf16_f32 v225, v154, v155
    v_cvt_pk_bf16_f32 v226, v156, v157
    v_cvt_pk_bf16_f32 v227, v158, v159
    v_mfma_f32_32x32x16_bf16 v[56:71], v[204:207], a[216:219], v[56:71]
    ds_read_b128 v[196:199], v12 offset:31744
    s_add_u32 s42, s43, 3584
    buffer_store_dwordx4 v[224:227], v8, s[16:19], s42 offen sc1
    v_mul_f32 v168, v233, v168
    v_mul_f32 v169, v233, v169
    s_waitcnt lgkmcnt(2)
    v_mfma_f32_32x32x16_bf16 v[56:71], v[184:187], a[224:227], v[56:71]
    ds_read_b128 v[200:203], v12 offset:32768
    v_mul_f32 v170, v233, v170
    v_mul_f32 v171, v233, v171
    v_mul_f32 v172, v233, v172
    v_mul_f32 v173, v233, v173
    v_mfma_f32_32x32x16_bf16 v[56:71], v[188:191], a[232:235], v[56:71]
    ds_read_b128 v[204:207], v12 offset:33792
    v_mul_f32 v174, v233, v174
    v_mul_f32 v175, v233, v175
    v_fma_f32 v216, v168, v168, s40
    v_fma_f32 v217, v169, v169, s40
    s_waitcnt lgkmcnt(2)
    v_mfma_f32_32x32x16_bf16 v[56:71], v[192:195], a[240:243], v[56:71]
    ds_read_b128 v[184:187], v12 offset:34816
    v_fma_f32 v218, v170, v170, s40
    v_fma_f32 v219, v171, v171, s40
    v_fma_f32 v220, v172, v172, s40
    v_fma_f32 v221, v173, v173, s40
    v_mfma_f32_32x32x16_bf16 v[56:71], v[196:199], a[248:251], v[56:71]
    ds_read_b128 v[188:191], v12 offset:35840
    v_fma_f32 v222, v174, v174, s40
    v_fma_f32 v223, v175, v175, s40
    v_mul_f32 v216, v216, v168
    v_mul_f32 v217, v217, v169
    s_waitcnt lgkmcnt(2)
    v_mfma_f32_32x32x16_bf16 v[56:71], v[200:203], v[16:19], v[56:71]
    ds_read_b128 v[192:195], v3 offset:8192
    v_mul_f32 v218, v218, v170
    v_mul_f32 v219, v219, v171
    v_mul_f32 v220, v220, v172
    v_mul_f32 v221, v221, v173
    v_mfma_f32_32x32x16_bf16 v[56:71], v[204:207], v[24:27], v[56:71]
    ds_read_b128 v[196:199], v12 offset:0
    v_mul_f32 v222, v222, v174
    v_mul_f32 v223, v223, v175
    v_exp_f32_e64 v216, -v216
    s_waitcnt lgkmcnt(2)
    v_mfma_f32_32x32x16_bf16 v[56:71], v[184:187], v[32:35], v[56:71]
    ds_read_b128 v[200:203], v12 offset:1024
    v_mul_f32 v168, v168, v176
    v_exp_f32_e64 v217, -v217
    v_mul_f32 v169, v169, v177
    v_mfma_f32_32x32x16_bf16 v[56:71], v[188:191], v[40:43], v[56:71]
    ds_read_b128 v[204:207], v12 offset:2048
    v_exp_f32_e64 v218, -v218
    v_mul_f32 v170, v170, v178
    s_waitcnt lgkmcnt(2)
    v_mfma_f32_32x32x16_bf16 v[56:71], v[192:195], v[48:51], v[56:71]
    ds_read_b128 v[184:187], v12 offset:3072
    v_exp_f32_e64 v219, -v219
    v_mul_f32 v171, v171, v179
    v_mfma_f32_32x32x16_bf16 v[72:87], v[196:199], a[4:7], 0
    ds_read_b128 v[188:191], v12 offset:4096
    v_exp_f32_e64 v220, -v220
    v_mul_f32 v172, v172, v180
    s_waitcnt lgkmcnt(2)
    v_mfma_f32_32x32x16_bf16 v[72:87], v[200:203], a[12:15], v[72:87]
    ds_read_b128 v[192:195], v12 offset:5120
    v_exp_f32_e64 v221, -v221
    v_mul_f32 v173, v173, v181
    v_mfma_f32_32x32x16_bf16 v[72:87], v[204:207], a[20:23], v[72:87]
    ds_read_b128 v[196:199], v12 offset:6144
    v_exp_f32_e64 v222, -v222
    v_mul_f32 v174, v174, v182
    s_waitcnt lgkmcnt(2)
    v_mfma_f32_32x32x16_bf16 v[72:87], v[184:187], a[28:31], v[72:87]
    ds_read_b128 v[200:203], v12 offset:7168
    v_exp_f32_e64 v223, -v223
    v_mul_f32 v175, v175, v183
    v_fma_f32 v216, v216, v235, v235
    v_mfma_f32_32x32x16_bf16 v[72:87], v[188:191], a[36:39], v[72:87]
    ds_read_b128 v[204:207], v12 offset:8192
    v_fma_f32 v217, v217, v235, v235
    v_fma_f32 v218, v218, v235, v235
    v_fma_f32 v219, v219, v235, v235
    v_fma_f32 v220, v220, v235, v235
    s_waitcnt lgkmcnt(2)
    v_mfma_f32_32x32x16_bf16 v[72:87], v[192:195], a[44:47], v[72:87]
    ds_read_b128 v[184:187], v12 offset:9216
    v_fma_f32 v221, v221, v235, v235
    v_fma_f32 v222, v222, v235, v235
    v_fma_f32 v223, v223, v235, v235
    v_mfma_f32_32x32x16_bf16 v[72:87], v[196:199], a[52:55], v[72:87]
    ds_read_b128 v[188:191], v12 offset:10240
    v_rcp_f32 v216, v216
    v_rcp_f32 v217, v217
    s_waitcnt lgkmcnt(2)
    v_mfma_f32_32x32x16_bf16 v[72:87], v[200:203], a[60:63], v[72:87]
    ds_read_b128 v[192:195], v12 offset:11264
    v_rcp_f32 v218, v218
    v_rcp_f32 v219, v219
    v_mfma_f32_32x32x16_bf16 v[72:87], v[204:207], a[68:71], v[72:87]
    ds_read_b128 v[196:199], v12 offset:12288
    v_rcp_f32 v220, v220
    v_rcp_f32 v221, v221
    s_waitcnt lgkmcnt(2)
    v_mfma_f32_32x32x16_bf16 v[72:87], v[184:187], a[76:79], v[72:87]
    ds_read_b128 v[200:203], v12 offset:13312
    v_rcp_f32 v222, v222
    v_rcp_f32 v223, v223
    v_mfma_f32_32x32x16_bf16 v[72:87], v[188:191], a[84:87], v[72:87]
    ds_read_b128 v[204:207], v12 offset:14336
    v_mul_f32 v168, v168, v216
    v_mul_f32 v169, v169, v217
    v_mul_f32 v170, v170, v218
    v_mul_f32 v171, v171, v219
    s_waitcnt lgkmcnt(2)
    v_mfma_f32_32x32x16_bf16 v[72:87], v[192:195], a[92:95], v[72:87]
    ds_read_b128 v[184:187], v12 offset:15360
    v_mul_f32 v172, v172, v220
    v_mul_f32 v173, v173, v221
    v_mul_f32 v174, v174, v222
    v_mul_f32 v175, v175, v223
    v_mfma_f32_32x32x16_bf16 v[72:87], v[196:199], a[100:103], v[72:87]
    ds_read_b128 v[188:191], v12 offset:16384
    v_cvt_pk_bf16_f32 v228, v168, v169
    v_cvt_pk_bf16_f32 v229, v170, v171
    v_cvt_pk_bf16_f32 v230, v172, v173
    v_cvt_pk_bf16_f32 v231, v174, v175
    s_waitcnt lgkmcnt(2)
    v_mfma_f32_32x32x16_bf16 v[72:87], v[200:203], a[108:111], v[72:87]
    ds_read_b128 v[192:195], v12 offset:17408
    s_add_u32 s42, s43, 298496
    buffer_store_dwordx4 v[228:231], v8, s[16:19], s42 offen sc1
    v_mul_f32 v56, v232, v56
    v_mul_f32 v57, v232, v57
    v_mfma_f32_32x32x16_bf16 v[72:87], v[204:207], a[116:119], v[72:87]
    ds_read_b128 v[196:199], v12 offset:18432
    v_mul_f32 v58, v232, v58
    v_mul_f32 v59, v232, v59
    v_mul_f32 v60, v232, v60
    v_mul_f32 v61, v232, v61
    s_waitcnt lgkmcnt(2)
    v_mfma_f32_32x32x16_bf16 v[72:87], v[184:187], a[124:127], v[72:87]
    ds_read_b128 v[200:203], v12 offset:19456
    v_mul_f32 v62, v232, v62
    v_mul_f32 v63, v232, v63
    v_fma_f32 v208, v56, v56, s40
    v_fma_f32 v209, v57, v57, s40
    v_mfma_f32_32x32x16_bf16 v[72:87], v[188:191], a[132:135], v[72:87]
    ds_read_b128 v[204:207], v12 offset:20480
    v_fma_f32 v210, v58, v58, s40
    v_fma_f32 v211, v59, v59, s40
    v_fma_f32 v212, v60, v60, s40
    v_fma_f32 v213, v61, v61, s40
    s_waitcnt lgkmcnt(2)
    v_mfma_f32_32x32x16_bf16 v[72:87], v[192:195], a[140:143], v[72:87]
    ds_read_b128 v[184:187], v12 offset:21504
    v_fma_f32 v214, v62, v62, s40
    v_fma_f32 v215, v63, v63, s40
    v_mul_f32 v208, v208, v56
    v_mul_f32 v209, v209, v57
    v_mfma_f32_32x32x16_bf16 v[72:87], v[196:199], a[148:151], v[72:87]
    ds_read_b128 v[188:191], v12 offset:22528
    v_mul_f32 v210, v210, v58
    v_mul_f32 v211, v211, v59
    v_mul_f32 v212, v212, v60
    v_mul_f32 v213, v213, v61
    s_waitcnt lgkmcnt(2)
    v_mfma_f32_32x32x16_bf16 v[72:87], v[200:203], a[156:159], v[72:87]
    ds_read_b128 v[192:195], v12 offset:23552
    v_mul_f32 v214, v214, v62
    v_mul_f32 v215, v215, v63
    v_exp_f32_e64 v208, -v208
    v_mfma_f32_32x32x16_bf16 v[72:87], v[204:207], a[164:167], v[72:87]
    ds_read_b128 v[196:199], v12 offset:24576
    v_mul_f32 v56, v56, v64
    v_exp_f32_e64 v209, -v209
    v_mul_f32 v57, v57, v65
    s_waitcnt lgkmcnt(2)
    v_mfma_f32_32x32x16_bf16 v[72:87], v[184:187], a[172:175], v[72:87]
    ds_read_b128 v[200:203], v12 offset:25600
    v_exp_f32_e64 v210, -v210
    v_mul_f32 v58, v58, v66
    v_mfma_f32_32x32x16_bf16 v[72:87], v[188:191], a[180:183], v[72:87]
    ds_read_b128 v[204:207], v12 offset:26624
    v_exp_f32_e64 v211, -v211
    v_mul_f32 v59, v59, v67
    s_waitcnt lgkmcnt(2)
    v_mfma_f32_32x32x16_bf16 v[72:87], v[192:195], a[188:191], v[72:87]
    ds_read_b128 v[184:187], v12 offset:27648
    v_exp_f32_e64 v212, -v212
    v_mul_f32 v60, v60, v68
    v_mfma_f32_32x32x16_bf16 v[72:87], v[196:199], a[196:199], v[72:87]
    ds_read_b128 v[188:191], v12 offset:28672
    v_exp_f32_e64 v213, -v213
    v_mul_f32 v61, v61, v69
    s_waitcnt lgkmcnt(2)
    v_mfma_f32_32x32x16_bf16 v[72:87], v[200:203], a[204:207], v[72:87]
    ds_read_b128 v[192:195], v12 offset:29696
    v_exp_f32_e64 v214, -v214
    v_mul_f32 v62, v62, v70
    v_mfma_f32_32x32x16_bf16 v[72:87], v[204:207], a[212:215], v[72:87]
    ds_read_b128 v[196:199], v12 offset:30720
    v_exp_f32_e64 v215, -v215
    v_mul_f32 v63, v63, v71
    v_fma_f32 v208, v208, v234, v234
    s_waitcnt lgkmcnt(2)
    v_mfma_f32_32x32x16_bf16 v[72:87], v[184:187], a[220:223], v[72:87]
    ds_read_b128 v[200:203], v12 offset:31744
    v_fma_f32 v209, v209, v234, v234
    v_fma_f32 v210, v210, v234, v234
    v_fma_f32 v211, v211, v234, v234
    v_fma_f32 v212, v212, v234, v234
    v_mfma_f32_32x32x16_bf16 v[72:87], v[188:191], a[228:231], v[72:87]
    ds_read_b128 v[204:207], v12 offset:32768
    v_fma_f32 v213, v213, v234, v234
    v_fma_f32 v214, v214, v234, v234
    v_fma_f32 v215, v215, v234, v234
    s_waitcnt lgkmcnt(2)
    v_mfma_f32_32x32x16_bf16 v[72:87], v[192:195], a[236:239], v[72:87]
    ds_read_b128 v[184:187], v12 offset:33792
    v_rcp_f32 v208, v208
    v_rcp_f32 v209, v209
    v_mfma_f32_32x32x16_bf16 v[72:87], v[196:199], a[244:247], v[72:87]
    ds_read_b128 v[188:191], v12 offset:34816
    v_rcp_f32 v210, v210
    v_rcp_f32 v211, v211
    s_waitcnt lgkmcnt(2)
    v_mfma_f32_32x32x16_bf16 v[72:87], v[200:203], a[252:255], v[72:87]
    ds_read_b128 v[192:195], v12 offset:35840
    v_rcp_f32 v212, v212
    v_rcp_f32 v213, v213
    v_mfma_f32_32x32x16_bf16 v[72:87], v[204:207], v[20:23], v[72:87]
    ds_read_b128 v[196:199], v3 offset:8192
    v_rcp_f32 v214, v214
    v_rcp_f32 v215, v215
    s_waitcnt lgkmcnt(2)
    v_mfma_f32_32x32x16_bf16 v[72:87], v[184:187], v[28:31], v[72:87]
    v_mul_f32 v56, v56, v208
    v_mul_f32 v57, v57, v209
    v_mul_f32 v58, v58, v210
    v_mul_f32 v59, v59, v211
    v_mfma_f32_32x32x16_bf16 v[72:87], v[188:191], v[36:39], v[72:87]
    v_mul_f32 v60, v60, v212
    v_mul_f32 v61, v61, v213
    v_mul_f32 v62, v62, v214
    v_mul_f32 v63, v63, v215
    s_waitcnt lgkmcnt(0)
    v_mfma_f32_32x32x16_bf16 v[72:87], v[192:195], v[44:47], v[72:87]
    v_cvt_pk_bf16_f32 v224, v56, v57
    v_cvt_pk_bf16_f32 v225, v58, v59
    v_cvt_pk_bf16_f32 v226, v60, v61
    v_cvt_pk_bf16_f32 v227, v62, v63
    v_mfma_f32_32x32x16_bf16 v[72:87], v[196:199], v[52:55], v[72:87]
    buffer_load_dword v243, v236, s[16:19], s47 offen offset:32 sc1
    s_add_u32 s42, s43, 4096
    buffer_store_dwordx4 v[224:227], v8, s[16:19], s42 offen sc1
    s_waitcnt vmcnt(1)
    s_mov_b32 s10, 262144
K456_P2A:
    v_cmp_ne_u32 vcc, 0, v243
    s_nop 0
    s_cmp_eq_u64 vcc, -1
    s_cbranch_scc1 K456_P2A_X
    buffer_load_dword v243, v236, s[16:19], s47 offen offset:32 sc1
    s_waitcnt vmcnt(0)
    s_sub_u32 s10, s10, 1
    s_cbranch_scc0 K456_P2A
K456_P2A_X:
    s_add_u32 s44, s46, 0
    s_add_u32 s45, s44, 147456
    buffer_load_dwordx4 a[0:3], v244, s[16:19], s44 offen sc1
    buffer_load_dwordx4 a[4:7], v244, s[16:19], s45 offen sc1
    buffer_load_dwordx4 a[8:11], v245, s[16:19], s44 offen sc1
    buffer_load_dwordx4 a[12:15], v245, s[16:19], s45 offen sc1
    buffer_load_dwordx4 a[16:19], v246, s[16:19], s44 offen sc1
    buffer_load_dwordx4 a[20:23], v246, s[16:19], s45 offen sc1
    buffer_load_dwordx4 a[24:27], v247, s[16:19], s44 offen sc1
    buffer_load_dwordx4 a[28:31], v247, s[16:19], s45 offen sc1
    s_add_u32 s44, s46, 1024
    s_add_u32 s45, s44, 147456
    buffer_load_dwordx4 a[32:35], v244, s[16:19], s44 offen sc1
    buffer_load_dwordx4 a[36:39], v244, s[16:19], s45 offen sc1
    buffer_load_dwordx4 a[40:43], v245, s[16:19], s44 offen sc1
    buffer_load_dwordx4 a[44:47], v245, s[16:19], s45 offen sc1
    buffer_load_dwordx4 a[48:51], v246, s[16:19], s44 offen sc1
    buffer_load_dwordx4 a[52:55], v246, s[16:19], s45 offen sc1
    buffer_load_dwordx4 a[56:59], v247, s[16:19], s44 offen sc1
    buffer_load_dwordx4 a[60:63], v247, s[16:19], s45 offen sc1
    v_mul_f32 v72, v233, v72
    v_mul_f32 v73, v233, v73
    v_mul_f32 v74, v233, v74
    v_mul_f32 v75, v233, v75
    v_mul_f32 v76, v233, v76
    v_mul_f32 v77, v233, v77
    v_mul_f32 v78, v233, v78
    v_mul_f32 v79, v233, v79
    v_fma_f32 v216, v72, v72, s40
    v_fma_f32 v217, v73, v73, s40
    v_fma_f32 v218, v74, v74, s40
    v_fma_f32 v219, v75, v75, s40
    v_fma_f32 v220, v76, v76, s40
    v_fma_f32 v221, v77, v77, s40
    v_fma_f32 v222, v78, v78, s40
    v_fma_f32 v223, v79, v79, s40
    v_mul_f32 v216, v216, v72
    v_mul_f32 v217, v217, v73
    v_mul_f32 v218, v218, v74
    v_mul_f32 v219, v219, v75
    v_mul_f32 v220, v220, v76
    v_mul_f32 v221, v221, v77
    v_mul_f32 v222, v222, v78
    v_mul_f32 v223, v223, v79
    v_exp_f32_e64 v216, -v216
    v_mul_f32 v72, v72, v80
    v_exp_f32_e64 v217, -v217
    v_mul_f32 v73, v73, v81
    v_exp_f32_e64 v218, -v218
    v_mul_f32 v74, v74, v82
    v_exp_f32_e64 v219, -v219
    v_mul_f32 v75, v75, v83
    v_exp_f32_e64 v220, -v220
    v_mul_f32 v76, v76, v84
    v_exp_f32_e64 v221, -v221
    v_mul_f32 v77, v77, v85
    v_exp_f32_e64 v222, -v222
    v_mul_f32 v78, v78, v86
    v_exp_f32_e64 v223, -v223
    v_mul_f32 v79, v79, v87
    v_fma_f32 v216, v216, v235, v235
    v_fma_f32 v217, v217, v235, v235
    v_fma_f32 v218, v218, v235, v235
    v_fma_f32 v219, v219, v235, v235
    v_fma_f32 v220, v220, v235, v235
    v_fma_f32 v221, v221, v235, v235
    v_fma_f32 v222, v222, v235, v235
    v_fma_f32 v223, v223, v235, v235
    v_rcp_f32 v216, v216
    v_rcp_f32 v217, v217
    v_rcp_f32 v218, v218
    v_rcp_f32 v219, v219
    v_rcp_f32 v220, v220
    v_rcp_f32 v221, v221
    v_rcp_f32 v222, v222
    v_rcp_f32 v223, v223
    v_mul_f32 v72, v72, v216
    v_mul_f32 v73, v73, v217
    v_mul_f32 v74, v74, v218
    v_mul_f32 v75, v75, v219
    v_mul_f32 v76, v76, v220
    v_mul_f32 v77, v77, v221
    v_mul_f32 v78, v78, v222
    v_mul_f32 v79, v79, v223
    v_cvt_pk_bf16_f32 v228, v72, v73
    v_cvt_pk_bf16_f32 v229, v74, v75
    v_cvt_pk_bf16_f32 v230, v76, v77
    v_cvt_pk_bf16_f32 v231, v78, v79
    s_add_u32 s42, s43, 299008
    buffer_store_dwordx4 v[228:231], v8, s[16:19], s42 offen sc1
    s_cmp_eq_u32 s59, 0
    s_cbranch_scc1 K456_S0
K456_S1:
    v_and_b32 v7, 15, v4
    v_lshrrev_b32 v8, 4, v4
    v_lshlrev_b32 v5, 4, v7
    v_and_b32 v9, 1, v8
    v_lshl_add_u32 v5, v9, 9, v5
    v_lshrrev_b32 v9, 1, v8
    v_lshl_add_u32 v5, v9, 3, v5
    v_lshlrev_b32 v6, 4, v8
    v_mul_u32_u24 v11, 1152, v7
    v_lshl_add_u32 v11, v8, 3, v11
    v_and_b32 v4, 3, v4
    v_lshlrev_b32 v4, 7, v4
    v_mov_b32 v9, 0x00003f80
    v_mov_b32 v10, 0x3f800000
    s_barrier
    ds_read_b128 v[52:55], v13 offset:0
    ds_read_b128 v[56:59], v13 offset:8192
    ds_read_b128 v[60:63], v13 offset:16384
    ds_read_b128 v[64:67], v13 offset:24576
    ds_read_b128 v[68:71], v13 offset:1024
    ds_read_b128 v[72:75], v13 offset:9216
    ds_read_b128 v[76:79], v13 offset:17408
    ds_read_b128 v[80:83], v13 offset:25600
    s_waitcnt vmcnt(9)
    s_waitcnt lgkmcnt(6)
    v_mfma_f32_16x16x32_bf16 v[100:103], v[52:55], a[0:3], 0
    ds_read_b128 v[84:87], v13 offset:2048
    v_mfma_f32_16x16x32_bf16 v[100:103], v[56:59], a[8:11], v[100:103]
    s_add_u32 m0, s62, 110592
    s_waitcnt lgkmcnt(5)
    v_mfma_f32_16x16x32_bf16 v[100:103], v[60:63], a[16:19], v[100:103]
    ds_read_b128 v[88:91], v13 offset:10240
    v_mfma_f32_16x16x32_bf16 v[100:103], v[64:67], a[24:27], v[100:103]
    buffer_load_dwordx4 v240, s[16:19], s50 offen offset:0 lds
    v_mfma_f32_16x16x32_bf16 v[104:107], v[52:55], a[4:7], 0
    ds_read_b128 v[92:95], v13 offset:18432
    v_mfma_f32_16x16x32_bf16 v[104:107], v[56:59], a[12:15], v[104:107]
    s_add_u32 s44, s46, 2048
    v_mfma_f32_16x16x32_bf16 v[104:107], v[60:63], a[20:23], v[104:107]
    ds_read_b128 v[96:99], v13 offset:26624
    v_mfma_f32_16x16x32_bf16 v[104:107], v[64:67], a[28:31], v[104:107]
    s_add_u32 s45, s44, 147456
    s_waitcnt lgkmcnt(6)
    v_mfma_f32_16x16x32_bf16 v[108:111], v[68:71], a[0:3], 0
    ds_read_b128 v[52:55], v13 offset:3072
    v_mfma_f32_16x16x32_bf16 v[108:111], v[72:75], a[8:11], v[108:111]
    buffer_load_dwordx4 a[64:67], v244, s[16:19], s44 offen sc1
    s_waitcnt lgkmcnt(5)
    v_mfma_f32_16x16x32_bf16 v[108:111], v[76:79], a[16:19], v[108:111]
    ds_read_b128 v[56:59], v13 offset:11264
    v_mfma_f32_16x16x32_bf16 v[108:111], v[80:83], a[24:27], v[108:111]
    buffer_load_dwordx4 v240, s[16:19], s51 offen offset:1024 lds
    v_mfma_f32_16x16x32_bf16 v[112:115], v[68:71], a[4:7], 0
    ds_read_b128 v[60:63], v13 offset:19456
    v_mfma_f32_16x16x32_bf16 v[112:115], v[72:75], a[12:15], v[112:115]
    v_mfma_f32_16x16x32_bf16 v[112:115], v[76:79], a[20:23], v[112:115]
    ds_read_b128 v[64:67], v13 offset:27648
    v_mfma_f32_16x16x32_bf16 v[112:115], v[80:83], a[28:31], v[112:115]
    buffer_load_dwordx4 a[68:71], v244, s[16:19], s45 offen sc1
    s_waitcnt lgkmcnt(6)
    v_mfma_f32_16x16x32_bf16 v[116:119], v[84:87], a[0:3], 0
    ds_read_b128 v[68:71], v13 offset:4096
    v_mfma_f32_16x16x32_bf16 v[116:119], v[88:91], a[8:11], v[116:119]
    buffer_load_dwordx4 v240, s[16:19], s52 offen offset:2048 lds
    s_waitcnt lgkmcnt(5)
    v_mfma_f32_16x16x32_bf16 v[116:119], v[92:95], a[16:19], v[116:119]
    ds_read_b128 v[72:75], v13 offset:12288
    v_mfma_f32_16x16x32_bf16 v[116:119], v[96:99], a[24:27], v[116:119]
    buffer_load_dwordx4 a[72:75], v245, s[16:19], s44 offen sc1
    v_mfma_f32_16x16x32_bf16 v[120:123], v[84:87], a[4:7], 0
    ds_read_b128 v[76:79], v13 offset:20480
    v_mfma_f32_16x16x32_bf16 v[120:123], v[88:91], a[12:15], v[120:123]
    v_mfma_f32_16x16x32_bf16 v[120:123], v[92:95], a[20:23], v[120:123]
    ds_read_b128 v[80:83], v13 offset:28672
    v_mfma_f32_16x16x32_bf16 v[120:123], v[96:99], a[28:31], v[120:123]
    buffer_load_dwordx4 v240, s[16:19], s53 offen offset:3072 lds
    s_waitcnt lgkmcnt(6)
    v_mfma_f32_16x16x32_bf16 v[124:127], v[52:55], a[0:3], 0
    ds_read_b128 v[84:87], v13 offset:5120
    v_mfma_f32_16x16x32_bf16 v[124:127], v[56:59], a[8:11], v[124:127]
    buffer_load_dwordx4 a[76:79], v245, s[16:19], s45 offen sc1
    s_waitcnt lgkmcnt(5)
    v_mfma_f32_16x16x32_bf16 v[124:127], v[60:63], a[16:19], v[124:127]
    ds_read_b128 v[88:91], v13 offset:13312
    v_mfma_f32_16x16x32_bf16 v[124:127], v[64:67], a[24:27], v[124:127]
    s_add_u32 m0, s62, 114688
    v_mfma_f32_16x16x32_bf16 v[128:131], v[52:55], a[4:7], 0
    ds_read_b128 v[92:95], v13 offset:21504
    v_mfma_f32_16x16x32_bf16 v[128:131], v[56:59], a[12:15], v[128:131]
    v_mfma_f32_16x16x32_bf16 v[128:131], v[60:63], a[20:23], v[128:131]
    ds_read_b128 v[96:99], v13 offset:29696
    v_mfma_f32_16x16x32_bf16 v[128:131], v[64:67], a[28:31], v[128:131]
    buffer_load_dwordx4 v240, s[16:19], s54 offen offset:0 lds
    s_waitcnt lgkmcnt(6)
    v_mfma_f32_16x16x32_bf16 v[132:135], v[68:71], a[0:3], 0
    ds_read_b128 v[52:55], v13 offset:6144
    v_mfma_f32_16x16x32_bf16 v[132:135], v[72:75], a[8:11], v[132:135]
    buffer_load_dwordx4 a[80:83], v246, s[16:19], s44 offen sc1
    s_waitcnt lgkmcnt(5)
    v_mfma_f32_16x16x32_bf16 v[132:135], v[76:79], a[16:19], v[132:135]
    ds_read_b128 v[56:59], v13 offset:14336
    v_mfma_f32_16x16x32_bf16 v[132:135], v[80:83], a[24:27], v[132:135]
    buffer_load_dwordx4 v240, s[16:19], s55 offen offset:1024 lds
    v_mfma_f32_16x16x32_bf16 v[136:139], v[68:71], a[4:7], 0
    ds_read_b128 v[60:63], v13 offset:22528
    v_mfma_f32_16x16x32_bf16 v[136:139], v[72:75], a[12:15], v[136:139]
    v_mfma_f32_16x16x32_bf16 v[136:139], v[76:79], a[20:23], v[136:139]
    ds_read_b128 v[64:67], v13 offset:30720
    v_mfma_f32_16x16x32_bf16 v[136:139], v[80:83], a[28:31], v[136:139]
    buffer_load_dwordx4 a[84:87], v246, s[16:19], s45 offen sc1
    s_waitcnt lgkmcnt(6)
    v_mfma_f32_16x16x32_bf16 v[140:143], v[84:87], a[0:3], 0
    ds_read_b128 v[68:71], v14 offset:0
    v_mfma_f32_16x16x32_bf16 v[140:143], v[88:91], a[8:11], v[140:143]
    buffer_load_dwordx4 v240, s[16:19], s56 offen offset:2048 lds
    s_waitcnt lgkmcnt(5)
    v_mfma_f32_16x16x32_bf16 v[140:143], v[92:95], a[16:19], v[140:143]
    ds_read_b128 v[72:75], v14 offset:8192
    v_mfma_f32_16x16x32_bf16 v[140:143], v[96:99], a[24:27], v[140:143]
    buffer_load_dwordx4 a[88:91], v247, s[16:19], s44 offen sc1
    v_mfma_f32_16x16x32_bf16 v[144:147], v[84:87], a[4:7], 0
    ds_read_b128 v[76:79], v14 offset:16384
    v_mfma_f32_16x16x32_bf16 v[144:147], v[88:91], a[12:15], v[144:147]
    v_add_u32 v240, 5120, v1
    v_mfma_f32_16x16x32_bf16 v[144:147], v[92:95], a[20:23], v[144:147]
    ds_read_b128 v[80:83], v14 offset:24576
    v_mfma_f32_16x16x32_bf16 v[144:147], v[96:99], a[28:31], v[144:147]
    buffer_load_dwordx4 a[92:95], v247, s[16:19], s45 offen sc1
    s_waitcnt lgkmcnt(6)
    v_mfma_f32_16x16x32_bf16 v[148:151], v[52:55], a[0:3], 0
    ds_read_b128 v[84:87], v14 offset:1024
    v_mfma_f32_16x16x32_bf16 v[148:151], v[56:59], a[8:11], v[148:151]
    s_waitcnt lgkmcnt(5)
    v_mfma_f32_16x16x32_bf16 v[148:151], v[60:63], a[16:19], v[148:151]
    ds_read_b128 v[88:91], v14 offset:9216
    v_mfma_f32_16x16x32_bf16 v[148:151], v[64:67], a[24:27], v[148:151]
    v_mfma_f32_16x16x32_bf16 v[152:155], v[52:55], a[4:7], 0
    ds_read_b128 v[92:95], v14 offset:17408
    v_mfma_f32_16x16x32_bf16 v[152:155], v[56:59], a[12:15], v[152:155]
    v_mfma_f32_16x16x32_bf16 v[152:155], v[60:63], a[20:23], v[152:155]
    ds_read_b128 v[96:99], v14 offset:25600
    v_mfma_f32_16x16x32_bf16 v[152:155], v[64:67], a[28:31], v[152:155]
    s_waitcnt vmcnt(16)
    s_waitcnt vmcnt(15)
    buffer_store_dword v242, v241, s[16:19], s29 offen sc1
    s_waitcnt lgkmcnt(6)
    v_mfma_f32_16x16x32_bf16 v[100:103], v[68:71], a[32:35], v[100:103]
    ds_read_b128 v[52:55], v14 offset:2048
    v_mfma_f32_16x16x32_bf16 v[100:103], v[72:75], a[40:43], v[100:103]
    s_add_u32 m0, s62, 0
    s_lshl_b32 s14, s60, 2
    s_waitcnt lgkmcnt(5)
    v_mfma_f32_16x16x32_bf16 v[100:103], v[76:79], a[48:51], v[100:103]
    ds_read_b128 v[56:59], v14 offset:10240
    v_mfma_f32_16x16x32_bf16 v[100:103], v[80:83], a[56:59], v[100:103]
    buffer_load_dwordx4 v240, s[16:19], s50 offen offset:0 lds
    s_add_u32 s14, s14, s3
    v_mfma_f32_16x16x32_bf16 v[104:107], v[68:71], a[36:39], v[104:107]
    ds_read_b128 v[60:63], v14 offset:18432
    v_mfma_f32_16x16x32_bf16 v[104:107], v[72:75], a[44:47], v[104:107]
    s_add_u32 s44, s46, 5120
    s_mul_i32 s31, s3, 3072
    v_mfma_f32_16x16x32_bf16 v[104:107], v[76:79], a[52:55], v[104:107]
    ds_read_b128 v[64:67], v14 offset:26624
    v_mfma_f32_16x16x32_bf16 v[104:107], v[80:83], a[60:63], v[104:107]
    s_add_u32 s45, s44, 147456
    s_lshl_b32 s39, s60, 2
    s_waitcnt lgkmcnt(6)
    v_mfma_f32_16x16x32_bf16 v[108:111], v[84:87], a[32:35], v[108:111]
    ds_read_b128 v[68:71], v14 offset:3072
    v_mfma_f32_16x16x32_bf16 v[108:111], v[88:91], a[40:43], v[108:111]
    buffer_load_dwordx4 a[96:99], v244, s[16:19], s44 offen sc1
    s_add_u32 s39, s39, s61
    s_waitcnt lgkmcnt(5)
    v_mfma_f32_16x16x32_bf16 v[108:111], v[92:95], a[48:51], v[108:111]
    ds_read_b128 v[72:75], v14 offset:11264
    v_mfma_f32_16x16x32_bf16 v[108:111], v[96:99], a[56:59], v[108:111]
    buffer_load_dwordx4 v240, s[16:19], s51 offen offset:1024 lds
    s_lshl_b32 s39, s39, 2
    v_mfma_f32_16x16x32_bf16 v[112:115], v[84:87], a[36:39], v[112:115]
    ds_read_b128 v[76:79], v14 offset:19456
    v_mfma_f32_16x16x32_bf16 v[112:115], v[88:91], a[44:47], v[112:115]
    s_add_u32 s39, s39, s3
    v_mfma_f32_16x16x32_bf16 v[112:115], v[92:95], a[52:55], v[112:115]
    ds_read_b128 v[80:83], v14 offset:27648
    v_mfma_f32_16x16x32_bf16 v[112:115], v[96:99], a[60:63], v[112:115]
    buffer_load_dwordx4 a[100:103], v244, s[16:19], s45 offen sc1
    s_lshl_b32 s49, s39, 9
    s_waitcnt lgkmcnt(6)
    v_mfma_f32_16x16x32_bf16 v[116:119], v[52:55], a[32:35], v[116:119]
    ds_read_b128 v[84:87], v14 offset:4096
    v_mfma_f32_16x16x32_bf16 v[116:119], v[56:59], a[40:43], v[116:119]
    buffer_load_dwordx4 v240, s[16:19], s52 offen offset:2048 lds
    s_add_u32 s49, s49, 0x60000
    s_waitcnt lgkmcnt(5)
    v_mfma_f32_16x16x32_bf16 v[116:119], v[60:63], a[48:51], v[116:119]
    ds_read_b128 v[88:91], v14 offset:12288
    v_mfma_f32_16x16x32_bf16 v[116:119], v[64:67], a[56:59], v[116:119]
    buffer_load_dwordx4 a[104:107], v245, s[16:19], s44 offen sc1
    s_lshl_b32 s48, s59, 7
    v_mfma_f32_16x16x32_bf16 v[120:123], v[52:55], a[36:39], v[120:123]
    ds_read_b128 v[92:95], v14 offset:20480
    v_mfma_f32_16x16x32_bf16 v[120:123], v[56:59], a[44:47], v[120:123]
    s_add_u32 s48, s48, s49
    v_mfma_f32_16x16x32_bf16 v[120:123], v[60:63], a[52:55], v[120:123]
    ds_read_b128 v[96:99], v14 offset:28672
    v_mfma_f32_16x16x32_bf16 v[120:123], v[64:67], a[60:63], v[120:123]
    buffer_load_dwordx4 v240, s[16:19], s53 offen offset:3072 lds
    s_mul_i32 s39, s39, 27648
    s_waitcnt lgkmcnt(6)
    v_mfma_f32_16x16x32_bf16 v[124:127], v[68:71], a[32:35], v[124:127]
    ds_read_b128 v[52:55], v14 offset:5120
    v_mfma_f32_16x16x32_bf16 v[124:127], v[72:75], a[40:43], v[124:127]
    buffer_load_dwordx4 a[108:111], v245, s[16:19], s45 offen sc1
    s_add_u32 s39, s39, 0x3d00000
    s_waitcnt lgkmcnt(5)
    v_mfma_f32_16x16x32_bf16 v[124:127], v[76:79], a[48:51], v[124:127]
    ds_read_b128 v[56:59], v14 offset:13312
    v_mfma_f32_16x16x32_bf16 v[124:127], v[80:83], a[56:59], v[124:127]
    s_add_u32 m0, s62, 4096
    s_lshl_b32 s40, s59, 3
    v_mfma_f32_16x16x32_bf16 v[128:131], v[68:71], a[36:39], v[128:131]
    ds_read_b128 v[60:63], v14 offset:21504
    v_mfma_f32_16x16x32_bf16 v[128:131], v[72:75], a[44:47], v[128:131]
    s_add_u32 s40, s40, 0x80000
    v_mfma_f32_16x16x32_bf16 v[128:131], v[76:79], a[52:55], v[128:131]
    ds_read_b128 v[64:67], v14 offset:29696
    v_mfma_f32_16x16x32_bf16 v[128:131], v[80:83], a[60:63], v[128:131]
    buffer_load_dwordx4 v240, s[16:19], s54 offen offset:0 lds
    s_bfe_u32 s41, 0x217110b, s40
    s_waitcnt lgkmcnt(6)
    v_mfma_f32_16x16x32_bf16 v[132:135], v[84:87], a[32:35], v[132:135]
    ds_read_b128 v[68:71], v14 offset:6144
    v_mfma_f32_16x16x32_bf16 v[132:135], v[88:91], a[40:43], v[132:135]
    buffer_load_dwordx4 a[112:115], v246, s[16:19], s44 offen sc1
    s_lshl_b32 s41, s41, 10
    s_waitcnt lgkmcnt(5)
    v_mfma_f32_16x16x32_bf16 v[132:135], v[92:95], a[48:51], v[132:135]
    ds_read_b128 v[72:75], v14 offset:14336
    v_mfma_f32_16x16x32_bf16 v[132:135], v[96:99], a[56:59], v[132:135]
    buffer_load_dwordx4 v240, s[16:19], s55 offen offset:1024 lds
    s_add_u32 s20, s41, s39
    v_mfma_f32_16x16x32_bf16 v[136:139], v[84:87], a[36:39], v[136:139]
    ds_read_b128 v[76:79], v14 offset:22528
    v_mfma_f32_16x16x32_bf16 v[136:139], v[88:91], a[44:47], v[136:139]
    s_bfe_u32 s41, 0x51a140e, s40
    v_mfma_f32_16x16x32_bf16 v[136:139], v[92:95], a[52:55], v[136:139]
    ds_read_b128 v[80:83], v14 offset:30720
    v_mfma_f32_16x16x32_bf16 v[136:139], v[96:99], a[60:63], v[136:139]
    buffer_load_dwordx4 a[116:119], v246, s[16:19], s45 offen sc1
    s_lshl_b32 s41, s41, 10
    s_waitcnt lgkmcnt(6)
    v_mfma_f32_16x16x32_bf16 v[140:143], v[52:55], a[32:35], v[140:143]
    s_waitcnt vmcnt(13)
    s_barrier
    ds_read_b128 v[84:87], v15 offset:0
    v_mfma_f32_16x16x32_bf16 v[140:143], v[56:59], a[40:43], v[140:143]
    buffer_load_dwordx4 v240, s[16:19], s56 offen offset:2048 lds
    s_add_u32 s21, s41, s39
    s_waitcnt lgkmcnt(5)
    v_mfma_f32_16x16x32_bf16 v[140:143], v[60:63], a[48:51], v[140:143]
    ds_read_b128 v[88:91], v15 offset:8192
    v_mfma_f32_16x16x32_bf16 v[140:143], v[64:67], a[56:59], v[140:143]
    buffer_load_dwordx4 a[120:123], v247, s[16:19], s44 offen sc1
    s_bfe_u32 s41, 0x8011610, s40
    v_mfma_f32_16x16x32_bf16 v[144:147], v[52:55], a[36:39], v[144:147]
    ds_read_b128 v[92:95], v15 offset:16384
    v_mfma_f32_16x16x32_bf16 v[144:147], v[56:59], a[44:47], v[144:147]
    v_add_u32 v240, 6144, v1
    s_lshl_b32 s41, s41, 10
    v_mfma_f32_16x16x32_bf16 v[144:147], v[60:63], a[52:55], v[144:147]
    ds_read_b128 v[96:99], v15 offset:24576
    v_mfma_f32_16x16x32_bf16 v[144:147], v[64:67], a[60:63], v[144:147]
    buffer_load_dwordx4 a[124:127], v247, s[16:19], s45 offen sc1
    s_add_u32 s22, s41, s39
    s_waitcnt lgkmcnt(6)
    v_mfma_f32_16x16x32_bf16 v[148:151], v[68:71], a[32:35], v[148:151]
    ds_read_b128 v[52:55], v15 offset:1024
    v_mfma_f32_16x16x32_bf16 v[148:151], v[72:75], a[40:43], v[148:151]
    s_bfe_u32 s41, 0xa041913, s40
    s_waitcnt lgkmcnt(5)
    v_mfma_f32_16x16x32_bf16 v[148:151], v[76:79], a[48:51], v[148:151]
    ds_read_b128 v[56:59], v15 offset:9216
    v_mfma_f32_16x16x32_bf16 v[148:151], v[80:83], a[56:59], v[148:151]
    s_lshl_b32 s41, s41, 10
    v_mfma_f32_16x16x32_bf16 v[152:155], v[68:71], a[36:39], v[152:155]
    ds_read_b128 v[60:63], v15 offset:17408
    v_mfma_f32_16x16x32_bf16 v[152:155], v[72:75], a[44:47], v[152:155]
    s_add_u32 s23, s41, s39
    v_mfma_f32_16x16x32_bf16 v[152:155], v[76:79], a[52:55], v[152:155]
    ds_read_b128 v[64:67], v15 offset:25600
    v_mfma_f32_16x16x32_bf16 v[152:155], v[80:83], a[60:63], v[152:155]
    s_bfe_u32 s41, 0xd070015, s40
    s_waitcnt lgkmcnt(6)
    v_mfma_f32_16x16x32_bf16 v[100:103], v[84:87], a[64:67], v[100:103]
    ds_read_b128 v[68:71], v15 offset:2048
    v_mfma_f32_16x16x32_bf16 v[100:103], v[88:91], a[72:75], v[100:103]
    s_add_u32 m0, s62, 36864
    s_lshl_b32 s41, s41, 10
    s_waitcnt lgkmcnt(5)
    v_mfma_f32_16x16x32_bf16 v[100:103], v[92:95], a[80:83], v[100:103]
    ds_read_b128 v[72:75], v15 offset:10240
    v_mfma_f32_16x16x32_bf16 v[100:103], v[96:99], a[88:91], v[100:103]
    buffer_load_dwordx4 v240, s[16:19], s50 offen offset:0 lds
    s_add_u32 s24, s41, s39
    v_mfma_f32_16x16x32_bf16 v[104:107], v[84:87], a[68:71], v[104:107]
    ds_read_b128 v[76:79], v15 offset:18432
    v_mfma_f32_16x16x32_bf16 v[104:107], v[88:91], a[76:79], v[104:107]
    s_add_u32 s44, s46, 6144
    s_bfe_u32 s41, 0xf090318, s40
    v_mfma_f32_16x16x32_bf16 v[104:107], v[92:95], a[84:87], v[104:107]
    ds_read_b128 v[80:83], v15 offset:26624
    v_mfma_f32_16x16x32_bf16 v[104:107], v[96:99], a[92:95], v[104:107]
    s_add_u32 s45, s44, 147456
    s_lshl_b32 s41, s41, 10
    s_waitcnt lgkmcnt(6)
    v_mfma_f32_16x16x32_bf16 v[108:111], v[52:55], a[64:67], v[108:111]
    ds_read_b128 v[84:87], v15 offset:3072
    v_mfma_f32_16x16x32_bf16 v[108:111], v[56:59], a[72:75], v[108:111]
    buffer_load_dwordx4 a[128:131], v244, s[16:19], s44 offen sc1
    s_add_u32 s25, s41, s39
    s_waitcnt lgkmcnt(5)
    v_mfma_f32_16x16x32_bf16 v[108:111], v[60:63], a[80:83], v[108:111]
    ds_read_b128 v[88:91], v15 offset:11264
    v_mfma_f32_16x16x32_bf16 v[108:111], v[64:67], a[88:91], v[108:111]
    buffer_load_dwordx4 v240, s[16:19], s51 offen offset:1024 lds
    s_bfe_u32 s41, 0x120c0600, s40
    v_mfma_f32_16x16x32_bf16 v[112:115], v[52:55], a[68:71], v[112:115]
    ds_read_b128 v[92:95], v15 offset:19456
    v_mfma_f32_16x16x32_bf16 v[112:115], v[56:59], a[76:79], v[112:115]
    s_lshl_b32 s41, s41, 10
    v_mfma_f32_16x16x32_bf16 v[112:115], v[60:63], a[84:87], v[112:115]
    ds_read_b128 v[96:99], v15 offset:27648
    v_mfma_f32_16x16x32_bf16 v[112:115], v[64:67], a[92:95], v[112:115]
    buffer_load_dwordx4 a[132:135], v244, s[16:19], s45 offen sc1
    s_add_u32 s26, s41, s39
    s_waitcnt lgkmcnt(6)
    v_mfma_f32_16x16x32_bf16 v[116:119], v[68:71], a[64:67], v[116:119]
    ds_read_b128 v[52:55], v15 offset:4096
    v_mfma_f32_16x16x32_bf16 v[116:119], v[72:75], a[72:75], v[116:119]
    buffer_load_dwordx4 v240, s[16:19], s52 offen offset:2048 lds
    s_bfe_u32 s41, 0x150f0903, s40
    s_waitcnt lgkmcnt(5)
    v_mfma_f32_16x16x32_bf16 v[116:119], v[76:79], a[80:83], v[116:119]
    ds_read_b128 v[56:59], v15 offset:12288
    v_mfma_f32_16x16x32_bf16 v[116:119], v[80:83], a[88:91], v[116:119]
    buffer_load_dwordx4 a[136:139], v245, s[16:19], s44 offen sc1
    s_lshl_b32 s41, s41, 10
    v_mfma_f32_16x16x32_bf16 v[120:123], v[68:71], a[68:71], v[120:123]
    ds_read_b128 v[60:63], v15 offset:20480
    v_mfma_f32_16x16x32_bf16 v[120:123], v[72:75], a[76:79], v[120:123]
    s_add_u32 s27, s41, s39
    v_mfma_f32_16x16x32_bf16 v[120:123], v[76:79], a[84:87], v[120:123]
    ds_read_b128 v[64:67], v15 offset:28672
    v_mfma_f32_16x16x32_bf16 v[120:123], v[80:83], a[92:95], v[120:123]
    buffer_load_dwordx4 v240, s[16:19], s53 offen offset:3072 lds
    s_bfe_u32 s41, 0x18120c06, s40
    s_waitcnt lgkmcnt(6)
    v_mfma_f32_16x16x32_bf16 v[124:127], v[84:87], a[64:67], v[124:127]
    ds_read_b128 v[68:71], v15 offset:5120
    v_mfma_f32_16x16x32_bf16 v[124:127], v[88:91], a[72:75], v[124:127]
    buffer_load_dwordx4 a[140:143], v245, s[16:19], s45 offen sc1
    s_lshl_b32 s41, s41, 10
    s_waitcnt lgkmcnt(5)
    v_mfma_f32_16x16x32_bf16 v[124:127], v[92:95], a[80:83], v[124:127]
    ds_read_b128 v[72:75], v15 offset:13312
    v_mfma_f32_16x16x32_bf16 v[124:127], v[96:99], a[88:91], v[124:127]
    s_add_u32 m0, s62, 40960
    s_add_u32 s28, s41, s39
    v_mfma_f32_16x16x32_bf16 v[128:131], v[84:87], a[68:71], v[128:131]
    ds_read_b128 v[76:79], v15 offset:21504
    v_mfma_f32_16x16x32_bf16 v[128:131], v[88:91], a[76:79], v[128:131]
    s_lshl_b32 s15, s59, 1
    v_mfma_f32_16x16x32_bf16 v[128:131], v[92:95], a[84:87], v[128:131]
    ds_read_b128 v[80:83], v15 offset:29696
    v_mfma_f32_16x16x32_bf16 v[128:131], v[96:99], a[92:95], v[128:131]
    buffer_load_dwordx4 v240, s[16:19], s54 offen offset:0 lds
    s_add_u32 s15, s15, 1
    s_waitcnt lgkmcnt(6)
    v_mfma_f32_16x16x32_bf16 v[132:135], v[52:55], a[64:67], v[132:135]
    ds_read_b128 v[84:87], v15 offset:6144
    v_mfma_f32_16x16x32_bf16 v[132:135], v[56:59], a[72:75], v[132:135]
    buffer_load_dwordx4 a[144:147], v246, s[16:19], s44 offen sc1
    s_cmp_eq_u32 s59, 0
    s_cselect_b32 s15, 0, s15
    s_waitcnt lgkmcnt(5)
    v_mfma_f32_16x16x32_bf16 v[132:135], v[60:63], a[80:83], v[132:135]
    ds_read_b128 v[88:91], v15 offset:14336
    v_mfma_f32_16x16x32_bf16 v[132:135], v[64:67], a[88:91], v[132:135]
    buffer_load_dwordx4 v240, s[16:19], s55 offen offset:1024 lds
    s_mul_i32 s43, s61, 9
    v_mfma_f32_16x16x32_bf16 v[136:139], v[52:55], a[68:71], v[136:139]
    ds_read_b128 v[92:95], v15 offset:22528
    v_mfma_f32_16x16x32_bf16 v[136:139], v[56:59], a[76:79], v[136:139]
    s_add_u32 s15, s15, s43
    v_mfma_f32_16x16x32_bf16 v[136:139], v[60:63], a[84:87], v[136:139]
    ds_read_b128 v[96:99], v15 offset:30720
    v_mfma_f32_16x16x32_bf16 v[136:139], v[64:67], a[92:95], v[136:139]
    buffer_load_dwordx4 a[148:151], v246, s[16:19], s45 offen sc1
    s_mul_i32 s32, s14, 36
    s_waitcnt lgkmcnt(6)
    v_mfma_f32_16x16x32_bf16 v[140:143], v[68:71], a[64:67], v[140:143]
    s_waitcnt vmcnt(12)
    s_barrier
    ds_read_b128 v[52:55], v12 offset:0
    v_mfma_f32_16x16x32_bf16 v[140:143], v[72:75], a[72:75], v[140:143]
    buffer_load_dwordx4 v240, s[16:19], s56 offen offset:2048 lds
    s_add_u32 s32, s32, s15
    s_waitcnt lgkmcnt(5)
    v_mfma_f32_16x16x32_bf16 v[140:143], v[76:79], a[80:83], v[140:143]
    ds_read_b128 v[56:59], v12 offset:8192
    v_mfma_f32_16x16x32_bf16 v[140:143], v[80:83], a[88:91], v[140:143]
    buffer_load_dwordx4 a[152:155], v247, s[16:19], s44 offen sc1
    s_lshl_b32 s32, s32, 10
    v_mfma_f32_16x16x32_bf16 v[144:147], v[68:71], a[68:71], v[144:147]
    ds_read_b128 v[60:63], v12 offset:16384
    v_mfma_f32_16x16x32_bf16 v[144:147], v[72:75], a[76:79], v[144:147]
    v_add_u32 v240, 7168, v1
    s_add_u32 s32, s32, 0x1500000
    v_mfma_f32_16x16x32_bf16 v[144:147], v[76:79], a[84:87], v[144:147]
    ds_read_b128 v[64:67], v12 offset:24576
    v_mfma_f32_16x16x32_bf16 v[144:147], v[80:83], a[92:95], v[144:147]
    buffer_load_dwordx4 a[156:159], v247, s[16:19], s45 offen sc1
    s_lshl_b32 s33, s15, 6
    s_waitcnt lgkmcnt(6)
    v_mfma_f32_16x16x32_bf16 v[148:151], v[84:87], a[64:67], v[148:151]
    ds_read_b128 v[68:71], v12 offset:1024
    v_mfma_f32_16x16x32_bf16 v[148:151], v[88:91], a[72:75], v[148:151]
    s_add_u32 s33, s33, 11520
    s_waitcnt lgkmcnt(5)
    v_mfma_f32_16x16x32_bf16 v[148:151], v[92:95], a[80:83], v[148:151]
    ds_read_b128 v[72:75], v12 offset:9216
    v_mfma_f32_16x16x32_bf16 v[148:151], v[96:99], a[88:91], v[148:151]
    s_mul_i32 s34, s14, 36864
    v_mfma_f32_16x16x32_bf16 v[152:155], v[84:87], a[68:71], v[152:155]
    ds_read_b128 v[76:79], v12 offset:17408
    v_mfma_f32_16x16x32_bf16 v[152:155], v[88:91], a[76:79], v[152:155]
    s_lshl_b32 s35, s15, 5
    v_mfma_f32_16x16x32_bf16 v[152:155], v[92:95], a[84:87], v[152:155]
    ds_read_b128 v[80:83], v12 offset:25600
    v_mfma_f32_16x16x32_bf16 v[152:155], v[96:99], a[92:95], v[152:155]
    s_add_u32 s34, s34, s35
    s_waitcnt lgkmcnt(6)
    v_mfma_f32_16x16x32_bf16 v[100:103], v[52:55], a[96:99], v[100:103]
    ds_read_b128 v[84:87], v12 offset:2048
    v_mfma_f32_16x16x32_bf16 v[100:103], v[56:59], a[104:107], v[100:103]
    buffer_load_dword v243, v237, s[16:19], 0 offen sc1
    s_add_u32 s35, s34, 18432
    s_waitcnt lgkmcnt(5)
    v_mfma_f32_16x16x32_bf16 v[100:103], v[60:63], a[112:115], v[100:103]
    ds_read_b128 v[88:91], v12 offset:10240
    v_mfma_f32_16x16x32_bf16 v[100:103], v[64:67], a[120:123], v[100:103]
    s_add_u32 m0, s62, 73728
    s_mov_b32 s12, s6
    v_mfma_f32_16x16x32_bf16 v[104:107], v[52:55], a[100:103], v[104:107]
    ds_read_b128 v[92:95], v12 offset:18432
    v_mfma_f32_16x16x32_bf16 v[104:107], v[56:59], a[108:111], v[104:107]
    s_mov_b32 s13, s7
    v_mfma_f32_16x16x32_bf16 v[104:107], v[60:63], a[116:119], v[104:107]
    ds_read_b128 v[96:99], v12 offset:26624
    v_mfma_f32_16x16x32_bf16 v[104:107], v[64:67], a[124:127], v[104:107]
    buffer_load_dwordx4 v240, s[16:19], s50 offen offset:0 lds
    s_mov_b32 s14, 0x240000
    s_waitcnt lgkmcnt(6)
    v_mfma_f32_16x16x32_bf16 v[108:111], v[68:71], a[96:99], v[108:111]
    ds_read_b128 v[52:55], v12 offset:3072
    v_mfma_f32_16x16x32_bf16 v[108:111], v[72:75], a[104:107], v[108:111]
    s_add_u32 s44, s46, 7168
    s_mov_b32 s15, 0x00020000
    s_waitcnt lgkmcnt(5)
    v_mfma_f32_16x16x32_bf16 v[108:111], v[76:79], a[112:115], v[108:111]
    ds_read_b128 v[56:59], v12 offset:11264
    v_mfma_f32_16x16x32_bf16 v[108:111], v[80:83], a[120:123], v[108:111]
    s_add_u32 s45, s44, 147456
    v_mfma_f32_16x16x32_bf16 v[112:115], v[68:71], a[100:103], v[112:115]
    ds_read_b128 v[60:63], v12 offset:19456
    v_mfma_f32_16x16x32_bf16 v[112:115], v[72:75], a[108:111], v[112:115]
    v_mfma_f32_16x16x32_bf16 v[112:115], v[76:79], a[116:119], v[112:115]
    ds_read_b128 v[64:67], v12 offset:27648
    v_mfma_f32_16x16x32_bf16 v[112:115], v[80:83], a[124:127], v[112:115]
    buffer_load_dwordx4 a[160:163], v244, s[16:19], s44 offen sc1
    s_waitcnt lgkmcnt(6)
    v_mfma_f32_16x16x32_bf16 v[116:119], v[84:87], a[96:99], v[116:119]
    ds_read_b128 v[68:71], v12 offset:4096
    v_mfma_f32_16x16x32_bf16 v[116:119], v[88:91], a[104:107], v[116:119]
    buffer_load_dwordx4 v240, s[16:19], s51 offen offset:1024 lds
    s_waitcnt lgkmcnt(5)
    v_mfma_f32_16x16x32_bf16 v[116:119], v[92:95], a[112:115], v[116:119]
    ds_read_b128 v[72:75], v12 offset:12288
    v_mfma_f32_16x16x32_bf16 v[116:119], v[96:99], a[120:123], v[116:119]
    buffer_load_dwordx4 a[164:167], v244, s[16:19], s45 offen sc1
    v_mfma_f32_16x16x32_bf16 v[120:123], v[84:87], a[100:103], v[120:123]
    ds_read_b128 v[76:79], v12 offset:20480
    v_mfma_f32_16x16x32_bf16 v[120:123], v[88:91], a[108:111], v[120:123]
    v_mfma_f32_16x16x32_bf16 v[120:123], v[92:95], a[116:119], v[120:123]
    ds_read_b128 v[80:83], v12 offset:28672
    v_mfma_f32_16x16x32_bf16 v[120:123], v[96:99], a[124:127], v[120:123]
    buffer_load_dwordx4 v240, s[16:19], s52 offen offset:2048 lds
    s_waitcnt lgkmcnt(6)
    v_mfma_f32_16x16x32_bf16 v[124:127], v[52:55], a[96:99], v[124:127]
    ds_read_b128 v[84:87], v12 offset:5120
    v_mfma_f32_16x16x32_bf16 v[124:127], v[56:59], a[104:107], v[124:127]
    buffer_load_dwordx4 a[168:171], v245, s[16:19], s44 offen sc1
    s_waitcnt lgkmcnt(5)
    v_mfma_f32_16x16x32_bf16 v[124:127], v[60:63], a[112:115], v[124:127]
    ds_read_b128 v[88:91], v12 offset:13312
    v_mfma_f32_16x16x32_bf16 v[124:127], v[64:67], a[120:123], v[124:127]
    buffer_load_dwordx4 v240, s[16:19], s53 offen offset:3072 lds
    v_mfma_f32_16x16x32_bf16 v[128:131], v[52:55], a[100:103], v[128:131]
    ds_read_b128 v[92:95], v12 offset:21504
    v_mfma_f32_16x16x32_bf16 v[128:131], v[56:59], a[108:111], v[128:131]
    v_mfma_f32_16x16x32_bf16 v[128:131], v[60:63], a[116:119], v[128:131]
    ds_read_b128 v[96:99], v12 offset:29696
    v_mfma_f32_16x16x32_bf16 v[128:131], v[64:67], a[124:127], v[128:131]
    buffer_load_dwordx4 a[172:175], v245, s[16:19], s45 offen sc1
    s_waitcnt lgkmcnt(6)
    v_mfma_f32_16x16x32_bf16 v[132:135], v[68:71], a[96:99], v[132:135]
    ds_read_b128 v[52:55], v12 offset:6144
    v_mfma_f32_16x16x32_bf16 v[132:135], v[72:75], a[104:107], v[132:135]
    s_add_u32 m0, s62, 77824
    s_waitcnt lgkmcnt(5)
    v_mfma_f32_16x16x32_bf16 v[132:135], v[76:79], a[112:115], v[132:135]
    ds_read_b128 v[56:59], v12 offset:14336
    v_mfma_f32_16x16x32_bf16 v[132:135], v[80:83], a[120:123], v[132:135]
    buffer_load_dwordx4 v240, s[16:19], s54 offen offset:0 lds
    v_mfma_f32_16x16x32_bf16 v[136:139], v[68:71], a[100:103], v[136:139]
    ds_read_b128 v[60:63], v12 offset:22528
    v_mfma_f32_16x16x32_bf16 v[136:139], v[72:75], a[108:111], v[136:139]
    v_mfma_f32_16x16x32_bf16 v[136:139], v[76:79], a[116:119], v[136:139]
    ds_read_b128 v[64:67], v12 offset:30720
    v_mfma_f32_16x16x32_bf16 v[136:139], v[80:83], a[124:127], v[136:139]
    buffer_load_dwordx4 a[176:179], v246, s[16:19], s44 offen sc1
    s_waitcnt lgkmcnt(6)
    v_mfma_f32_16x16x32_bf16 v[140:143], v[84:87], a[96:99], v[140:143]
    s_waitcnt vmcnt(11)
    s_barrier
    ds_read_b128 v[68:71], v13 offset:0
    v_mfma_f32_16x16x32_bf16 v[140:143], v[88:91], a[104:107], v[140:143]
    buffer_load_dwordx4 v240, s[16:19], s55 offen offset:1024 lds
    s_waitcnt lgkmcnt(5)
    v_mfma_f32_16x16x32_bf16 v[140:143], v[92:95], a[112:115], v[140:143]
    ds_read_b128 v[72:75], v13 offset:8192
    v_mfma_f32_16x16x32_bf16 v[140:143], v[96:99], a[120:123], v[140:143]
    buffer_load_dwordx4 a[180:183], v246, s[16:19], s45 offen sc1
    v_mfma_f32_16x16x32_bf16 v[144:147], v[84:87], a[100:103], v[144:147]
    ds_read_b128 v[76:79], v13 offset:16384
    v_mfma_f32_16x16x32_bf16 v[144:147], v[88:91], a[108:111], v[144:147]
    v_mfma_f32_16x16x32_bf16 v[144:147], v[92:95], a[116:119], v[144:147]
    ds_read_b128 v[80:83], v13 offset:24576
    v_mfma_f32_16x16x32_bf16 v[144:147], v[96:99], a[124:127], v[144:147]
    buffer_load_dwordx4 v240, s[16:19], s56 offen offset:2048 lds
    s_waitcnt lgkmcnt(6)
    v_mfma_f32_16x16x32_bf16 v[148:151], v[52:55], a[96:99], v[148:151]
    ds_read_b128 v[84:87], v13 offset:1024
    v_mfma_f32_16x16x32_bf16 v[148:151], v[56:59], a[104:107], v[148:151]
    buffer_load_dwordx4 a[184:187], v247, s[16:19], s44 offen sc1
    s_waitcnt lgkmcnt(5)
    v_mfma_f32_16x16x32_bf16 v[148:151], v[60:63], a[112:115], v[148:151]
    ds_read_b128 v[88:91], v13 offset:9216
    v_mfma_f32_16x16x32_bf16 v[148:151], v[64:67], a[120:123], v[148:151]
    v_add_u32 v240, 3072, v1
    v_mfma_f32_16x16x32_bf16 v[152:155], v[52:55], a[100:103], v[152:155]
    ds_read_b128 v[92:95], v13 offset:17408
    v_mfma_f32_16x16x32_bf16 v[152:155], v[56:59], a[108:111], v[152:155]
    v_mfma_f32_16x16x32_bf16 v[152:155], v[60:63], a[116:119], v[152:155]
    ds_read_b128 v[96:99], v13 offset:25600
    v_mfma_f32_16x16x32_bf16 v[152:155], v[64:67], a[124:127], v[152:155]
    buffer_load_dwordx4 a[188:191], v247, s[16:19], s45 offen sc1
    s_waitcnt vmcnt(15)
    s_mov_b32 s10, 262144
K456_C7_P2B:
    v_cmp_ne_u32 vcc, 0, v243
    s_nop 0
    s_cmp_eq_u64 vcc, -1
    s_cbranch_scc1 K456_C7_P2B_X
    buffer_load_dword v243, v237, s[16:19], 0 offen offset:0 sc1
    s_waitcnt vmcnt(0)
    s_sub_u32 s10, s10, 1
    s_cbranch_scc0 K456_C7_P2B
K456_C7_P2B_X:
    s_waitcnt lgkmcnt(6)
    v_mfma_f32_16x16x32_bf16 v[100:103], v[68:71], a[128:131], v[100:103]
    ds_read_b128 v[52:55], v13 offset:2048
    v_mfma_f32_16x16x32_bf16 v[100:103], v[72:75], a[136:139], v[100:103]
    s_add_u32 m0, s62, 110592
    s_waitcnt lgkmcnt(5)
    v_mfma_f32_16x16x32_bf16 v[100:103], v[76:79], a[144:147], v[100:103]
    ds_read_b128 v[56:59], v13 offset:10240
    v_mfma_f32_16x16x32_bf16 v[100:103], v[80:83], a[152:155], v[100:103]
    buffer_load_dwordx4 v240, s[16:19], s50 offen offset:0 lds
    v_mfma_f32_16x16x32_bf16 v[104:107], v[68:71], a[132:135], v[104:107]
    ds_read_b128 v[60:63], v13 offset:18432
    v_mfma_f32_16x16x32_bf16 v[104:107], v[72:75], a[140:143], v[104:107]
    s_add_u32 s44, s46, 3072
    v_mfma_f32_16x16x32_bf16 v[104:107], v[76:79], a[148:151], v[104:107]
    ds_read_b128 v[64:67], v13 offset:26624
    v_mfma_f32_16x16x32_bf16 v[104:107], v[80:83], a[156:159], v[104:107]
    s_add_u32 s45, s44, 147456
    s_waitcnt lgkmcnt(6)
    v_mfma_f32_16x16x32_bf16 v[108:111], v[84:87], a[128:131], v[108:111]
    ds_read_b128 v[68:71], v13 offset:3072
    v_mfma_f32_16x16x32_bf16 v[108:111], v[88:91], a[136:139], v[108:111]
    buffer_load_dwordx4 a[192:195], v244, s[16:19], s44 offen sc1
    s_waitcnt lgkmcnt(5)
    v_mfma_f32_16x16x32_bf16 v[108:111], v[92:95], a[144:147], v[108:111]
    ds_read_b128 v[72:75], v13 offset:11264
    v_mfma_f32_16x16x32_bf16 v[108:111], v[96:99], a[152:155], v[108:111]
    buffer_load_dwordx4 v240, s[16:19], s51 offen offset:1024 lds
    v_mfma_f32_16x16x32_bf16 v[112:115], v[84:87], a[132:135], v[112:115]
    ds_read_b128 v[76:79], v13 offset:19456
    v_mfma_f32_16x16x32_bf16 v[112:115], v[88:91], a[140:143], v[112:115]
    v_mfma_f32_16x16x32_bf16 v[112:115], v[92:95], a[148:151], v[112:115]
    ds_read_b128 v[80:83], v13 offset:27648
    v_mfma_f32_16x16x32_bf16 v[112:115], v[96:99], a[156:159], v[112:115]
    buffer_load_dwordx4 a[196:199], v244, s[16:19], s45 offen sc1
    s_waitcnt lgkmcnt(6)
    v_mfma_f32_16x16x32_bf16 v[116:119], v[52:55], a[128:131], v[116:119]
    ds_read_b128 v[84:87], v13 offset:4096
    v_mfma_f32_16x16x32_bf16 v[116:119], v[56:59], a[136:139], v[116:119]
    buffer_load_dwordx4 v240, s[16:19], s52 offen offset:2048 lds
    s_waitcnt lgkmcnt(5)
    v_mfma_f32_16x16x32_bf16 v[116:119], v[60:63], a[144:147], v[116:119]
    ds_read_b128 v[88:91], v13 offset:12288
    v_mfma_f32_16x16x32_bf16 v[116:119], v[64:67], a[152:155], v[116:119]
    buffer_load_dwordx4 a[200:203], v245, s[16:19], s44 offen sc1
    v_mfma_f32_16x16x32_bf16 v[120:123], v[52:55], a[132:135], v[120:123]
    ds_read_b128 v[92:95], v13 offset:20480
    v_mfma_f32_16x16x32_bf16 v[120:123], v[56:59], a[140:143], v[120:123]
    v_mfma_f32_16x16x32_bf16 v[120:123], v[60:63], a[148:151], v[120:123]
    ds_read_b128 v[96:99], v13 offset:28672
    v_mfma_f32_16x16x32_bf16 v[120:123], v[64:67], a[156:159], v[120:123]
    buffer_load_dwordx4 v240, s[16:19], s53 offen offset:3072 lds
    s_waitcnt lgkmcnt(6)
    v_mfma_f32_16x16x32_bf16 v[124:127], v[68:71], a[128:131], v[124:127]
    ds_read_b128 v[52:55], v13 offset:5120
    v_mfma_f32_16x16x32_bf16 v[124:127], v[72:75], a[136:139], v[124:127]
    buffer_load_dwordx4 a[204:207], v245, s[16:19], s45 offen sc1
    s_waitcnt lgkmcnt(5)
    v_mfma_f32_16x16x32_bf16 v[124:127], v[76:79], a[144:147], v[124:127]
    ds_read_b128 v[56:59], v13 offset:13312
    v_mfma_f32_16x16x32_bf16 v[124:127], v[80:83], a[152:155], v[124:127]
    s_add_u32 m0, s62, 114688
    v_mfma_f32_16x16x32_bf16 v[128:131], v[68:71], a[132:135], v[128:131]
    ds_read_b128 v[60:63], v13 offset:21504
    v_mfma_f32_16x16x32_bf16 v[128:131], v[72:75], a[140:143], v[128:131]
    v_mfma_f32_16x16x32_bf16 v[128:131], v[76:79], a[148:151], v[128:131]
    ds_read_b128 v[64:67], v13 offset:29696
    v_mfma_f32_16x16x32_bf16 v[128:131], v[80:83], a[156:159], v[128:131]
    buffer_load_dwordx4 v240, s[16:19], s54 offen offset:0 lds
    s_waitcnt lgkmcnt(6)
    v_mfma_f32_16x16x32_bf16 v[132:135], v[84:87], a[128:131], v[132:135]
    ds_read_b128 v[68:71], v13 offset:6144
    v_mfma_f32_16x16x32_bf16 v[132:135], v[88:91], a[136:139], v[132:135]
    buffer_load_dwordx4 a[208:211], v246, s[16:19], s44 offen sc1
    s_waitcnt lgkmcnt(5)
    v_mfma_f32_16x16x32_bf16 v[132:135], v[92:95], a[144:147], v[132:135]
    ds_read_b128 v[72:75], v13 offset:14336
    v_mfma_f32_16x16x32_bf16 v[132:135], v[96:99], a[152:155], v[132:135]
    buffer_load_dwordx4 v240, s[16:19], s55 offen offset:1024 lds
    v_mfma_f32_16x16x32_bf16 v[136:139], v[84:87], a[132:135], v[136:139]
    ds_read_b128 v[76:79], v13 offset:22528
    v_mfma_f32_16x16x32_bf16 v[136:139], v[88:91], a[140:143], v[136:139]
    v_mfma_f32_16x16x32_bf16 v[136:139], v[92:95], a[148:151], v[136:139]
    ds_read_b128 v[80:83], v13 offset:30720
    v_mfma_f32_16x16x32_bf16 v[136:139], v[96:99], a[156:159], v[136:139]
    buffer_load_dwordx4 a[212:215], v246, s[16:19], s45 offen sc1
    s_waitcnt lgkmcnt(6)
    v_mfma_f32_16x16x32_bf16 v[140:143], v[52:55], a[128:131], v[140:143]
    s_waitcnt vmcnt(12)
    s_barrier
    ds_read_b128 v[84:87], v14 offset:0
    v_mfma_f32_16x16x32_bf16 v[140:143], v[56:59], a[136:139], v[140:143]
    buffer_load_dwordx4 v240, s[16:19], s56 offen offset:2048 lds
    s_waitcnt lgkmcnt(5)
    v_mfma_f32_16x16x32_bf16 v[140:143], v[60:63], a[144:147], v[140:143]
    ds_read_b128 v[88:91], v14 offset:8192
    v_mfma_f32_16x16x32_bf16 v[140:143], v[64:67], a[152:155], v[140:143]
    buffer_load_dwordx4 a[216:219], v247, s[16:19], s44 offen sc1
    v_mfma_f32_16x16x32_bf16 v[144:147], v[52:55], a[132:135], v[144:147]
    ds_read_b128 v[92:95], v14 offset:16384
    v_mfma_f32_16x16x32_bf16 v[144:147], v[56:59], a[140:143], v[144:147]
    v_add_u32 v240, 4096, v1
    v_mfma_f32_16x16x32_bf16 v[144:147], v[60:63], a[148:151], v[144:147]
    ds_read_b128 v[96:99], v14 offset:24576
    v_mfma_f32_16x16x32_bf16 v[144:147], v[64:67], a[156:159], v[144:147]
    buffer_load_dwordx4 a[220:223], v247, s[16:19], s45 offen sc1
    s_waitcnt lgkmcnt(6)
    v_mfma_f32_16x16x32_bf16 v[148:151], v[68:71], a[128:131], v[148:151]
    ds_read_b128 v[52:55], v14 offset:1024
    v_mfma_f32_16x16x32_bf16 v[148:151], v[72:75], a[136:139], v[148:151]
    s_waitcnt lgkmcnt(5)
    v_mfma_f32_16x16x32_bf16 v[148:151], v[76:79], a[144:147], v[148:151]
    ds_read_b128 v[56:59], v14 offset:9216
    v_mfma_f32_16x16x32_bf16 v[148:151], v[80:83], a[152:155], v[148:151]
    v_mfma_f32_16x16x32_bf16 v[152:155], v[68:71], a[132:135], v[152:155]
    ds_read_b128 v[60:63], v14 offset:17408
    v_mfma_f32_16x16x32_bf16 v[152:155], v[72:75], a[140:143], v[152:155]
    v_mfma_f32_16x16x32_bf16 v[152:155], v[76:79], a[148:151], v[152:155]
    ds_read_b128 v[64:67], v14 offset:25600
    v_mfma_f32_16x16x32_bf16 v[152:155], v[80:83], a[156:159], v[152:155]
    s_waitcnt lgkmcnt(6)
    v_mfma_f32_16x16x32_bf16 v[100:103], v[84:87], a[160:163], v[100:103]
    ds_read_b128 v[68:71], v14 offset:2048
    v_mfma_f32_16x16x32_bf16 v[100:103], v[88:91], a[168:171], v[100:103]
    s_add_u32 m0, s62, 0
    s_waitcnt lgkmcnt(5)
    v_mfma_f32_16x16x32_bf16 v[100:103], v[92:95], a[176:179], v[100:103]
    ds_read_b128 v[72:75], v14 offset:10240
    v_mfma_f32_16x16x32_bf16 v[100:103], v[96:99], a[184:187], v[100:103]
    buffer_load_dwordx4 v240, s[16:19], s50 offen offset:0 lds
    v_mfma_f32_16x16x32_bf16 v[104:107], v[84:87], a[164:167], v[104:107]
    ds_read_b128 v[76:79], v14 offset:18432
    v_mfma_f32_16x16x32_bf16 v[104:107], v[88:91], a[172:175], v[104:107]
    s_add_u32 s44, s46, 4096
    v_mfma_f32_16x16x32_bf16 v[104:107], v[92:95], a[180:183], v[104:107]
    ds_read_b128 v[80:83], v14 offset:26624
    v_mfma_f32_16x16x32_bf16 v[104:107], v[96:99], a[188:191], v[104:107]
    s_add_u32 s45, s44, 147456
    s_waitcnt lgkmcnt(6)
    v_mfma_f32_16x16x32_bf16 v[108:111], v[52:55], a[160:163], v[108:111]
    ds_read_b128 v[84:87], v14 offset:3072
    v_mfma_f32_16x16x32_bf16 v[108:111], v[56:59], a[168:171], v[108:111]
    buffer_load_dwordx4 a[224:227], v244, s[16:19], s44 offen sc1
    s_waitcnt lgkmcnt(5)
    v_mfma_f32_16x16x32_bf16 v[108:111], v[60:63], a[176:179], v[108:111]
    ds_read_b128 v[88:91], v14 offset:11264
    v_mfma_f32_16x16x32_bf16 v[108:111], v[64:67], a[184:187], v[108:111]
    buffer_load_dwordx4 v240, s[16:19], s51 offen offset:1024 lds
    v_mfma_f32_16x16x32_bf16 v[112:115], v[52:55], a[164:167], v[112:115]
    ds_read_b128 v[92:95], v14 offset:19456
    v_mfma_f32_16x16x32_bf16 v[112:115], v[56:59], a[172:175], v[112:115]
    v_mfma_f32_16x16x32_bf16 v[112:115], v[60:63], a[180:183], v[112:115]
    ds_read_b128 v[96:99], v14 offset:27648
    v_mfma_f32_16x16x32_bf16 v[112:115], v[64:67], a[188:191], v[112:115]
    buffer_load_dwordx4 a[228:231], v244, s[16:19], s45 offen sc1
    s_waitcnt lgkmcnt(6)
    v_mfma_f32_16x16x32_bf16 v[116:119], v[68:71], a[160:163], v[116:119]
    ds_read_b128 v[52:55], v14 offset:4096
    v_mfma_f32_16x16x32_bf16 v[116:119], v[72:75], a[168:171], v[116:119]
    buffer_load_dwordx4 v240, s[16:19], s52 offen offset:2048 lds
    s_waitcnt lgkmcnt(5)
    v_mfma_f32_16x16x32_bf16 v[116:119], v[76:79], a[176:179], v[116:119]
    ds_read_b128 v[56:59], v14 offset:12288
    v_mfma_f32_16x16x32_bf16 v[116:119], v[80:83], a[184:187], v[116:119]
    buffer_load_dwordx4 a[232:235], v245, s[16:19], s44 offen sc1
    v_mfma_f32_16x16x32_bf16 v[120:123], v[68:71], a[164:167], v[120:123]
    ds_read_b128 v[60:63], v14 offset:20480
    v_mfma_f32_16x16x32_bf16 v[120:123], v[72:75], a[172:175], v[120:123]
    v_mfma_f32_16x16x32_bf16 v[120:123], v[76:79], a[180:183], v[120:123]
    ds_read_b128 v[64:67], v14 offset:28672
    v_mfma_f32_16x16x32_bf16 v[120:123], v[80:83], a[188:191], v[120:123]
    buffer_load_dwordx4 v240, s[16:19], s53 offen offset:3072 lds
    s_waitcnt lgkmcnt(6)
    v_mfma_f32_16x16x32_bf16 v[124:127], v[84:87], a[160:163], v[124:127]
    ds_read_b128 v[68:71], v14 offset:5120
    v_mfma_f32_16x16x32_bf16 v[124:127], v[88:91], a[168:171], v[124:127]
    buffer_load_dwordx4 a[236:239], v245, s[16:19], s45 offen sc1
    s_waitcnt lgkmcnt(5)
    v_mfma_f32_16x16x32_bf16 v[124:127], v[92:95], a[176:179], v[124:127]
    ds_read_b128 v[72:75], v14 offset:13312
    v_mfma_f32_16x16x32_bf16 v[124:127], v[96:99], a[184:187], v[124:127]
    s_add_u32 m0, s62, 4096
    v_mfma_f32_16x16x32_bf16 v[128:131], v[84:87], a[164:167], v[128:131]
    ds_read_b128 v[76:79], v14 offset:21504
    v_mfma_f32_16x16x32_bf16 v[128:131], v[88:91], a[172:175], v[128:131]
    v_mfma_f32_16x16x32_bf16 v[128:131], v[92:95], a[180:183], v[128:131]
    ds_read_b128 v[80:83], v14 offset:29696
    v_mfma_f32_16x16x32_bf16 v[128:131], v[96:99], a[188:191], v[128:131]
    buffer_load_dwordx4 v240, s[16:19], s54 offen offset:0 lds
    s_waitcnt lgkmcnt(6)
    v_mfma_f32_16x16x32_bf16 v[132:135], v[52:55], a[160:163], v[132:135]
    ds_read_b128 v[84:87], v14 offset:6144
    v_mfma_f32_16x16x32_bf16 v[132:135], v[56:59], a[168:171], v[132:135]
    buffer_load_dwordx4 a[240:243], v246, s[16:19], s44 offen sc1
    s_waitcnt lgkmcnt(5)
    v_mfma_f32_16x16x32_bf16 v[132:135], v[60:63], a[176:179], v[132:135]
    ds_read_b128 v[88:91], v14 offset:14336
    v_mfma_f32_16x16x32_bf16 v[132:135], v[64:67], a[184:187], v[132:135]
    buffer_load_dwordx4 v240, s[16:19], s55 offen offset:1024 lds
    v_mfma_f32_16x16x32_bf16 v[136:139], v[52:55], a[164:167], v[136:139]
    ds_read_b128 v[92:95], v14 offset:22528
    v_mfma_f32_16x16x32_bf16 v[136:139], v[56:59], a[172:175], v[136:139]
    v_mfma_f32_16x16x32_bf16 v[136:139], v[60:63], a[180:183], v[136:139]
    ds_read_b128 v[96:99], v14 offset:30720
    v_mfma_f32_16x16x32_bf16 v[136:139], v[64:67], a[188:191], v[136:139]
    buffer_load_dwordx4 a[244:247], v246, s[16:19], s45 offen sc1
    s_waitcnt lgkmcnt(6)
    v_mfma_f32_16x16x32_bf16 v[140:143], v[68:71], a[160:163], v[140:143]
    s_waitcnt vmcnt(12)
    s_barrier
    ds_read_b128 v[52:55], v15 offset:0
    v_mfma_f32_16x16x32_bf16 v[140:143], v[72:75], a[168:171], v[140:143]
    buffer_load_dwordx4 v240, s[16:19], s56 offen offset:2048 lds
    s_waitcnt lgkmcnt(5)
    v_mfma_f32_16x16x32_bf16 v[140:143], v[76:79], a[176:179], v[140:143]
    ds_read_b128 v[56:59], v15 offset:8192
    v_mfma_f32_16x16x32_bf16 v[140:143], v[80:83], a[184:187], v[140:143]
    buffer_load_dwordx4 a[248:251], v247, s[16:19], s44 offen sc1
    v_mfma_f32_16x16x32_bf16 v[144:147], v[68:71], a[164:167], v[144:147]
    ds_read_b128 v[60:63], v15 offset:16384
    v_mfma_f32_16x16x32_bf16 v[144:147], v[72:75], a[172:175], v[144:147]
    v_add_u32 v240, 8192, v1
    v_mfma_f32_16x16x32_bf16 v[144:147], v[76:79], a[180:183], v[144:147]
    ds_read_b128 v[64:67], v15 offset:24576
    v_mfma_f32_16x16x32_bf16 v[144:147], v[80:83], a[188:191], v[144:147]
    buffer_load_dwordx4 a[252:255], v247, s[16:19], s45 offen sc1
    s_waitcnt lgkmcnt(6)
    v_mfma_f32_16x16x32_bf16 v[148:151], v[84:87], a[160:163], v[148:151]
    ds_read_b128 v[68:71], v15 offset:1024
    v_mfma_f32_16x16x32_bf16 v[148:151], v[88:91], a[168:171], v[148:151]
    s_waitcnt lgkmcnt(5)
    v_mfma_f32_16x16x32_bf16 v[148:151], v[92:95], a[176:179], v[148:151]
    ds_read_b128 v[72:75], v15 offset:9216
    v_mfma_f32_16x16x32_bf16 v[148:151], v[96:99], a[184:187], v[148:151]
    v_mfma_f32_16x16x32_bf16 v[152:155], v[84:87], a[164:167], v[152:155]
    ds_read_b128 v[76:79], v15 offset:17408
    v_mfma_f32_16x16x32_bf16 v[152:155], v[88:91], a[172:175], v[152:155]
    v_mfma_f32_16x16x32_bf16 v[152:155], v[92:95], a[180:183], v[152:155]
    ds_read_b128 v[80:83], v15 offset:25600
    v_mfma_f32_16x16x32_bf16 v[152:155], v[96:99], a[188:191], v[152:155]
    s_waitcnt lgkmcnt(6)
    v_mfma_f32_16x16x32_bf16 v[100:103], v[52:55], a[192:195], v[100:103]
    ds_read_b128 v[84:87], v15 offset:2048
    v_mfma_f32_16x16x32_bf16 v[100:103], v[56:59], a[200:203], v[100:103]
    s_add_u32 m0, s62, 36864
    s_waitcnt lgkmcnt(5)
    v_mfma_f32_16x16x32_bf16 v[100:103], v[60:63], a[208:211], v[100:103]
    ds_read_b128 v[88:91], v15 offset:10240
    v_mfma_f32_16x16x32_bf16 v[100:103], v[64:67], a[216:219], v[100:103]
    buffer_load_dwordx4 v240, s[16:19], s50 offen offset:0 lds
    v_mfma_f32_16x16x32_bf16 v[104:107], v[52:55], a[196:199], v[104:107]
    ds_read_b128 v[92:95], v15 offset:18432
    v_mfma_f32_16x16x32_bf16 v[104:107], v[56:59], a[204:207], v[104:107]
    s_add_u32 s44, s46, 8192
    v_mfma_f32_16x16x32_bf16 v[104:107], v[60:63], a[212:215], v[104:107]
    ds_read_b128 v[96:99], v15 offset:26624
    v_mfma_f32_16x16x32_bf16 v[104:107], v[64:67], a[220:223], v[104:107]
    s_add_u32 s45, s44, 147456
    s_waitcnt lgkmcnt(6)
    v_mfma_f32_16x16x32_bf16 v[108:111], v[68:71], a[192:195], v[108:111]
    ds_read_b128 v[52:55], v15 offset:3072
    v_mfma_f32_16x16x32_bf16 v[108:111], v[72:75], a[200:203], v[108:111]
    buffer_load_dwordx4 v[20:23], v244, s[16:19], s44 offen sc1
    s_waitcnt lgkmcnt(5)
    v_mfma_f32_16x16x32_bf16 v[108:111], v[76:79], a[208:211], v[108:111]
    ds_read_b128 v[56:59], v15 offset:11264
    v_mfma_f32_16x16x32_bf16 v[108:111], v[80:83], a[216:219], v[108:111]
    buffer_load_dwordx4 v240, s[16:19], s51 offen offset:1024 lds
    v_mfma_f32_16x16x32_bf16 v[112:115], v[68:71], a[196:199], v[112:115]
    ds_read_b128 v[60:63], v15 offset:19456
    v_mfma_f32_16x16x32_bf16 v[112:115], v[72:75], a[204:207], v[112:115]
    v_mfma_f32_16x16x32_bf16 v[112:115], v[76:79], a[212:215], v[112:115]
    ds_read_b128 v[64:67], v15 offset:27648
    v_mfma_f32_16x16x32_bf16 v[112:115], v[80:83], a[220:223], v[112:115]
    buffer_load_dwordx4 v[24:27], v244, s[16:19], s45 offen sc1
    s_waitcnt lgkmcnt(6)
    v_mfma_f32_16x16x32_bf16 v[116:119], v[84:87], a[192:195], v[116:119]
    ds_read_b128 v[68:71], v15 offset:4096
    v_mfma_f32_16x16x32_bf16 v[116:119], v[88:91], a[200:203], v[116:119]
    buffer_load_dwordx4 v240, s[16:19], s52 offen offset:2048 lds
    s_waitcnt lgkmcnt(5)
    v_mfma_f32_16x16x32_bf16 v[116:119], v[92:95], a[208:211], v[116:119]
    ds_read_b128 v[72:75], v15 offset:12288
    v_mfma_f32_16x16x32_bf16 v[116:119], v[96:99], a[216:219], v[116:119]
    buffer_load_dwordx4 v[28:31], v245, s[16:19], s44 offen sc1
    v_mfma_f32_16x16x32_bf16 v[120:123], v[84:87], a[196:199], v[120:123]
    ds_read_b128 v[76:79], v15 offset:20480
    v_mfma_f32_16x16x32_bf16 v[120:123], v[88:91], a[204:207], v[120:123]
    v_mfma_f32_16x16x32_bf16 v[120:123], v[92:95], a[212:215], v[120:123]
    ds_read_b128 v[80:83], v15 offset:28672
    v_mfma_f32_16x16x32_bf16 v[120:123], v[96:99], a[220:223], v[120:123]
    buffer_load_dwordx4 v240, s[16:19], s53 offen offset:3072 lds
    s_waitcnt lgkmcnt(6)
    v_mfma_f32_16x16x32_bf16 v[124:127], v[52:55], a[192:195], v[124:127]
    ds_read_b128 v[84:87], v15 offset:5120
    v_mfma_f32_16x16x32_bf16 v[124:127], v[56:59], a[200:203], v[124:127]
    buffer_load_dwordx4 v[32:35], v245, s[16:19], s45 offen sc1
    s_waitcnt lgkmcnt(5)
    v_mfma_f32_16x16x32_bf16 v[124:127], v[60:63], a[208:211], v[124:127]
    ds_read_b128 v[88:91], v15 offset:13312
    v_mfma_f32_16x16x32_bf16 v[124:127], v[64:67], a[216:219], v[124:127]
    s_add_u32 m0, s62, 40960
    v_mfma_f32_16x16x32_bf16 v[128:131], v[52:55], a[196:199], v[128:131]
    ds_read_b128 v[92:95], v15 offset:21504
    v_mfma_f32_16x16x32_bf16 v[128:131], v[56:59], a[204:207], v[128:131]
    v_mfma_f32_16x16x32_bf16 v[128:131], v[60:63], a[212:215], v[128:131]
    ds_read_b128 v[96:99], v15 offset:29696
    v_mfma_f32_16x16x32_bf16 v[128:131], v[64:67], a[220:223], v[128:131]
    buffer_load_dwordx4 v240, s[16:19], s54 offen offset:0 lds
    s_waitcnt lgkmcnt(6)
    v_mfma_f32_16x16x32_bf16 v[132:135], v[68:71], a[192:195], v[132:135]
    ds_read_b128 v[52:55], v15 offset:6144
    v_mfma_f32_16x16x32_bf16 v[132:135], v[72:75], a[200:203], v[132:135]
    buffer_load_dwordx4 v[36:39], v246, s[16:19], s44 offen sc1
    s_waitcnt lgkmcnt(5)
    v_mfma_f32_16x16x32_bf16 v[132:135], v[76:79], a[208:211], v[132:135]
    ds_read_b128 v[56:59], v15 offset:14336
    v_mfma_f32_16x16x32_bf16 v[132:135], v[80:83], a[216:219], v[132:135]
    buffer_load_dwordx4 v240, s[16:19], s55 offen offset:1024 lds
    v_mfma_f32_16x16x32_bf16 v[136:139], v[68:71], a[196:199], v[136:139]
    ds_read_b128 v[60:63], v15 offset:22528
    v_mfma_f32_16x16x32_bf16 v[136:139], v[72:75], a[204:207], v[136:139]
    v_mfma_f32_16x16x32_bf16 v[136:139], v[76:79], a[212:215], v[136:139]
    ds_read_b128 v[64:67], v15 offset:30720
    v_mfma_f32_16x16x32_bf16 v[136:139], v[80:83], a[220:223], v[136:139]
    buffer_load_dwordx4 v[40:43], v246, s[16:19], s45 offen sc1
    s_waitcnt lgkmcnt(6)
    v_mfma_f32_16x16x32_bf16 v[140:143], v[84:87], a[192:195], v[140:143]
    s_waitcnt vmcnt(12)
    s_barrier
    ds_read_b128 v[68:71], v12 offset:0
    v_mfma_f32_16x16x32_bf16 v[140:143], v[88:91], a[200:203], v[140:143]
    buffer_load_dwordx4 v240, s[16:19], s56 offen offset:2048 lds
    s_waitcnt lgkmcnt(5)
    v_mfma_f32_16x16x32_bf16 v[140:143], v[92:95], a[208:211], v[140:143]
    ds_read_b128 v[72:75], v12 offset:8192
    v_mfma_f32_16x16x32_bf16 v[140:143], v[96:99], a[216:219], v[140:143]
    buffer_load_dwordx4 v[44:47], v247, s[16:19], s44 offen sc1
    v_mfma_f32_16x16x32_bf16 v[144:147], v[84:87], a[196:199], v[144:147]
    ds_read_b128 v[76:79], v12 offset:16384
    v_mfma_f32_16x16x32_bf16 v[144:147], v[88:91], a[204:207], v[144:147]
    v_add_u32 v240, 0, v1
    v_mfma_f32_16x16x32_bf16 v[144:147], v[92:95], a[212:215], v[144:147]
    ds_read_b128 v[80:83], v12 offset:24576
    v_mfma_f32_16x16x32_bf16 v[144:147], v[96:99], a[220:223], v[144:147]
    buffer_load_dwordx4 v[48:51], v247, s[16:19], s45 offen sc1
    s_waitcnt lgkmcnt(6)
    v_mfma_f32_16x16x32_bf16 v[148:151], v[52:55], a[192:195], v[148:151]
    ds_read_b128 v[84:87], v12 offset:1024
    v_mfma_f32_16x16x32_bf16 v[148:151], v[56:59], a[200:203], v[148:151]
    s_waitcnt lgkmcnt(5)
    v_mfma_f32_16x16x32_bf16 v[148:151], v[60:63], a[208:211], v[148:151]
    ds_read_b128 v[88:91], v12 offset:9216
    v_mfma_f32_16x16x32_bf16 v[148:151], v[64:67], a[216:219], v[148:151]
    v_mfma_f32_16x16x32_bf16 v[152:155], v[52:55], a[196:199], v[152:155]
    ds_read_b128 v[92:95], v12 offset:17408
    v_mfma_f32_16x16x32_bf16 v[152:155], v[56:59], a[204:207], v[152:155]
    v_mfma_f32_16x16x32_bf16 v[152:155], v[60:63], a[212:215], v[152:155]
    ds_read_b128 v[96:99], v12 offset:25600
    v_mfma_f32_16x16x32_bf16 v[152:155], v[64:67], a[220:223], v[152:155]
    s_waitcnt lgkmcnt(6)
    v_mfma_f32_16x16x32_bf16 v[100:103], v[68:71], a[224:227], v[100:103]
    ds_read_b128 v[52:55], v12 offset:2048
    v_mfma_f32_16x16x32_bf16 v[100:103], v[72:75], a[232:235], v[100:103]
    s_add_u32 m0, s31, 73728
    s_waitcnt lgkmcnt(5)
    v_mfma_f32_16x16x32_bf16 v[100:103], v[76:79], a[240:243], v[100:103]
    ds_read_b128 v[56:59], v12 offset:10240
    v_mfma_f32_16x16x32_bf16 v[100:103], v[80:83], a[248:251], v[100:103]
    buffer_load_dwordx4 v240, s[16:19], s57 offen offset:0 lds
    v_mfma_f32_16x16x32_bf16 v[104:107], v[68:71], a[228:231], v[104:107]
    ds_read_b128 v[60:63], v12 offset:18432
    v_mfma_f32_16x16x32_bf16 v[104:107], v[72:75], a[236:239], v[104:107]
    v_mfma_f32_16x16x32_bf16 v[104:107], v[76:79], a[244:247], v[104:107]
    ds_read_b128 v[64:67], v12 offset:26624
    v_mfma_f32_16x16x32_bf16 v[104:107], v[80:83], a[252:255], v[104:107]
    buffer_load_dwordx4 v240, s[16:19], s58 offen offset:1024 lds
    s_waitcnt lgkmcnt(6)
    v_mfma_f32_16x16x32_bf16 v[108:111], v[84:87], a[224:227], v[108:111]
    ds_read_b128 v[68:71], v12 offset:3072
    v_mfma_f32_16x16x32_bf16 v[108:111], v[88:91], a[232:235], v[108:111]
    v_add_u32 v240, 1024, v1
    s_waitcnt lgkmcnt(5)
    v_mfma_f32_16x16x32_bf16 v[108:111], v[92:95], a[240:243], v[108:111]
    ds_read_b128 v[72:75], v12 offset:11264
    v_mfma_f32_16x16x32_bf16 v[108:111], v[96:99], a[248:251], v[108:111]
    s_add_u32 m0, s31, 86016
    v_mfma_f32_16x16x32_bf16 v[112:115], v[84:87], a[228:231], v[112:115]
    ds_read_b128 v[76:79], v12 offset:19456
    v_mfma_f32_16x16x32_bf16 v[112:115], v[88:91], a[236:239], v[112:115]
    v_mfma_f32_16x16x32_bf16 v[112:115], v[92:95], a[244:247], v[112:115]
    ds_read_b128 v[80:83], v12 offset:27648
    v_mfma_f32_16x16x32_bf16 v[112:115], v[96:99], a[252:255], v[112:115]
    buffer_load_dwordx4 v240, s[16:19], s57 offen offset:0 lds
    s_waitcnt lgkmcnt(6)
    v_mfma_f32_16x16x32_bf16 v[116:119], v[52:55], a[224:227], v[116:119]
    ds_read_b128 v[84:87], v12 offset:4096
    v_mfma_f32_16x16x32_bf16 v[116:119], v[56:59], a[232:235], v[116:119]
    buffer_load_dwordx4 v240, s[16:19], s58 offen offset:1024 lds
    s_waitcnt lgkmcnt(5)
    v_mfma_f32_16x16x32_bf16 v[116:119], v[60:63], a[240:243], v[116:119]
    ds_read_b128 v[88:91], v12 offset:12288
    v_mfma_f32_16x16x32_bf16 v[116:119], v[64:67], a[248:251], v[116:119]
    v_add_u32 v240, 2048, v1
    v_mfma_f32_16x16x32_bf16 v[120:123], v[52:55], a[228:231], v[120:123]
    ds_read_b128 v[92:95], v12 offset:20480
    v_mfma_f32_16x16x32_bf16 v[120:123], v[56:59], a[236:239], v[120:123]
    s_add_u32 m0, s31, 98304
    v_mfma_f32_16x16x32_bf16 v[120:123], v[60:63], a[244:247], v[120:123]
    ds_read_b128 v[96:99], v12 offset:28672
    v_mfma_f32_16x16x32_bf16 v[120:123], v[64:67], a[252:255], v[120:123]
    buffer_load_dwordx4 v240, s[16:19], s57 offen offset:0 lds
    s_waitcnt lgkmcnt(6)
    v_mfma_f32_16x16x32_bf16 v[124:127], v[68:71], a[224:227], v[124:127]
    ds_read_b128 v[52:55], v12 offset:5120
    v_mfma_f32_16x16x32_bf16 v[124:127], v[72:75], a[232:235], v[124:127]
    buffer_load_dwordx4 v240, s[16:19], s58 offen offset:1024 lds
    s_waitcnt lgkmcnt(5)
    v_mfma_f32_16x16x32_bf16 v[124:127], v[76:79], a[240:243], v[124:127]
    ds_read_b128 v[56:59], v12 offset:13312
    v_mfma_f32_16x16x32_bf16 v[124:127], v[80:83], a[248:251], v[124:127]
    v_add_u32 v240, 5120, v1
    v_mfma_f32_16x16x32_bf16 v[128:131], v[68:71], a[228:231], v[128:131]
    ds_read_b128 v[60:63], v12 offset:21504
    v_mfma_f32_16x16x32_bf16 v[128:131], v[72:75], a[236:239], v[128:131]
    v_mfma_f32_16x16x32_bf16 v[128:131], v[76:79], a[244:247], v[128:131]
    ds_read_b128 v[64:67], v12 offset:29696
    v_mfma_f32_16x16x32_bf16 v[128:131], v[80:83], a[252:255], v[128:131]
    s_waitcnt lgkmcnt(6)
    v_mfma_f32_16x16x32_bf16 v[132:135], v[84:87], a[224:227], v[132:135]
    ds_read_b128 v[68:71], v12 offset:6144
    v_mfma_f32_16x16x32_bf16 v[132:135], v[88:91], a[232:235], v[132:135]
    s_waitcnt lgkmcnt(5)
    v_mfma_f32_16x16x32_bf16 v[132:135], v[92:95], a[240:243], v[132:135]
    ds_read_b128 v[72:75], v12 offset:14336
    v_mfma_f32_16x16x32_bf16 v[132:135], v[96:99], a[248:251], v[132:135]
    v_mfma_f32_16x16x32_bf16 v[136:139], v[84:87], a[228:231], v[136:139]
    ds_read_b128 v[76:79], v12 offset:22528
    v_mfma_f32_16x16x32_bf16 v[136:139], v[88:91], a[236:239], v[136:139]
    v_mfma_f32_16x16x32_bf16 v[136:139], v[92:95], a[244:247], v[136:139]
    ds_read_b128 v[80:83], v12 offset:30720
    v_mfma_f32_16x16x32_bf16 v[136:139], v[96:99], a[252:255], v[136:139]
    s_waitcnt lgkmcnt(6)
    v_mfma_f32_16x16x32_bf16 v[140:143], v[52:55], a[224:227], v[140:143]
    s_waitcnt vmcnt(6)
    s_barrier
    ds_read_b128 v[84:87], v13 offset:0
    v_mfma_f32_16x16x32_bf16 v[140:143], v[56:59], a[232:235], v[140:143]
    s_waitcnt lgkmcnt(5)
    v_mfma_f32_16x16x32_bf16 v[140:143], v[60:63], a[240:243], v[140:143]
    ds_read_b128 v[88:91], v13 offset:8192
    v_mfma_f32_16x16x32_bf16 v[140:143], v[64:67], a[248:251], v[140:143]
    v_mfma_f32_16x16x32_bf16 v[144:147], v[52:55], a[228:231], v[144:147]
    ds_read_b128 v[92:95], v13 offset:16384
    v_mfma_f32_16x16x32_bf16 v[144:147], v[56:59], a[236:239], v[144:147]
    v_mfma_f32_16x16x32_bf16 v[144:147], v[60:63], a[244:247], v[144:147]
    ds_read_b128 v[96:99], v13 offset:24576
    v_mfma_f32_16x16x32_bf16 v[144:147], v[64:67], a[252:255], v[144:147]
    s_waitcnt lgkmcnt(6)
    v_mfma_f32_16x16x32_bf16 v[148:151], v[68:71], a[224:227], v[148:151]
    ds_read_b128 v[52:55], v13 offset:1024
    v_mfma_f32_16x16x32_bf16 v[148:151], v[72:75], a[232:235], v[148:151]
    s_waitcnt lgkmcnt(5)
    v_mfma_f32_16x16x32_bf16 v[148:151], v[76:79], a[240:243], v[148:151]
    ds_read_b128 v[56:59], v13 offset:9216
    v_mfma_f32_16x16x32_bf16 v[148:151], v[80:83], a[248:251], v[148:151]
    v_mfma_f32_16x16x32_bf16 v[152:155], v[68:71], a[228:231], v[152:155]
    ds_read_b128 v[60:63], v13 offset:17408
    v_mfma_f32_16x16x32_bf16 v[152:155], v[72:75], a[236:239], v[152:155]
    v_mfma_f32_16x16x32_bf16 v[152:155], v[76:79], a[244:247], v[152:155]
    ds_read_b128 v[64:67], v13 offset:25600
    v_mfma_f32_16x16x32_bf16 v[152:155], v[80:83], a[252:255], v[152:155]
    s_waitcnt lgkmcnt(6)
    v_mfma_f32_16x16x32_bf16 v[100:103], v[84:87], v[20:23], v[100:103]
    ds_read_b128 v[68:71], v13 offset:2048
    v_mfma_f32_16x16x32_bf16 v[100:103], v[88:91], v[28:31], v[100:103]
    s_add_u32 m0, s31, 110592
    s_waitcnt lgkmcnt(5)
    v_mfma_f32_16x16x32_bf16 v[100:103], v[92:95], v[36:39], v[100:103]
    ds_read_b128 v[72:75], v13 offset:10240
    v_mfma_f32_16x16x32_bf16 v[100:103], v[96:99], v[44:47], v[100:103]
    buffer_load_dwordx4 v240, s[16:19], s57 offen offset:0 lds
    v_mfma_f32_16x16x32_bf16 v[104:107], v[84:87], v[24:27], v[104:107]
    ds_read_b128 v[76:79], v13 offset:18432
    v_mfma_f32_16x16x32_bf16 v[104:107], v[88:91], v[32:35], v[104:107]
    v_mfma_f32_16x16x32_bf16 v[104:107], v[92:95], v[40:43], v[104:107]
    ds_read_b128 v[80:83], v13 offset:26624
    v_mfma_f32_16x16x32_bf16 v[104:107], v[96:99], v[48:51], v[104:107]
    buffer_load_dwordx4 v240, s[16:19], s58 offen offset:1024 lds
    s_waitcnt lgkmcnt(6)
    v_mfma_f32_16x16x32_bf16 v[108:111], v[52:55], v[20:23], v[108:111]
    ds_read_b128 v[84:87], v13 offset:3072
    v_mfma_f32_16x16x32_bf16 v[108:111], v[56:59], v[28:31], v[108:111]
    v_add_u32 v240, 6144, v1
    s_waitcnt lgkmcnt(5)
    v_mfma_f32_16x16x32_bf16 v[108:111], v[60:63], v[36:39], v[108:111]
    ds_read_b128 v[88:91], v13 offset:11264
    v_mfma_f32_16x16x32_bf16 v[108:111], v[64:67], v[44:47], v[108:111]
    s_add_u32 m0, s31, 122880
    v_mfma_f32_16x16x32_bf16 v[112:115], v[52:55], v[24:27], v[112:115]
    ds_read_b128 v[92:95], v13 offset:19456
    v_mfma_f32_16x16x32_bf16 v[112:115], v[56:59], v[32:35], v[112:115]
    v_mfma_f32_16x16x32_bf16 v[112:115], v[60:63], v[40:43], v[112:115]
    ds_read_b128 v[96:99], v13 offset:27648
    v_mfma_f32_16x16x32_bf16 v[112:115], v[64:67], v[48:51], v[112:115]
    buffer_load_dwordx4 v240, s[16:19], s57 offen offset:0 lds
    s_waitcnt lgkmcnt(6)
    v_mfma_f32_16x16x32_bf16 v[116:119], v[68:71], v[20:23], v[116:119]
    ds_read_b128 v[52:55], v13 offset:4096
    v_mfma_f32_16x16x32_bf16 v[116:119], v[72:75], v[28:31], v[116:119]
    buffer_load_dwordx4 v240, s[16:19], s58 offen offset:1024 lds
    s_waitcnt lgkmcnt(5)
    v_mfma_f32_16x16x32_bf16 v[116:119], v[76:79], v[36:39], v[116:119]
    ds_read_b128 v[56:59], v13 offset:12288
    v_mfma_f32_16x16x32_bf16 v[116:119], v[80:83], v[44:47], v[116:119]
    v_add_u32 v240, 7168, v1
    v_mfma_f32_16x16x32_bf16 v[120:123], v[68:71], v[24:27], v[120:123]
    ds_read_b128 v[60:63], v13 offset:20480
    v_mfma_f32_16x16x32_bf16 v[120:123], v[72:75], v[32:35], v[120:123]
    s_add_u32 m0, s31, 135168
    v_mfma_f32_16x16x32_bf16 v[120:123], v[76:79], v[40:43], v[120:123]
    ds_read_b128 v[64:67], v13 offset:28672
    v_mfma_f32_16x16x32_bf16 v[120:123], v[80:83], v[48:51], v[120:123]
    buffer_load_dwordx4 v240, s[16:19], s57 offen offset:0 lds
    s_waitcnt lgkmcnt(6)
    v_mfma_f32_16x16x32_bf16 v[124:127], v[84:87], v[20:23], v[124:127]
    ds_read_b128 v[68:71], v13 offset:5120
    v_mfma_f32_16x16x32_bf16 v[124:127], v[88:91], v[28:31], v[124:127]
    buffer_load_dwordx4 v240, s[16:19], s58 offen offset:1024 lds
    s_waitcnt lgkmcnt(5)
    v_mfma_f32_16x16x32_bf16 v[124:127], v[92:95], v[36:39], v[124:127]
    ds_read_b128 v[72:75], v13 offset:13312
    v_mfma_f32_16x16x32_bf16 v[124:127], v[96:99], v[44:47], v[124:127]
    v_add_u32 v240, 3072, v1
    v_mfma_f32_16x16x32_bf16 v[128:131], v[84:87], v[24:27], v[128:131]
    ds_read_b128 v[76:79], v13 offset:21504
    v_mfma_f32_16x16x32_bf16 v[128:131], v[88:91], v[32:35], v[128:131]
    v_mfma_f32_16x16x32_bf16 v[128:131], v[92:95], v[40:43], v[128:131]
    ds_read_b128 v[80:83], v13 offset:29696
    v_mfma_f32_16x16x32_bf16 v[128:131], v[96:99], v[48:51], v[128:131]
    s_waitcnt lgkmcnt(6)
    v_mfma_f32_16x16x32_bf16 v[132:135], v[52:55], v[20:23], v[132:135]
    ds_read_b128 v[84:87], v13 offset:6144
    v_mfma_f32_16x16x32_bf16 v[132:135], v[56:59], v[28:31], v[132:135]
    s_waitcnt lgkmcnt(5)
    v_mfma_f32_16x16x32_bf16 v[132:135], v[60:63], v[36:39], v[132:135]
    ds_read_b128 v[88:91], v13 offset:14336
    v_mfma_f32_16x16x32_bf16 v[132:135], v[64:67], v[44:47], v[132:135]
    v_mfma_f32_16x16x32_bf16 v[136:139], v[52:55], v[24:27], v[136:139]
    ds_read_b128 v[92:95], v13 offset:22528
    v_mfma_f32_16x16x32_bf16 v[136:139], v[56:59], v[32:35], v[136:139]
    v_mfma_f32_16x16x32_bf16 v[136:139], v[60:63], v[40:43], v[136:139]
    ds_read_b128 v[96:99], v13 offset:30720
    v_mfma_f32_16x16x32_bf16 v[136:139], v[64:67], v[48:51], v[136:139]
    s_waitcnt lgkmcnt(6)
    v_mfma_f32_16x16x32_bf16 v[140:143], v[68:71], v[20:23], v[140:143]
    s_waitcnt vmcnt(6)
    s_barrier
    ds_read_b128 v[52:55], v14 offset:0
    v_mfma_f32_16x16x32_bf16 v[140:143], v[72:75], v[28:31], v[140:143]
    s_add_u32 m0, s31, 0
    s_waitcnt lgkmcnt(5)
    v_mfma_f32_16x16x32_bf16 v[140:143], v[76:79], v[36:39], v[140:143]
    ds_read_b128 v[56:59], v14 offset:3072
    v_mfma_f32_16x16x32_bf16 v[140:143], v[80:83], v[44:47], v[140:143]
    buffer_load_dwordx4 v240, s[16:19], s57 offen offset:0 lds
    v_mfma_f32_16x16x32_bf16 v[144:147], v[68:71], v[24:27], v[144:147]
    ds_read_b128 v[60:63], v14 offset:6144
    v_mfma_f32_16x16x32_bf16 v[144:147], v[72:75], v[32:35], v[144:147]
    v_mfma_f32_16x16x32_bf16 v[144:147], v[76:79], v[40:43], v[144:147]
    ds_read_b128 v[64:67], v14 offset:9216
    v_mfma_f32_16x16x32_bf16 v[144:147], v[80:83], v[48:51], v[144:147]
    buffer_load_dwordx4 v240, s[16:19], s58 offen offset:1024 lds
    s_waitcnt lgkmcnt(6)
    v_mfma_f32_16x16x32_bf16 v[148:151], v[84:87], v[20:23], v[148:151]
    ds_read_b128 v[68:71], v14 offset:12288
    v_mfma_f32_16x16x32_bf16 v[148:151], v[88:91], v[28:31], v[148:151]
    v_add_u32 v240, 4096, v1
    s_waitcnt lgkmcnt(5)
    v_mfma_f32_16x16x32_bf16 v[148:151], v[92:95], v[36:39], v[148:151]
    ds_read_b128 v[72:75], v14 offset:15360
    v_mfma_f32_16x16x32_bf16 v[148:151], v[96:99], v[44:47], v[148:151]
    s_add_u32 m0, s31, 12288
    v_mfma_f32_16x16x32_bf16 v[152:155], v[84:87], v[24:27], v[152:155]
    ds_read_b128 v[76:79], v14 offset:18432
    v_mfma_f32_16x16x32_bf16 v[152:155], v[88:91], v[32:35], v[152:155]
    v_mfma_f32_16x16x32_bf16 v[152:155], v[92:95], v[40:43], v[152:155]
    ds_read_b128 v[80:83], v14 offset:21504
    v_mfma_f32_16x16x32_bf16 v[152:155], v[96:99], v[48:51], v[152:155]
    buffer_load_dwordx4 v240, s[16:19], s57 offen offset:0 lds
    buffer_load_dwordx4 v240, s[16:19], s58 offen offset:1024 lds
    v_add_u32 v240, 8192, v1
    s_add_u32 m0, s31, 24576
    s_nop 0
    buffer_load_dwordx4 v240, s[16:19], s57 offen offset:0 lds
    buffer_load_dwordx4 v240, s[16:19], s58 offen offset:1024 lds
    v_add_u32 v240, 0, v1
    v_cvt_pk_bf16_f32 v172, v100, v101
    v_cvt_pk_bf16_f32 v173, v102, v103
    v_cvt_pk_bf16_f32 v174, v104, v105
    v_cvt_pk_bf16_f32 v175, v106, v107
    buffer_store_dwordx4 v[172:175], v1, s[16:19], s20 offen sc1
    v_cvt_pk_bf16_f32 v176, v108, v109
    v_cvt_pk_bf16_f32 v177, v110, v111
    v_cvt_pk_bf16_f32 v178, v112, v113
    v_cvt_pk_bf16_f32 v179, v114, v115
    buffer_store_dwordx4 v[176:179], v1, s[16:19], s21 offen sc1
    v_cvt_pk_bf16_f32 v180, v116, v117
    v_cvt_pk_bf16_f32 v181, v118, v119
    v_cvt_pk_bf16_f32 v182, v120, v121
    v_cvt_pk_bf16_f32 v183, v122, v123
    buffer_store_dwordx4 v[180:183], v1, s[16:19], s22 offen sc1
    v_cvt_pk_bf16_f32 v184, v124, v125
    v_cvt_pk_bf16_f32 v185, v126, v127
    v_cvt_pk_bf16_f32 v186, v128, v129
    v_cvt_pk_bf16_f32 v187, v130, v131
    buffer_store_dwordx4 v[184:187], v1, s[16:19], s23 offen sc1
    v_cvt_pk_bf16_f32 v188, v132, v133
    v_cvt_pk_bf16_f32 v189, v134, v135
    v_cvt_pk_bf16_f32 v190, v136, v137
    v_cvt_pk_bf16_f32 v191, v138, v139
    buffer_store_dwordx4 v[188:191], v1, s[16:19], s24 offen sc1
    v_cvt_pk_bf16_f32 v192, v140, v141
    v_cvt_pk_bf16_f32 v193, v142, v143
    v_cvt_pk_bf16_f32 v194, v144, v145
    v_cvt_pk_bf16_f32 v195, v146, v147
    buffer_store_dwordx4 v[192:195], v1, s[16:19], s25 offen sc1
    v_cvt_pk_bf16_f32 v196, v148, v149
    v_cvt_pk_bf16_f32 v197, v150, v151
    v_cvt_pk_bf16_f32 v198, v152, v153
    v_cvt_pk_bf16_f32 v199, v154, v155
    buffer_store_dwordx4 v[196:199], v1, s[16:19], s26 offen sc1
    s_waitcnt lgkmcnt(6)
    v_mfma_f32_16x16x32_bf16 v[156:159], v[52:55], a[0:3], 0
    ds_read_b128 v[84:87], v14 offset:24576
    v_mfma_f32_16x16x32_bf16 v[156:159], v[56:59], a[8:11], v[156:159]
    s_waitcnt lgkmcnt(5)
    v_mfma_f32_16x16x32_bf16 v[156:159], v[60:63], a[16:19], v[156:159]
    ds_read_b128 v[88:91], v14 offset:27648
    v_mfma_f32_16x16x32_bf16 v[156:159], v[64:67], a[24:27], v[156:159]
    v_mfma_f32_16x16x32_bf16 v[160:163], v[52:55], a[4:7], 0
    ds_read_b128 v[92:95], v14 offset:30720
    v_mfma_f32_16x16x32_bf16 v[160:163], v[56:59], a[12:15], v[160:163]
    v_mfma_f32_16x16x32_bf16 v[160:163], v[60:63], a[20:23], v[160:163]
    ds_read_b128 v[96:99], v14 offset:33792
    v_mfma_f32_16x16x32_bf16 v[160:163], v[64:67], a[28:31], v[160:163]
    s_waitcnt lgkmcnt(6)
    v_mfma_f32_16x16x32_bf16 v[156:159], v[68:71], a[32:35], v[156:159]
    ds_read_b128 v[52:55], v14 offset:1024
    v_mfma_f32_16x16x32_bf16 v[156:159], v[72:75], a[40:43], v[156:159]
    s_waitcnt lgkmcnt(5)
    v_mfma_f32_16x16x32_bf16 v[156:159], v[76:79], a[48:51], v[156:159]
    ds_read_b128 v[56:59], v14 offset:4096
    v_mfma_f32_16x16x32_bf16 v[156:159], v[80:83], a[56:59], v[156:159]
    v_mfma_f32_16x16x32_bf16 v[160:163], v[68:71], a[36:39], v[160:163]
    ds_read_b128 v[60:63], v14 offset:7168
    v_mfma_f32_16x16x32_bf16 v[160:163], v[72:75], a[44:47], v[160:163]
    v_mfma_f32_16x16x32_bf16 v[160:163], v[76:79], a[52:55], v[160:163]
    ds_read_b128 v[64:67], v14 offset:10240
    v_mfma_f32_16x16x32_bf16 v[160:163], v[80:83], a[60:63], v[160:163]
    s_waitcnt lgkmcnt(6)
    v_mfma_f32_16x16x32_bf16 v[156:159], v[84:87], a[64:67], v[156:159]
    ds_read_b128 v[68:71], v14 offset:13312
    v_mfma_f32_16x16x32_bf16 v[156:159], v[88:91], a[72:75], v[156:159]
    s_waitcnt lgkmcnt(5)
    v_mfma_f32_16x16x32_bf16 v[156:159], v[92:95], a[80:83], v[156:159]
    ds_read_b128 v[72:75], v14 offset:16384
    v_mfma_f32_16x16x32_bf16 v[156:159], v[96:99], a[88:91], v[156:159]
    v_mfma_f32_16x16x32_bf16 v[160:163], v[84:87], a[68:71], v[160:163]
    ds_read_b128 v[76:79], v14 offset:19456
    v_mfma_f32_16x16x32_bf16 v[160:163], v[88:91], a[76:79], v[160:163]
    v_mfma_f32_16x16x32_bf16 v[160:163], v[92:95], a[84:87], v[160:163]
    ds_read_b128 v[80:83], v14 offset:22528
    v_mfma_f32_16x16x32_bf16 v[160:163], v[96:99], a[92:95], v[160:163]
    s_waitcnt lgkmcnt(6)
    v_mfma_f32_16x16x32_bf16 v[164:167], v[52:55], a[0:3], 0
    ds_read_b128 v[84:87], v14 offset:25600
    v_mfma_f32_16x16x32_bf16 v[164:167], v[56:59], a[8:11], v[164:167]
    s_waitcnt lgkmcnt(5)
    v_mfma_f32_16x16x32_bf16 v[164:167], v[60:63], a[16:19], v[164:167]
    ds_read_b128 v[88:91], v14 offset:28672
    v_mfma_f32_16x16x32_bf16 v[164:167], v[64:67], a[24:27], v[164:167]
    v_mfma_f32_16x16x32_bf16 v[168:171], v[52:55], a[4:7], 0
    ds_read_b128 v[92:95], v14 offset:31744
    v_mfma_f32_16x16x32_bf16 v[168:171], v[56:59], a[12:15], v[168:171]
    v_mfma_f32_16x16x32_bf16 v[168:171], v[60:63], a[20:23], v[168:171]
    ds_read_b128 v[96:99], v14 offset:34816
    v_mfma_f32_16x16x32_bf16 v[168:171], v[64:67], a[28:31], v[168:171]
    s_waitcnt lgkmcnt(6)
    v_mfma_f32_16x16x32_bf16 v[164:167], v[68:71], a[32:35], v[164:167]
    s_waitcnt vmcnt(13)
    s_barrier
    ds_read_b128 v[52:55], v15 offset:0
    v_mfma_f32_16x16x32_bf16 v[164:167], v[72:75], a[40:43], v[164:167]
    s_waitcnt lgkmcnt(5)
    v_mfma_f32_16x16x32_bf16 v[164:167], v[76:79], a[48:51], v[164:167]
    ds_read_b128 v[56:59], v15 offset:3072
    v_mfma_f32_16x16x32_bf16 v[164:167], v[80:83], a[56:59], v[164:167]
    v_mfma_f32_16x16x32_bf16 v[168:171], v[68:71], a[36:39], v[168:171]
    ds_read_b128 v[60:63], v15 offset:6144
    v_mfma_f32_16x16x32_bf16 v[168:171], v[72:75], a[44:47], v[168:171]
    v_mfma_f32_16x16x32_bf16 v[168:171], v[76:79], a[52:55], v[168:171]
    ds_read_b128 v[64:67], v15 offset:9216
    v_mfma_f32_16x16x32_bf16 v[168:171], v[80:83], a[60:63], v[168:171]
    s_waitcnt lgkmcnt(6)
    v_mfma_f32_16x16x32_bf16 v[164:167], v[84:87], a[64:67], v[164:167]
    ds_read_b128 v[68:71], v15 offset:12288
    v_mfma_f32_16x16x32_bf16 v[164:167], v[88:91], a[72:75], v[164:167]
    s_waitcnt lgkmcnt(5)
    v_mfma_f32_16x16x32_bf16 v[164:167], v[92:95], a[80:83], v[164:167]
    ds_read_b128 v[72:75], v15 offset:15360
    v_mfma_f32_16x16x32_bf16 v[164:167], v[96:99], a[88:91], v[164:167]
    v_mfma_f32_16x16x32_bf16 v[168:171], v[84:87], a[68:71], v[168:171]
    ds_read_b128 v[76:79], v15 offset:18432
    v_mfma_f32_16x16x32_bf16 v[168:171], v[88:91], a[76:79], v[168:171]
    v_mfma_f32_16x16x32_bf16 v[168:171], v[92:95], a[84:87], v[168:171]
    ds_read_b128 v[80:83], v15 offset:21504
    v_mfma_f32_16x16x32_bf16 v[168:171], v[96:99], a[92:95], v[168:171]
    s_waitcnt lgkmcnt(6)
    v_mfma_f32_16x16x32_bf16 v[156:159], v[52:55], a[96:99], v[156:159]
    ds_read_b128 v[84:87], v15 offset:24576
    v_mfma_f32_16x16x32_bf16 v[156:159], v[56:59], a[104:107], v[156:159]
    s_waitcnt lgkmcnt(5)
    v_mfma_f32_16x16x32_bf16 v[156:159], v[60:63], a[112:115], v[156:159]
    ds_read_b128 v[88:91], v15 offset:27648
    v_mfma_f32_16x16x32_bf16 v[156:159], v[64:67], a[120:123], v[156:159]
    v_mfma_f32_16x16x32_bf16 v[160:163], v[52:55], a[100:103], v[160:163]
    ds_read_b128 v[92:95], v15 offset:30720
    v_mfma_f32_16x16x32_bf16 v[160:163], v[56:59], a[108:111], v[160:163]
    v_mfma_f32_16x16x32_bf16 v[160:163], v[60:63], a[116:119], v[160:163]
    ds_read_b128 v[96:99], v15 offset:33792
    v_mfma_f32_16x16x32_bf16 v[160:163], v[64:67], a[124:127], v[160:163]
    s_waitcnt lgkmcnt(6)
    v_mfma_f32_16x16x32_bf16 v[156:159], v[68:71], a[128:131], v[156:159]
    ds_read_b128 v[52:55], v15 offset:1024
    v_mfma_f32_16x16x32_bf16 v[156:159], v[72:75], a[136:139], v[156:159]
    s_waitcnt lgkmcnt(5)
    v_mfma_f32_16x16x32_bf16 v[156:159], v[76:79], a[144:147], v[156:159]
    ds_read_b128 v[56:59], v15 offset:4096
    v_mfma_f32_16x16x32_bf16 v[156:159], v[80:83], a[152:155], v[156:159]
    v_mfma_f32_16x16x32_bf16 v[160:163], v[68:71], a[132:135], v[160:163]
    ds_read_b128 v[60:63], v15 offset:7168
    v_mfma_f32_16x16x32_bf16 v[160:163], v[72:75], a[140:143], v[160:163]
    v_mfma_f32_16x16x32_bf16 v[160:163], v[76:79], a[148:151], v[160:163]
    ds_read_b128 v[64:67], v15 offset:10240
    v_mfma_f32_16x16x32_bf16 v[160:163], v[80:83], a[156:159], v[160:163]
    s_waitcnt lgkmcnt(6)
    v_mfma_f32_16x16x32_bf16 v[156:159], v[84:87], a[160:163], v[156:159]
    ds_read_b128 v[68:71], v15 offset:13312
    v_mfma_f32_16x16x32_bf16 v[156:159], v[88:91], a[168:171], v[156:159]
    s_waitcnt lgkmcnt(5)
    v_mfma_f32_16x16x32_bf16 v[156:159], v[92:95], a[176:179], v[156:159]
    ds_read_b128 v[72:75], v15 offset:16384
    v_mfma_f32_16x16x32_bf16 v[156:159], v[96:99], a[184:187], v[156:159]
    v_mfma_f32_16x16x32_bf16 v[160:163], v[84:87], a[164:167], v[160:163]
    ds_read_b128 v[76:79], v15 offset:19456
    v_mfma_f32_16x16x32_bf16 v[160:163], v[88:91], a[172:175], v[160:163]
    v_mfma_f32_16x16x32_bf16 v[160:163], v[92:95], a[180:183], v[160:163]
    ds_read_b128 v[80:83], v15 offset:22528
    v_mfma_f32_16x16x32_bf16 v[160:163], v[96:99], a[188:191], v[160:163]
    s_waitcnt lgkmcnt(6)
    v_mfma_f32_16x16x32_bf16 v[164:167], v[52:55], a[96:99], v[164:167]
    ds_read_b128 v[84:87], v15 offset:25600
    v_mfma_f32_16x16x32_bf16 v[164:167], v[56:59], a[104:107], v[164:167]
    s_waitcnt lgkmcnt(5)
    v_mfma_f32_16x16x32_bf16 v[164:167], v[60:63], a[112:115], v[164:167]
    ds_read_b128 v[88:91], v15 offset:28672
    v_mfma_f32_16x16x32_bf16 v[164:167], v[64:67], a[120:123], v[164:167]
    v_mfma_f32_16x16x32_bf16 v[168:171], v[52:55], a[100:103], v[168:171]
    ds_read_b128 v[92:95], v15 offset:31744
    v_mfma_f32_16x16x32_bf16 v[168:171], v[56:59], a[108:111], v[168:171]
    v_mfma_f32_16x16x32_bf16 v[168:171], v[60:63], a[116:119], v[168:171]
    ds_read_b128 v[96:99], v15 offset:34816
    v_mfma_f32_16x16x32_bf16 v[168:171], v[64:67], a[124:127], v[168:171]
    s_waitcnt lgkmcnt(6)
    v_mfma_f32_16x16x32_bf16 v[164:167], v[68:71], a[128:131], v[164:167]
    s_waitcnt vmcnt(7)
    s_barrier
    ds_read_b128 v[52:55], v12 offset:0
    v_mfma_f32_16x16x32_bf16 v[164:167], v[72:75], a[136:139], v[164:167]
    s_waitcnt lgkmcnt(5)
    v_mfma_f32_16x16x32_bf16 v[164:167], v[76:79], a[144:147], v[164:167]
    ds_read_b128 v[56:59], v12 offset:3072
    v_mfma_f32_16x16x32_bf16 v[164:167], v[80:83], a[152:155], v[164:167]
    v_mfma_f32_16x16x32_bf16 v[168:171], v[68:71], a[132:135], v[168:171]
    ds_read_b128 v[60:63], v12 offset:6144
    v_mfma_f32_16x16x32_bf16 v[168:171], v[72:75], a[140:143], v[168:171]
    v_mfma_f32_16x16x32_bf16 v[168:171], v[76:79], a[148:151], v[168:171]
    ds_read_b128 v[64:67], v12 offset:9216
    v_mfma_f32_16x16x32_bf16 v[168:171], v[80:83], a[156:159], v[168:171]
    s_waitcnt lgkmcnt(6)
    v_mfma_f32_16x16x32_bf16 v[164:167], v[84:87], a[160:163], v[164:167]
    ds_read_b128 v[68:71], v12 offset:12288
    v_mfma_f32_16x16x32_bf16 v[164:167], v[88:91], a[168:171], v[164:167]
    s_waitcnt lgkmcnt(5)
    v_mfma_f32_16x16x32_bf16 v[164:167], v[92:95], a[176:179], v[164:167]
    ds_read_b128 v[72:75], v12 offset:15360
    v_mfma_f32_16x16x32_bf16 v[164:167], v[96:99], a[184:187], v[164:167]
    v_mfma_f32_16x16x32_bf16 v[168:171], v[84:87], a[164:167], v[168:171]
    ds_read_b128 v[76:79], v12 offset:18432
    v_mfma_f32_16x16x32_bf16 v[168:171], v[88:91], a[172:175], v[168:171]
    v_mfma_f32_16x16x32_bf16 v[168:171], v[92:95], a[180:183], v[168:171]
    ds_read_b128 v[80:83], v12 offset:21504
    v_mfma_f32_16x16x32_bf16 v[168:171], v[96:99], a[188:191], v[168:171]
    s_waitcnt vmcnt(0)
    buffer_store_dword v242, v241, s[16:19], s48 offen sc1
    s_waitcnt lgkmcnt(6)
    v_mfma_f32_16x16x32_bf16 v[156:159], v[52:55], a[192:195], v[156:159]
    ds_read_b128 v[84:87], v12 offset:24576
    v_mfma_f32_16x16x32_bf16 v[156:159], v[56:59], a[200:203], v[156:159]
    buffer_load_dwordx2 v[208:209], v5, s[16:19], s32 offen offset:0 sc1
    s_waitcnt lgkmcnt(5)
    v_mfma_f32_16x16x32_bf16 v[156:159], v[60:63], a[208:211], v[156:159]
    ds_read_b128 v[88:91], v12 offset:27648
    v_mfma_f32_16x16x32_bf16 v[156:159], v[64:67], a[216:219], v[156:159]
    buffer_load_dwordx2 v[210:211], v5, s[16:19], s32 offen offset:256 sc1
    v_mfma_f32_16x16x32_bf16 v[160:163], v[52:55], a[196:199], v[160:163]
    ds_read_b128 v[92:95], v12 offset:30720
    v_mfma_f32_16x16x32_bf16 v[160:163], v[56:59], a[204:207], v[160:163]
    v_mfma_f32_16x16x32_bf16 v[160:163], v[60:63], a[212:215], v[160:163]
    ds_read_b128 v[96:99], v12 offset:33792
    v_mfma_f32_16x16x32_bf16 v[160:163], v[64:67], a[220:223], v[160:163]
    buffer_load_dwordx4 v[220:223], v6, s[16:19], s33 offen offset:0
    s_waitcnt lgkmcnt(6)
    v_mfma_f32_16x16x32_bf16 v[156:159], v[68:71], a[224:227], v[156:159]
    ds_read_b128 v[52:55], v12 offset:1024
    v_mfma_f32_16x16x32_bf16 v[156:159], v[72:75], a[232:235], v[156:159]
    buffer_load_dwordx2 v[212:213], v5, s[16:19], s32 offen offset:1024 sc1
    s_waitcnt lgkmcnt(5)
    v_mfma_f32_16x16x32_bf16 v[156:159], v[76:79], a[240:243], v[156:159]
    ds_read_b128 v[56:59], v12 offset:4096
    v_mfma_f32_16x16x32_bf16 v[156:159], v[80:83], a[248:251], v[156:159]
    buffer_load_dwordx2 v[214:215], v5, s[16:19], s32 offen offset:1280 sc1
    v_mfma_f32_16x16x32_bf16 v[160:163], v[68:71], a[228:231], v[160:163]
    ds_read_b128 v[60:63], v12 offset:7168
    v_mfma_f32_16x16x32_bf16 v[160:163], v[72:75], a[236:239], v[160:163]
    v_mfma_f32_16x16x32_bf16 v[160:163], v[76:79], a[244:247], v[160:163]
    ds_read_b128 v[64:67], v12 offset:10240
    v_mfma_f32_16x16x32_bf16 v[160:163], v[80:83], a[252:255], v[160:163]
    buffer_load_dwordx4 v[224:227], v6, s[16:19], s33 offen offset:64
    s_waitcnt lgkmcnt(6)
    v_mfma_f32_16x16x32_bf16 v[156:159], v[84:87], v[20:23], v[156:159]
    ds_read_b128 v[68:71], v12 offset:13312
    v_mfma_f32_16x16x32_bf16 v[156:159], v[88:91], v[28:31], v[156:159]
    s_waitcnt lgkmcnt(5)
    v_mfma_f32_16x16x32_bf16 v[156:159], v[92:95], v[36:39], v[156:159]
    ds_read_b128 v[72:75], v12 offset:16384
    v_mfma_f32_16x16x32_bf16 v[156:159], v[96:99], v[44:47], v[156:159]
    v_mfma_f32_16x16x32_bf16 v[160:163], v[84:87], v[24:27], v[160:163]
    ds_read_b128 v[76:79], v12 offset:19456
    v_mfma_f32_16x16x32_bf16 v[160:163], v[88:91], v[32:35], v[160:163]
    v_mfma_f32_16x16x32_bf16 v[160:163], v[92:95], v[40:43], v[160:163]
    ds_read_b128 v[80:83], v12 offset:22528
    v_mfma_f32_16x16x32_bf16 v[160:163], v[96:99], v[48:51], v[160:163]
    s_waitcnt lgkmcnt(6)
    v_mfma_f32_16x16x32_bf16 v[164:167], v[52:55], a[192:195], v[164:167]
    ds_read_b128 v[84:87], v12 offset:25600
    v_mfma_f32_16x16x32_bf16 v[164:167], v[56:59], a[200:203], v[164:167]
    s_waitcnt lgkmcnt(5)
    v_mfma_f32_16x16x32_bf16 v[164:167], v[60:63], a[208:211], v[164:167]
    ds_read_b128 v[88:91], v12 offset:28672
    v_mfma_f32_16x16x32_bf16 v[164:167], v[64:67], a[216:219], v[164:167]
    v_mfma_f32_16x16x32_bf16 v[168:171], v[52:55], a[196:199], v[168:171]
    ds_read_b128 v[92:95], v12 offset:31744
    v_mfma_f32_16x16x32_bf16 v[168:171], v[56:59], a[204:207], v[168:171]
    v_mfma_f32_16x16x32_bf16 v[168:171], v[60:63], a[212:215], v[168:171]
    ds_read_b128 v[96:99], v12 offset:34816
    v_mfma_f32_16x16x32_bf16 v[168:171], v[64:67], a[220:223], v[168:171]
    s_waitcnt lgkmcnt(6)
    v_mfma_f32_16x16x32_bf16 v[164:167], v[68:71], a[224:227], v[164:167]
    v_mfma_f32_16x16x32_bf16 v[164:167], v[72:75], a[232:235], v[164:167]
    s_waitcnt lgkmcnt(4)
    v_mfma_f32_16x16x32_bf16 v[164:167], v[76:79], a[240:243], v[164:167]
    v_mfma_f32_16x16x32_bf16 v[164:167], v[80:83], a[248:251], v[164:167]
    v_mfma_f32_16x16x32_bf16 v[168:171], v[68:71], a[228:231], v[168:171]
    v_mfma_f32_16x16x32_bf16 v[168:171], v[72:75], a[236:239], v[168:171]
    v_mfma_f32_16x16x32_bf16 v[168:171], v[76:79], a[244:247], v[168:171]
    v_mfma_f32_16x16x32_bf16 v[168:171], v[80:83], a[252:255], v[168:171]
    s_waitcnt lgkmcnt(2)
    v_mfma_f32_16x16x32_bf16 v[164:167], v[84:87], v[20:23], v[164:167]
    v_mfma_f32_16x16x32_bf16 v[164:167], v[88:91], v[28:31], v[164:167]
    s_waitcnt lgkmcnt(0)
    v_mfma_f32_16x16x32_bf16 v[164:167], v[92:95], v[36:39], v[164:167]
    v_mfma_f32_16x16x32_bf16 v[164:167], v[96:99], v[44:47], v[164:167]
    v_mfma_f32_16x16x32_bf16 v[168:171], v[84:87], v[24:27], v[168:171]
    v_mfma_f32_16x16x32_bf16 v[168:171], v[88:91], v[32:35], v[168:171]
    v_mfma_f32_16x16x32_bf16 v[168:171], v[92:95], v[40:43], v[168:171]
    v_mfma_f32_16x16x32_bf16 v[168:171], v[96:99], v[48:51], v[168:171]
    s_mov_b32 s43, 262144
K456_C7_P3:
    buffer_load_dword v16, v4, s[16:19], s49 offen sc1
    s_waitcnt vmcnt(0)
    v_cmp_eq_u32 vcc, 0, v16
    s_cbranch_vccz K456_C7_P3_X
    s_sub_u32 s43, s43, 1
    s_cbranch_scc0 K456_C7_P3
K456_C7_P3_X:
    buffer_load_dwordx4 v[172:175], v1, s[16:19], s27 offen offset:0 sc1
    buffer_load_dwordx4 v[176:179], v1, s[16:19], s27 offen offset:1024 sc1
    buffer_load_dwordx4 v[180:183], v1, s[16:19], s27 offen offset:2048 sc1
    buffer_load_dwordx4 v[184:187], v1, s[16:19], s28 offen offset:0 sc1
    buffer_load_dwordx4 v[188:191], v1, s[16:19], s28 offen offset:1024 sc1
    buffer_load_dwordx4 v[192:195], v1, s[16:19], s28 offen offset:2048 sc1
    v_lshlrev_b32 v52, 16, v208
    v_and_b32 v53, 0xffff0000, v208
    v_lshlrev_b32 v54, 16, v209
    v_and_b32 v55, 0xffff0000, v209
    v_lshlrev_b32 v56, 16, v210
    v_and_b32 v57, 0xffff0000, v210
    v_lshlrev_b32 v58, 16, v211
    v_and_b32 v59, 0xffff0000, v211
    v_lshlrev_b32 v60, 16, v212
    v_and_b32 v61, 0xffff0000, v212
    v_lshlrev_b32 v62, 16, v213
    v_and_b32 v63, 0xffff0000, v213
    v_lshlrev_b32 v64, 16, v214
    v_and_b32 v65, 0xffff0000, v214
    v_lshlrev_b32 v66, 16, v215
    v_and_b32 v67, 0xffff0000, v215
    s_waitcnt vmcnt(3)
    v_dot2_f32_bf16 v156, v172, v9, v156
    v_dot2_f32_bf16 v157, v172, v10, v157
    v_dot2_f32_bf16 v158, v173, v9, v158
    v_dot2_f32_bf16 v159, v173, v10, v159
    v_dot2_f32_bf16 v160, v174, v9, v160
    v_dot2_f32_bf16 v161, v174, v10, v161
    v_dot2_f32_bf16 v162, v175, v9, v162
    v_dot2_f32_bf16 v163, v175, v10, v163
    v_dot2_f32_bf16 v156, v176, v9, v156
    v_dot2_f32_bf16 v157, v176, v10, v157
    v_dot2_f32_bf16 v158, v177, v9, v158
    v_dot2_f32_bf16 v159, v177, v10, v159
    v_dot2_f32_bf16 v160, v178, v9, v160
    v_dot2_f32_bf16 v161, v178, v10, v161
    v_dot2_f32_bf16 v162, v179, v9, v162
    v_dot2_f32_bf16 v163, v179, v10, v163
    v_dot2_f32_bf16 v156, v180, v9, v156
    v_dot2_f32_bf16 v157, v180, v10, v157
    v_dot2_f32_bf16 v158, v181, v9, v158
    v_dot2_f32_bf16 v159, v181, v10, v159
    v_dot2_f32_bf16 v160, v182, v9, v160
    v_dot2_f32_bf16 v161, v182, v10, v161
    v_dot2_f32_bf16 v162, v183, v9, v162
    v_dot2_f32_bf16 v163, v183, v10, v163
    v_fmac_f32 v52, v220, v156
    v_fmac_f32 v53, v221, v157
    v_fmac_f32 v54, v222, v158
    v_fmac_f32 v55, v223, v159
    v_fmac_f32 v56, v220, v160
    v_fmac_f32 v57, v221, v161
    v_fmac_f32 v58, v222, v162
    v_fmac_f32 v59, v223, v163
    v_cvt_pk_bf16_f32 v208, v52, v53
    v_cvt_pk_bf16_f32 v209, v54, v55
    buffer_store_dwordx2 v[208:209], v11, s[12:15], s34 offen offset:0
    v_cvt_pk_bf16_f32 v210, v56, v57
    v_cvt_pk_bf16_f32 v211, v58, v59
    buffer_store_dwordx2 v[210:211], v11, s[12:15], s35 offen offset:0
    s_waitcnt vmcnt(2)
    v_dot2_f32_bf16 v164, v184, v9, v164
    v_dot2_f32_bf16 v165, v184, v10, v165
    v_dot2_f32_bf16 v166, v185, v9, v166
    v_dot2_f32_bf16 v167, v185, v10, v167
    v_dot2_f32_bf16 v168, v186, v9, v168
    v_dot2_f32_bf16 v169, v186, v10, v169
    v_dot2_f32_bf16 v170, v187, v9, v170
    v_dot2_f32_bf16 v171, v187, v10, v171
    v_dot2_f32_bf16 v164, v188, v9, v164
    v_dot2_f32_bf16 v165, v188, v10, v165
    v_dot2_f32_bf16 v166, v189, v9, v166
    v_dot2_f32_bf16 v167, v189, v10, v167
    v_dot2_f32_bf16 v168, v190, v9, v168
    v_dot2_f32_bf16 v169, v190, v10, v169
    v_dot2_f32_bf16 v170, v191, v9, v170
    v_dot2_f32_bf16 v171, v191, v10, v171
    v_dot2_f32_bf16 v164, v192, v9, v164
    v_dot2_f32_bf16 v165, v192, v10, v165
    v_dot2_f32_bf16 v166, v193, v9, v166
    v_dot2_f32_bf16 v167, v193, v10, v167
    v_dot2_f32_bf16 v168, v194, v9, v168
    v_dot2_f32_bf16 v169, v194, v10, v169
    v_dot2_f32_bf16 v170, v195, v9, v170
    v_dot2_f32_bf16 v171, v195, v10, v171
    v_fmac_f32 v60, v224, v164
    v_fmac_f32 v61, v225, v165
    v_fmac_f32 v62, v226, v166
    v_fmac_f32 v63, v227, v167
    v_fmac_f32 v64, v224, v168
    v_fmac_f32 v65, v225, v169
    v_fmac_f32 v66, v226, v170
    v_fmac_f32 v67, v227, v171
    v_cvt_pk_bf16_f32 v212, v60, v61
    v_cvt_pk_bf16_f32 v213, v62, v63
    buffer_store_dwordx2 v[212:213], v11, s[12:15], s34 offen offset:32
    v_cvt_pk_bf16_f32 v214, v64, v65
    v_cvt_pk_bf16_f32 v215, v66, v67
    buffer_store_dwordx2 v[214:215], v11, s[12:15], s35 offen offset:32
    s_branch K456_END
K456_S0:
    v_and_b32 v7, 15, v4
    v_lshrrev_b32 v8, 4, v4
    v_lshlrev_b32 v5, 4, v7
    v_and_b32 v9, 1, v8
    v_lshl_add_u32 v5, v9, 9, v5
    v_lshrrev_b32 v9, 1, v8
    v_lshl_add_u32 v5, v9, 3, v5
    v_lshlrev_b32 v6, 4, v8
    v_mul_u32_u24 v11, 1152, v7
    v_lshl_add_u32 v11, v8, 3, v11
    v_and_b32 v4, 3, v4
    v_lshlrev_b32 v4, 7, v4
    v_mov_b32 v9, 0x00003f80
    v_mov_b32 v10, 0x3f800000
    s_barrier
    ds_read_b128 v[52:55], v13 offset:0
    ds_read_b128 v[56:59], v13 offset:8192
    ds_read_b128 v[60:63], v13 offset:16384
    ds_read_b128 v[64:67], v13 offset:24576
    ds_read_b128 v[68:71], v13 offset:1024
    ds_read_b128 v[72:75], v13 offset:9216
    ds_read_b128 v[76:79], v13 offset:17408
    ds_read_b128 v[80:83], v13 offset:25600
    s_waitcnt vmcnt(9)
    s_waitcnt lgkmcnt(6)
    v_mfma_f32_16x16x32_bf16 v[100:103], v[52:55], a[0:3], 0
    ds_read_b128 v[84:87], v13 offset:2048
    v_mfma_f32_16x16x32_bf16 v[100:103], v[56:59], a[8:11], v[100:103]
    s_add_u32 m0, s62, 110592
    s_waitcnt lgkmcnt(5)
    v_mfma_f32_16x16x32_bf16 v[100:103], v[60:63], a[16:19], v[100:103]
    ds_read_b128 v[88:91], v13 offset:10240
    v_mfma_f32_16x16x32_bf16 v[100:103], v[64:67], a[24:27], v[100:103]
    buffer_load_dwordx4 v240, s[16:19], s50 offen offset:0 lds
    v_mfma_f32_16x16x32_bf16 v[104:107], v[52:55], a[4:7], 0
    ds_read_b128 v[92:95], v13 offset:18432
    v_mfma_f32_16x16x32_bf16 v[104:107], v[56:59], a[12:15], v[104:107]
    s_add_u32 s44, s46, 2048
    v_mfma_f32_16x16x32_bf16 v[104:107], v[60:63], a[20:23], v[104:107]
    ds_read_b128 v[96:99], v13 offset:26624
    v_mfma_f32_16x16x32_bf16 v[104:107], v[64:67], a[28:31], v[104:107]
    s_add_u32 s45, s44, 147456
    s_waitcnt lgkmcnt(6)
    v_mfma_f32_16x16x32_bf16 v[108:111], v[68:71], a[0:3], 0
    ds_read_b128 v[52:55], v13 offset:3072
    v_mfma_f32_16x16x32_bf16 v[108:111], v[72:75], a[8:11], v[108:111]
    buffer_load_dwordx4 a[64:67], v244, s[16:19], s44 offen sc1
    s_waitcnt lgkmcnt(5)
    v_mfma_f32_16x16x32_bf16 v[108:111], v[76:79], a[16:19], v[108:111]
    ds_read_b128 v[56:59], v13 offset:11264
    v_mfma_f32_16x16x32_bf16 v[108:111], v[80:83], a[24:27], v[108:111]
    buffer_load_dwordx4 v240, s[16:19], s51 offen offset:1024 lds
    v_mfma_f32_16x16x32_bf16 v[112:115], v[68:71], a[4:7], 0
    ds_read_b128 v[60:63], v13 offset:19456
    v_mfma_f32_16x16x32_bf16 v[112:115], v[72:75], a[12:15], v[112:115]
    v_mfma_f32_16x16x32_bf16 v[112:115], v[76:79], a[20:23], v[112:115]
    ds_read_b128 v[64:67], v13 offset:27648
    v_mfma_f32_16x16x32_bf16 v[112:115], v[80:83], a[28:31], v[112:115]
    buffer_load_dwordx4 a[68:71], v244, s[16:19], s45 offen sc1
    s_waitcnt lgkmcnt(6)
    v_mfma_f32_16x16x32_bf16 v[116:119], v[84:87], a[0:3], 0
    ds_read_b128 v[68:71], v13 offset:4096
    v_mfma_f32_16x16x32_bf16 v[116:119], v[88:91], a[8:11], v[116:119]
    buffer_load_dwordx4 v240, s[16:19], s52 offen offset:2048 lds
    s_waitcnt lgkmcnt(5)
    v_mfma_f32_16x16x32_bf16 v[116:119], v[92:95], a[16:19], v[116:119]
    ds_read_b128 v[72:75], v13 offset:12288
    v_mfma_f32_16x16x32_bf16 v[116:119], v[96:99], a[24:27], v[116:119]
    buffer_load_dwordx4 a[72:75], v245, s[16:19], s44 offen sc1
    v_mfma_f32_16x16x32_bf16 v[120:123], v[84:87], a[4:7], 0
    ds_read_b128 v[76:79], v13 offset:20480
    v_mfma_f32_16x16x32_bf16 v[120:123], v[88:91], a[12:15], v[120:123]
    v_mfma_f32_16x16x32_bf16 v[120:123], v[92:95], a[20:23], v[120:123]
    ds_read_b128 v[80:83], v13 offset:28672
    v_mfma_f32_16x16x32_bf16 v[120:123], v[96:99], a[28:31], v[120:123]
    buffer_load_dwordx4 v240, s[16:19], s53 offen offset:3072 lds
    s_waitcnt lgkmcnt(6)
    v_mfma_f32_16x16x32_bf16 v[124:127], v[52:55], a[0:3], 0
    ds_read_b128 v[84:87], v13 offset:5120
    v_mfma_f32_16x16x32_bf16 v[124:127], v[56:59], a[8:11], v[124:127]
    buffer_load_dwordx4 a[76:79], v245, s[16:19], s45 offen sc1
    s_waitcnt lgkmcnt(5)
    v_mfma_f32_16x16x32_bf16 v[124:127], v[60:63], a[16:19], v[124:127]
    ds_read_b128 v[88:91], v13 offset:13312
    v_mfma_f32_16x16x32_bf16 v[124:127], v[64:67], a[24:27], v[124:127]
    s_add_u32 m0, s62, 114688
    v_mfma_f32_16x16x32_bf16 v[128:131], v[52:55], a[4:7], 0
    ds_read_b128 v[92:95], v13 offset:21504
    v_mfma_f32_16x16x32_bf16 v[128:131], v[56:59], a[12:15], v[128:131]
    v_mfma_f32_16x16x32_bf16 v[128:131], v[60:63], a[20:23], v[128:131]
    ds_read_b128 v[96:99], v13 offset:29696
    v_mfma_f32_16x16x32_bf16 v[128:131], v[64:67], a[28:31], v[128:131]
    buffer_load_dwordx4 v240, s[16:19], s54 offen offset:0 lds
    s_waitcnt lgkmcnt(6)
    v_mfma_f32_16x16x32_bf16 v[132:135], v[68:71], a[0:3], 0
    ds_read_b128 v[52:55], v14 offset:0
    v_mfma_f32_16x16x32_bf16 v[132:135], v[72:75], a[8:11], v[132:135]
    buffer_load_dwordx4 a[80:83], v246, s[16:19], s44 offen sc1
    s_waitcnt lgkmcnt(5)
    v_mfma_f32_16x16x32_bf16 v[132:135], v[76:79], a[16:19], v[132:135]
    ds_read_b128 v[56:59], v14 offset:8192
    v_mfma_f32_16x16x32_bf16 v[132:135], v[80:83], a[24:27], v[132:135]
    buffer_load_dwordx4 v240, s[16:19], s55 offen offset:1024 lds
    v_mfma_f32_16x16x32_bf16 v[136:139], v[68:71], a[4:7], 0
    ds_read_b128 v[60:63], v14 offset:16384
    v_mfma_f32_16x16x32_bf16 v[136:139], v[72:75], a[12:15], v[136:139]
    v_mfma_f32_16x16x32_bf16 v[136:139], v[76:79], a[20:23], v[136:139]
    ds_read_b128 v[64:67], v14 offset:24576
    v_mfma_f32_16x16x32_bf16 v[136:139], v[80:83], a[28:31], v[136:139]
    buffer_load_dwordx4 a[84:87], v246, s[16:19], s45 offen sc1
    s_waitcnt lgkmcnt(6)
    v_mfma_f32_16x16x32_bf16 v[140:143], v[84:87], a[0:3], 0
    ds_read_b128 v[68:71], v14 offset:1024
    v_mfma_f32_16x16x32_bf16 v[140:143], v[88:91], a[8:11], v[140:143]
    v_add_u32 v240, 5120, v1
    s_waitcnt lgkmcnt(5)
    v_mfma_f32_16x16x32_bf16 v[140:143], v[92:95], a[16:19], v[140:143]
    ds_read_b128 v[72:75], v14 offset:9216
    v_mfma_f32_16x16x32_bf16 v[140:143], v[96:99], a[24:27], v[140:143]
    buffer_load_dwordx4 a[88:91], v247, s[16:19], s44 offen sc1
    v_mfma_f32_16x16x32_bf16 v[144:147], v[84:87], a[4:7], 0
    ds_read_b128 v[76:79], v14 offset:17408
    v_mfma_f32_16x16x32_bf16 v[144:147], v[88:91], a[12:15], v[144:147]
    v_mfma_f32_16x16x32_bf16 v[144:147], v[92:95], a[20:23], v[144:147]
    ds_read_b128 v[80:83], v14 offset:25600
    v_mfma_f32_16x16x32_bf16 v[144:147], v[96:99], a[28:31], v[144:147]
    buffer_load_dwordx4 a[92:95], v247, s[16:19], s45 offen sc1
    s_waitcnt vmcnt(15)
    s_waitcnt vmcnt(14)
    buffer_store_dword v242, v241, s[16:19], s29 offen sc1
    s_waitcnt lgkmcnt(6)
    v_mfma_f32_16x16x32_bf16 v[100:103], v[52:55], a[32:35], v[100:103]
    ds_read_b128 v[84:87], v14 offset:2048
    v_mfma_f32_16x16x32_bf16 v[100:103], v[56:59], a[40:43], v[100:103]
    s_add_u32 m0, s62, 0
    s_lshl_b32 s14, s60, 2
    s_waitcnt lgkmcnt(5)
    v_mfma_f32_16x16x32_bf16 v[100:103], v[60:63], a[48:51], v[100:103]
    ds_read_b128 v[88:91], v14 offset:10240
    v_mfma_f32_16x16x32_bf16 v[100:103], v[64:67], a[56:59], v[100:103]
    buffer_load_dwordx4 v240, s[16:19], s50 offen offset:0 lds
    s_add_u32 s14, s14, s3
    v_mfma_f32_16x16x32_bf16 v[104:107], v[52:55], a[36:39], v[104:107]
    ds_read_b128 v[92:95], v14 offset:18432
    v_mfma_f32_16x16x32_bf16 v[104:107], v[56:59], a[44:47], v[104:107]
    s_add_u32 s44, s46, 5120
    s_mul_i32 s31, s3, 3072
    v_mfma_f32_16x16x32_bf16 v[104:107], v[60:63], a[52:55], v[104:107]
    ds_read_b128 v[96:99], v14 offset:26624
    v_mfma_f32_16x16x32_bf16 v[104:107], v[64:67], a[60:63], v[104:107]
    s_add_u32 s45, s44, 147456
    s_lshl_b32 s39, s60, 2
    s_waitcnt lgkmcnt(6)
    v_mfma_f32_16x16x32_bf16 v[108:111], v[68:71], a[32:35], v[108:111]
    ds_read_b128 v[52:55], v14 offset:3072
    v_mfma_f32_16x16x32_bf16 v[108:111], v[72:75], a[40:43], v[108:111]
    buffer_load_dwordx4 a[96:99], v244, s[16:19], s44 offen sc1
    s_add_u32 s39, s39, s61
    s_waitcnt lgkmcnt(5)
    v_mfma_f32_16x16x32_bf16 v[108:111], v[76:79], a[48:51], v[108:111]
    ds_read_b128 v[56:59], v14 offset:11264
    v_mfma_f32_16x16x32_bf16 v[108:111], v[80:83], a[56:59], v[108:111]
    buffer_load_dwordx4 v240, s[16:19], s51 offen offset:1024 lds
    s_lshl_b32 s39, s39, 2
    v_mfma_f32_16x16x32_bf16 v[112:115], v[68:71], a[36:39], v[112:115]
    ds_read_b128 v[60:63], v14 offset:19456
    v_mfma_f32_16x16x32_bf16 v[112:115], v[72:75], a[44:47], v[112:115]
    s_add_u32 s39, s39, s3
    v_mfma_f32_16x16x32_bf16 v[112:115], v[76:79], a[52:55], v[112:115]
    ds_read_b128 v[64:67], v14 offset:27648
    v_mfma_f32_16x16x32_bf16 v[112:115], v[80:83], a[60:63], v[112:115]
    buffer_load_dwordx4 a[100:103], v244, s[16:19], s45 offen sc1
    s_lshl_b32 s49, s39, 9
    s_waitcnt lgkmcnt(6)
    v_mfma_f32_16x16x32_bf16 v[116:119], v[84:87], a[32:35], v[116:119]
    ds_read_b128 v[68:71], v14 offset:4096
    v_mfma_f32_16x16x32_bf16 v[116:119], v[88:91], a[40:43], v[116:119]
    buffer_load_dwordx4 v240, s[16:19], s52 offen offset:2048 lds
    s_add_u32 s49, s49, 0x60000
    s_waitcnt lgkmcnt(5)
    v_mfma_f32_16x16x32_bf16 v[116:119], v[92:95], a[48:51], v[116:119]
    ds_read_b128 v[72:75], v14 offset:12288
    v_mfma_f32_16x16x32_bf16 v[116:119], v[96:99], a[56:59], v[116:119]
    buffer_load_dwordx4 a[104:107], v245, s[16:19], s44 offen sc1
    s_lshl_b32 s48, s59, 7
    v_mfma_f32_16x16x32_bf16 v[120:123], v[84:87], a[36:39], v[120:123]
    ds_read_b128 v[76:79], v14 offset:20480
    v_mfma_f32_16x16x32_bf16 v[120:123], v[88:91], a[44:47], v[120:123]
    s_add_u32 s48, s48, s49
    v_mfma_f32_16x16x32_bf16 v[120:123], v[92:95], a[52:55], v[120:123]
    ds_read_b128 v[80:83], v14 offset:28672
    v_mfma_f32_16x16x32_bf16 v[120:123], v[96:99], a[60:63], v[120:123]
    buffer_load_dwordx4 v240, s[16:19], s53 offen offset:3072 lds
    s_mul_i32 s39, s39, 27648
    s_waitcnt lgkmcnt(6)
    v_mfma_f32_16x16x32_bf16 v[124:127], v[52:55], a[32:35], v[124:127]
    ds_read_b128 v[84:87], v14 offset:5120
    v_mfma_f32_16x16x32_bf16 v[124:127], v[56:59], a[40:43], v[124:127]
    buffer_load_dwordx4 a[108:111], v245, s[16:19], s45 offen sc1
    s_add_u32 s39, s39, 0x3d00000
    s_waitcnt lgkmcnt(5)
    v_mfma_f32_16x16x32_bf16 v[124:127], v[60:63], a[48:51], v[124:127]
    ds_read_b128 v[88:91], v14 offset:13312
    v_mfma_f32_16x16x32_bf16 v[124:127], v[64:67], a[56:59], v[124:127]
    s_add_u32 m0, s62, 4096
    s_lshl_b32 s40, s59, 3
    v_mfma_f32_16x16x32_bf16 v[128:131], v[52:55], a[36:39], v[128:131]
    ds_read_b128 v[92:95], v14 offset:21504
    v_mfma_f32_16x16x32_bf16 v[128:131], v[56:59], a[44:47], v[128:131]
    s_add_u32 s40, s40, 0x80000
    v_mfma_f32_16x16x32_bf16 v[128:131], v[60:63], a[52:55], v[128:131]
    ds_read_b128 v[96:99], v14 offset:29696
    v_mfma_f32_16x16x32_bf16 v[128:131], v[64:67], a[60:63], v[128:131]
    buffer_load_dwordx4 v240, s[16:19], s54 offen offset:0 lds
    s_bfe_u32 s41, 0x217110b, s40
    s_waitcnt lgkmcnt(6)
    v_mfma_f32_16x16x32_bf16 v[132:135], v[68:71], a[32:35], v[132:135]
    s_waitcnt vmcnt(10)
    s_barrier
    ds_read_b128 v[52:55], v15 offset:0
    v_mfma_f32_16x16x32_bf16 v[132:135], v[72:75], a[40:43], v[132:135]
    buffer_load_dwordx4 a[112:115], v246, s[16:19], s44 offen sc1
    s_lshl_b32 s41, s41, 10
    s_waitcnt lgkmcnt(5)
    v_mfma_f32_16x16x32_bf16 v[132:135], v[76:79], a[48:51], v[132:135]
    ds_read_b128 v[56:59], v15 offset:8192
    v_mfma_f32_16x16x32_bf16 v[132:135], v[80:83], a[56:59], v[132:135]
    buffer_load_dwordx4 v240, s[16:19], s55 offen offset:1024 lds
    s_add_u32 s20, s41, s39
    v_mfma_f32_16x16x32_bf16 v[136:139], v[68:71], a[36:39], v[136:139]
    ds_read_b128 v[60:63], v15 offset:16384
    v_mfma_f32_16x16x32_bf16 v[136:139], v[72:75], a[44:47], v[136:139]
    s_bfe_u32 s41, 0x51a140e, s40
    v_mfma_f32_16x16x32_bf16 v[136:139], v[76:79], a[52:55], v[136:139]
    ds_read_b128 v[64:67], v15 offset:24576
    v_mfma_f32_16x16x32_bf16 v[136:139], v[80:83], a[60:63], v[136:139]
    buffer_load_dwordx4 a[116:119], v246, s[16:19], s45 offen sc1
    s_lshl_b32 s41, s41, 10
    s_waitcnt lgkmcnt(6)
    v_mfma_f32_16x16x32_bf16 v[140:143], v[84:87], a[32:35], v[140:143]
    ds_read_b128 v[68:71], v15 offset:1024
    v_mfma_f32_16x16x32_bf16 v[140:143], v[88:91], a[40:43], v[140:143]
    v_add_u32 v240, 6144, v1
    s_add_u32 s21, s41, s39
    s_waitcnt lgkmcnt(5)
    v_mfma_f32_16x16x32_bf16 v[140:143], v[92:95], a[48:51], v[140:143]
    ds_read_b128 v[72:75], v15 offset:9216
    v_mfma_f32_16x16x32_bf16 v[140:143], v[96:99], a[56:59], v[140:143]
    buffer_load_dwordx4 a[120:123], v247, s[16:19], s44 offen sc1
    s_bfe_u32 s41, 0x8011610, s40
    v_mfma_f32_16x16x32_bf16 v[144:147], v[84:87], a[36:39], v[144:147]
    ds_read_b128 v[76:79], v15 offset:17408
    v_mfma_f32_16x16x32_bf16 v[144:147], v[88:91], a[44:47], v[144:147]
    s_lshl_b32 s41, s41, 10
    v_mfma_f32_16x16x32_bf16 v[144:147], v[92:95], a[52:55], v[144:147]
    ds_read_b128 v[80:83], v15 offset:25600
    v_mfma_f32_16x16x32_bf16 v[144:147], v[96:99], a[60:63], v[144:147]
    buffer_load_dwordx4 a[124:127], v247, s[16:19], s45 offen sc1
    s_add_u32 s22, s41, s39
    s_waitcnt lgkmcnt(6)
    v_mfma_f32_16x16x32_bf16 v[100:103], v[52:55], a[64:67], v[100:103]
    ds_read_b128 v[84:87], v15 offset:2048
    v_mfma_f32_16x16x32_bf16 v[100:103], v[56:59], a[72:75], v[100:103]
    s_add_u32 m0, s62, 36864
    s_bfe_u32 s41, 0xa041913, s40
    s_waitcnt lgkmcnt(5)
    v_mfma_f32_16x16x32_bf16 v[100:103], v[60:63], a[80:83], v[100:103]
    ds_read_b128 v[88:91], v15 offset:10240
    v_mfma_f32_16x16x32_bf16 v[100:103], v[64:67], a[88:91], v[100:103]
    buffer_load_dwordx4 v240, s[16:19], s50 offen offset:0 lds
    s_lshl_b32 s41, s41, 10
    v_mfma_f32_16x16x32_bf16 v[104:107], v[52:55], a[68:71], v[104:107]
    ds_read_b128 v[92:95], v15 offset:18432
    v_mfma_f32_16x16x32_bf16 v[104:107], v[56:59], a[76:79], v[104:107]
    s_add_u32 s44, s46, 6144
    s_add_u32 s23, s41, s39
    v_mfma_f32_16x16x32_bf16 v[104:107], v[60:63], a[84:87], v[104:107]
    ds_read_b128 v[96:99], v15 offset:26624
    v_mfma_f32_16x16x32_bf16 v[104:107], v[64:67], a[92:95], v[104:107]
    s_add_u32 s45, s44, 147456
    s_bfe_u32 s41, 0xd070015, s40
    s_waitcnt lgkmcnt(6)
    v_mfma_f32_16x16x32_bf16 v[108:111], v[68:71], a[64:67], v[108:111]
    ds_read_b128 v[52:55], v15 offset:3072
    v_mfma_f32_16x16x32_bf16 v[108:111], v[72:75], a[72:75], v[108:111]
    buffer_load_dwordx4 a[128:131], v244, s[16:19], s44 offen sc1
    s_lshl_b32 s41, s41, 10
    s_waitcnt lgkmcnt(5)
    v_mfma_f32_16x16x32_bf16 v[108:111], v[76:79], a[80:83], v[108:111]
    ds_read_b128 v[56:59], v15 offset:11264
    v_mfma_f32_16x16x32_bf16 v[108:111], v[80:83], a[88:91], v[108:111]
    buffer_load_dwordx4 v240, s[16:19], s51 offen offset:1024 lds
    s_add_u32 s24, s41, s39
    v_mfma_f32_16x16x32_bf16 v[112:115], v[68:71], a[68:71], v[112:115]
    ds_read_b128 v[60:63], v15 offset:19456
    v_mfma_f32_16x16x32_bf16 v[112:115], v[72:75], a[76:79], v[112:115]
    s_bfe_u32 s41, 0xf090318, s40
    v_mfma_f32_16x16x32_bf16 v[112:115], v[76:79], a[84:87], v[112:115]
    ds_read_b128 v[64:67], v15 offset:27648
    v_mfma_f32_16x16x32_bf16 v[112:115], v[80:83], a[92:95], v[112:115]
    buffer_load_dwordx4 a[132:135], v244, s[16:19], s45 offen sc1
    s_lshl_b32 s41, s41, 10
    s_waitcnt lgkmcnt(6)
    v_mfma_f32_16x16x32_bf16 v[116:119], v[84:87], a[64:67], v[116:119]
    ds_read_b128 v[68:71], v15 offset:4096
    v_mfma_f32_16x16x32_bf16 v[116:119], v[88:91], a[72:75], v[116:119]
    buffer_load_dwordx4 v240, s[16:19], s52 offen offset:2048 lds
    s_add_u32 s25, s41, s39
    s_waitcnt lgkmcnt(5)
    v_mfma_f32_16x16x32_bf16 v[116:119], v[92:95], a[80:83], v[116:119]
    ds_read_b128 v[72:75], v15 offset:12288
    v_mfma_f32_16x16x32_bf16 v[116:119], v[96:99], a[88:91], v[116:119]
    buffer_load_dwordx4 a[136:139], v245, s[16:19], s44 offen sc1
    s_bfe_u32 s41, 0x120c0600, s40
    v_mfma_f32_16x16x32_bf16 v[120:123], v[84:87], a[68:71], v[120:123]
    ds_read_b128 v[76:79], v15 offset:20480
    v_mfma_f32_16x16x32_bf16 v[120:123], v[88:91], a[76:79], v[120:123]
    s_lshl_b32 s41, s41, 10
    v_mfma_f32_16x16x32_bf16 v[120:123], v[92:95], a[84:87], v[120:123]
    ds_read_b128 v[80:83], v15 offset:28672
    v_mfma_f32_16x16x32_bf16 v[120:123], v[96:99], a[92:95], v[120:123]
    buffer_load_dwordx4 v240, s[16:19], s53 offen offset:3072 lds
    s_add_u32 s26, s41, s39
    s_waitcnt lgkmcnt(6)
    v_mfma_f32_16x16x32_bf16 v[124:127], v[52:55], a[64:67], v[124:127]
    ds_read_b128 v[84:87], v15 offset:5120
    v_mfma_f32_16x16x32_bf16 v[124:127], v[56:59], a[72:75], v[124:127]
    buffer_load_dwordx4 a[140:143], v245, s[16:19], s45 offen sc1
    s_bfe_u32 s41, 0x150f0903, s40
    s_waitcnt lgkmcnt(5)
    v_mfma_f32_16x16x32_bf16 v[124:127], v[60:63], a[80:83], v[124:127]
    ds_read_b128 v[88:91], v15 offset:13312
    v_mfma_f32_16x16x32_bf16 v[124:127], v[64:67], a[88:91], v[124:127]
    s_add_u32 m0, s62, 40960
    s_lshl_b32 s41, s41, 10
    v_mfma_f32_16x16x32_bf16 v[128:131], v[52:55], a[68:71], v[128:131]
    ds_read_b128 v[92:95], v15 offset:21504
    v_mfma_f32_16x16x32_bf16 v[128:131], v[56:59], a[76:79], v[128:131]
    s_add_u32 s27, s41, s39
    v_mfma_f32_16x16x32_bf16 v[128:131], v[60:63], a[84:87], v[128:131]
    ds_read_b128 v[96:99], v15 offset:29696
    v_mfma_f32_16x16x32_bf16 v[128:131], v[64:67], a[92:95], v[128:131]
    buffer_load_dwordx4 v240, s[16:19], s54 offen offset:0 lds
    s_bfe_u32 s41, 0x18120c06, s40
    s_waitcnt lgkmcnt(6)
    v_mfma_f32_16x16x32_bf16 v[132:135], v[68:71], a[64:67], v[132:135]
    s_waitcnt vmcnt(9)
    s_barrier
    ds_read_b128 v[52:55], v12 offset:0
    v_mfma_f32_16x16x32_bf16 v[132:135], v[72:75], a[72:75], v[132:135]
    buffer_load_dwordx4 a[144:147], v246, s[16:19], s44 offen sc1
    s_lshl_b32 s41, s41, 10
    s_waitcnt lgkmcnt(5)
    v_mfma_f32_16x16x32_bf16 v[132:135], v[76:79], a[80:83], v[132:135]
    ds_read_b128 v[56:59], v12 offset:8192
    v_mfma_f32_16x16x32_bf16 v[132:135], v[80:83], a[88:91], v[132:135]
    buffer_load_dwordx4 v240, s[16:19], s55 offen offset:1024 lds
    s_add_u32 s28, s41, s39
    v_mfma_f32_16x16x32_bf16 v[136:139], v[68:71], a[68:71], v[136:139]
    ds_read_b128 v[60:63], v12 offset:16384
    v_mfma_f32_16x16x32_bf16 v[136:139], v[72:75], a[76:79], v[136:139]
    s_lshl_b32 s15, s59, 1
    v_mfma_f32_16x16x32_bf16 v[136:139], v[76:79], a[84:87], v[136:139]
    ds_read_b128 v[64:67], v12 offset:24576
    v_mfma_f32_16x16x32_bf16 v[136:139], v[80:83], a[92:95], v[136:139]
    buffer_load_dwordx4 a[148:151], v246, s[16:19], s45 offen sc1
    s_add_u32 s15, s15, 1
    s_waitcnt lgkmcnt(6)
    v_mfma_f32_16x16x32_bf16 v[140:143], v[84:87], a[64:67], v[140:143]
    ds_read_b128 v[68:71], v12 offset:1024
    v_mfma_f32_16x16x32_bf16 v[140:143], v[88:91], a[72:75], v[140:143]
    v_add_u32 v240, 7168, v1
    s_cmp_eq_u32 s59, 0
    s_cselect_b32 s15, 0, s15
    s_waitcnt lgkmcnt(5)
    v_mfma_f32_16x16x32_bf16 v[140:143], v[92:95], a[80:83], v[140:143]
    ds_read_b128 v[72:75], v12 offset:9216
    v_mfma_f32_16x16x32_bf16 v[140:143], v[96:99], a[88:91], v[140:143]
    buffer_load_dwordx4 a[152:155], v247, s[16:19], s44 offen sc1
    s_mul_i32 s43, s61, 9
    v_mfma_f32_16x16x32_bf16 v[144:147], v[84:87], a[68:71], v[144:147]
    ds_read_b128 v[76:79], v12 offset:17408
    v_mfma_f32_16x16x32_bf16 v[144:147], v[88:91], a[76:79], v[144:147]
    s_add_u32 s15, s15, s43
    v_mfma_f32_16x16x32_bf16 v[144:147], v[92:95], a[84:87], v[144:147]
    ds_read_b128 v[80:83], v12 offset:25600
    v_mfma_f32_16x16x32_bf16 v[144:147], v[96:99], a[92:95], v[144:147]
    buffer_load_dwordx4 a[156:159], v247, s[16:19], s45 offen sc1
    s_mul_i32 s32, s14, 36
    s_waitcnt lgkmcnt(6)
    v_mfma_f32_16x16x32_bf16 v[100:103], v[52:55], a[96:99], v[100:103]
    ds_read_b128 v[84:87], v12 offset:2048
    v_mfma_f32_16x16x32_bf16 v[100:103], v[56:59], a[104:107], v[100:103]
    buffer_load_dword v243, v237, s[16:19], 0 offen sc1
    s_add_u32 s32, s32, s15
    s_waitcnt lgkmcnt(5)
    v_mfma_f32_16x16x32_bf16 v[100:103], v[60:63], a[112:115], v[100:103]
    ds_read_b128 v[88:91], v12 offset:10240
    v_mfma_f32_16x16x32_bf16 v[100:103], v[64:67], a[120:123], v[100:103]
    s_add_u32 m0, s62, 73728
    s_lshl_b32 s32, s32, 10
    v_mfma_f32_16x16x32_bf16 v[104:107], v[52:55], a[100:103], v[104:107]
    ds_read_b128 v[92:95], v12 offset:18432
    v_mfma_f32_16x16x32_bf16 v[104:107], v[56:59], a[108:111], v[104:107]
    s_add_u32 s32, s32, 0x1500000
    v_mfma_f32_16x16x32_bf16 v[104:107], v[60:63], a[116:119], v[104:107]
    ds_read_b128 v[96:99], v12 offset:26624
    v_mfma_f32_16x16x32_bf16 v[104:107], v[64:67], a[124:127], v[104:107]
    buffer_load_dwordx4 v240, s[16:19], s50 offen offset:0 lds
    s_lshl_b32 s33, s15, 6
    s_waitcnt lgkmcnt(6)
    v_mfma_f32_16x16x32_bf16 v[108:111], v[68:71], a[96:99], v[108:111]
    ds_read_b128 v[52:55], v12 offset:3072
    v_mfma_f32_16x16x32_bf16 v[108:111], v[72:75], a[104:107], v[108:111]
    s_add_u32 s44, s46, 7168
    s_add_u32 s33, s33, 11520
    s_waitcnt lgkmcnt(5)
    v_mfma_f32_16x16x32_bf16 v[108:111], v[76:79], a[112:115], v[108:111]
    ds_read_b128 v[56:59], v12 offset:11264
    v_mfma_f32_16x16x32_bf16 v[108:111], v[80:83], a[120:123], v[108:111]
    s_add_u32 s45, s44, 147456
    s_mul_i32 s34, s14, 36864
    v_mfma_f32_16x16x32_bf16 v[112:115], v[68:71], a[100:103], v[112:115]
    ds_read_b128 v[60:63], v12 offset:19456
    v_mfma_f32_16x16x32_bf16 v[112:115], v[72:75], a[108:111], v[112:115]
    s_lshl_b32 s35, s15, 5
    v_mfma_f32_16x16x32_bf16 v[112:115], v[76:79], a[116:119], v[112:115]
    ds_read_b128 v[64:67], v12 offset:27648
    v_mfma_f32_16x16x32_bf16 v[112:115], v[80:83], a[124:127], v[112:115]
    buffer_load_dwordx4 a[160:163], v244, s[16:19], s44 offen sc1
    s_add_u32 s34, s34, s35
    s_waitcnt lgkmcnt(6)
    v_mfma_f32_16x16x32_bf16 v[116:119], v[84:87], a[96:99], v[116:119]
    ds_read_b128 v[68:71], v12 offset:4096
    v_mfma_f32_16x16x32_bf16 v[116:119], v[88:91], a[104:107], v[116:119]
    buffer_load_dwordx4 v240, s[16:19], s51 offen offset:1024 lds
    s_add_u32 s35, s34, 18432
    s_waitcnt lgkmcnt(5)
    v_mfma_f32_16x16x32_bf16 v[116:119], v[92:95], a[112:115], v[116:119]
    ds_read_b128 v[72:75], v12 offset:12288
    v_mfma_f32_16x16x32_bf16 v[116:119], v[96:99], a[120:123], v[116:119]
    buffer_load_dwordx4 a[164:167], v244, s[16:19], s45 offen sc1
    s_mov_b32 s12, s6
    v_mfma_f32_16x16x32_bf16 v[120:123], v[84:87], a[100:103], v[120:123]
    ds_read_b128 v[76:79], v12 offset:20480
    v_mfma_f32_16x16x32_bf16 v[120:123], v[88:91], a[108:111], v[120:123]
    s_mov_b32 s13, s7
    v_mfma_f32_16x16x32_bf16 v[120:123], v[92:95], a[116:119], v[120:123]
    ds_read_b128 v[80:83], v12 offset:28672
    v_mfma_f32_16x16x32_bf16 v[120:123], v[96:99], a[124:127], v[120:123]
    buffer_load_dwordx4 v240, s[16:19], s52 offen offset:2048 lds
    s_mov_b32 s14, 0x240000
    s_waitcnt lgkmcnt(6)
    v_mfma_f32_16x16x32_bf16 v[124:127], v[52:55], a[96:99], v[124:127]
    ds_read_b128 v[84:87], v12 offset:5120
    v_mfma_f32_16x16x32_bf16 v[124:127], v[56:59], a[104:107], v[124:127]
    buffer_load_dwordx4 a[168:171], v245, s[16:19], s44 offen sc1
    s_mov_b32 s15, 0x00020000
    s_waitcnt lgkmcnt(5)
    v_mfma_f32_16x16x32_bf16 v[124:127], v[60:63], a[112:115], v[124:127]
    ds_read_b128 v[88:91], v12 offset:13312
    v_mfma_f32_16x16x32_bf16 v[124:127], v[64:67], a[120:123], v[124:127]
    buffer_load_dwordx4 v240, s[16:19], s53 offen offset:3072 lds
    v_mfma_f32_16x16x32_bf16 v[128:131], v[52:55], a[100:103], v[128:131]
    ds_read_b128 v[92:95], v12 offset:21504
    v_mfma_f32_16x16x32_bf16 v[128:131], v[56:59], a[108:111], v[128:131]
    v_mfma_f32_16x16x32_bf16 v[128:131], v[60:63], a[116:119], v[128:131]
    ds_read_b128 v[96:99], v12 offset:29696
    v_mfma_f32_16x16x32_bf16 v[128:131], v[64:67], a[124:127], v[128:131]
    buffer_load_dwordx4 a[172:175], v245, s[16:19], s45 offen sc1
    s_waitcnt lgkmcnt(6)
    v_mfma_f32_16x16x32_bf16 v[132:135], v[68:71], a[96:99], v[132:135]
    s_waitcnt vmcnt(9)
    s_barrier
    ds_read_b128 v[52:55], v13 offset:0
    v_mfma_f32_16x16x32_bf16 v[132:135], v[72:75], a[104:107], v[132:135]
    s_add_u32 m0, s62, 77824
    s_waitcnt lgkmcnt(5)
    v_mfma_f32_16x16x32_bf16 v[132:135], v[76:79], a[112:115], v[132:135]
    ds_read_b128 v[56:59], v13 offset:8192
    v_mfma_f32_16x16x32_bf16 v[132:135], v[80:83], a[120:123], v[132:135]
    buffer_load_dwordx4 v240, s[16:19], s54 offen offset:0 lds
    v_mfma_f32_16x16x32_bf16 v[136:139], v[68:71], a[100:103], v[136:139]
    ds_read_b128 v[60:63], v13 offset:16384
    v_mfma_f32_16x16x32_bf16 v[136:139], v[72:75], a[108:111], v[136:139]
    v_mfma_f32_16x16x32_bf16 v[136:139], v[76:79], a[116:119], v[136:139]
    ds_read_b128 v[64:67], v13 offset:24576
    v_mfma_f32_16x16x32_bf16 v[136:139], v[80:83], a[124:127], v[136:139]
    buffer_load_dwordx4 a[176:179], v246, s[16:19], s44 offen sc1
    s_waitcnt lgkmcnt(6)
    v_mfma_f32_16x16x32_bf16 v[140:143], v[84:87], a[96:99], v[140:143]
    ds_read_b128 v[68:71], v13 offset:1024
    v_mfma_f32_16x16x32_bf16 v[140:143], v[88:91], a[104:107], v[140:143]
    buffer_load_dwordx4 v240, s[16:19], s55 offen offset:1024 lds
    s_waitcnt lgkmcnt(5)
    v_mfma_f32_16x16x32_bf16 v[140:143], v[92:95], a[112:115], v[140:143]
    ds_read_b128 v[72:75], v13 offset:9216
    v_mfma_f32_16x16x32_bf16 v[140:143], v[96:99], a[120:123], v[140:143]
    buffer_load_dwordx4 a[180:183], v246, s[16:19], s45 offen sc1
    v_mfma_f32_16x16x32_bf16 v[144:147], v[84:87], a[100:103], v[144:147]
    ds_read_b128 v[76:79], v13 offset:17408
    v_mfma_f32_16x16x32_bf16 v[144:147], v[88:91], a[108:111], v[144:147]
    v_add_u32 v240, 3072, v1
    v_mfma_f32_16x16x32_bf16 v[144:147], v[92:95], a[116:119], v[144:147]
    ds_read_b128 v[80:83], v13 offset:25600
    v_mfma_f32_16x16x32_bf16 v[144:147], v[96:99], a[124:127], v[144:147]
    buffer_load_dwordx4 a[184:187], v247, s[16:19], s44 offen sc1
    s_waitcnt vmcnt(13)
    s_mov_b32 s10, 262144
K456_C6_P2B:
    v_cmp_ne_u32 vcc, 0, v243
    s_nop 0
    s_cmp_eq_u64 vcc, -1
    s_cbranch_scc1 K456_C6_P2B_X
    buffer_load_dword v243, v237, s[16:19], 0 offen offset:0 sc1
    s_waitcnt vmcnt(0)
    s_sub_u32 s10, s10, 1
    s_cbranch_scc0 K456_C6_P2B
K456_C6_P2B_X:
    s_waitcnt lgkmcnt(6)
    v_mfma_f32_16x16x32_bf16 v[100:103], v[52:55], a[128:131], v[100:103]
    ds_read_b128 v[84:87], v13 offset:2048
    v_mfma_f32_16x16x32_bf16 v[100:103], v[56:59], a[136:139], v[100:103]
    buffer_load_dwordx4 a[188:191], v247, s[16:19], s45 offen sc1
    s_waitcnt lgkmcnt(5)
    v_mfma_f32_16x16x32_bf16 v[100:103], v[60:63], a[144:147], v[100:103]
    ds_read_b128 v[88:91], v13 offset:10240
    v_mfma_f32_16x16x32_bf16 v[100:103], v[64:67], a[152:155], v[100:103]
    s_add_u32 m0, s62, 110592
    v_mfma_f32_16x16x32_bf16 v[104:107], v[52:55], a[132:135], v[104:107]
    ds_read_b128 v[92:95], v13 offset:18432
    v_mfma_f32_16x16x32_bf16 v[104:107], v[56:59], a[140:143], v[104:107]
    v_mfma_f32_16x16x32_bf16 v[104:107], v[60:63], a[148:151], v[104:107]
    ds_read_b128 v[96:99], v13 offset:26624
    v_mfma_f32_16x16x32_bf16 v[104:107], v[64:67], a[156:159], v[104:107]
    buffer_load_dwordx4 v240, s[16:19], s50 offen offset:0 lds
    s_waitcnt lgkmcnt(6)
    v_mfma_f32_16x16x32_bf16 v[108:111], v[68:71], a[128:131], v[108:111]
    ds_read_b128 v[52:55], v13 offset:3072
    v_mfma_f32_16x16x32_bf16 v[108:111], v[72:75], a[136:139], v[108:111]
    s_add_u32 s44, s46, 3072
    s_waitcnt lgkmcnt(5)
    v_mfma_f32_16x16x32_bf16 v[108:111], v[76:79], a[144:147], v[108:111]
    ds_read_b128 v[56:59], v13 offset:11264
    v_mfma_f32_16x16x32_bf16 v[108:111], v[80:83], a[152:155], v[108:111]
    s_add_u32 s45, s44, 147456
    v_mfma_f32_16x16x32_bf16 v[112:115], v[68:71], a[132:135], v[112:115]
    ds_read_b128 v[60:63], v13 offset:19456
    v_mfma_f32_16x16x32_bf16 v[112:115], v[72:75], a[140:143], v[112:115]
    v_mfma_f32_16x16x32_bf16 v[112:115], v[76:79], a[148:151], v[112:115]
    ds_read_b128 v[64:67], v13 offset:27648
    v_mfma_f32_16x16x32_bf16 v[112:115], v[80:83], a[156:159], v[112:115]
    buffer_load_dwordx4 a[192:195], v244, s[16:19], s44 offen sc1
    s_waitcnt lgkmcnt(6)
    v_mfma_f32_16x16x32_bf16 v[116:119], v[84:87], a[128:131], v[116:119]
    ds_read_b128 v[68:71], v13 offset:4096
    v_mfma_f32_16x16x32_bf16 v[116:119], v[88:91], a[136:139], v[116:119]
    buffer_load_dwordx4 v240, s[16:19], s51 offen offset:1024 lds
    s_waitcnt lgkmcnt(5)
    v_mfma_f32_16x16x32_bf16 v[116:119], v[92:95], a[144:147], v[116:119]
    ds_read_b128 v[72:75], v13 offset:12288
    v_mfma_f32_16x16x32_bf16 v[116:119], v[96:99], a[152:155], v[116:119]
    buffer_load_dwordx4 a[196:199], v244, s[16:19], s45 offen sc1
    v_mfma_f32_16x16x32_bf16 v[120:123], v[84:87], a[132:135], v[120:123]
    ds_read_b128 v[76:79], v13 offset:20480
    v_mfma_f32_16x16x32_bf16 v[120:123], v[88:91], a[140:143], v[120:123]
    v_mfma_f32_16x16x32_bf16 v[120:123], v[92:95], a[148:151], v[120:123]
    ds_read_b128 v[80:83], v13 offset:28672
    v_mfma_f32_16x16x32_bf16 v[120:123], v[96:99], a[156:159], v[120:123]
    buffer_load_dwordx4 v240, s[16:19], s52 offen offset:2048 lds
    s_waitcnt lgkmcnt(6)
    v_mfma_f32_16x16x32_bf16 v[124:127], v[52:55], a[128:131], v[124:127]
    ds_read_b128 v[84:87], v13 offset:5120
    v_mfma_f32_16x16x32_bf16 v[124:127], v[56:59], a[136:139], v[124:127]
    buffer_load_dwordx4 a[200:203], v245, s[16:19], s44 offen sc1
    s_waitcnt lgkmcnt(5)
    v_mfma_f32_16x16x32_bf16 v[124:127], v[60:63], a[144:147], v[124:127]
    ds_read_b128 v[88:91], v13 offset:13312
    v_mfma_f32_16x16x32_bf16 v[124:127], v[64:67], a[152:155], v[124:127]
    buffer_load_dwordx4 v240, s[16:19], s53 offen offset:3072 lds
    v_mfma_f32_16x16x32_bf16 v[128:131], v[52:55], a[132:135], v[128:131]
    ds_read_b128 v[92:95], v13 offset:21504
    v_mfma_f32_16x16x32_bf16 v[128:131], v[56:59], a[140:143], v[128:131]
    v_mfma_f32_16x16x32_bf16 v[128:131], v[60:63], a[148:151], v[128:131]
    ds_read_b128 v[96:99], v13 offset:29696
    v_mfma_f32_16x16x32_bf16 v[128:131], v[64:67], a[156:159], v[128:131]
    buffer_load_dwordx4 a[204:207], v245, s[16:19], s45 offen sc1
    s_waitcnt lgkmcnt(6)
    v_mfma_f32_16x16x32_bf16 v[132:135], v[68:71], a[128:131], v[132:135]
    s_waitcnt vmcnt(8)
    s_barrier
    ds_read_b128 v[52:55], v14 offset:0
    v_mfma_f32_16x16x32_bf16 v[132:135], v[72:75], a[136:139], v[132:135]
    s_add_u32 m0, s62, 114688
    s_waitcnt lgkmcnt(5)
    v_mfma_f32_16x16x32_bf16 v[132:135], v[76:79], a[144:147], v[132:135]
    ds_read_b128 v[56:59], v14 offset:8192
    v_mfma_f32_16x16x32_bf16 v[132:135], v[80:83], a[152:155], v[132:135]
    buffer_load_dwordx4 v240, s[16:19], s54 offen offset:0 lds
    v_mfma_f32_16x16x32_bf16 v[136:139], v[68:71], a[132:135], v[136:139]
    ds_read_b128 v[60:63], v14 offset:16384
    v_mfma_f32_16x16x32_bf16 v[136:139], v[72:75], a[140:143], v[136:139]
    v_mfma_f32_16x16x32_bf16 v[136:139], v[76:79], a[148:151], v[136:139]
    ds_read_b128 v[64:67], v14 offset:24576
    v_mfma_f32_16x16x32_bf16 v[136:139], v[80:83], a[156:159], v[136:139]
    buffer_load_dwordx4 a[208:211], v246, s[16:19], s44 offen sc1
    s_waitcnt lgkmcnt(6)
    v_mfma_f32_16x16x32_bf16 v[140:143], v[84:87], a[128:131], v[140:143]
    ds_read_b128 v[68:71], v14 offset:1024
    v_mfma_f32_16x16x32_bf16 v[140:143], v[88:91], a[136:139], v[140:143]
    buffer_load_dwordx4 v240, s[16:19], s55 offen offset:1024 lds
    s_waitcnt lgkmcnt(5)
    v_mfma_f32_16x16x32_bf16 v[140:143], v[92:95], a[144:147], v[140:143]
    ds_read_b128 v[72:75], v14 offset:9216
    v_mfma_f32_16x16x32_bf16 v[140:143], v[96:99], a[152:155], v[140:143]
    buffer_load_dwordx4 a[212:215], v246, s[16:19], s45 offen sc1
    v_mfma_f32_16x16x32_bf16 v[144:147], v[84:87], a[132:135], v[144:147]
    ds_read_b128 v[76:79], v14 offset:17408
    v_mfma_f32_16x16x32_bf16 v[144:147], v[88:91], a[140:143], v[144:147]
    v_add_u32 v240, 4096, v1
    v_mfma_f32_16x16x32_bf16 v[144:147], v[92:95], a[148:151], v[144:147]
    ds_read_b128 v[80:83], v14 offset:25600
    v_mfma_f32_16x16x32_bf16 v[144:147], v[96:99], a[156:159], v[144:147]
    buffer_load_dwordx4 a[216:219], v247, s[16:19], s44 offen sc1
    s_waitcnt lgkmcnt(6)
    v_mfma_f32_16x16x32_bf16 v[100:103], v[52:55], a[160:163], v[100:103]
    ds_read_b128 v[84:87], v14 offset:2048
    v_mfma_f32_16x16x32_bf16 v[100:103], v[56:59], a[168:171], v[100:103]
    buffer_load_dwordx4 a[220:223], v247, s[16:19], s45 offen sc1
    s_waitcnt lgkmcnt(5)
    v_mfma_f32_16x16x32_bf16 v[100:103], v[60:63], a[176:179], v[100:103]
    ds_read_b128 v[88:91], v14 offset:10240
    v_mfma_f32_16x16x32_bf16 v[100:103], v[64:67], a[184:187], v[100:103]
    s_add_u32 m0, s62, 0
    v_mfma_f32_16x16x32_bf16 v[104:107], v[52:55], a[164:167], v[104:107]
    ds_read_b128 v[92:95], v14 offset:18432
    v_mfma_f32_16x16x32_bf16 v[104:107], v[56:59], a[172:175], v[104:107]
    v_mfma_f32_16x16x32_bf16 v[104:107], v[60:63], a[180:183], v[104:107]
    ds_read_b128 v[96:99], v14 offset:26624
    v_mfma_f32_16x16x32_bf16 v[104:107], v[64:67], a[188:191], v[104:107]
    buffer_load_dwordx4 v240, s[16:19], s50 offen offset:0 lds
    s_waitcnt lgkmcnt(6)
    v_mfma_f32_16x16x32_bf16 v[108:111], v[68:71], a[160:163], v[108:111]
    ds_read_b128 v[52:55], v14 offset:3072
    v_mfma_f32_16x16x32_bf16 v[108:111], v[72:75], a[168:171], v[108:111]
    s_add_u32 s44, s46, 4096
    s_waitcnt lgkmcnt(5)
    v_mfma_f32_16x16x32_bf16 v[108:111], v[76:79], a[176:179], v[108:111]
    ds_read_b128 v[56:59], v14 offset:11264
    v_mfma_f32_16x16x32_bf16 v[108:111], v[80:83], a[184:187], v[108:111]
    s_add_u32 s45, s44, 147456
    v_mfma_f32_16x16x32_bf16 v[112:115], v[68:71], a[164:167], v[112:115]
    ds_read_b128 v[60:63], v14 offset:19456
    v_mfma_f32_16x16x32_bf16 v[112:115], v[72:75], a[172:175], v[112:115]
    v_mfma_f32_16x16x32_bf16 v[112:115], v[76:79], a[180:183], v[112:115]
    ds_read_b128 v[64:67], v14 offset:27648
    v_mfma_f32_16x16x32_bf16 v[112:115], v[80:83], a[188:191], v[112:115]
    buffer_load_dwordx4 a[224:227], v244, s[16:19], s44 offen sc1
    s_waitcnt lgkmcnt(6)
    v_mfma_f32_16x16x32_bf16 v[116:119], v[84:87], a[160:163], v[116:119]
    ds_read_b128 v[68:71], v14 offset:4096
    v_mfma_f32_16x16x32_bf16 v[116:119], v[88:91], a[168:171], v[116:119]
    buffer_load_dwordx4 v240, s[16:19], s51 offen offset:1024 lds
    s_waitcnt lgkmcnt(5)
    v_mfma_f32_16x16x32_bf16 v[116:119], v[92:95], a[176:179], v[116:119]
    ds_read_b128 v[72:75], v14 offset:12288
    v_mfma_f32_16x16x32_bf16 v[116:119], v[96:99], a[184:187], v[116:119]
    buffer_load_dwordx4 a[228:231], v244, s[16:19], s45 offen sc1
    v_mfma_f32_16x16x32_bf16 v[120:123], v[84:87], a[164:167], v[120:123]
    ds_read_b128 v[76:79], v14 offset:20480
    v_mfma_f32_16x16x32_bf16 v[120:123], v[88:91], a[172:175], v[120:123]
    v_mfma_f32_16x16x32_bf16 v[120:123], v[92:95], a[180:183], v[120:123]
    ds_read_b128 v[80:83], v14 offset:28672
    v_mfma_f32_16x16x32_bf16 v[120:123], v[96:99], a[188:191], v[120:123]
    buffer_load_dwordx4 v240, s[16:19], s52 offen offset:2048 lds
    s_waitcnt lgkmcnt(6)
    v_mfma_f32_16x16x32_bf16 v[124:127], v[52:55], a[160:163], v[124:127]
    ds_read_b128 v[84:87], v14 offset:5120
    v_mfma_f32_16x16x32_bf16 v[124:127], v[56:59], a[168:171], v[124:127]
    buffer_load_dwordx4 a[232:235], v245, s[16:19], s44 offen sc1
    s_waitcnt lgkmcnt(5)
    v_mfma_f32_16x16x32_bf16 v[124:127], v[60:63], a[176:179], v[124:127]
    ds_read_b128 v[88:91], v14 offset:13312
    v_mfma_f32_16x16x32_bf16 v[124:127], v[64:67], a[184:187], v[124:127]
    buffer_load_dwordx4 v240, s[16:19], s53 offen offset:3072 lds
    v_mfma_f32_16x16x32_bf16 v[128:131], v[52:55], a[164:167], v[128:131]
    ds_read_b128 v[92:95], v14 offset:21504
    v_mfma_f32_16x16x32_bf16 v[128:131], v[56:59], a[172:175], v[128:131]
    v_mfma_f32_16x16x32_bf16 v[128:131], v[60:63], a[180:183], v[128:131]
    ds_read_b128 v[96:99], v14 offset:29696
    v_mfma_f32_16x16x32_bf16 v[128:131], v[64:67], a[188:191], v[128:131]
    buffer_load_dwordx4 a[236:239], v245, s[16:19], s45 offen sc1
    s_waitcnt lgkmcnt(6)
    v_mfma_f32_16x16x32_bf16 v[132:135], v[68:71], a[160:163], v[132:135]
    s_waitcnt vmcnt(8)
    s_barrier
    ds_read_b128 v[52:55], v15 offset:0
    v_mfma_f32_16x16x32_bf16 v[132:135], v[72:75], a[168:171], v[132:135]
    s_add_u32 m0, s62, 4096
    s_waitcnt lgkmcnt(5)
    v_mfma_f32_16x16x32_bf16 v[132:135], v[76:79], a[176:179], v[132:135]
    ds_read_b128 v[56:59], v15 offset:8192
    v_mfma_f32_16x16x32_bf16 v[132:135], v[80:83], a[184:187], v[132:135]
    buffer_load_dwordx4 v240, s[16:19], s54 offen offset:0 lds
    v_mfma_f32_16x16x32_bf16 v[136:139], v[68:71], a[164:167], v[136:139]
    ds_read_b128 v[60:63], v15 offset:16384
    v_mfma_f32_16x16x32_bf16 v[136:139], v[72:75], a[172:175], v[136:139]
    v_mfma_f32_16x16x32_bf16 v[136:139], v[76:79], a[180:183], v[136:139]
    ds_read_b128 v[64:67], v15 offset:24576
    v_mfma_f32_16x16x32_bf16 v[136:139], v[80:83], a[188:191], v[136:139]
    buffer_load_dwordx4 a[240:243], v246, s[16:19], s44 offen sc1
    s_waitcnt lgkmcnt(6)
    v_mfma_f32_16x16x32_bf16 v[140:143], v[84:87], a[160:163], v[140:143]
    ds_read_b128 v[68:71], v15 offset:1024
    v_mfma_f32_16x16x32_bf16 v[140:143], v[88:91], a[168:171], v[140:143]
    buffer_load_dwordx4 v240, s[16:19], s55 offen offset:1024 lds
    s_waitcnt lgkmcnt(5)
    v_mfma_f32_16x16x32_bf16 v[140:143], v[92:95], a[176:179], v[140:143]
    ds_read_b128 v[72:75], v15 offset:9216
    v_mfma_f32_16x16x32_bf16 v[140:143], v[96:99], a[184:187], v[140:143]
    buffer_load_dwordx4 a[244:247], v246, s[16:19], s45 offen sc1
    v_mfma_f32_16x16x32_bf16 v[144:147], v[84:87], a[164:167], v[144:147]
    ds_read_b128 v[76:79], v15 offset:17408
    v_mfma_f32_16x16x32_bf16 v[144:147], v[88:91], a[172:175], v[144:147]
    v_add_u32 v240, 8192, v1
    v_mfma_f32_16x16x32_bf16 v[144:147], v[92:95], a[180:183], v[144:147]
    ds_read_b128 v[80:83], v15 offset:25600
    v_mfma_f32_16x16x32_bf16 v[144:147], v[96:99], a[188:191], v[144:147]
    buffer_load_dwordx4 a[248:251], v247, s[16:19], s44 offen sc1
    s_waitcnt lgkmcnt(6)
    v_mfma_f32_16x16x32_bf16 v[100:103], v[52:55], a[192:195], v[100:103]
    ds_read_b128 v[84:87], v15 offset:2048
    v_mfma_f32_16x16x32_bf16 v[100:103], v[56:59], a[200:203], v[100:103]
    buffer_load_dwordx4 a[252:255], v247, s[16:19], s45 offen sc1
    s_waitcnt lgkmcnt(5)
    v_mfma_f32_16x16x32_bf16 v[100:103], v[60:63], a[208:211], v[100:103]
    ds_read_b128 v[88:91], v15 offset:10240
    v_mfma_f32_16x16x32_bf16 v[100:103], v[64:67], a[216:219], v[100:103]
    s_add_u32 m0, s62, 36864
    v_mfma_f32_16x16x32_bf16 v[104:107], v[52:55], a[196:199], v[104:107]
    ds_read_b128 v[92:95], v15 offset:18432
    v_mfma_f32_16x16x32_bf16 v[104:107], v[56:59], a[204:207], v[104:107]
    v_mfma_f32_16x16x32_bf16 v[104:107], v[60:63], a[212:215], v[104:107]
    ds_read_b128 v[96:99], v15 offset:26624
    v_mfma_f32_16x16x32_bf16 v[104:107], v[64:67], a[220:223], v[104:107]
    buffer_load_dwordx4 v240, s[16:19], s50 offen offset:0 lds
    s_waitcnt lgkmcnt(6)
    v_mfma_f32_16x16x32_bf16 v[108:111], v[68:71], a[192:195], v[108:111]
    ds_read_b128 v[52:55], v15 offset:3072
    v_mfma_f32_16x16x32_bf16 v[108:111], v[72:75], a[200:203], v[108:111]
    s_add_u32 s44, s46, 8192
    s_waitcnt lgkmcnt(5)
    v_mfma_f32_16x16x32_bf16 v[108:111], v[76:79], a[208:211], v[108:111]
    ds_read_b128 v[56:59], v15 offset:11264
    v_mfma_f32_16x16x32_bf16 v[108:111], v[80:83], a[216:219], v[108:111]
    s_add_u32 s45, s44, 147456
    v_mfma_f32_16x16x32_bf16 v[112:115], v[68:71], a[196:199], v[112:115]
    ds_read_b128 v[60:63], v15 offset:19456
    v_mfma_f32_16x16x32_bf16 v[112:115], v[72:75], a[204:207], v[112:115]
    v_mfma_f32_16x16x32_bf16 v[112:115], v[76:79], a[212:215], v[112:115]
    ds_read_b128 v[64:67], v15 offset:27648
    v_mfma_f32_16x16x32_bf16 v[112:115], v[80:83], a[220:223], v[112:115]
    buffer_load_dwordx4 v[20:23], v244, s[16:19], s44 offen sc1
    s_waitcnt lgkmcnt(6)
    v_mfma_f32_16x16x32_bf16 v[116:119], v[84:87], a[192:195], v[116:119]
    ds_read_b128 v[68:71], v15 offset:4096
    v_mfma_f32_16x16x32_bf16 v[116:119], v[88:91], a[200:203], v[116:119]
    buffer_load_dwordx4 v240, s[16:19], s51 offen offset:1024 lds
    s_waitcnt lgkmcnt(5)
    v_mfma_f32_16x16x32_bf16 v[116:119], v[92:95], a[208:211], v[116:119]
    ds_read_b128 v[72:75], v15 offset:12288
    v_mfma_f32_16x16x32_bf16 v[116:119], v[96:99], a[216:219], v[116:119]
    buffer_load_dwordx4 v[24:27], v244, s[16:19], s45 offen sc1
    v_mfma_f32_16x16x32_bf16 v[120:123], v[84:87], a[196:199], v[120:123]
    ds_read_b128 v[76:79], v15 offset:20480
    v_mfma_f32_16x16x32_bf16 v[120:123], v[88:91], a[204:207], v[120:123]
    v_mfma_f32_16x16x32_bf16 v[120:123], v[92:95], a[212:215], v[120:123]
    ds_read_b128 v[80:83], v15 offset:28672
    v_mfma_f32_16x16x32_bf16 v[120:123], v[96:99], a[220:223], v[120:123]
    buffer_load_dwordx4 v240, s[16:19], s52 offen offset:2048 lds
    s_waitcnt lgkmcnt(6)
    v_mfma_f32_16x16x32_bf16 v[124:127], v[52:55], a[192:195], v[124:127]
    ds_read_b128 v[84:87], v15 offset:5120
    v_mfma_f32_16x16x32_bf16 v[124:127], v[56:59], a[200:203], v[124:127]
    buffer_load_dwordx4 v[28:31], v245, s[16:19], s44 offen sc1
    s_waitcnt lgkmcnt(5)
    v_mfma_f32_16x16x32_bf16 v[124:127], v[60:63], a[208:211], v[124:127]
    ds_read_b128 v[88:91], v15 offset:13312
    v_mfma_f32_16x16x32_bf16 v[124:127], v[64:67], a[216:219], v[124:127]
    buffer_load_dwordx4 v240, s[16:19], s53 offen offset:3072 lds
    v_mfma_f32_16x16x32_bf16 v[128:131], v[52:55], a[196:199], v[128:131]
    ds_read_b128 v[92:95], v15 offset:21504
    v_mfma_f32_16x16x32_bf16 v[128:131], v[56:59], a[204:207], v[128:131]
    v_mfma_f32_16x16x32_bf16 v[128:131], v[60:63], a[212:215], v[128:131]
    ds_read_b128 v[96:99], v15 offset:29696
    v_mfma_f32_16x16x32_bf16 v[128:131], v[64:67], a[220:223], v[128:131]
    buffer_load_dwordx4 v[32:35], v245, s[16:19], s45 offen sc1
    s_waitcnt lgkmcnt(6)
    v_mfma_f32_16x16x32_bf16 v[132:135], v[68:71], a[192:195], v[132:135]
    s_waitcnt vmcnt(8)
    s_barrier
    ds_read_b128 v[52:55], v12 offset:0
    v_mfma_f32_16x16x32_bf16 v[132:135], v[72:75], a[200:203], v[132:135]
    s_add_u32 m0, s62, 40960
    s_waitcnt lgkmcnt(5)
    v_mfma_f32_16x16x32_bf16 v[132:135], v[76:79], a[208:211], v[132:135]
    ds_read_b128 v[56:59], v12 offset:8192
    v_mfma_f32_16x16x32_bf16 v[132:135], v[80:83], a[216:219], v[132:135]
    buffer_load_dwordx4 v240, s[16:19], s54 offen offset:0 lds
    v_mfma_f32_16x16x32_bf16 v[136:139], v[68:71], a[196:199], v[136:139]
    ds_read_b128 v[60:63], v12 offset:16384
    v_mfma_f32_16x16x32_bf16 v[136:139], v[72:75], a[204:207], v[136:139]
    v_mfma_f32_16x16x32_bf16 v[136:139], v[76:79], a[212:215], v[136:139]
    ds_read_b128 v[64:67], v12 offset:24576
    v_mfma_f32_16x16x32_bf16 v[136:139], v[80:83], a[220:223], v[136:139]
    buffer_load_dwordx4 v[36:39], v246, s[16:19], s44 offen sc1
    s_waitcnt lgkmcnt(6)
    v_mfma_f32_16x16x32_bf16 v[140:143], v[84:87], a[192:195], v[140:143]
    ds_read_b128 v[68:71], v12 offset:1024
    v_mfma_f32_16x16x32_bf16 v[140:143], v[88:91], a[200:203], v[140:143]
    buffer_load_dwordx4 v240, s[16:19], s55 offen offset:1024 lds
    s_waitcnt lgkmcnt(5)
    v_mfma_f32_16x16x32_bf16 v[140:143], v[92:95], a[208:211], v[140:143]
    ds_read_b128 v[72:75], v12 offset:9216
    v_mfma_f32_16x16x32_bf16 v[140:143], v[96:99], a[216:219], v[140:143]
    buffer_load_dwordx4 v[40:43], v246, s[16:19], s45 offen sc1
    v_mfma_f32_16x16x32_bf16 v[144:147], v[84:87], a[196:199], v[144:147]
    ds_read_b128 v[76:79], v12 offset:17408
    v_mfma_f32_16x16x32_bf16 v[144:147], v[88:91], a[204:207], v[144:147]
    v_add_u32 v240, 0, v1
    v_mfma_f32_16x16x32_bf16 v[144:147], v[92:95], a[212:215], v[144:147]
    ds_read_b128 v[80:83], v12 offset:25600
    v_mfma_f32_16x16x32_bf16 v[144:147], v[96:99], a[220:223], v[144:147]
    buffer_load_dwordx4 v[44:47], v247, s[16:19], s44 offen sc1
    s_waitcnt lgkmcnt(6)
    v_mfma_f32_16x16x32_bf16 v[100:103], v[52:55], a[224:227], v[100:103]
    ds_read_b128 v[84:87], v12 offset:2048
    v_mfma_f32_16x16x32_bf16 v[100:103], v[56:59], a[232:235], v[100:103]
    buffer_load_dwordx4 v[48:51], v247, s[16:19], s45 offen sc1
    s_waitcnt lgkmcnt(5)
    v_mfma_f32_16x16x32_bf16 v[100:103], v[60:63], a[240:243], v[100:103]
    ds_read_b128 v[88:91], v12 offset:10240
    v_mfma_f32_16x16x32_bf16 v[100:103], v[64:67], a[248:251], v[100:103]
    s_add_u32 m0, s31, 73728
    v_mfma_f32_16x16x32_bf16 v[104:107], v[52:55], a[228:231], v[104:107]
    ds_read_b128 v[92:95], v12 offset:18432
    v_mfma_f32_16x16x32_bf16 v[104:107], v[56:59], a[236:239], v[104:107]
    v_mfma_f32_16x16x32_bf16 v[104:107], v[60:63], a[244:247], v[104:107]
    ds_read_b128 v[96:99], v12 offset:26624
    v_mfma_f32_16x16x32_bf16 v[104:107], v[64:67], a[252:255], v[104:107]
    buffer_load_dwordx4 v240, s[16:19], s56 offen offset:0 lds
    s_waitcnt lgkmcnt(6)
    v_mfma_f32_16x16x32_bf16 v[108:111], v[68:71], a[224:227], v[108:111]
    ds_read_b128 v[52:55], v12 offset:3072
    v_mfma_f32_16x16x32_bf16 v[108:111], v[72:75], a[232:235], v[108:111]
    buffer_load_dwordx4 v240, s[16:19], s57 offen offset:1024 lds
    s_waitcnt lgkmcnt(5)
    v_mfma_f32_16x16x32_bf16 v[108:111], v[76:79], a[240:243], v[108:111]
    ds_read_b128 v[56:59], v12 offset:11264
    v_mfma_f32_16x16x32_bf16 v[108:111], v[80:83], a[248:251], v[108:111]
    buffer_load_dwordx4 v240, s[16:19], s58 offen offset:2048 lds
    v_mfma_f32_16x16x32_bf16 v[112:115], v[68:71], a[228:231], v[112:115]
    ds_read_b128 v[60:63], v12 offset:19456
    v_mfma_f32_16x16x32_bf16 v[112:115], v[72:75], a[236:239], v[112:115]
    v_add_u32 v240, 1024, v1
    v_mfma_f32_16x16x32_bf16 v[112:115], v[76:79], a[244:247], v[112:115]
    ds_read_b128 v[64:67], v12 offset:27648
    v_mfma_f32_16x16x32_bf16 v[112:115], v[80:83], a[252:255], v[112:115]
    s_add_u32 m0, s31, 86016
    s_waitcnt lgkmcnt(6)
    v_mfma_f32_16x16x32_bf16 v[116:119], v[84:87], a[224:227], v[116:119]
    ds_read_b128 v[68:71], v12 offset:4096
    v_mfma_f32_16x16x32_bf16 v[116:119], v[88:91], a[232:235], v[116:119]
    buffer_load_dwordx4 v240, s[16:19], s56 offen offset:0 lds
    s_waitcnt lgkmcnt(5)
    v_mfma_f32_16x16x32_bf16 v[116:119], v[92:95], a[240:243], v[116:119]
    ds_read_b128 v[72:75], v12 offset:12288
    v_mfma_f32_16x16x32_bf16 v[116:119], v[96:99], a[248:251], v[116:119]
    buffer_load_dwordx4 v240, s[16:19], s57 offen offset:1024 lds
    v_mfma_f32_16x16x32_bf16 v[120:123], v[84:87], a[228:231], v[120:123]
    ds_read_b128 v[76:79], v12 offset:20480
    v_mfma_f32_16x16x32_bf16 v[120:123], v[88:91], a[236:239], v[120:123]
    v_mfma_f32_16x16x32_bf16 v[120:123], v[92:95], a[244:247], v[120:123]
    ds_read_b128 v[80:83], v12 offset:28672
    v_mfma_f32_16x16x32_bf16 v[120:123], v[96:99], a[252:255], v[120:123]
    buffer_load_dwordx4 v240, s[16:19], s58 offen offset:2048 lds
    s_waitcnt lgkmcnt(6)
    v_mfma_f32_16x16x32_bf16 v[124:127], v[52:55], a[224:227], v[124:127]
    ds_read_b128 v[84:87], v12 offset:5120
    v_mfma_f32_16x16x32_bf16 v[124:127], v[56:59], a[232:235], v[124:127]
    v_add_u32 v240, 2048, v1
    s_waitcnt lgkmcnt(5)
    v_mfma_f32_16x16x32_bf16 v[124:127], v[60:63], a[240:243], v[124:127]
    ds_read_b128 v[88:91], v12 offset:13312
    v_mfma_f32_16x16x32_bf16 v[124:127], v[64:67], a[248:251], v[124:127]
    s_add_u32 m0, s31, 98304
    v_mfma_f32_16x16x32_bf16 v[128:131], v[52:55], a[228:231], v[128:131]
    ds_read_b128 v[92:95], v12 offset:21504
    v_mfma_f32_16x16x32_bf16 v[128:131], v[56:59], a[236:239], v[128:131]
    v_mfma_f32_16x16x32_bf16 v[128:131], v[60:63], a[244:247], v[128:131]
    ds_read_b128 v[96:99], v12 offset:29696
    v_mfma_f32_16x16x32_bf16 v[128:131], v[64:67], a[252:255], v[128:131]
    buffer_load_dwordx4 v240, s[16:19], s56 offen offset:0 lds
    s_waitcnt lgkmcnt(6)
    v_mfma_f32_16x16x32_bf16 v[132:135], v[68:71], a[224:227], v[132:135]
    s_waitcnt vmcnt(7)
    s_barrier
    ds_read_b128 v[52:55], v13 offset:0
    v_mfma_f32_16x16x32_bf16 v[132:135], v[72:75], a[232:235], v[132:135]
    buffer_load_dwordx4 v240, s[16:19], s57 offen offset:1024 lds
    s_waitcnt lgkmcnt(5)
    v_mfma_f32_16x16x32_bf16 v[132:135], v[76:79], a[240:243], v[132:135]
    ds_read_b128 v[56:59], v13 offset:8192
    v_mfma_f32_16x16x32_bf16 v[132:135], v[80:83], a[248:251], v[132:135]
    buffer_load_dwordx4 v240, s[16:19], s58 offen offset:2048 lds
    v_mfma_f32_16x16x32_bf16 v[136:139], v[68:71], a[228:231], v[136:139]
    ds_read_b128 v[60:63], v13 offset:16384
    v_mfma_f32_16x16x32_bf16 v[136:139], v[72:75], a[236:239], v[136:139]
    v_add_u32 v240, 5120, v1
    v_mfma_f32_16x16x32_bf16 v[136:139], v[76:79], a[244:247], v[136:139]
    ds_read_b128 v[64:67], v13 offset:24576
    v_mfma_f32_16x16x32_bf16 v[136:139], v[80:83], a[252:255], v[136:139]
    s_waitcnt lgkmcnt(6)
    v_mfma_f32_16x16x32_bf16 v[140:143], v[84:87], a[224:227], v[140:143]
    ds_read_b128 v[68:71], v13 offset:1024
    v_mfma_f32_16x16x32_bf16 v[140:143], v[88:91], a[232:235], v[140:143]
    s_waitcnt lgkmcnt(5)
    v_mfma_f32_16x16x32_bf16 v[140:143], v[92:95], a[240:243], v[140:143]
    ds_read_b128 v[72:75], v13 offset:9216
    v_mfma_f32_16x16x32_bf16 v[140:143], v[96:99], a[248:251], v[140:143]
    v_mfma_f32_16x16x32_bf16 v[144:147], v[84:87], a[228:231], v[144:147]
    ds_read_b128 v[76:79], v13 offset:17408
    v_mfma_f32_16x16x32_bf16 v[144:147], v[88:91], a[236:239], v[144:147]
    v_mfma_f32_16x16x32_bf16 v[144:147], v[92:95], a[244:247], v[144:147]
    ds_read_b128 v[80:83], v13 offset:25600
    v_mfma_f32_16x16x32_bf16 v[144:147], v[96:99], a[252:255], v[144:147]
    s_waitcnt lgkmcnt(6)
    v_mfma_f32_16x16x32_bf16 v[100:103], v[52:55], v[20:23], v[100:103]
    ds_read_b128 v[84:87], v13 offset:2048
    v_mfma_f32_16x16x32_bf16 v[100:103], v[56:59], v[28:31], v[100:103]
    s_add_u32 m0, s31, 110592
    s_waitcnt lgkmcnt(5)
    v_mfma_f32_16x16x32_bf16 v[100:103], v[60:63], v[36:39], v[100:103]
    ds_read_b128 v[88:91], v13 offset:10240
    v_mfma_f32_16x16x32_bf16 v[100:103], v[64:67], v[44:47], v[100:103]
    buffer_load_dwordx4 v240, s[16:19], s56 offen offset:0 lds
    v_mfma_f32_16x16x32_bf16 v[104:107], v[52:55], v[24:27], v[104:107]
    ds_read_b128 v[92:95], v13 offset:18432
    v_mfma_f32_16x16x32_bf16 v[104:107], v[56:59], v[32:35], v[104:107]
    v_mfma_f32_16x16x32_bf16 v[104:107], v[60:63], v[40:43], v[104:107]
    ds_read_b128 v[96:99], v13 offset:26624
    v_mfma_f32_16x16x32_bf16 v[104:107], v[64:67], v[48:51], v[104:107]
    buffer_load_dwordx4 v240, s[16:19], s57 offen offset:1024 lds
    s_waitcnt lgkmcnt(6)
    v_mfma_f32_16x16x32_bf16 v[108:111], v[68:71], v[20:23], v[108:111]
    ds_read_b128 v[52:55], v13 offset:3072
    v_mfma_f32_16x16x32_bf16 v[108:111], v[72:75], v[28:31], v[108:111]
    buffer_load_dwordx4 v240, s[16:19], s58 offen offset:2048 lds
    s_waitcnt lgkmcnt(5)
    v_mfma_f32_16x16x32_bf16 v[108:111], v[76:79], v[36:39], v[108:111]
    ds_read_b128 v[56:59], v13 offset:11264
    v_mfma_f32_16x16x32_bf16 v[108:111], v[80:83], v[44:47], v[108:111]
    v_add_u32 v240, 6144, v1
    v_mfma_f32_16x16x32_bf16 v[112:115], v[68:71], v[24:27], v[112:115]
    ds_read_b128 v[60:63], v13 offset:19456
    v_mfma_f32_16x16x32_bf16 v[112:115], v[72:75], v[32:35], v[112:115]
    s_add_u32 m0, s31, 122880
    v_mfma_f32_16x16x32_bf16 v[112:115], v[76:79], v[40:43], v[112:115]
    ds_read_b128 v[64:67], v13 offset:27648
    v_mfma_f32_16x16x32_bf16 v[112:115], v[80:83], v[48:51], v[112:115]
    buffer_load_dwordx4 v240, s[16:19], s56 offen offset:0 lds
    s_waitcnt lgkmcnt(6)
    v_mfma_f32_16x16x32_bf16 v[116:119], v[84:87], v[20:23], v[116:119]
    ds_read_b128 v[68:71], v13 offset:4096
    v_mfma_f32_16x16x32_bf16 v[116:119], v[88:91], v[28:31], v[116:119]
    buffer_load_dwordx4 v240, s[16:19], s57 offen offset:1024 lds
    s_waitcnt lgkmcnt(5)
    v_mfma_f32_16x16x32_bf16 v[116:119], v[92:95], v[36:39], v[116:119]
    ds_read_b128 v[72:75], v13 offset:12288
    v_mfma_f32_16x16x32_bf16 v[116:119], v[96:99], v[44:47], v[116:119]
    buffer_load_dwordx4 v240, s[16:19], s58 offen offset:2048 lds
    v_mfma_f32_16x16x32_bf16 v[120:123], v[84:87], v[24:27], v[120:123]
    ds_read_b128 v[76:79], v13 offset:20480
    v_mfma_f32_16x16x32_bf16 v[120:123], v[88:91], v[32:35], v[120:123]
    v_add_u32 v240, 7168, v1
    v_mfma_f32_16x16x32_bf16 v[120:123], v[92:95], v[40:43], v[120:123]
    ds_read_b128 v[80:83], v13 offset:28672
    v_mfma_f32_16x16x32_bf16 v[120:123], v[96:99], v[48:51], v[120:123]
    s_add_u32 m0, s31, 135168
    s_waitcnt lgkmcnt(6)
    v_mfma_f32_16x16x32_bf16 v[124:127], v[52:55], v[20:23], v[124:127]
    ds_read_b128 v[84:87], v13 offset:5120
    v_mfma_f32_16x16x32_bf16 v[124:127], v[56:59], v[28:31], v[124:127]
    buffer_load_dwordx4 v240, s[16:19], s56 offen offset:0 lds
    s_waitcnt lgkmcnt(5)
    v_mfma_f32_16x16x32_bf16 v[124:127], v[60:63], v[36:39], v[124:127]
    ds_read_b128 v[88:91], v13 offset:13312
    v_mfma_f32_16x16x32_bf16 v[124:127], v[64:67], v[44:47], v[124:127]
    buffer_load_dwordx4 v240, s[16:19], s57 offen offset:1024 lds
    v_mfma_f32_16x16x32_bf16 v[128:131], v[52:55], v[24:27], v[128:131]
    ds_read_b128 v[92:95], v13 offset:21504
    v_mfma_f32_16x16x32_bf16 v[128:131], v[56:59], v[32:35], v[128:131]
    v_mfma_f32_16x16x32_bf16 v[128:131], v[60:63], v[40:43], v[128:131]
    ds_read_b128 v[96:99], v13 offset:29696
    v_mfma_f32_16x16x32_bf16 v[128:131], v[64:67], v[48:51], v[128:131]
    buffer_load_dwordx4 v240, s[16:19], s58 offen offset:2048 lds
    s_waitcnt lgkmcnt(6)
    v_mfma_f32_16x16x32_bf16 v[132:135], v[68:71], v[20:23], v[132:135]
    s_waitcnt vmcnt(9)
    s_barrier
    ds_read_b128 v[52:55], v14 offset:0
    v_mfma_f32_16x16x32_bf16 v[132:135], v[72:75], v[28:31], v[132:135]
    v_add_u32 v240, 3072, v1
    s_waitcnt lgkmcnt(5)
    v_mfma_f32_16x16x32_bf16 v[132:135], v[76:79], v[36:39], v[132:135]
    ds_read_b128 v[56:59], v14 offset:3072
    v_mfma_f32_16x16x32_bf16 v[132:135], v[80:83], v[44:47], v[132:135]
    s_add_u32 m0, s31, 0
    v_mfma_f32_16x16x32_bf16 v[136:139], v[68:71], v[24:27], v[136:139]
    ds_read_b128 v[60:63], v14 offset:6144
    v_mfma_f32_16x16x32_bf16 v[136:139], v[72:75], v[32:35], v[136:139]
    v_mfma_f32_16x16x32_bf16 v[136:139], v[76:79], v[40:43], v[136:139]
    ds_read_b128 v[64:67], v14 offset:9216
    v_mfma_f32_16x16x32_bf16 v[136:139], v[80:83], v[48:51], v[136:139]
    buffer_load_dwordx4 v240, s[16:19], s56 offen offset:0 lds
    s_waitcnt lgkmcnt(6)
    v_mfma_f32_16x16x32_bf16 v[140:143], v[84:87], v[20:23], v[140:143]
    ds_read_b128 v[68:71], v14 offset:12288
    v_mfma_f32_16x16x32_bf16 v[140:143], v[88:91], v[28:31], v[140:143]
    buffer_load_dwordx4 v240, s[16:19], s57 offen offset:1024 lds
    s_waitcnt lgkmcnt(5)
    v_mfma_f32_16x16x32_bf16 v[140:143], v[92:95], v[36:39], v[140:143]
    ds_read_b128 v[72:75], v14 offset:15360
    v_mfma_f32_16x16x32_bf16 v[140:143], v[96:99], v[44:47], v[140:143]
    buffer_load_dwordx4 v240, s[16:19], s58 offen offset:2048 lds
    v_mfma_f32_16x16x32_bf16 v[144:147], v[84:87], v[24:27], v[144:147]
    ds_read_b128 v[76:79], v14 offset:18432
    v_mfma_f32_16x16x32_bf16 v[144:147], v[88:91], v[32:35], v[144:147]
    v_add_u32 v240, 4096, v1
    v_mfma_f32_16x16x32_bf16 v[144:147], v[92:95], v[40:43], v[144:147]
    ds_read_b128 v[80:83], v14 offset:21504
    v_mfma_f32_16x16x32_bf16 v[144:147], v[96:99], v[48:51], v[144:147]
    s_add_u32 m0, s31, 12288
    s_nop 0
    buffer_load_dwordx4 v240, s[16:19], s56 offen offset:0 lds
    buffer_load_dwordx4 v240, s[16:19], s57 offen offset:1024 lds
    buffer_load_dwordx4 v240, s[16:19], s58 offen offset:2048 lds
    v_add_u32 v240, 8192, v1
    s_add_u32 m0, s31, 24576
    s_nop 0
    buffer_load_dwordx4 v240, s[16:19], s56 offen offset:0 lds
    buffer_load_dwordx4 v240, s[16:19], s57 offen offset:1024 lds
    buffer_load_dwordx4 v240, s[16:19], s58 offen offset:2048 lds
    v_add_u32 v240, 0, v1
    v_cvt_pk_bf16_f32 v172, v100, v101
    v_cvt_pk_bf16_f32 v173, v102, v103
    v_cvt_pk_bf16_f32 v174, v104, v105
    v_cvt_pk_bf16_f32 v175, v106, v107
    buffer_store_dwordx4 v[172:175], v1, s[16:19], s20 offen sc1
    v_cvt_pk_bf16_f32 v176, v108, v109
    v_cvt_pk_bf16_f32 v177, v110, v111
    v_cvt_pk_bf16_f32 v178, v112, v113
    v_cvt_pk_bf16_f32 v179, v114, v115
    buffer_store_dwordx4 v[176:179], v1, s[16:19], s21 offen sc1
    v_cvt_pk_bf16_f32 v180, v116, v117
    v_cvt_pk_bf16_f32 v181, v118, v119
    v_cvt_pk_bf16_f32 v182, v120, v121
    v_cvt_pk_bf16_f32 v183, v122, v123
    buffer_store_dwordx4 v[180:183], v1, s[16:19], s22 offen sc1
    v_cvt_pk_bf16_f32 v184, v124, v125
    v_cvt_pk_bf16_f32 v185, v126, v127
    v_cvt_pk_bf16_f32 v186, v128, v129
    v_cvt_pk_bf16_f32 v187, v130, v131
    buffer_store_dwordx4 v[184:187], v1, s[16:19], s23 offen sc1
    v_cvt_pk_bf16_f32 v188, v132, v133
    v_cvt_pk_bf16_f32 v189, v134, v135
    v_cvt_pk_bf16_f32 v190, v136, v137
    v_cvt_pk_bf16_f32 v191, v138, v139
    buffer_store_dwordx4 v[188:191], v1, s[16:19], s24 offen sc1
    v_cvt_pk_bf16_f32 v192, v140, v141
    v_cvt_pk_bf16_f32 v193, v142, v143
    v_cvt_pk_bf16_f32 v194, v144, v145
    v_cvt_pk_bf16_f32 v195, v146, v147
    buffer_store_dwordx4 v[192:195], v1, s[16:19], s25 offen sc1
    s_waitcnt lgkmcnt(6)
    v_mfma_f32_16x16x32_bf16 v[148:151], v[52:55], a[0:3], 0
    ds_read_b128 v[84:87], v14 offset:24576
    v_mfma_f32_16x16x32_bf16 v[148:151], v[56:59], a[8:11], v[148:151]
    s_waitcnt lgkmcnt(5)
    v_mfma_f32_16x16x32_bf16 v[148:151], v[60:63], a[16:19], v[148:151]
    ds_read_b128 v[88:91], v14 offset:27648
    v_mfma_f32_16x16x32_bf16 v[148:151], v[64:67], a[24:27], v[148:151]
    v_mfma_f32_16x16x32_bf16 v[152:155], v[52:55], a[4:7], 0
    ds_read_b128 v[92:95], v14 offset:30720
    v_mfma_f32_16x16x32_bf16 v[152:155], v[56:59], a[12:15], v[152:155]
    v_mfma_f32_16x16x32_bf16 v[152:155], v[60:63], a[20:23], v[152:155]
    ds_read_b128 v[96:99], v14 offset:33792
    v_mfma_f32_16x16x32_bf16 v[152:155], v[64:67], a[28:31], v[152:155]
    s_waitcnt lgkmcnt(6)
    v_mfma_f32_16x16x32_bf16 v[148:151], v[68:71], a[32:35], v[148:151]
    ds_read_b128 v[52:55], v14 offset:1024
    v_mfma_f32_16x16x32_bf16 v[148:151], v[72:75], a[40:43], v[148:151]
    s_waitcnt lgkmcnt(5)
    v_mfma_f32_16x16x32_bf16 v[148:151], v[76:79], a[48:51], v[148:151]
    ds_read_b128 v[56:59], v14 offset:4096
    v_mfma_f32_16x16x32_bf16 v[148:151], v[80:83], a[56:59], v[148:151]
    v_mfma_f32_16x16x32_bf16 v[152:155], v[68:71], a[36:39], v[152:155]
    ds_read_b128 v[60:63], v14 offset:7168
    v_mfma_f32_16x16x32_bf16 v[152:155], v[72:75], a[44:47], v[152:155]
    v_mfma_f32_16x16x32_bf16 v[152:155], v[76:79], a[52:55], v[152:155]
    ds_read_b128 v[64:67], v14 offset:10240
    v_mfma_f32_16x16x32_bf16 v[152:155], v[80:83], a[60:63], v[152:155]
    s_waitcnt lgkmcnt(6)
    v_mfma_f32_16x16x32_bf16 v[148:151], v[84:87], a[64:67], v[148:151]
    ds_read_b128 v[68:71], v14 offset:13312
    v_mfma_f32_16x16x32_bf16 v[148:151], v[88:91], a[72:75], v[148:151]
    s_waitcnt lgkmcnt(5)
    v_mfma_f32_16x16x32_bf16 v[148:151], v[92:95], a[80:83], v[148:151]
    ds_read_b128 v[72:75], v14 offset:16384
    v_mfma_f32_16x16x32_bf16 v[148:151], v[96:99], a[88:91], v[148:151]
    v_mfma_f32_16x16x32_bf16 v[152:155], v[84:87], a[68:71], v[152:155]
    ds_read_b128 v[76:79], v14 offset:19456
    v_mfma_f32_16x16x32_bf16 v[152:155], v[88:91], a[76:79], v[152:155]
    v_mfma_f32_16x16x32_bf16 v[152:155], v[92:95], a[84:87], v[152:155]
    ds_read_b128 v[80:83], v14 offset:22528
    v_mfma_f32_16x16x32_bf16 v[152:155], v[96:99], a[92:95], v[152:155]
    s_waitcnt lgkmcnt(6)
    v_mfma_f32_16x16x32_bf16 v[156:159], v[52:55], a[0:3], 0
    ds_read_b128 v[84:87], v14 offset:25600
    v_mfma_f32_16x16x32_bf16 v[156:159], v[56:59], a[8:11], v[156:159]
    s_waitcnt lgkmcnt(5)
    v_mfma_f32_16x16x32_bf16 v[156:159], v[60:63], a[16:19], v[156:159]
    ds_read_b128 v[88:91], v14 offset:28672
    v_mfma_f32_16x16x32_bf16 v[156:159], v[64:67], a[24:27], v[156:159]
    v_mfma_f32_16x16x32_bf16 v[160:163], v[52:55], a[4:7], 0
    ds_read_b128 v[92:95], v14 offset:31744
    v_mfma_f32_16x16x32_bf16 v[160:163], v[56:59], a[12:15], v[160:163]
    v_mfma_f32_16x16x32_bf16 v[160:163], v[60:63], a[20:23], v[160:163]
    ds_read_b128 v[96:99], v14 offset:34816
    v_mfma_f32_16x16x32_bf16 v[160:163], v[64:67], a[28:31], v[160:163]
    s_waitcnt lgkmcnt(6)
    v_mfma_f32_16x16x32_bf16 v[156:159], v[68:71], a[32:35], v[156:159]
    ds_read_b128 v[52:55], v14 offset:2048
    v_mfma_f32_16x16x32_bf16 v[156:159], v[72:75], a[40:43], v[156:159]
    s_waitcnt lgkmcnt(5)
    v_mfma_f32_16x16x32_bf16 v[156:159], v[76:79], a[48:51], v[156:159]
    ds_read_b128 v[56:59], v14 offset:5120
    v_mfma_f32_16x16x32_bf16 v[156:159], v[80:83], a[56:59], v[156:159]
    v_mfma_f32_16x16x32_bf16 v[160:163], v[68:71], a[36:39], v[160:163]
    ds_read_b128 v[60:63], v14 offset:8192
    v_mfma_f32_16x16x32_bf16 v[160:163], v[72:75], a[44:47], v[160:163]
    v_mfma_f32_16x16x32_bf16 v[160:163], v[76:79], a[52:55], v[160:163]
    ds_read_b128 v[64:67], v14 offset:11264
    v_mfma_f32_16x16x32_bf16 v[160:163], v[80:83], a[60:63], v[160:163]
    s_waitcnt lgkmcnt(6)
    v_mfma_f32_16x16x32_bf16 v[156:159], v[84:87], a[64:67], v[156:159]
    ds_read_b128 v[68:71], v14 offset:14336
    v_mfma_f32_16x16x32_bf16 v[156:159], v[88:91], a[72:75], v[156:159]
    s_waitcnt lgkmcnt(5)
    v_mfma_f32_16x16x32_bf16 v[156:159], v[92:95], a[80:83], v[156:159]
    ds_read_b128 v[72:75], v14 offset:17408
    v_mfma_f32_16x16x32_bf16 v[156:159], v[96:99], a[88:91], v[156:159]
    v_mfma_f32_16x16x32_bf16 v[160:163], v[84:87], a[68:71], v[160:163]
    ds_read_b128 v[76:79], v14 offset:20480
    v_mfma_f32_16x16x32_bf16 v[160:163], v[88:91], a[76:79], v[160:163]
    v_mfma_f32_16x16x32_bf16 v[160:163], v[92:95], a[84:87], v[160:163]
    ds_read_b128 v[80:83], v14 offset:23552
    v_mfma_f32_16x16x32_bf16 v[160:163], v[96:99], a[92:95], v[160:163]
    s_waitcnt lgkmcnt(6)
    v_mfma_f32_16x16x32_bf16 v[164:167], v[52:55], a[0:3], 0
    ds_read_b128 v[84:87], v14 offset:26624
    v_mfma_f32_16x16x32_bf16 v[164:167], v[56:59], a[8:11], v[164:167]
    s_waitcnt lgkmcnt(5)
    v_mfma_f32_16x16x32_bf16 v[164:167], v[60:63], a[16:19], v[164:167]
    ds_read_b128 v[88:91], v14 offset:29696
    v_mfma_f32_16x16x32_bf16 v[164:167], v[64:67], a[24:27], v[164:167]
    v_mfma_f32_16x16x32_bf16 v[168:171], v[52:55], a[4:7], 0
    ds_read_b128 v[92:95], v14 offset:32768
    v_mfma_f32_16x16x32_bf16 v[168:171], v[56:59], a[12:15], v[168:171]
    v_mfma_f32_16x16x32_bf16 v[168:171], v[60:63], a[20:23], v[168:171]
    ds_read_b128 v[96:99], v14 offset:35840
    v_mfma_f32_16x16x32_bf16 v[168:171], v[64:67], a[28:31], v[168:171]
    s_waitcnt lgkmcnt(6)
    v_mfma_f32_16x16x32_bf16 v[164:167], v[68:71], a[32:35], v[164:167]
    s_waitcnt vmcnt(15)
    s_barrier
    ds_read_b128 v[52:55], v15 offset:0
    v_mfma_f32_16x16x32_bf16 v[164:167], v[72:75], a[40:43], v[164:167]
    s_waitcnt lgkmcnt(5)
    v_mfma_f32_16x16x32_bf16 v[164:167], v[76:79], a[48:51], v[164:167]
    ds_read_b128 v[56:59], v15 offset:3072
    v_mfma_f32_16x16x32_bf16 v[164:167], v[80:83], a[56:59], v[164:167]
    v_mfma_f32_16x16x32_bf16 v[168:171], v[68:71], a[36:39], v[168:171]
    ds_read_b128 v[60:63], v15 offset:6144
    v_mfma_f32_16x16x32_bf16 v[168:171], v[72:75], a[44:47], v[168:171]
    v_mfma_f32_16x16x32_bf16 v[168:171], v[76:79], a[52:55], v[168:171]
    ds_read_b128 v[64:67], v15 offset:9216
    v_mfma_f32_16x16x32_bf16 v[168:171], v[80:83], a[60:63], v[168:171]
    s_waitcnt lgkmcnt(6)
    v_mfma_f32_16x16x32_bf16 v[164:167], v[84:87], a[64:67], v[164:167]
    ds_read_b128 v[68:71], v15 offset:12288
    v_mfma_f32_16x16x32_bf16 v[164:167], v[88:91], a[72:75], v[164:167]
    s_waitcnt lgkmcnt(5)
    v_mfma_f32_16x16x32_bf16 v[164:167], v[92:95], a[80:83], v[164:167]
    ds_read_b128 v[72:75], v15 offset:15360
    v_mfma_f32_16x16x32_bf16 v[164:167], v[96:99], a[88:91], v[164:167]
    v_mfma_f32_16x16x32_bf16 v[168:171], v[84:87], a[68:71], v[168:171]
    ds_read_b128 v[76:79], v15 offset:18432
    v_mfma_f32_16x16x32_bf16 v[168:171], v[88:91], a[76:79], v[168:171]
    v_mfma_f32_16x16x32_bf16 v[168:171], v[92:95], a[84:87], v[168:171]
    ds_read_b128 v[80:83], v15 offset:21504
    v_mfma_f32_16x16x32_bf16 v[168:171], v[96:99], a[92:95], v[168:171]
    s_waitcnt lgkmcnt(6)
    v_mfma_f32_16x16x32_bf16 v[148:151], v[52:55], a[96:99], v[148:151]
    ds_read_b128 v[84:87], v15 offset:24576
    v_mfma_f32_16x16x32_bf16 v[148:151], v[56:59], a[104:107], v[148:151]
    s_waitcnt lgkmcnt(5)
    v_mfma_f32_16x16x32_bf16 v[148:151], v[60:63], a[112:115], v[148:151]
    ds_read_b128 v[88:91], v15 offset:27648
    v_mfma_f32_16x16x32_bf16 v[148:151], v[64:67], a[120:123], v[148:151]
    v_mfma_f32_16x16x32_bf16 v[152:155], v[52:55], a[100:103], v[152:155]
    ds_read_b128 v[92:95], v15 offset:30720
    v_mfma_f32_16x16x32_bf16 v[152:155], v[56:59], a[108:111], v[152:155]
    v_mfma_f32_16x16x32_bf16 v[152:155], v[60:63], a[116:119], v[152:155]
    ds_read_b128 v[96:99], v15 offset:33792
    v_mfma_f32_16x16x32_bf16 v[152:155], v[64:67], a[124:127], v[152:155]
    s_waitcnt lgkmcnt(6)
    v_mfma_f32_16x16x32_bf16 v[148:151], v[68:71], a[128:131], v[148:151]
    ds_read_b128 v[52:55], v15 offset:1024
    v_mfma_f32_16x16x32_bf16 v[148:151], v[72:75], a[136:139], v[148:151]
    s_waitcnt lgkmcnt(5)
    v_mfma_f32_16x16x32_bf16 v[148:151], v[76:79], a[144:147], v[148:151]
    ds_read_b128 v[56:59], v15 offset:4096
    v_mfma_f32_16x16x32_bf16 v[148:151], v[80:83], a[152:155], v[148:151]
    v_mfma_f32_16x16x32_bf16 v[152:155], v[68:71], a[132:135], v[152:155]
    ds_read_b128 v[60:63], v15 offset:7168
    v_mfma_f32_16x16x32_bf16 v[152:155], v[72:75], a[140:143], v[152:155]
    v_mfma_f32_16x16x32_bf16 v[152:155], v[76:79], a[148:151], v[152:155]
    ds_read_b128 v[64:67], v15 offset:10240
    v_mfma_f32_16x16x32_bf16 v[152:155], v[80:83], a[156:159], v[152:155]
    s_waitcnt lgkmcnt(6)
    v_mfma_f32_16x16x32_bf16 v[148:151], v[84:87], a[160:163], v[148:151]
    ds_read_b128 v[68:71], v15 offset:13312
    v_mfma_f32_16x16x32_bf16 v[148:151], v[88:91], a[168:171], v[148:151]
    s_waitcnt lgkmcnt(5)
    v_mfma_f32_16x16x32_bf16 v[148:151], v[92:95], a[176:179], v[148:151]
    ds_read_b128 v[72:75], v15 offset:16384
    v_mfma_f32_16x16x32_bf16 v[148:151], v[96:99], a[184:187], v[148:151]
    v_mfma_f32_16x16x32_bf16 v[152:155], v[84:87], a[164:167], v[152:155]
    ds_read_b128 v[76:79], v15 offset:19456
    v_mfma_f32_16x16x32_bf16 v[152:155], v[88:91], a[172:175], v[152:155]
    v_mfma_f32_16x16x32_bf16 v[152:155], v[92:95], a[180:183], v[152:155]
    ds_read_b128 v[80:83], v15 offset:22528
    v_mfma_f32_16x16x32_bf16 v[152:155], v[96:99], a[188:191], v[152:155]
    s_waitcnt lgkmcnt(6)
    v_mfma_f32_16x16x32_bf16 v[156:159], v[52:55], a[96:99], v[156:159]
    ds_read_b128 v[84:87], v15 offset:25600
    v_mfma_f32_16x16x32_bf16 v[156:159], v[56:59], a[104:107], v[156:159]
    s_waitcnt lgkmcnt(5)
    v_mfma_f32_16x16x32_bf16 v[156:159], v[60:63], a[112:115], v[156:159]
    ds_read_b128 v[88:91], v15 offset:28672
    v_mfma_f32_16x16x32_bf16 v[156:159], v[64:67], a[120:123], v[156:159]
    v_mfma_f32_16x16x32_bf16 v[160:163], v[52:55], a[100:103], v[160:163]
    ds_read_b128 v[92:95], v15 offset:31744
    v_mfma_f32_16x16x32_bf16 v[160:163], v[56:59], a[108:111], v[160:163]
    v_mfma_f32_16x16x32_bf16 v[160:163], v[60:63], a[116:119], v[160:163]
    ds_read_b128 v[96:99], v15 offset:34816
    v_mfma_f32_16x16x32_bf16 v[160:163], v[64:67], a[124:127], v[160:163]
    s_waitcnt lgkmcnt(6)
    v_mfma_f32_16x16x32_bf16 v[156:159], v[68:71], a[128:131], v[156:159]
    ds_read_b128 v[52:55], v15 offset:2048
    v_mfma_f32_16x16x32_bf16 v[156:159], v[72:75], a[136:139], v[156:159]
    s_waitcnt lgkmcnt(5)
    v_mfma_f32_16x16x32_bf16 v[156:159], v[76:79], a[144:147], v[156:159]
    ds_read_b128 v[56:59], v15 offset:5120
    v_mfma_f32_16x16x32_bf16 v[156:159], v[80:83], a[152:155], v[156:159]
    v_mfma_f32_16x16x32_bf16 v[160:163], v[68:71], a[132:135], v[160:163]
    ds_read_b128 v[60:63], v15 offset:8192
    v_mfma_f32_16x16x32_bf16 v[160:163], v[72:75], a[140:143], v[160:163]
    v_mfma_f32_16x16x32_bf16 v[160:163], v[76:79], a[148:151], v[160:163]
    ds_read_b128 v[64:67], v15 offset:11264
    v_mfma_f32_16x16x32_bf16 v[160:163], v[80:83], a[156:159], v[160:163]
    s_waitcnt lgkmcnt(6)
    v_mfma_f32_16x16x32_bf16 v[156:159], v[84:87], a[160:163], v[156:159]
    ds_read_b128 v[68:71], v15 offset:14336
    v_mfma_f32_16x16x32_bf16 v[156:159], v[88:91], a[168:171], v[156:159]
    s_waitcnt lgkmcnt(5)
    v_mfma_f32_16x16x32_bf16 v[156:159], v[92:95], a[176:179], v[156:159]
    ds_read_b128 v[72:75], v15 offset:17408
    v_mfma_f32_16x16x32_bf16 v[156:159], v[96:99], a[184:187], v[156:159]
    v_mfma_f32_16x16x32_bf16 v[160:163], v[84:87], a[164:167], v[160:163]
    ds_read_b128 v[76:79], v15 offset:20480
    v_mfma_f32_16x16x32_bf16 v[160:163], v[88:91], a[172:175], v[160:163]
    v_mfma_f32_16x16x32_bf16 v[160:163], v[92:95], a[180:183], v[160:163]
    ds_read_b128 v[80:83], v15 offset:23552
    v_mfma_f32_16x16x32_bf16 v[160:163], v[96:99], a[188:191], v[160:163]
    s_waitcnt lgkmcnt(6)
    v_mfma_f32_16x16x32_bf16 v[164:167], v[52:55], a[96:99], v[164:167]
    ds_read_b128 v[84:87], v15 offset:26624
    v_mfma_f32_16x16x32_bf16 v[164:167], v[56:59], a[104:107], v[164:167]
    s_waitcnt lgkmcnt(5)
    v_mfma_f32_16x16x32_bf16 v[164:167], v[60:63], a[112:115], v[164:167]
    ds_read_b128 v[88:91], v15 offset:29696
    v_mfma_f32_16x16x32_bf16 v[164:167], v[64:67], a[120:123], v[164:167]
    v_mfma_f32_16x16x32_bf16 v[168:171], v[52:55], a[100:103], v[168:171]
    ds_read_b128 v[92:95], v15 offset:32768
    v_mfma_f32_16x16x32_bf16 v[168:171], v[56:59], a[108:111], v[168:171]
    v_mfma_f32_16x16x32_bf16 v[168:171], v[60:63], a[116:119], v[168:171]
    ds_read_b128 v[96:99], v15 offset:35840
    v_mfma_f32_16x16x32_bf16 v[168:171], v[64:67], a[124:127], v[168:171]
    s_waitcnt lgkmcnt(6)
    v_mfma_f32_16x16x32_bf16 v[164:167], v[68:71], a[128:131], v[164:167]
    s_waitcnt vmcnt(6)
    s_barrier
    ds_read_b128 v[52:55], v12 offset:0
    v_mfma_f32_16x16x32_bf16 v[164:167], v[72:75], a[136:139], v[164:167]
    s_waitcnt lgkmcnt(5)
    v_mfma_f32_16x16x32_bf16 v[164:167], v[76:79], a[144:147], v[164:167]
    ds_read_b128 v[56:59], v12 offset:3072
    v_mfma_f32_16x16x32_bf16 v[164:167], v[80:83], a[152:155], v[164:167]
    v_mfma_f32_16x16x32_bf16 v[168:171], v[68:71], a[132:135], v[168:171]
    ds_read_b128 v[60:63], v12 offset:6144
    v_mfma_f32_16x16x32_bf16 v[168:171], v[72:75], a[140:143], v[168:171]
    v_mfma_f32_16x16x32_bf16 v[168:171], v[76:79], a[148:151], v[168:171]
    ds_read_b128 v[64:67], v12 offset:9216
    v_mfma_f32_16x16x32_bf16 v[168:171], v[80:83], a[156:159], v[168:171]
    s_waitcnt lgkmcnt(6)
    v_mfma_f32_16x16x32_bf16 v[164:167], v[84:87], a[160:163], v[164:167]
    ds_read_b128 v[68:71], v12 offset:12288
    v_mfma_f32_16x16x32_bf16 v[164:167], v[88:91], a[168:171], v[164:167]
    s_waitcnt lgkmcnt(5)
    v_mfma_f32_16x16x32_bf16 v[164:167], v[92:95], a[176:179], v[164:167]
    ds_read_b128 v[72:75], v12 offset:15360
    v_mfma_f32_16x16x32_bf16 v[164:167], v[96:99], a[184:187], v[164:167]
    v_mfma_f32_16x16x32_bf16 v[168:171], v[84:87], a[164:167], v[168:171]
    ds_read_b128 v[76:79], v12 offset:18432
    v_mfma_f32_16x16x32_bf16 v[168:171], v[88:91], a[172:175], v[168:171]
    v_mfma_f32_16x16x32_bf16 v[168:171], v[92:95], a[180:183], v[168:171]
    ds_read_b128 v[80:83], v12 offset:21504
    v_mfma_f32_16x16x32_bf16 v[168:171], v[96:99], a[188:191], v[168:171]
    s_waitcnt vmcnt(0)
    buffer_store_dword v242, v241, s[16:19], s48 offen sc1
    s_waitcnt lgkmcnt(6)
    v_mfma_f32_16x16x32_bf16 v[148:151], v[52:55], a[192:195], v[148:151]
    ds_read_b128 v[84:87], v12 offset:24576
    v_mfma_f32_16x16x32_bf16 v[148:151], v[56:59], a[200:203], v[148:151]
    buffer_load_dwordx2 v[208:209], v5, s[16:19], s32 offen offset:0 sc1
    s_waitcnt lgkmcnt(5)
    v_mfma_f32_16x16x32_bf16 v[148:151], v[60:63], a[208:211], v[148:151]
    ds_read_b128 v[88:91], v12 offset:27648
    v_mfma_f32_16x16x32_bf16 v[148:151], v[64:67], a[216:219], v[148:151]
    buffer_load_dwordx2 v[210:211], v5, s[16:19], s32 offen offset:256 sc1
    v_mfma_f32_16x16x32_bf16 v[152:155], v[52:55], a[196:199], v[152:155]
    ds_read_b128 v[92:95], v12 offset:30720
    v_mfma_f32_16x16x32_bf16 v[152:155], v[56:59], a[204:207], v[152:155]
    v_mfma_f32_16x16x32_bf16 v[152:155], v[60:63], a[212:215], v[152:155]
    ds_read_b128 v[96:99], v12 offset:33792
    v_mfma_f32_16x16x32_bf16 v[152:155], v[64:67], a[220:223], v[152:155]
    buffer_load_dwordx4 v[220:223], v6, s[16:19], s33 offen offset:0
    s_waitcnt lgkmcnt(6)
    v_mfma_f32_16x16x32_bf16 v[148:151], v[68:71], a[224:227], v[148:151]
    ds_read_b128 v[52:55], v12 offset:1024
    v_mfma_f32_16x16x32_bf16 v[148:151], v[72:75], a[232:235], v[148:151]
    buffer_load_dwordx2 v[212:213], v5, s[16:19], s32 offen offset:1024 sc1
    s_waitcnt lgkmcnt(5)
    v_mfma_f32_16x16x32_bf16 v[148:151], v[76:79], a[240:243], v[148:151]
    ds_read_b128 v[56:59], v12 offset:4096
    v_mfma_f32_16x16x32_bf16 v[148:151], v[80:83], a[248:251], v[148:151]
    buffer_load_dwordx2 v[214:215], v5, s[16:19], s32 offen offset:1280 sc1
    v_mfma_f32_16x16x32_bf16 v[152:155], v[68:71], a[228:231], v[152:155]
    ds_read_b128 v[60:63], v12 offset:7168
    v_mfma_f32_16x16x32_bf16 v[152:155], v[72:75], a[236:239], v[152:155]
    v_mfma_f32_16x16x32_bf16 v[152:155], v[76:79], a[244:247], v[152:155]
    ds_read_b128 v[64:67], v12 offset:10240
    v_mfma_f32_16x16x32_bf16 v[152:155], v[80:83], a[252:255], v[152:155]
    buffer_load_dwordx4 v[224:227], v6, s[16:19], s33 offen offset:64
    s_waitcnt lgkmcnt(6)
    v_mfma_f32_16x16x32_bf16 v[148:151], v[84:87], v[20:23], v[148:151]
    ds_read_b128 v[68:71], v12 offset:13312
    v_mfma_f32_16x16x32_bf16 v[148:151], v[88:91], v[28:31], v[148:151]
    buffer_load_dwordx2 v[216:217], v5, s[16:19], s32 offen offset:2048 sc1
    s_waitcnt lgkmcnt(5)
    v_mfma_f32_16x16x32_bf16 v[148:151], v[92:95], v[36:39], v[148:151]
    ds_read_b128 v[72:75], v12 offset:16384
    v_mfma_f32_16x16x32_bf16 v[148:151], v[96:99], v[44:47], v[148:151]
    buffer_load_dwordx2 v[218:219], v5, s[16:19], s32 offen offset:2304 sc1
    v_mfma_f32_16x16x32_bf16 v[152:155], v[84:87], v[24:27], v[152:155]
    ds_read_b128 v[76:79], v12 offset:19456
    v_mfma_f32_16x16x32_bf16 v[152:155], v[88:91], v[32:35], v[152:155]
    v_mfma_f32_16x16x32_bf16 v[152:155], v[92:95], v[40:43], v[152:155]
    ds_read_b128 v[80:83], v12 offset:22528
    v_mfma_f32_16x16x32_bf16 v[152:155], v[96:99], v[48:51], v[152:155]
    buffer_load_dwordx4 v[228:231], v6, s[16:19], s33 offen offset:128
    s_waitcnt lgkmcnt(6)
    v_mfma_f32_16x16x32_bf16 v[156:159], v[52:55], a[192:195], v[156:159]
    ds_read_b128 v[84:87], v12 offset:25600
    v_mfma_f32_16x16x32_bf16 v[156:159], v[56:59], a[200:203], v[156:159]
    s_waitcnt lgkmcnt(5)
    v_mfma_f32_16x16x32_bf16 v[156:159], v[60:63], a[208:211], v[156:159]
    ds_read_b128 v[88:91], v12 offset:28672
    v_mfma_f32_16x16x32_bf16 v[156:159], v[64:67], a[216:219], v[156:159]
    v_mfma_f32_16x16x32_bf16 v[160:163], v[52:55], a[196:199], v[160:163]
    ds_read_b128 v[92:95], v12 offset:31744
    v_mfma_f32_16x16x32_bf16 v[160:163], v[56:59], a[204:207], v[160:163]
    v_mfma_f32_16x16x32_bf16 v[160:163], v[60:63], a[212:215], v[160:163]
    ds_read_b128 v[96:99], v12 offset:34816
    v_mfma_f32_16x16x32_bf16 v[160:163], v[64:67], a[220:223], v[160:163]
    s_waitcnt lgkmcnt(6)
    v_mfma_f32_16x16x32_bf16 v[156:159], v[68:71], a[224:227], v[156:159]
    ds_read_b128 v[52:55], v12 offset:2048
    v_mfma_f32_16x16x32_bf16 v[156:159], v[72:75], a[232:235], v[156:159]
    s_waitcnt lgkmcnt(5)
    v_mfma_f32_16x16x32_bf16 v[156:159], v[76:79], a[240:243], v[156:159]
    ds_read_b128 v[56:59], v12 offset:5120
    v_mfma_f32_16x16x32_bf16 v[156:159], v[80:83], a[248:251], v[156:159]
    v_mfma_f32_16x16x32_bf16 v[160:163], v[68:71], a[228:231], v[160:163]
    ds_read_b128 v[60:63], v12 offset:8192
    v_mfma_f32_16x16x32_bf16 v[160:163], v[72:75], a[236:239], v[160:163]
    v_mfma_f32_16x16x32_bf16 v[160:163], v[76:79], a[244:247], v[160:163]
    ds_read_b128 v[64:67], v12 offset:11264
    v_mfma_f32_16x16x32_bf16 v[160:163], v[80:83], a[252:255], v[160:163]
    s_waitcnt lgkmcnt(6)
    v_mfma_f32_16x16x32_bf16 v[156:159], v[84:87], v[20:23], v[156:159]
    ds_read_b128 v[68:71], v12 offset:14336
    v_mfma_f32_16x16x32_bf16 v[156:159], v[88:91], v[28:31], v[156:159]
    s_waitcnt lgkmcnt(5)
    v_mfma_f32_16x16x32_bf16 v[156:159], v[92:95], v[36:39], v[156:159]
    ds_read_b128 v[72:75], v12 offset:17408
    v_mfma_f32_16x16x32_bf16 v[156:159], v[96:99], v[44:47], v[156:159]
    v_mfma_f32_16x16x32_bf16 v[160:163], v[84:87], v[24:27], v[160:163]
    ds_read_b128 v[76:79], v12 offset:20480
    v_mfma_f32_16x16x32_bf16 v[160:163], v[88:91], v[32:35], v[160:163]
    v_mfma_f32_16x16x32_bf16 v[160:163], v[92:95], v[40:43], v[160:163]
    ds_read_b128 v[80:83], v12 offset:23552
    v_mfma_f32_16x16x32_bf16 v[160:163], v[96:99], v[48:51], v[160:163]
    s_waitcnt lgkmcnt(6)
    v_mfma_f32_16x16x32_bf16 v[164:167], v[52:55], a[192:195], v[164:167]
    ds_read_b128 v[84:87], v12 offset:26624
    v_mfma_f32_16x16x32_bf16 v[164:167], v[56:59], a[200:203], v[164:167]
    s_waitcnt lgkmcnt(5)
    v_mfma_f32_16x16x32_bf16 v[164:167], v[60:63], a[208:211], v[164:167]
    ds_read_b128 v[88:91], v12 offset:29696
    v_mfma_f32_16x16x32_bf16 v[164:167], v[64:67], a[216:219], v[164:167]
    v_mfma_f32_16x16x32_bf16 v[168:171], v[52:55], a[196:199], v[168:171]
    ds_read_b128 v[92:95], v12 offset:32768
    v_mfma_f32_16x16x32_bf16 v[168:171], v[56:59], a[204:207], v[168:171]
    v_mfma_f32_16x16x32_bf16 v[168:171], v[60:63], a[212:215], v[168:171]
    ds_read_b128 v[96:99], v12 offset:35840
    v_mfma_f32_16x16x32_bf16 v[168:171], v[64:67], a[220:223], v[168:171]
    s_waitcnt lgkmcnt(6)
    v_mfma_f32_16x16x32_bf16 v[164:167], v[68:71], a[224:227], v[164:167]
    v_mfma_f32_16x16x32_bf16 v[164:167], v[72:75], a[232:235], v[164:167]
    s_waitcnt lgkmcnt(4)
    v_mfma_f32_16x16x32_bf16 v[164:167], v[76:79], a[240:243], v[164:167]
    v_mfma_f32_16x16x32_bf16 v[164:167], v[80:83], a[248:251], v[164:167]
    v_mfma_f32_16x16x32_bf16 v[168:171], v[68:71], a[228:231], v[168:171]
    v_mfma_f32_16x16x32_bf16 v[168:171], v[72:75], a[236:239], v[168:171]
    v_mfma_f32_16x16x32_bf16 v[168:171], v[76:79], a[244:247], v[168:171]
    v_mfma_f32_16x16x32_bf16 v[168:171], v[80:83], a[252:255], v[168:171]
    s_waitcnt lgkmcnt(2)
    v_mfma_f32_16x16x32_bf16 v[164:167], v[84:87], v[20:23], v[164:167]
    v_mfma_f32_16x16x32_bf16 v[164:167], v[88:91], v[28:31], v[164:167]
    s_waitcnt lgkmcnt(0)
    v_mfma_f32_16x16x32_bf16 v[164:167], v[92:95], v[36:39], v[164:167]
    v_mfma_f32_16x16x32_bf16 v[164:167], v[96:99], v[44:47], v[164:167]
    v_mfma_f32_16x16x32_bf16 v[168:171], v[84:87], v[24:27], v[168:171]
    v_mfma_f32_16x16x32_bf16 v[168:171], v[88:91], v[32:35], v[168:171]
    v_mfma_f32_16x16x32_bf16 v[168:171], v[92:95], v[40:43], v[168:171]
    v_mfma_f32_16x16x32_bf16 v[168:171], v[96:99], v[48:51], v[168:171]
    s_mov_b32 s43, 262144
K456_C6_P3:
    buffer_load_dword v16, v4, s[16:19], s49 offen sc1
    s_waitcnt vmcnt(0)
    v_cmp_eq_u32 vcc, 0, v16
    s_cbranch_vccz K456_C6_P3_X
    s_sub_u32 s43, s43, 1
    s_cbranch_scc0 K456_C6_P3
K456_C6_P3_X:
    buffer_load_dwordx4 v[172:175], v1, s[16:19], s26 offen offset:0 sc1
    buffer_load_dwordx4 v[176:179], v1, s[16:19], s26 offen offset:1024 sc1
    buffer_load_dwordx4 v[180:183], v1, s[16:19], s26 offen offset:2048 sc1
    buffer_load_dwordx4 v[184:187], v1, s[16:19], s27 offen offset:0 sc1
    buffer_load_dwordx4 v[188:191], v1, s[16:19], s27 offen offset:1024 sc1
    buffer_load_dwordx4 v[192:195], v1, s[16:19], s27 offen offset:2048 sc1
    buffer_load_dwordx4 v[196:199], v1, s[16:19], s28 offen offset:0 sc1
    buffer_load_dwordx4 v[200:203], v1, s[16:19], s28 offen offset:1024 sc1
    buffer_load_dwordx4 v[204:207], v1, s[16:19], s28 offen offset:2048 sc1
    v_lshlrev_b32 v52, 16, v208
    v_and_b32 v53, 0xffff0000, v208
    v_lshlrev_b32 v54, 16, v209
    v_and_b32 v55, 0xffff0000, v209
    v_lshlrev_b32 v56, 16, v210
    v_and_b32 v57, 0xffff0000, v210
    v_lshlrev_b32 v58, 16, v211
    v_and_b32 v59, 0xffff0000, v211
    v_lshlrev_b32 v60, 16, v212
    v_and_b32 v61, 0xffff0000, v212
    v_lshlrev_b32 v62, 16, v213
    v_and_b32 v63, 0xffff0000, v213
    v_lshlrev_b32 v64, 16, v214
    v_and_b32 v65, 0xffff0000, v214
    v_lshlrev_b32 v66, 16, v215
    v_and_b32 v67, 0xffff0000, v215
    v_lshlrev_b32 v68, 16, v216
    v_and_b32 v69, 0xffff0000, v216
    v_lshlrev_b32 v70, 16, v217
    v_and_b32 v71, 0xffff0000, v217
    v_lshlrev_b32 v72, 16, v218
    v_and_b32 v73, 0xffff0000, v218
    v_lshlrev_b32 v74, 16, v219
    v_and_b32 v75, 0xffff0000, v219
    s_waitcnt vmcnt(6)
    v_dot2_f32_bf16 v148, v172, v9, v148
    v_dot2_f32_bf16 v149, v172, v10, v149
    v_dot2_f32_bf16 v150, v173, v9, v150
    v_dot2_f32_bf16 v151, v173, v10, v151
    v_dot2_f32_bf16 v152, v174, v9, v152
    v_dot2_f32_bf16 v153, v174, v10, v153
    v_dot2_f32_bf16 v154, v175, v9, v154
    v_dot2_f32_bf16 v155, v175, v10, v155
    v_dot2_f32_bf16 v148, v176, v9, v148
    v_dot2_f32_bf16 v149, v176, v10, v149
    v_dot2_f32_bf16 v150, v177, v9, v150
    v_dot2_f32_bf16 v151, v177, v10, v151
    v_dot2_f32_bf16 v152, v178, v9, v152
    v_dot2_f32_bf16 v153, v178, v10, v153
    v_dot2_f32_bf16 v154, v179, v9, v154
    v_dot2_f32_bf16 v155, v179, v10, v155
    v_dot2_f32_bf16 v148, v180, v9, v148
    v_dot2_f32_bf16 v149, v180, v10, v149
    v_dot2_f32_bf16 v150, v181, v9, v150
    v_dot2_f32_bf16 v151, v181, v10, v151
    v_dot2_f32_bf16 v152, v182, v9, v152
    v_dot2_f32_bf16 v153, v182, v10, v153
    v_dot2_f32_bf16 v154, v183, v9, v154
    v_dot2_f32_bf16 v155, v183, v10, v155
    v_fmac_f32 v52, v220, v148
    v_fmac_f32 v53, v221, v149
    v_fmac_f32 v54, v222, v150
    v_fmac_f32 v55, v223, v151
    v_fmac_f32 v56, v220, v152
    v_fmac_f32 v57, v221, v153
    v_fmac_f32 v58, v222, v154
    v_fmac_f32 v59, v223, v155
    v_cvt_pk_bf16_f32 v208, v52, v53
    v_cvt_pk_bf16_f32 v209, v54, v55
    buffer_store_dwordx2 v[208:209], v11, s[12:15], s34 offen offset:0
    v_cvt_pk_bf16_f32 v210, v56, v57
    v_cvt_pk_bf16_f32 v211, v58, v59
    buffer_store_dwordx2 v[210:211], v11, s[12:15], s35 offen offset:0
    s_waitcnt vmcnt(5)
    v_dot2_f32_bf16 v156, v184, v9, v156
    v_dot2_f32_bf16 v157, v184, v10, v157
    v_dot2_f32_bf16 v158, v185, v9, v158
    v_dot2_f32_bf16 v159, v185, v10, v159
    v_dot2_f32_bf16 v160, v186, v9, v160
    v_dot2_f32_bf16 v161, v186, v10, v161
    v_dot2_f32_bf16 v162, v187, v9, v162
    v_dot2_f32_bf16 v163, v187, v10, v163
    v_dot2_f32_bf16 v156, v188, v9, v156
    v_dot2_f32_bf16 v157, v188, v10, v157
    v_dot2_f32_bf16 v158, v189, v9, v158
    v_dot2_f32_bf16 v159, v189, v10, v159
    v_dot2_f32_bf16 v160, v190, v9, v160
    v_dot2_f32_bf16 v161, v190, v10, v161
    v_dot2_f32_bf16 v162, v191, v9, v162
    v_dot2_f32_bf16 v163, v191, v10, v163
    v_dot2_f32_bf16 v156, v192, v9, v156
    v_dot2_f32_bf16 v157, v192, v10, v157
    v_dot2_f32_bf16 v158, v193, v9, v158
    v_dot2_f32_bf16 v159, v193, v10, v159
    v_dot2_f32_bf16 v160, v194, v9, v160
    v_dot2_f32_bf16 v161, v194, v10, v161
    v_dot2_f32_bf16 v162, v195, v9, v162
    v_dot2_f32_bf16 v163, v195, v10, v163
    v_fmac_f32 v60, v224, v156
    v_fmac_f32 v61, v225, v157
    v_fmac_f32 v62, v226, v158
    v_fmac_f32 v63, v227, v159
    v_fmac_f32 v64, v224, v160
    v_fmac_f32 v65, v225, v161
    v_fmac_f32 v66, v226, v162
    v_fmac_f32 v67, v227, v163
    v_cvt_pk_bf16_f32 v212, v60, v61
    v_cvt_pk_bf16_f32 v213, v62, v63
    buffer_store_dwordx2 v[212:213], v11, s[12:15], s34 offen offset:32
    v_cvt_pk_bf16_f32 v214, v64, v65
    v_cvt_pk_bf16_f32 v215, v66, v67
    buffer_store_dwordx2 v[214:215], v11, s[12:15], s35 offen offset:32
    s_waitcnt vmcnt(4)
    v_dot2_f32_bf16 v164, v196, v9, v164
    v_dot2_f32_bf16 v165, v196, v10, v165
    v_dot2_f32_bf16 v166, v197, v9, v166
    v_dot2_f32_bf16 v167, v197, v10, v167
    v_dot2_f32_bf16 v168, v198, v9, v168
    v_dot2_f32_bf16 v169, v198, v10, v169
    v_dot2_f32_bf16 v170, v199, v9, v170
    v_dot2_f32_bf16 v171, v199, v10, v171
    v_dot2_f32_bf16 v164, v200, v9, v164
    v_dot2_f32_bf16 v165, v200, v10, v165
    v_dot2_f32_bf16 v166, v201, v9, v166
    v_dot2_f32_bf16 v167, v201, v10, v167
    v_dot2_f32_bf16 v168, v202, v9, v168
    v_dot2_f32_bf16 v169, v202, v10, v169
    v_dot2_f32_bf16 v170, v203, v9, v170
    v_dot2_f32_bf16 v171, v203, v10, v171
    v_dot2_f32_bf16 v164, v204, v9, v164
    v_dot2_f32_bf16 v165, v204, v10, v165
    v_dot2_f32_bf16 v166, v205, v9, v166
    v_dot2_f32_bf16 v167, v205, v10, v167
    v_dot2_f32_bf16 v168, v206, v9, v168
    v_dot2_f32_bf16 v169, v206, v10, v169
    v_dot2_f32_bf16 v170, v207, v9, v170
    v_dot2_f32_bf16 v171, v207, v10, v171
    v_fmac_f32 v68, v228, v164
    v_fmac_f32 v69, v229, v165
    v_fmac_f32 v70, v230, v166
    v_fmac_f32 v71, v231, v167
    v_fmac_f32 v72, v228, v168
    v_fmac_f32 v73, v229, v169
    v_fmac_f32 v74, v230, v170
    v_fmac_f32 v75, v231, v171
    v_cvt_pk_bf16_f32 v216, v68, v69
    v_cvt_pk_bf16_f32 v217, v70, v71
    buffer_store_dwordx2 v[216:217], v11, s[12:15], s34 offen offset:64
    v_cvt_pk_bf16_f32 v218, v72, v73
    v_cvt_pk_bf16_f32 v219, v74, v75
    buffer_store_dwordx2 v[218:219], v11, s[12:15], s35 offen offset:64
K456_END:
K456_EXIT:
    s_endpgm
k4_kernel_end:
.section .rodata,"a"
.p2align 6
.amdhsa_kernel k1_kernel
  .amdhsa_next_free_vgpr 64
  .amdhsa_next_free_sgpr 102
  .amdhsa_accum_offset 64
  .amdhsa_group_segment_fixed_size 0
  .amdhsa_kernarg_size 96
  .amdhsa_user_sgpr_count 2
  .amdhsa_user_sgpr_kernarg_segment_ptr 1
  .amdhsa_system_sgpr_workgroup_id_x 1
.end_amdhsa_kernel
.p2align 6
.amdhsa_kernel k2_kernel
  .amdhsa_next_free_vgpr 244
  .amdhsa_next_free_sgpr 102
  .amdhsa_accum_offset 212
  .amdhsa_group_segment_fixed_size 0
  .amdhsa_kernarg_size 96
  .amdhsa_user_sgpr_count 2
  .amdhsa_user_sgpr_kernarg_segment_ptr 1
  .amdhsa_system_sgpr_workgroup_id_x 1
.end_amdhsa_kernel
.p2align 6
.amdhsa_kernel k3_kernel
  .amdhsa_next_free_vgpr 160
  .amdhsa_next_free_sgpr 102
  .amdhsa_accum_offset 160
  .amdhsa_group_segment_fixed_size 0
  .amdhsa_kernarg_size 96
  .amdhsa_user_sgpr_count 2
  .amdhsa_user_sgpr_kernarg_segment_ptr 1
  .amdhsa_system_sgpr_workgroup_id_x 1
.end_amdhsa_kernel
.p2align 6
.amdhsa_kernel k4_kernel
  .amdhsa_next_free_vgpr 504
  .amdhsa_next_free_sgpr 102
  .amdhsa_accum_offset 248
  .amdhsa_group_segment_fixed_size 0
  .amdhsa_kernarg_size 96
  .amdhsa_user_sgpr_count 2
  .amdhsa_user_sgpr_kernarg_segment_ptr 1
  .amdhsa_system_sgpr_workgroup_id_x 1
.end_amdhsa_kernel
```
